```python
import torch

def _softmax(x, axis=-1):
    return torch.softmax(x, dim=axis)
def _gelu(x):
    return torch.nn.functional.gelu(x, approximate="tanh")
def _silu(x):
    return torch.nn.functional.silu(x)
def _sigmoid(x):
    return torch.sigmoid(x)
def _layernorm(x, axis=-1, eps=1e-5):
    m = x.mean(dim=axis, keepdim=True)
    v = x.var(dim=axis, keepdim=True, unbiased=False)
    return (x - m) / torch.sqrt(v + eps)
def _scatter_add(tgt, idx, src, axis=0):
    return tgt.clone().index_add_(axis, idx, src)
def _segment_sum(src, seg, n):
    out = torch.zeros((n,) + src.shape[1:], dtype=src.dtype)
    return out.index_add_(0, seg, src)
def _pad(x, pw):
    flat = tuple(v for pair in reversed(pw) for v in pair)
    return torch.nn.functional.pad(x, flat)

kernel_name = 'interleave_layers__linear_kernel_hedgehog__glu_gated_bilinear__prompt'

def setup_inputs():

    _w = (lambda a: (lambda t: t.to(torch.bfloat16) if t.is_floating_point() else t)(torch.as_tensor(a)))
    def _A_setup():
        B, S, D, H = 1, 2048, 512, 32
        Dh = D // H
        return {
            "x": _w((lambda *s: torch.randn(*s, dtype=torch.bfloat16) * 0.05)(B, S, D)),
            "wqkv": _w((lambda *s: torch.randn(*s, dtype=torch.bfloat16) * 0.4)(D, 3 * D)),
            "w_phi": _w((lambda *s: torch.randn(*s, dtype=torch.bfloat16) * 0.4)(H, Dh, Dh) * (Dh ** -0.5)),
            "wo": _w((lambda *s: torch.randn(*s, dtype=torch.bfloat16) * 0.05)(D, D)),
        }
    _A_in = _A_setup()

    def _B_setup():
        B, S, D, F = 1, 2048, 512, 1792
        return {
            "x": _w((lambda *s: torch.randn(*s, dtype=torch.bfloat16) * 0.05)(B, S, D)),
            "w_gate": _w((lambda *s: torch.randn(*s, dtype=torch.bfloat16) * 1.6)(D, F) * (D ** -0.5)),
            "w_up": _w((lambda *s: torch.randn(*s, dtype=torch.bfloat16) * 1.6)(D, F) * (D ** -0.5)),
            "w_down": _w((lambda *s: torch.randn(*s, dtype=torch.bfloat16) * 1.6)(F, D) * (F ** -0.5)),
        }
    _B_in = _B_setup()

    return {
        "A_x": _A_in["x"],
        "A_wqkv": _A_in["wqkv"],
        "A_w_phi": _A_in["w_phi"],
        "A_wo": _A_in["wo"],
        "B_x": _B_in["x"],
        "B_w_gate": _B_in["w_gate"],
        "B_w_up": _B_in["w_up"],
        "B_w_down": _B_in["w_down"],
    }

def reference(A_x, A_wqkv, A_w_phi, A_wo, B_x, B_w_gate, B_w_up, B_w_down):
    def _A_ref(x, wqkv, w_phi, wo):
        B, S, D = x.shape
        H = 32; Dh = D // H
        qkv = (lambda x, *d: x.permute(*d))((x @ wqkv).reshape(B, S, 3, H, Dh), 2, 0, 3, 1, 4)
        q, k, v = qkv[0], qkv[1], qkv[2]
        pq = torch.einsum("bhsd,hdf->bhsf", q, w_phi)
        pk = torch.einsum("bhsd,hdf->bhsf", k, w_phi)
        phi_q = torch.concatenate([_softmax(pq, axis=-1), _softmax(-pq, axis=-1)], axis=-1)
        phi_k = torch.concatenate([_softmax(pk, axis=-1), _softmax(-pk, axis=-1)], axis=-1)
        kv = torch.einsum("bhsf,bhsd->bhfd", phi_k, v)
        z  = torch.einsum("bhsf->bhf", phi_k)
        num = torch.einsum("bhqf,bhfd->bhqd", phi_q, kv)
        den = torch.einsum("bhqf,bhf->bhq", phi_q, z)[..., None] + 1e-6
        o = num / den
        return (lambda x, *d: x.permute(*d))(o, 0, 2, 1, 3).reshape(B, S, D) @ wo

    def _B_ref(x, w_gate, w_up, w_down):
        g = torch.einsum("bsd,df->bsf", x, w_gate)
        u = torch.einsum("bsd,df->bsf", x, w_up)
        h = g * u
        return torch.einsum("bsf,fd->bsd", h, w_down)

    x = A_x
    x = x + _A_ref(_layernorm(x, axis=-1), A_wqkv, A_w_phi, A_wo)
    x = x + _B_ref(_layernorm(x, axis=-1), B_w_gate, B_w_up, B_w_down)
    x = x + _A_ref(_layernorm(x, axis=-1), A_wqkv, A_w_phi, A_wo)
    x = x + _B_ref(_layernorm(x, axis=-1), B_w_gate, B_w_up, B_w_down)
    return x
```

```asm
; @launch grid=(256,1,1) block=(256,1,1) lds=163840
.amdgcn_target "amdgcn-amd-amdhsa--gfx950"
.text
.globl interleave_layers__linear_kernel_hedgehog__glu_gated_bilinear__prompt_kernel
.p2align 8
.type interleave_layers__linear_kernel_hedgehog__glu_gated_bilinear__prompt_kernel,@function
interleave_layers__linear_kernel_hedgehog__glu_gated_bilinear__prompt_kernel:
s_load_dwordx2 s[28:29], s[0:1], 0
s_load_dwordx2 s[32:33], s[0:1], 8
s_cmp_ge_u32 s2, 256
s_cbranch_scc1 L_end
s_getpc_b64 s[4:5]
v_lshrrev_b32 v11, 6, v0
v_and_b32 v7, 15, v0
s_lshr_b32 s82, s2, 3
v_readfirstlane_b32 s68, v11
v_lshlrev_b32 v251, 7, v7
s_lshl_b32 s77, s82, 11
v_add_u32_e64 v7, s77, v251
global_load_dword a0, v7, s[4:5]
s_getreg_b32 s76, hwreg(HW_REG_XCC_ID, 0, 4)
s_lshl_b32 s80, s82, 2
s_add_u32 s80, s80, s68
s_mul_i32 s93, s80, 3072
s_and_b32 s79, s76, 7
s_lshl_b32 s77, s79, 7
s_add_u32 s77, s77, s80
s_lshl_b32 s92, s77, 11
v_and_b32 v7, 0x80, v251
v_bfe_u32 v11, v0, 1, 1
v_lshl_add_u32 v250, v11, 10, v7
s_mov_b32 s30, 2097152
s_mov_b32 s31, 0x20000
s_mov_b32 s34, 1572864
s_mov_b32 s35, 0x20000
s_waitcnt lgkmcnt(0)
s_add_u32 s94, s93, 1024
buffer_load_dword a0, v251, s[32:35], s94 offen
buffer_load_dword a0, v250, s[28:31], s92 offen offset:0
s_add_u32 s94, s93, 394240
buffer_load_dword a0, v251, s[32:35], s94 offen
buffer_load_dword a0, v250, s[28:31], s92 offen offset:256
s_load_dwordx2 s[44:45], s[0:1], 16
s_load_dwordx2 s[36:37], s[0:1], 80
s_load_dwordx2 s[52:53], s[0:1], 40
s_load_dwordx2 s[56:57], s[0:1], 48
s_load_dwordx2 s[60:61], s[0:1], 56
s_load_dwordx2 s[40:41], s[0:1], 72
s_load_dwordx2 s[48:49], s[0:1], 24
s_load_dwordx2 s[64:65], s[0:1], 64
v_and_b32 v0, 63, v0
v_lshlrev_b32_e64 v1, 4, v0
s_lshl_b32 s69, s79, 1
s_lshr_b32 s77, s2, 7
s_add_u32 s69, s69, s77
s_bfe_u32 s70, s2, 0x40003
s_lshl_b32 s71, s69, 2
s_add_u32 s71, s71, s68
s_and_b32 s72, s70, 7
s_lshr_b32 s73, s70, 3
s_lshr_b32 s74, s68, 1
s_and_b32 s75, s68, 1
v_lshrrev_b32 v7, 3, v0
v_lshrrev_b32 v11, 4, v0
v_xor_b32 v11, v11, v0
v_and_b32 v11, 7, v11
v_lshlrev_b32_e64 v11, 4, v11
v_lshl_add_u32 v144, v7, 10, v11
v_xor_b32_e64 v145, 64, v144
s_lshl_b32 s89, s71, 15
s_lshl_b32 s90, s68, 14
s_add_u32 s90, s90, 67584
v_lshrrev_b32_e64 v7, 3, v0
v_mul_u32_u24 v7, 3072, v7
v_and_b32_e64 v154, 3, v0
v_lshl_add_u32 v7, v154, 4, v7
v_lshrrev_b32 v154, 2, v0
v_lshrrev_b32 v11, 4, v0
v_xor_b32 v154, v154, v11
v_and_b32 v154, 1, v154
v_mul_u32_u24 v154, 1024, v154
v_add_u32 v7, 1024, v7
v_add_u32_e64 v154, v154, v7
s_mul_i32 s97, s68, 98304
s_lshl_b32 s78, s70, 6
s_add_u32 s97, s97, s78
s_lshl_b32 s98, s68, 12
s_add_u32 m0, s90, 0
s_add_u32 s94, s89, 0
buffer_load_dwordx4 v144, s[28:31], s94 offen lds
s_add_u32 m0, s90, 1024
s_add_u32 s94, s89, 8192
buffer_load_dwordx4 v145, s[28:31], s94 offen lds
s_add_u32 m0, s90, 2048
s_add_u32 s94, s89, 16384
buffer_load_dwordx4 v144, s[28:31], s94 offen lds
s_add_u32 m0, s90, 3072
s_add_u32 s94, s89, 24576
buffer_load_dwordx4 v145, s[28:31], s94 offen lds
s_add_u32 m0, s90, 4096
s_add_u32 s94, s89, 128
buffer_load_dwordx4 v144, s[28:31], s94 offen lds
s_add_u32 m0, s90, 5120
s_add_u32 s94, s89, 8320
buffer_load_dwordx4 v145, s[28:31], s94 offen lds
s_mov_b32 s46, 16384
s_mov_b32 s47, 0x20000
s_mov_b32 s38, 25165824
s_mov_b32 s39, 0x20000
s_mov_b32 s54, 1835008
s_mov_b32 s55, 0x20000
s_mov_b32 s58, 1835008
s_mov_b32 s59, 0x20000
s_mov_b32 s62, 1835008
s_mov_b32 s63, 0x20000
s_mov_b32 s42, 256
s_mov_b32 s43, 0x20000
s_mov_b32 s50, 524288
s_mov_b32 s51, 0x20000
s_mov_b32 s66, 2097152
s_mov_b32 s67, 0x20000
s_mov_b32 s91, 0
s_waitcnt lgkmcnt(0)
s_mov_b32 m0, 157696
s_lshl_b32 s77, s70, 10
buffer_load_dwordx4 v1, s[44:47], s77 offen lds
s_cmp_lg_u32 s68, 3
s_cbranch_scc1 Lclr_1
s_lshl_b32 s77, s69, 8
s_lshl_b32 s78, s70, 2
s_add_u32 s77, s77, s78
s_lshl_b32 s78, s70, 8
s_lshl_b32 s79, s69, 2
s_add_u32 s78, s78, s79
s_lshr_b32 s79, s2, 4
s_and_b32 s81, s2, 15
s_lshl_b32 s82, s79, 8
s_lshl_b32 s94, s81, 2
s_add_u32 s82, s82, s94
s_lshl_b32 s81, s81, 8
s_lshl_b32 s79, s79, 2
s_add_u32 s81, s81, s79
s_lshl_b32 s79, s2, 2
v_mov_b32 v11, s78
v_writelane_b32 v11, s77, 0
v_writelane_b32 v11, s79, 3
v_writelane_b32 v11, s82, 4
v_writelane_b32 v11, s81, 5
v_writelane_b32 v11, s81, 6
v_lshl_add_u32 v11, v0, 12, v11
v_mov_b32_e64 v7, 0
s_mov_b64 exec, 0x7f
buffer_store_dword v7, v11, s[36:39], 0 offen sc1
s_mov_b64 exec, 0x77
buffer_store_dword v7, v11, s[36:39], 0 offen offset:64 sc1
buffer_store_dword v7, v11, s[36:39], 0 offen offset:128 sc1
buffer_store_dword v7, v11, s[36:39], 0 offen offset:192 sc1
s_mov_b64 exec, -1
Lclr_1:
s_lshr_b32 s96, s2, 3
s_lshl_b32 s96, s96, 2
s_add_u32 s96, s96, s68
s_mul_i32 s95, s96, 12288
s_lshl_b32 s19, s96, 12
v_and_b32 v7, 7, v0
v_lshlrev_b32_e64 v7, 7, v7
v_bfe_u32 v5, v0, 3, 2
v_lshl_add_u32 v14, v5, 10, v7
v_mul_u32_u24 v5, 3072, v5
v_add_u32_e64 v5, v5, v7
v_bfe_u32 v7, v0, 2, 2
v_lshrrev_b32_e64 v11, 5, v0
v_lshl_add_u32 v12, v11, 3, v7
v_and_b32 v13, 1, v0
v_lshlrev_b32 v13, 4, v13
v_bfe_u32 v6, v0, 1, 1
v_lshl_add_u32 v13, v6, 3, v13
v_bfe_u32 v6, v0, 4, 1
v_lshl_add_u32 v13, v6, 5, v13
v_lshl_add_u32 v4, v12, 6, v13
v_add_u32 v4, 67584, v4
v_lshl_add_u32 v2, v12, 7, v13
v_lshrrev_b32_e64 v7, 1, v7
v_lshl_add_u32 v2, v7, 6, v2
v_xor_b32_e64 v3, 64, v2
s_add_u32 m0, s90, 6144
s_add_u32 s94, s89, 16512
buffer_load_dwordx4 v144, s[28:31], s94 offen lds
v_lshlrev_b32_e64 v10, 5, v11
v_add_u32 v10, 65536, v10
s_lshl_b32 s77, s71, 6
s_lshl_b32 s78, s70, 2
s_add_u32 s83, s77, s78
s_mov_b32 s84, 0x3fb8aa3b
s_mov_b32 s85, 0x3fb8aa3b
s_mov_b32 s86, 0x3f803f80
s_mov_b32 s87, 0x3f80
s_mov_b32 s88, 0x3f800000
v_bfe_u32 v7, v0, 2, 1
v_cmp_eq_u32 vcc, v7, v11
v_and_b32 v7, 1, v0
v_lshlrev_b32_e64 v7, 4, v7
v_mov_b32 v12, 0x3f80
v_lshlrev_b32 v12, v7, v12
v_cndmask_b32 v12, 0, v12, vcc
v_bfe_u32 v7, v0, 1, 1
v_bfe_u32 v13, v0, 3, 2
v_lshl_add_u32 v7, v13, 1, v7
v_cmp_eq_u32 vcc, 0, v7
s_nop 1
v_cndmask_b32 v13, 0, v12, vcc
v_accvgpr_write_b32 a224, v13
s_add_u32 m0, s90, 7168
s_add_u32 s94, s89, 24704
buffer_load_dwordx4 v145, s[28:31], s94 offen lds
v_cmp_eq_u32 vcc, 1, v7
s_nop 1
v_cndmask_b32 v13, 0, v12, vcc
v_accvgpr_write_b32 a225, v13
v_cmp_eq_u32 vcc, 2, v7
s_nop 1
v_cndmask_b32 v13, 0, v12, vcc
v_accvgpr_write_b32 a226, v13
v_cmp_eq_u32 vcc, 3, v7
s_nop 1
v_cndmask_b32 v13, 0, v12, vcc
v_accvgpr_write_b32 a227, v13
v_cmp_eq_u32 vcc, 4, v7
s_nop 1
v_cndmask_b32 v13, 0, v12, vcc
v_accvgpr_write_b32 a228, v13
v_cmp_eq_u32 vcc, 5, v7
s_nop 1
v_cndmask_b32 v13, 0, v12, vcc
v_accvgpr_write_b32 a229, v13
s_add_u32 m0, s98, 0
s_add_u32 s94, s97, 0
buffer_load_dwordx4 v154, s[32:35], s94 offen lds
v_cmp_eq_u32 vcc, 6, v7
s_nop 1
v_cndmask_b32 v13, 0, v12, vcc
v_accvgpr_write_b32 a230, v13
v_cmp_eq_u32 vcc, 7, v7
s_nop 1
v_cndmask_b32 v13, 0, v12, vcc
v_accvgpr_write_b32 a231, v13
s_lshl_b32 s77, s69, 2
s_lshl_b32 s78, s73, 1
s_add_u32 s77, s77, s78
s_add_u32 s77, s77, s75
s_lshl_b32 s77, s77, 12
s_lshl_b32 s78, s72, 9
s_add_u32 s77, s77, s78
s_add_u32 s77, s77, 262144
v_and_b32 v219, 3, v0
v_lshl_add_u32 v219, v219, 7, s77
v_lshrrev_b32 v7, 3, v0
v_and_b32 v11, 7, v0
buffer_load_dword a0, v219, s[36:39], 0 offen
v_lshlrev_b32_e64 v11, 4, v11
v_lshl_add_u32 v13, v7, 10, v11
v_mul_u32_u24 v7, 3584, v7
v_add_u32_e64 v12, v7, v11
s_min_u32 s81, s2, 223
s_and_b32 s77, s81, 7
s_lshl_b32 s77, s77, 2
s_add_u32 s77, s77, s68
s_mul_i32 s77, s77, 57344
s_lshr_b32 s78, s81, 3
s_lshl_b32 s78, s78, 7
s_add_u32 s99, s77, s78
s_lshl_b32 s100, s68, 11
s_lshl_b32 s77, s81, 2
s_add_u32 s77, s77, s68
s_and_b32 s78, s77, 7
s_lshl_b32 s78, s78, 7
s_lshr_b32 s77, s77, 3
s_lshl_b32 s77, s77, 14
s_add_u32 s101, s77, s78
v_bfe_u32 v7, v0, 2, 2
v_lshrrev_b32_e64 v11, 5, v0
v_lshl_add_u32 v7, v11, 3, v7
v_and_b32 v11, 3, v0
v_lshlrev_b32 v11, 3, v11
v_lshl_add_u32 v7, v7, 5, v11
v_add_u32 v222, 157696, v7
v_bfe_u32 v11, v0, 4, 1
v_mul_u32_u24 v11, 0x8000, v11
v_lshl_or_b32 v223, v11, 16, v11
v_and_b32_e64 v7, 31, v0
s_add_u32 m0, s98, 1024
s_add_u32 s94, s97, 24576
buffer_load_dwordx4 v154, s[32:35], s94 offen lds
v_bfe_u32 v11, v0, 1, 3
v_lshrrev_b32 v6, 5, v0
v_xor_b32 v11, v11, v6
v_lshlrev_b32_e64 v11, 4, v11
v_lshl_add_u32 v11, v7, 7, v11
v_xor_b32 v146, 0, v11
v_add_u32 v146, s90, v146
v_xor_b32 v147, 32, v11
v_add_u32 v147, s90, v147
v_xor_b32 v148, 64, v11
v_add_u32 v148, s90, v148
v_xor_b32 v149, 96, v11
v_add_u32 v149, s90, v149
v_mov_b32 v150, 0
v_mov_b32_e64 v151, 0
s_add_u32 m0, s98, 2048
s_add_u32 s94, s97, 49152
buffer_load_dwordx4 v154, s[32:35], s94 offen lds
v_mov_b32 v152, 0
v_mov_b32 v153, 0
v_mov_b32 v156, 0
v_mov_b32 v157, 0
v_mov_b32 v158, 0
v_mov_b32 v159, 0
v_add_u32 v220, s98, v2
v_add_u32 v221, s98, v3
s_min_u32 s26, s2, 223
s_lshr_b32 s77, s26, 3
s_lshl_b32 s77, s77, 2
s_add_u32 s77, s77, s68
s_mul_i32 s78, s77, 9363
s_lshr_b32 s78, s78, 16
s_mul_i32 s79, s78, 7
s_sub_u32 s79, s77, s79
s_mul_i32 s78, s78, 229376
s_add_u32 s78, s78, 18874368
s_and_b32 s81, s26, 7
s_mov_b32 s11, 10240
s_cmp_ge_u32 s79, 5
s_cselect_b32 s11, 2048, s11
s_cselect_b32 s82, 153600, 0
s_cmp_ge_u32 s79, 6
s_cselect_b32 s82, 184320, s82
s_lshl_b32 s79, s79, 11
s_add_u32 s78, s78, s79
s_add_u32 s78, s78, s82
s_mul_i32 s79, s81, s11
s_lshl_b32 s79, s79, 1
s_add_u32 s10, s78, s79
s_mul_i32 s81, s81, 112
s_add_u32 s81, s81, s77
s_lshl_b32 s81, s81, 7
s_add_u32 s12, s81, 131072
s_lshl_b32 s77, s26, 2
s_add_u32 s77, s77, s68
s_and_b32 s79, s77, 7
s_mul_i32 s13, s79, 229376
s_lshr_b32 s77, s77, 3
s_mul_i32 s78, s77, 9363
s_lshr_b32 s78, s78, 16
s_mul_i32 s79, s78, 7
s_sub_u32 s79, s77, s79
s_lshr_b32 s77, s78, 2
s_mul_i32 s77, s77, 57344
s_add_u32 s13, s13, s77
s_and_b32 s78, s78, 3
s_lshr_b32 s81, s79, 1
s_lshl_b32 s81, s81, 2
s_add_u32 s81, s81, s78
s_and_b32 s82, s79, 1
s_lshr_b32 s77, s78, 1
s_add_u32 s77, s77, 12
s_and_b32 s78, s78, 1
s_cmp_eq_u32 s79, 6
s_cselect_b32 s81, s77, s81
s_cselect_b32 s82, s78, s82
s_lshl_b32 s81, s81, 12
s_lshl_b32 s82, s82, 9
s_add_u32 s13, s13, s81
s_add_u32 s13, s13, s82
s_add_u32 s13, s13, 23068672
s_add_u32 m0, s98, 3072
s_add_u32 s94, s97, 73728
buffer_load_dwordx4 v154, s[32:35], s94 offen lds
s_add_u32 s94, s93, 787456
buffer_load_dword a0, v251, s[32:35], s94 offen
buffer_load_dword a0, v250, s[28:31], s92 offen offset:512
s_add_u32 m0, s90, 8192
s_add_u32 s94, s89, 256
buffer_load_dwordx4 v144, s[28:31], s94 offen lds
s_add_u32 m0, s90, 9216
s_add_u32 s94, s89, 8448
buffer_load_dwordx4 v145, s[28:31], s94 offen lds
s_add_u32 m0, s90, 10240
s_add_u32 s94, s89, 16640
buffer_load_dwordx4 v144, s[28:31], s94 offen lds
s_add_u32 m0, s90, 11264
s_add_u32 s94, s89, 24832
buffer_load_dwordx4 v145, s[28:31], s94 offen lds
s_add_u32 m0, s90, 12288
s_add_u32 s94, s89, 384
buffer_load_dwordx4 v144, s[28:31], s94 offen lds
s_add_u32 m0, s90, 13312
s_add_u32 s94, s89, 8576
buffer_load_dwordx4 v145, s[28:31], s94 offen lds
s_add_u32 m0, s90, 14336
s_add_u32 s94, s89, 16768
buffer_load_dwordx4 v144, s[28:31], s94 offen lds
s_add_u32 m0, s90, 15360
s_add_u32 s94, s89, 24960
buffer_load_dwordx4 v145, s[28:31], s94 offen lds
s_add_u32 m0, s98, 16384
s_add_u32 s94, s97, 393216
buffer_load_dwordx4 v154, s[32:35], s94 offen lds
s_add_u32 m0, s98, 17408
s_add_u32 s94, s97, 417792
buffer_load_dwordx4 v154, s[32:35], s94 offen lds
s_waitcnt vmcnt(17)
ds_read_b128 v[16:19], v146 offset:0
ds_read_b128 v[20:23], v147 offset:0
ds_read_b128 v[24:27], v148 offset:0
ds_read_b128 v[28:31], v149 offset:0
ds_read_b128 v[32:35], v146 offset:4096
ds_read_b128 v[36:39], v147 offset:4096
ds_read_b128 v[40:43], v148 offset:4096
ds_read_b128 v[44:47], v149 offset:4096
s_waitcnt vmcnt(12)
ds_read_b64_tr_b16 v[224:225], v220 offset:0
ds_read_b64_tr_b16 v[226:227], v220 offset:512
ds_read_b64_tr_b16 v[228:229], v221 offset:0
ds_read_b64_tr_b16 v[230:231], v221 offset:512
ds_read_b64_tr_b16 v[232:233], v220 offset:2048
ds_read_b64_tr_b16 v[234:235], v220 offset:2560
ds_read_b64_tr_b16 v[236:237], v221 offset:2048
ds_read_b64_tr_b16 v[238:239], v221 offset:2560
s_barrier
s_waitcnt lgkmcnt(8)
ds_read_b64_tr_b16 v[192:193], v2 offset:0
ds_read_b64_tr_b16 v[194:195], v2 offset:512
ds_read_b64_tr_b16 v[196:197], v3 offset:0
ds_read_b64_tr_b16 v[198:199], v3 offset:512
ds_read_b64_tr_b16 v[200:201], v2 offset:2048
ds_read_b64_tr_b16 v[202:203], v2 offset:2560
ds_read_b64_tr_b16 v[204:205], v3 offset:2048
ds_read_b64_tr_b16 v[206:207], v3 offset:2560
v_dot2c_f32_bf16 v150, s86, v16
v_dot2c_f32_bf16 v152, v16, v16
v_dot2c_f32_bf16 v151, s86, v17
v_dot2c_f32_bf16 v153, v17, v17
v_dot2c_f32_bf16 v150, s86, v18
v_dot2c_f32_bf16 v152, v18, v18
v_dot2c_f32_bf16 v151, s86, v19
v_dot2c_f32_bf16 v153, v19, v19
v_dot2c_f32_bf16 v150, s86, v20
v_dot2c_f32_bf16 v152, v20, v20
v_dot2c_f32_bf16 v151, s86, v21
v_dot2c_f32_bf16 v153, v21, v21
v_dot2c_f32_bf16 v150, s86, v22
v_dot2c_f32_bf16 v152, v22, v22
v_dot2c_f32_bf16 v151, s86, v23
s_add_u32 m0, s98, 18432
s_add_u32 s94, s97, 442368
buffer_load_dwordx4 v154, s[32:35], s94 offen lds
v_dot2c_f32_bf16 v153, v23, v23
v_dot2c_f32_bf16 v150, s86, v24
v_dot2c_f32_bf16 v152, v24, v24
v_dot2c_f32_bf16 v151, s86, v25
v_dot2c_f32_bf16 v153, v25, v25
v_dot2c_f32_bf16 v150, s86, v26
v_dot2c_f32_bf16 v152, v26, v26
v_dot2c_f32_bf16 v151, s86, v27
v_dot2c_f32_bf16 v153, v27, v27
v_dot2c_f32_bf16 v150, s86, v28
v_dot2c_f32_bf16 v152, v28, v28
v_dot2c_f32_bf16 v151, s86, v29
v_dot2c_f32_bf16 v153, v29, v29
v_dot2c_f32_bf16 v150, s86, v30
v_dot2c_f32_bf16 v152, v30, v30
s_add_u32 m0, s98, 19456
s_add_u32 s94, s97, 466944
buffer_load_dwordx4 v154, s[32:35], s94 offen lds
v_dot2c_f32_bf16 v151, s86, v31
v_dot2c_f32_bf16 v153, v31, v31
v_dot2c_f32_bf16 v150, s86, v32
v_dot2c_f32_bf16 v152, v32, v32
v_dot2c_f32_bf16 v151, s86, v33
v_dot2c_f32_bf16 v153, v33, v33
v_dot2c_f32_bf16 v150, s86, v34
v_dot2c_f32_bf16 v152, v34, v34
v_dot2c_f32_bf16 v151, s86, v35
v_dot2c_f32_bf16 v153, v35, v35
s_add_u32 s94, s93, 1180672
buffer_load_dword a0, v251, s[32:35], s94 offen
v_dot2c_f32_bf16 v150, s86, v36
v_dot2c_f32_bf16 v152, v36, v36
v_dot2c_f32_bf16 v151, s86, v37
v_dot2c_f32_bf16 v153, v37, v37
v_dot2c_f32_bf16 v150, s86, v38
v_dot2c_f32_bf16 v152, v38, v38
v_dot2c_f32_bf16 v151, s86, v39
v_dot2c_f32_bf16 v153, v39, v39
v_dot2c_f32_bf16 v150, s86, v40
v_dot2c_f32_bf16 v152, v40, v40
buffer_load_dword a0, v250, s[28:31], s92 offen offset:768
v_dot2c_f32_bf16 v151, s86, v41
v_dot2c_f32_bf16 v153, v41, v41
v_dot2c_f32_bf16 v150, s86, v42
v_dot2c_f32_bf16 v152, v42, v42
v_dot2c_f32_bf16 v151, s86, v43
v_dot2c_f32_bf16 v153, v43, v43
v_dot2c_f32_bf16 v150, s86, v44
v_dot2c_f32_bf16 v152, v44, v44
v_dot2c_f32_bf16 v151, s86, v45
v_dot2c_f32_bf16 v153, v45, v45
v_dot2c_f32_bf16 v150, s86, v46
v_dot2c_f32_bf16 v152, v46, v46
v_dot2c_f32_bf16 v151, s86, v47
v_dot2c_f32_bf16 v153, v47, v47
s_waitcnt lgkmcnt(8)
v_dot2c_f32_bf16 v156, s86, v224
s_add_u32 m0, s90, 0
s_add_u32 s94, s89, 512
buffer_load_dwordx4 v144, s[28:31], s94 offen lds
v_dot2c_f32_bf16 v157, s86, v225
v_dot2c_f32_bf16 v156, s86, v226
v_dot2c_f32_bf16 v157, s86, v227
v_dot2c_f32_bf16 v158, s86, v228
v_dot2c_f32_bf16 v159, s86, v229
v_dot2c_f32_bf16 v158, s86, v230
v_dot2c_f32_bf16 v159, s86, v231
v_dot2c_f32_bf16 v156, s86, v232
v_dot2c_f32_bf16 v157, s86, v233
v_dot2c_f32_bf16 v156, s86, v234
v_dot2c_f32_bf16 v157, s86, v235
v_dot2c_f32_bf16 v158, s86, v236
v_dot2c_f32_bf16 v159, s86, v237
v_dot2c_f32_bf16 v158, s86, v238
v_dot2c_f32_bf16 v159, s86, v239
s_add_u32 m0, s90, 1024
s_add_u32 s94, s89, 8704
buffer_load_dwordx4 v145, s[28:31], s94 offen lds
ds_read_b64_tr_b16 v[240:241], v222 offset:0
ds_read_b64_tr_b16 v[242:243], v222 offset:128
ds_read_b64_tr_b16 v[244:245], v222 offset:512
ds_read_b64_tr_b16 v[246:247], v222 offset:640
s_waitcnt lgkmcnt(8)
v_mfma_f32_32x32x16_bf16 v[160:175], v[192:195], v[16:19], 0
ds_read_b64_tr_b16 v[208:209], v2 offset:4096
ds_read_b64_tr_b16 v[210:211], v2 offset:4608
v_mfma_f32_32x32x16_bf16 v[176:191], v[196:199], v[16:19], 0
s_add_u32 m0, s90, 2048
s_add_u32 s94, s89, 16896
buffer_load_dwordx4 v144, s[28:31], s94 offen lds
ds_read_b64_tr_b16 v[212:213], v3 offset:4096
ds_read_b64_tr_b16 v[214:215], v3 offset:4608
s_waitcnt lgkmcnt(8)
v_mfma_f32_32x32x16_bf16 v[160:175], v[200:203], v[20:23], v[160:175]
ds_read_b64_tr_b16 v[192:193], v2 offset:6144
ds_read_b64_tr_b16 v[194:195], v2 offset:6656
v_mfma_f32_32x32x16_bf16 v[176:191], v[204:207], v[20:23], v[176:191]
s_add_u32 m0, s90, 3072
s_add_u32 s94, s89, 25088
buffer_load_dwordx4 v145, s[28:31], s94 offen lds
ds_read_b64_tr_b16 v[196:197], v3 offset:6144
ds_read_b64_tr_b16 v[198:199], v3 offset:6656
s_waitcnt lgkmcnt(4)
v_mfma_f32_32x32x16_bf16 v[160:175], v[208:211], v[24:27], v[160:175]
ds_read_b64_tr_b16 v[200:201], v2 offset:8192
ds_read_b64_tr_b16 v[202:203], v2 offset:8704
v_mfma_f32_32x32x16_bf16 v[176:191], v[212:215], v[24:27], v[176:191]
s_add_u32 m0, s90, 4096
s_add_u32 s94, s89, 640
buffer_load_dwordx4 v144, s[28:31], s94 offen lds
ds_read_b64_tr_b16 v[204:205], v3 offset:8192
ds_read_b64_tr_b16 v[206:207], v3 offset:8704
s_waitcnt lgkmcnt(4)
v_mfma_f32_32x32x16_bf16 v[160:175], v[192:195], v[28:31], v[160:175]
ds_read_b64_tr_b16 v[208:209], v2 offset:10240
ds_read_b64_tr_b16 v[210:211], v2 offset:10752
v_xor_b32 v240, v223, v240
v_accvgpr_write_b32 a232, v240
v_xor_b32_e64 v241, v223, v241
v_mfma_f32_32x32x16_bf16 v[176:191], v[196:199], v[28:31], v[176:191]
s_add_u32 m0, s90, 5120
s_add_u32 s94, s89, 8832
buffer_load_dwordx4 v145, s[28:31], s94 offen lds
ds_read_b64_tr_b16 v[212:213], v3 offset:10240
ds_read_b64_tr_b16 v[214:215], v3 offset:10752
v_accvgpr_write_b32 a233, v241
v_xor_b32_e64 v242, v223, v242
v_accvgpr_write_b32 a234, v242
s_waitcnt lgkmcnt(4)
v_mfma_f32_32x32x16_bf16 v[160:175], v[200:203], v[32:35], v[160:175]
ds_read_b64_tr_b16 v[192:193], v2 offset:12288
ds_read_b64_tr_b16 v[194:195], v2 offset:12800
v_xor_b32 v243, v223, v243
v_accvgpr_write_b32 a235, v243
v_xor_b32_e64 v244, v223, v244
v_mfma_f32_32x32x16_bf16 v[176:191], v[204:207], v[32:35], v[176:191]
s_add_u32 m0, s90, 6144
s_add_u32 s94, s89, 17024
buffer_load_dwordx4 v144, s[28:31], s94 offen lds
ds_read_b64_tr_b16 v[196:197], v3 offset:12288
ds_read_b64_tr_b16 v[198:199], v3 offset:12800
v_accvgpr_write_b32 a236, v244
v_xor_b32_e64 v245, v223, v245
v_accvgpr_write_b32 a237, v245
s_waitcnt lgkmcnt(4)
v_mfma_f32_32x32x16_bf16 v[160:175], v[208:211], v[36:39], v[160:175]
ds_read_b64_tr_b16 v[200:201], v2 offset:14336
ds_read_b64_tr_b16 v[202:203], v2 offset:14848
v_xor_b32 v246, v223, v246
v_accvgpr_write_b32 a238, v246
v_xor_b32_e64 v247, v223, v247
v_mfma_f32_32x32x16_bf16 v[176:191], v[212:215], v[36:39], v[176:191]
s_add_u32 m0, s90, 7168
s_add_u32 s94, s89, 25216
buffer_load_dwordx4 v145, s[28:31], s94 offen lds
ds_read_b64_tr_b16 v[204:205], v3 offset:14336
ds_read_b64_tr_b16 v[206:207], v3 offset:14848
s_waitcnt vmcnt(14)
v_accvgpr_write_b32 a239, v247
s_waitcnt lgkmcnt(4)
v_mfma_f32_32x32x16_bf16 v[160:175], v[192:195], v[40:43], v[160:175]
ds_read_b128 v[48:51], v146 offset:8192
ds_read_b128 v[52:55], v147 offset:8192
v_mfma_f32_32x32x16_bf16 v[176:191], v[196:199], v[40:43], v[176:191]
s_add_u32 m0, s98, 32768
s_add_u32 s94, s97, 786432
buffer_load_dwordx4 v154, s[32:35], s94 offen lds
ds_read_b128 v[56:59], v148 offset:8192
ds_read_b128 v[60:63], v149 offset:8192
s_waitcnt lgkmcnt(4)
v_mfma_f32_32x32x16_bf16 v[160:175], v[200:203], v[44:47], v[160:175]
ds_read_b128 v[64:67], v146 offset:12288
ds_read_b128 v[68:71], v147 offset:12288
v_mfma_f32_32x32x16_bf16 v[176:191], v[204:207], v[44:47], v[176:191]
s_add_u32 m0, s98, 33792
s_add_u32 s94, s97, 811008
buffer_load_dwordx4 v154, s[32:35], s94 offen lds
ds_read_b128 v[72:75], v148 offset:12288
ds_read_b128 v[76:79], v149 offset:12288
s_waitcnt vmcnt(12)
ds_read_b64_tr_b16 v[224:225], v220 offset:16384
ds_read_b64_tr_b16 v[226:227], v220 offset:16896
ds_read_b64_tr_b16 v[228:229], v221 offset:16384
ds_read_b64_tr_b16 v[230:231], v221 offset:16896
ds_read_b64_tr_b16 v[232:233], v220 offset:18432
ds_read_b64_tr_b16 v[234:235], v220 offset:18944
ds_read_b64_tr_b16 v[236:237], v221 offset:18432
ds_read_b64_tr_b16 v[238:239], v221 offset:18944
s_barrier
s_waitcnt lgkmcnt(8)
ds_read_b64_tr_b16 v[208:209], v2 offset:16384
ds_read_b64_tr_b16 v[210:211], v2 offset:16896
ds_read_b64_tr_b16 v[212:213], v3 offset:16384
ds_read_b64_tr_b16 v[214:215], v3 offset:16896
ds_read_b64_tr_b16 v[192:193], v2 offset:18432
ds_read_b64_tr_b16 v[194:195], v2 offset:18944
ds_read_b64_tr_b16 v[196:197], v3 offset:18432
ds_read_b64_tr_b16 v[198:199], v3 offset:18944
v_dot2c_f32_bf16 v150, s86, v48
v_dot2c_f32_bf16 v152, v48, v48
v_dot2c_f32_bf16 v151, s86, v49
v_dot2c_f32_bf16 v153, v49, v49
v_dot2c_f32_bf16 v150, s86, v50
v_dot2c_f32_bf16 v152, v50, v50
v_dot2c_f32_bf16 v151, s86, v51
v_dot2c_f32_bf16 v153, v51, v51
v_dot2c_f32_bf16 v150, s86, v52
v_dot2c_f32_bf16 v152, v52, v52
v_dot2c_f32_bf16 v151, s86, v53
v_dot2c_f32_bf16 v153, v53, v53
v_dot2c_f32_bf16 v150, s86, v54
v_dot2c_f32_bf16 v152, v54, v54
v_dot2c_f32_bf16 v151, s86, v55
s_add_u32 m0, s98, 34816
s_add_u32 s94, s97, 835584
buffer_load_dwordx4 v154, s[32:35], s94 offen lds
v_dot2c_f32_bf16 v153, v55, v55
v_dot2c_f32_bf16 v150, s86, v56
v_dot2c_f32_bf16 v152, v56, v56
v_dot2c_f32_bf16 v151, s86, v57
v_dot2c_f32_bf16 v153, v57, v57
v_dot2c_f32_bf16 v150, s86, v58
v_dot2c_f32_bf16 v152, v58, v58
v_dot2c_f32_bf16 v151, s86, v59
v_dot2c_f32_bf16 v153, v59, v59
v_dot2c_f32_bf16 v150, s86, v60
v_dot2c_f32_bf16 v152, v60, v60
v_dot2c_f32_bf16 v151, s86, v61
v_dot2c_f32_bf16 v153, v61, v61
v_dot2c_f32_bf16 v150, s86, v62
v_dot2c_f32_bf16 v152, v62, v62
s_add_u32 m0, s98, 35840
s_add_u32 s94, s97, 860160
buffer_load_dwordx4 v154, s[32:35], s94 offen lds
v_dot2c_f32_bf16 v151, s86, v63
v_dot2c_f32_bf16 v153, v63, v63
v_dot2c_f32_bf16 v150, s86, v64
v_dot2c_f32_bf16 v152, v64, v64
v_dot2c_f32_bf16 v151, s86, v65
v_dot2c_f32_bf16 v153, v65, v65
v_dot2c_f32_bf16 v150, s86, v66
v_dot2c_f32_bf16 v152, v66, v66
v_dot2c_f32_bf16 v151, s86, v67
v_dot2c_f32_bf16 v153, v67, v67
v_dot2c_f32_bf16 v150, s86, v68
v_dot2c_f32_bf16 v152, v68, v68
v_dot2c_f32_bf16 v151, s86, v69
v_dot2c_f32_bf16 v153, v69, v69
v_dot2c_f32_bf16 v150, s86, v70
s_add_u32 m0, s90, 8192
s_add_u32 s94, s89, 768
buffer_load_dwordx4 v144, s[28:31], s94 offen lds
v_dot2c_f32_bf16 v152, v70, v70
v_dot2c_f32_bf16 v151, s86, v71
v_dot2c_f32_bf16 v153, v71, v71
v_dot2c_f32_bf16 v150, s86, v72
v_dot2c_f32_bf16 v152, v72, v72
v_dot2c_f32_bf16 v151, s86, v73
v_dot2c_f32_bf16 v153, v73, v73
v_dot2c_f32_bf16 v150, s86, v74
v_dot2c_f32_bf16 v152, v74, v74
v_dot2c_f32_bf16 v151, s86, v75
v_dot2c_f32_bf16 v153, v75, v75
v_dot2c_f32_bf16 v150, s86, v76
v_dot2c_f32_bf16 v152, v76, v76
v_dot2c_f32_bf16 v151, s86, v77
v_dot2c_f32_bf16 v153, v77, v77
s_add_u32 m0, s90, 9216
s_add_u32 s94, s89, 8960
buffer_load_dwordx4 v145, s[28:31], s94 offen lds
v_dot2c_f32_bf16 v150, s86, v78
v_dot2c_f32_bf16 v152, v78, v78
v_dot2c_f32_bf16 v151, s86, v79
v_dot2c_f32_bf16 v153, v79, v79
s_waitcnt lgkmcnt(8)
v_dot2c_f32_bf16 v156, s86, v224
v_dot2c_f32_bf16 v157, s86, v225
v_dot2c_f32_bf16 v156, s86, v226
v_dot2c_f32_bf16 v157, s86, v227
v_dot2c_f32_bf16 v158, s86, v228
v_dot2c_f32_bf16 v159, s86, v229
v_dot2c_f32_bf16 v158, s86, v230
v_dot2c_f32_bf16 v159, s86, v231
v_dot2c_f32_bf16 v156, s86, v232
v_dot2c_f32_bf16 v157, s86, v233
v_dot2c_f32_bf16 v156, s86, v234
s_add_u32 m0, s90, 10240
s_add_u32 s94, s89, 17152
buffer_load_dwordx4 v144, s[28:31], s94 offen lds
v_dot2c_f32_bf16 v157, s86, v235
v_dot2c_f32_bf16 v158, s86, v236
v_dot2c_f32_bf16 v159, s86, v237
v_dot2c_f32_bf16 v158, s86, v238
v_dot2c_f32_bf16 v159, s86, v239
s_waitcnt lgkmcnt(4)
v_mfma_f32_32x32x16_bf16 v[160:175], v[208:211], v[48:51], v[160:175]
ds_read_b64_tr_b16 v[200:201], v2 offset:20480
ds_read_b64_tr_b16 v[202:203], v2 offset:20992
v_mfma_f32_32x32x16_bf16 v[176:191], v[212:215], v[48:51], v[176:191]
s_add_u32 m0, s90, 11264
s_add_u32 s94, s89, 25344
buffer_load_dwordx4 v145, s[28:31], s94 offen lds
ds_read_b64_tr_b16 v[204:205], v3 offset:20480
ds_read_b64_tr_b16 v[206:207], v3 offset:20992
s_waitcnt lgkmcnt(4)
v_mfma_f32_32x32x16_bf16 v[160:175], v[192:195], v[52:55], v[160:175]
ds_read_b64_tr_b16 v[208:209], v2 offset:22528
ds_read_b64_tr_b16 v[210:211], v2 offset:23040
v_mfma_f32_32x32x16_bf16 v[176:191], v[196:199], v[52:55], v[176:191]
s_add_u32 m0, s90, 12288
s_add_u32 s94, s89, 896
buffer_load_dwordx4 v144, s[28:31], s94 offen lds
ds_read_b64_tr_b16 v[212:213], v3 offset:22528
ds_read_b64_tr_b16 v[214:215], v3 offset:23040
s_waitcnt lgkmcnt(4)
v_mfma_f32_32x32x16_bf16 v[160:175], v[200:203], v[56:59], v[160:175]
ds_read_b64_tr_b16 v[192:193], v2 offset:24576
ds_read_b64_tr_b16 v[194:195], v2 offset:25088
v_mfma_f32_32x32x16_bf16 v[176:191], v[204:207], v[56:59], v[176:191]
s_add_u32 m0, s90, 13312
s_add_u32 s94, s89, 9088
buffer_load_dwordx4 v145, s[28:31], s94 offen lds
ds_read_b64_tr_b16 v[196:197], v3 offset:24576
ds_read_b64_tr_b16 v[198:199], v3 offset:25088
s_waitcnt lgkmcnt(4)
v_mfma_f32_32x32x16_bf16 v[160:175], v[208:211], v[60:63], v[160:175]
ds_read_b64_tr_b16 v[200:201], v2 offset:26624
ds_read_b64_tr_b16 v[202:203], v2 offset:27136
v_mfma_f32_32x32x16_bf16 v[176:191], v[212:215], v[60:63], v[176:191]
s_add_u32 m0, s90, 14336
s_add_u32 s94, s89, 17280
buffer_load_dwordx4 v144, s[28:31], s94 offen lds
ds_read_b64_tr_b16 v[204:205], v3 offset:26624
ds_read_b64_tr_b16 v[206:207], v3 offset:27136
s_waitcnt lgkmcnt(4)
v_mfma_f32_32x32x16_bf16 v[160:175], v[192:195], v[64:67], v[160:175]
ds_read_b64_tr_b16 v[208:209], v2 offset:28672
ds_read_b64_tr_b16 v[210:211], v2 offset:29184
v_mfma_f32_32x32x16_bf16 v[176:191], v[196:199], v[64:67], v[176:191]
s_add_u32 m0, s90, 15360
s_add_u32 s94, s89, 25472
buffer_load_dwordx4 v145, s[28:31], s94 offen lds
ds_read_b64_tr_b16 v[212:213], v3 offset:28672
ds_read_b64_tr_b16 v[214:215], v3 offset:29184
s_waitcnt lgkmcnt(4)
v_mfma_f32_32x32x16_bf16 v[160:175], v[200:203], v[68:71], v[160:175]
ds_read_b64_tr_b16 v[192:193], v2 offset:30720
ds_read_b64_tr_b16 v[194:195], v2 offset:31232
v_mfma_f32_32x32x16_bf16 v[176:191], v[204:207], v[68:71], v[176:191]
s_add_u32 m0, s98, 49152
s_add_u32 s94, s97, 1179648
buffer_load_dwordx4 v154, s[32:35], s94 offen lds
ds_read_b64_tr_b16 v[196:197], v3 offset:30720
ds_read_b64_tr_b16 v[198:199], v3 offset:31232
s_waitcnt vmcnt(13)
s_waitcnt lgkmcnt(4)
v_mfma_f32_32x32x16_bf16 v[160:175], v[208:211], v[72:75], v[160:175]
ds_read_b128 v[80:83], v146 offset:0
ds_read_b128 v[84:87], v147 offset:0
v_mfma_f32_32x32x16_bf16 v[176:191], v[212:215], v[72:75], v[176:191]
s_add_u32 m0, s98, 50176
s_add_u32 s94, s97, 1204224
buffer_load_dwordx4 v154, s[32:35], s94 offen lds
ds_read_b128 v[88:91], v148 offset:0
ds_read_b128 v[92:95], v149 offset:0
s_waitcnt lgkmcnt(4)
v_mfma_f32_32x32x16_bf16 v[160:175], v[192:195], v[76:79], v[160:175]
ds_read_b128 v[96:99], v146 offset:4096
ds_read_b128 v[100:103], v147 offset:4096
v_mfma_f32_32x32x16_bf16 v[176:191], v[196:199], v[76:79], v[176:191]
s_add_u32 m0, s98, 51200
s_add_u32 s94, s97, 1228800
buffer_load_dwordx4 v154, s[32:35], s94 offen lds
ds_read_b128 v[104:107], v148 offset:4096
ds_read_b128 v[108:111], v149 offset:4096
s_waitcnt vmcnt(11)
ds_read_b64_tr_b16 v[224:225], v220 offset:32768
ds_read_b64_tr_b16 v[226:227], v220 offset:33280
ds_read_b64_tr_b16 v[228:229], v221 offset:32768
ds_read_b64_tr_b16 v[230:231], v221 offset:33280
ds_read_b64_tr_b16 v[232:233], v220 offset:34816
ds_read_b64_tr_b16 v[234:235], v220 offset:35328
ds_read_b64_tr_b16 v[236:237], v221 offset:34816
ds_read_b64_tr_b16 v[238:239], v221 offset:35328
s_barrier
s_waitcnt lgkmcnt(8)
ds_read_b64_tr_b16 v[200:201], v2 offset:32768
ds_read_b64_tr_b16 v[202:203], v2 offset:33280
ds_read_b64_tr_b16 v[204:205], v3 offset:32768
ds_read_b64_tr_b16 v[206:207], v3 offset:33280
ds_read_b64_tr_b16 v[208:209], v2 offset:34816
ds_read_b64_tr_b16 v[210:211], v2 offset:35328
ds_read_b64_tr_b16 v[212:213], v3 offset:34816
ds_read_b64_tr_b16 v[214:215], v3 offset:35328
v_dot2c_f32_bf16 v150, s86, v80
v_dot2c_f32_bf16 v152, v80, v80
v_dot2c_f32_bf16 v151, s86, v81
v_dot2c_f32_bf16 v153, v81, v81
v_dot2c_f32_bf16 v150, s86, v82
v_dot2c_f32_bf16 v152, v82, v82
v_dot2c_f32_bf16 v151, s86, v83
v_dot2c_f32_bf16 v153, v83, v83
v_dot2c_f32_bf16 v150, s86, v84
v_dot2c_f32_bf16 v152, v84, v84
v_dot2c_f32_bf16 v151, s86, v85
v_dot2c_f32_bf16 v153, v85, v85
v_dot2c_f32_bf16 v150, s86, v86
v_dot2c_f32_bf16 v152, v86, v86
v_dot2c_f32_bf16 v151, s86, v87
s_add_u32 m0, s98, 52224
s_add_u32 s94, s97, 1253376
buffer_load_dwordx4 v154, s[32:35], s94 offen lds
v_dot2c_f32_bf16 v153, v87, v87
v_dot2c_f32_bf16 v150, s86, v88
v_dot2c_f32_bf16 v152, v88, v88
v_dot2c_f32_bf16 v151, s86, v89
v_dot2c_f32_bf16 v153, v89, v89
v_dot2c_f32_bf16 v150, s86, v90
v_dot2c_f32_bf16 v152, v90, v90
v_dot2c_f32_bf16 v151, s86, v91
v_dot2c_f32_bf16 v153, v91, v91
v_dot2c_f32_bf16 v150, s86, v92
v_dot2c_f32_bf16 v152, v92, v92
v_dot2c_f32_bf16 v151, s86, v93
v_dot2c_f32_bf16 v153, v93, v93
v_dot2c_f32_bf16 v150, s86, v94
v_dot2c_f32_bf16 v152, v94, v94
v_dot2c_f32_bf16 v151, s86, v95
v_dot2c_f32_bf16 v153, v95, v95
v_dot2c_f32_bf16 v150, s86, v96
v_dot2c_f32_bf16 v152, v96, v96
v_dot2c_f32_bf16 v151, s86, v97
v_dot2c_f32_bf16 v153, v97, v97
v_dot2c_f32_bf16 v150, s86, v98
v_dot2c_f32_bf16 v152, v98, v98
v_dot2c_f32_bf16 v151, s86, v99
v_dot2c_f32_bf16 v153, v99, v99
buffer_load_dword a0, v5, s[32:35], s95 offen
v_dot2c_f32_bf16 v150, s86, v100
v_dot2c_f32_bf16 v152, v100, v100
v_dot2c_f32_bf16 v151, s86, v101
v_dot2c_f32_bf16 v153, v101, v101
v_dot2c_f32_bf16 v150, s86, v102
v_dot2c_f32_bf16 v152, v102, v102
v_dot2c_f32_bf16 v151, s86, v103
v_dot2c_f32_bf16 v153, v103, v103
v_dot2c_f32_bf16 v150, s86, v104
v_dot2c_f32_bf16 v152, v104, v104
v_dot2c_f32_bf16 v151, s86, v105
v_dot2c_f32_bf16 v153, v105, v105
v_dot2c_f32_bf16 v150, s86, v106
v_dot2c_f32_bf16 v152, v106, v106
v_dot2c_f32_bf16 v151, s86, v107
v_dot2c_f32_bf16 v153, v107, v107
v_dot2c_f32_bf16 v150, s86, v108
v_dot2c_f32_bf16 v152, v108, v108
v_dot2c_f32_bf16 v151, s86, v109
v_dot2c_f32_bf16 v153, v109, v109
v_dot2c_f32_bf16 v150, s86, v110
v_dot2c_f32_bf16 v152, v110, v110
v_dot2c_f32_bf16 v151, s86, v111
v_dot2c_f32_bf16 v153, v111, v111
s_waitcnt lgkmcnt(8)
v_dot2c_f32_bf16 v156, s86, v224
v_dot2c_f32_bf16 v157, s86, v225
v_dot2c_f32_bf16 v156, s86, v226
v_dot2c_f32_bf16 v157, s86, v227
v_dot2c_f32_bf16 v158, s86, v228
v_dot2c_f32_bf16 v159, s86, v229
s_add_u32 m0, s100, 133120
s_add_u32 s94, s99, 0
buffer_load_dwordx4 v12, s[52:55], s94 offen lds
v_dot2c_f32_bf16 v158, s86, v230
v_dot2c_f32_bf16 v159, s86, v231
v_dot2c_f32_bf16 v156, s86, v232
v_dot2c_f32_bf16 v157, s86, v233
v_dot2c_f32_bf16 v156, s86, v234
v_dot2c_f32_bf16 v157, s86, v235
v_dot2c_f32_bf16 v158, s86, v236
v_dot2c_f32_bf16 v159, s86, v237
v_dot2c_f32_bf16 v158, s86, v238
v_dot2c_f32_bf16 v159, s86, v239
s_waitcnt lgkmcnt(4)
v_mfma_f32_32x32x16_bf16 v[160:175], v[200:203], v[80:83], v[160:175]
ds_read_b64_tr_b16 v[192:193], v2 offset:36864
ds_read_b64_tr_b16 v[194:195], v2 offset:37376
v_mfma_f32_32x32x16_bf16 v[176:191], v[204:207], v[80:83], v[176:191]
ds_read_b64_tr_b16 v[196:197], v3 offset:36864
ds_read_b64_tr_b16 v[198:199], v3 offset:37376
s_waitcnt lgkmcnt(4)
v_mfma_f32_32x32x16_bf16 v[160:175], v[208:211], v[84:87], v[160:175]
s_add_u32 m0, s100, 134144
s_add_u32 s94, s99, 28672
buffer_load_dwordx4 v12, s[52:55], s94 offen lds
ds_read_b64_tr_b16 v[200:201], v2 offset:38912
ds_read_b64_tr_b16 v[202:203], v2 offset:39424
v_mfma_f32_32x32x16_bf16 v[176:191], v[212:215], v[84:87], v[176:191]
ds_read_b64_tr_b16 v[204:205], v3 offset:38912
ds_read_b64_tr_b16 v[206:207], v3 offset:39424
s_waitcnt lgkmcnt(4)
v_mfma_f32_32x32x16_bf16 v[160:175], v[192:195], v[88:91], v[160:175]
ds_read_b64_tr_b16 v[208:209], v2 offset:40960
ds_read_b64_tr_b16 v[210:211], v2 offset:41472
v_mfma_f32_32x32x16_bf16 v[176:191], v[196:199], v[88:91], v[176:191]
ds_read_b64_tr_b16 v[212:213], v3 offset:40960
ds_read_b64_tr_b16 v[214:215], v3 offset:41472
s_waitcnt lgkmcnt(4)
v_mfma_f32_32x32x16_bf16 v[160:175], v[200:203], v[92:95], v[160:175]
s_add_u32 m0, s100, 141312
s_add_u32 s94, s99, 0
buffer_load_dwordx4 v12, s[56:59], s94 offen lds
ds_read_b64_tr_b16 v[192:193], v2 offset:43008
ds_read_b64_tr_b16 v[194:195], v2 offset:43520
v_mfma_f32_32x32x16_bf16 v[176:191], v[204:207], v[92:95], v[176:191]
ds_read_b64_tr_b16 v[196:197], v3 offset:43008
ds_read_b64_tr_b16 v[198:199], v3 offset:43520
s_waitcnt lgkmcnt(4)
v_mfma_f32_32x32x16_bf16 v[160:175], v[208:211], v[96:99], v[160:175]
ds_read_b64_tr_b16 v[200:201], v2 offset:45056
ds_read_b64_tr_b16 v[202:203], v2 offset:45568
v_mfma_f32_32x32x16_bf16 v[176:191], v[212:215], v[96:99], v[176:191]
ds_read_b64_tr_b16 v[204:205], v3 offset:45056
ds_read_b64_tr_b16 v[206:207], v3 offset:45568
s_waitcnt lgkmcnt(4)
v_mfma_f32_32x32x16_bf16 v[160:175], v[192:195], v[100:103], v[160:175]
s_add_u32 m0, s100, 142336
s_add_u32 s94, s99, 28672
buffer_load_dwordx4 v12, s[56:59], s94 offen lds
ds_read_b64_tr_b16 v[208:209], v2 offset:47104
ds_read_b64_tr_b16 v[210:211], v2 offset:47616
v_mfma_f32_32x32x16_bf16 v[176:191], v[196:199], v[100:103], v[176:191]
ds_read_b64_tr_b16 v[212:213], v3 offset:47104
ds_read_b64_tr_b16 v[214:215], v3 offset:47616
s_waitcnt vmcnt(9)
s_waitcnt lgkmcnt(4)
v_mfma_f32_32x32x16_bf16 v[160:175], v[200:203], v[104:107], v[160:175]
ds_read_b128 v[112:115], v146 offset:8192
ds_read_b128 v[116:119], v147 offset:8192
v_mfma_f32_32x32x16_bf16 v[176:191], v[204:207], v[104:107], v[176:191]
ds_read_b128 v[120:123], v148 offset:8192
ds_read_b128 v[124:127], v149 offset:8192
s_waitcnt lgkmcnt(4)
v_mfma_f32_32x32x16_bf16 v[160:175], v[208:211], v[108:111], v[160:175]
s_add_u32 m0, s100, 149504
s_add_u32 s94, s101, 0
buffer_load_dwordx4 v13, s[60:63], s94 offen lds
ds_read_b128 v[128:131], v146 offset:12288
ds_read_b128 v[132:135], v147 offset:12288
v_mfma_f32_32x32x16_bf16 v[176:191], v[212:215], v[108:111], v[176:191]
ds_read_b128 v[136:139], v148 offset:12288
ds_read_b128 v[140:143], v149 offset:12288
s_waitcnt vmcnt(6)
ds_read_b64_tr_b16 v[224:225], v220 offset:49152
ds_read_b64_tr_b16 v[226:227], v220 offset:49664
ds_read_b64_tr_b16 v[228:229], v221 offset:49152
ds_read_b64_tr_b16 v[230:231], v221 offset:49664
ds_read_b64_tr_b16 v[232:233], v220 offset:51200
ds_read_b64_tr_b16 v[234:235], v220 offset:51712
ds_read_b64_tr_b16 v[236:237], v221 offset:51200
ds_read_b64_tr_b16 v[238:239], v221 offset:51712
s_barrier
s_waitcnt lgkmcnt(8)
ds_read_b64_tr_b16 v[192:193], v2 offset:49152
ds_read_b64_tr_b16 v[194:195], v2 offset:49664
ds_read_b64_tr_b16 v[196:197], v3 offset:49152
ds_read_b64_tr_b16 v[198:199], v3 offset:49664
ds_read_b64_tr_b16 v[200:201], v2 offset:51200
ds_read_b64_tr_b16 v[202:203], v2 offset:51712
ds_read_b64_tr_b16 v[204:205], v3 offset:51200
ds_read_b64_tr_b16 v[206:207], v3 offset:51712
v_dot2c_f32_bf16 v150, s86, v112
v_dot2c_f32_bf16 v152, v112, v112
v_dot2c_f32_bf16 v151, s86, v113
v_dot2c_f32_bf16 v153, v113, v113
v_dot2c_f32_bf16 v150, s86, v114
v_dot2c_f32_bf16 v152, v114, v114
v_dot2c_f32_bf16 v151, s86, v115
v_dot2c_f32_bf16 v153, v115, v115
v_dot2c_f32_bf16 v150, s86, v116
v_dot2c_f32_bf16 v152, v116, v116
v_dot2c_f32_bf16 v151, s86, v117
v_dot2c_f32_bf16 v153, v117, v117
v_dot2c_f32_bf16 v150, s86, v118
v_dot2c_f32_bf16 v152, v118, v118
v_dot2c_f32_bf16 v151, s86, v119
v_dot2c_f32_bf16 v153, v119, v119
v_dot2c_f32_bf16 v150, s86, v120
v_dot2c_f32_bf16 v152, v120, v120
v_dot2c_f32_bf16 v151, s86, v121
v_dot2c_f32_bf16 v153, v121, v121
v_dot2c_f32_bf16 v150, s86, v122
v_dot2c_f32_bf16 v152, v122, v122
s_add_u32 m0, s100, 150528
s_add_u32 s94, s101, 8192
buffer_load_dwordx4 v13, s[60:63], s94 offen lds
v_dot2c_f32_bf16 v151, s86, v123
v_dot2c_f32_bf16 v153, v123, v123
v_dot2c_f32_bf16 v150, s86, v124
v_dot2c_f32_bf16 v152, v124, v124
v_dot2c_f32_bf16 v151, s86, v125
v_dot2c_f32_bf16 v153, v125, v125
v_dot2c_f32_bf16 v150, s86, v126
v_dot2c_f32_bf16 v152, v126, v126
v_dot2c_f32_bf16 v151, s86, v127
v_dot2c_f32_bf16 v153, v127, v127
v_dot2c_f32_bf16 v150, s86, v128
v_dot2c_f32_bf16 v152, v128, v128
v_dot2c_f32_bf16 v151, s86, v129
v_dot2c_f32_bf16 v153, v129, v129
v_dot2c_f32_bf16 v150, s86, v130
v_dot2c_f32_bf16 v152, v130, v130
v_dot2c_f32_bf16 v151, s86, v131
v_dot2c_f32_bf16 v153, v131, v131
v_dot2c_f32_bf16 v150, s86, v132
v_dot2c_f32_bf16 v152, v132, v132
v_dot2c_f32_bf16 v151, s86, v133
v_dot2c_f32_bf16 v153, v133, v133
v_dot2c_f32_bf16 v150, s86, v134
v_dot2c_f32_bf16 v152, v134, v134
v_dot2c_f32_bf16 v151, s86, v135
v_dot2c_f32_bf16 v153, v135, v135
v_dot2c_f32_bf16 v150, s86, v136
v_dot2c_f32_bf16 v152, v136, v136
v_dot2c_f32_bf16 v151, s86, v137
v_dot2c_f32_bf16 v153, v137, v137
v_dot2c_f32_bf16 v150, s86, v138
v_dot2c_f32_bf16 v152, v138, v138
v_dot2c_f32_bf16 v151, s86, v139
v_dot2c_f32_bf16 v153, v139, v139
v_dot2c_f32_bf16 v150, s86, v140
v_dot2c_f32_bf16 v152, v140, v140
v_dot2c_f32_bf16 v151, s86, v141
v_dot2c_f32_bf16 v153, v141, v141
v_dot2c_f32_bf16 v150, s86, v142
v_dot2c_f32_bf16 v152, v142, v142
v_dot2c_f32_bf16 v151, s86, v143
v_dot2c_f32_bf16 v153, v143, v143
s_waitcnt lgkmcnt(8)
v_dot2c_f32_bf16 v156, s86, v224
v_dot2c_f32_bf16 v157, s86, v225
v_dot2c_f32_bf16 v156, s86, v226
v_dot2c_f32_bf16 v157, s86, v227
v_dot2c_f32_bf16 v158, s86, v228
v_dot2c_f32_bf16 v159, s86, v229
v_dot2c_f32_bf16 v158, s86, v230
v_dot2c_f32_bf16 v159, s86, v231
v_dot2c_f32_bf16 v156, s86, v232
v_dot2c_f32_bf16 v157, s86, v233
v_dot2c_f32_bf16 v156, s86, v234
v_dot2c_f32_bf16 v157, s86, v235
v_dot2c_f32_bf16 v158, s86, v236
v_dot2c_f32_bf16 v159, s86, v237
v_dot2c_f32_bf16 v158, s86, v238
v_dot2c_f32_bf16 v159, s86, v239
s_cmp_lg_u32 s68, 3
s_cbranch_scc1 Lpub_2
s_min_u32 s26, s76, 14
s_add_u32 s26, s26, 1
s_and_b32 s27, s2, 3
s_lshl_b32 s27, s27, 3
s_lshl_b32 s27, s26, s27
s_and_b32 s94, s2, 0xfc
v_mov_b32 v252, s27
v_mov_b32 v253, s94
s_mov_b64 exec, 1
buffer_atomic_or v252, v253, s[40:43], 0 offen sc1
s_mov_b64 exec, -1
Lpub_2:
s_waitcnt lgkmcnt(4)
v_mfma_f32_32x32x16_bf16 v[160:175], v[192:195], v[112:115], v[160:175]
ds_read_b64_tr_b16 v[208:209], v2 offset:53248
ds_read_b64_tr_b16 v[210:211], v2 offset:53760
v_add_f32 v150, v150, v151
v_add_f32 v152, v152, v153
s_nop 1
v_permlane32_swap_b32 v150, v152
v_mfma_f32_32x32x16_bf16 v[176:191], v[196:199], v[112:115], v[176:191]
ds_read_b64_tr_b16 v[212:213], v3 offset:53248
ds_read_b64_tr_b16 v[214:215], v3 offset:53760
v_add_f32 v150, v150, v152
v_mov_b32 v152, v150
s_nop 1
v_permlane32_swap_b32_e64 v150, v152
s_waitcnt lgkmcnt(4)
v_mfma_f32_32x32x16_bf16 v[160:175], v[200:203], v[116:119], v[160:175]
ds_read_b64_tr_b16 v[192:193], v2 offset:55296
ds_read_b64_tr_b16 v[194:195], v2 offset:55808
v_mul_f32 v8, -0.001953125, v150
v_mul_f32 v152, 0.001953125, v152
v_fma_f32 v152, -v8, v8, v152
v_mfma_f32_32x32x16_bf16 v[176:191], v[204:207], v[116:119], v[176:191]
ds_read_b64_tr_b16 v[196:197], v3 offset:55296
ds_read_b64_tr_b16 v[198:199], v3 offset:55808
v_max_f32_e64 v152, 0, v152
v_add_f32 v152, 0x3727c5ac, v152
v_rsq_f32 v9, v152
s_waitcnt lgkmcnt(4)
v_mfma_f32_32x32x16_bf16 v[160:175], v[208:211], v[120:123], v[160:175]
ds_read_b64_tr_b16 v[200:201], v2 offset:57344
ds_read_b64_tr_b16 v[202:203], v2 offset:57856
v_and_b32_e64 v7, 19, v0
v_bfe_u32 v11, v0, 2, 1
v_lshl_add_u32 v7, v11, 3, v7
v_mfma_f32_32x32x16_bf16 v[176:191], v[212:215], v[120:123], v[176:191]
ds_read_b64_tr_b16 v[204:205], v3 offset:57344
ds_read_b64_tr_b16 v[206:207], v3 offset:57856
v_bfe_u32 v11, v0, 3, 1
v_lshl_add_u32 v7, v11, 2, v7
v_lshlrev_b32 v11, 2, v7
s_waitcnt lgkmcnt(4)
v_mfma_f32_32x32x16_bf16 v[160:175], v[192:195], v[124:127], v[160:175]
ds_read_b64_tr_b16 v[208:209], v2 offset:59392
ds_read_b64_tr_b16 v[210:211], v2 offset:59904
s_mul_i32 s77, s68, 256
s_add_u32 s77, s77, 158720
v_add_u32_e64 v11, s77, v11
v_mfma_f32_32x32x16_bf16 v[176:191], v[196:199], v[124:127], v[176:191]
ds_read_b64_tr_b16 v[212:213], v3 offset:59392
ds_read_b64_tr_b16 v[214:215], v3 offset:59904
v_add_f32 v156, v156, v157
v_mov_b32 v157, v156
s_nop 1
v_permlane32_swap_b32_e64 v156, v157
s_waitcnt lgkmcnt(4)
v_mfma_f32_32x32x16_bf16 v[160:175], v[200:203], v[128:131], v[160:175]
ds_read_b64_tr_b16 v[192:193], v2 offset:61440
ds_read_b64_tr_b16 v[194:195], v2 offset:61952
v_add_f32 v156, v156, v157
v_add_f32 v158, v158, v159
v_mov_b32_e64 v159, v158
v_mfma_f32_32x32x16_bf16 v[176:191], v[204:207], v[128:131], v[176:191]
ds_read_b64_tr_b16 v[196:197], v3 offset:61440
ds_read_b64_tr_b16 v[198:199], v3 offset:61952
v_permlane32_swap_b32 v158, v159
v_add_f32 v158, v158, v159
s_lshl_b32 s77, s70, 4
s_waitcnt lgkmcnt(4)
v_mfma_f32_32x32x16_bf16 v[160:175], v[208:211], v[132:135], v[160:175]
ds_read_b64_tr_b16 v[200:201], v2 offset:63488
ds_read_b64_tr_b16 v[202:203], v2 offset:64000
s_add_u32 s77, s77, s69
s_mul_i32 s77, s77, 2304
s_add_u32 s20, s77, 1048576
v_mfma_f32_32x32x16_bf16 v[176:191], v[212:215], v[132:135], v[176:191]
ds_read_b64_tr_b16 v[204:205], v3 offset:63488
ds_read_b64_tr_b16 v[206:207], v3 offset:64000
s_lshl_b32 s78, s68, 9
s_add_u32 s21, s78, s20
s_lshl_b32 s77, s70, 8
s_waitcnt lgkmcnt(4)
v_mfma_f32_32x32x16_bf16 v[160:175], v[192:195], v[136:139], v[160:175]
s_lshl_b32 s78, s68, 6
s_add_u32 s77, s77, s78
s_add_u32 s23, s77, 4096
v_mfma_f32_32x32x16_bf16 v[176:191], v[196:199], v[136:139], v[176:191]
s_lshl_b32 s78, s69, 2
s_add_u32 s22, s23, s78
s_lshl_b32 s24, s68, 8
s_waitcnt lgkmcnt(0)
v_mfma_f32_32x32x16_bf16 v[160:175], v[200:203], v[140:143], v[160:175]
s_add_u32 s24, s24, 112640
s_mul_i32 s25, s68, 3072
s_add_u32 s25, s25, 100352
v_mfma_f32_32x32x16_bf16 v[176:191], v[204:207], v[140:143], v[176:191]
ds_write_b32 v11, v156 offset:0
ds_write_b32 v11, v158 offset:128
v_lshrrev_b32 v7, 2, v0
v_mul_u32_u24 v7, 3072, v7
v_and_b32_e64 v5, 3, v0
v_lshl_add_u32 v5, v5, 4, v7
s_mul_i32 s95, s68, 393216
s_lshl_b32 s78, s70, 6
s_add_u32 s95, s95, s78
s_lshl_b32 s96, s68, 13
s_waitcnt lgkmcnt(0)
s_barrier
v_lshlrev_b32 v7, 2, v0
v_add_u32 v11, 158720, v7
ds_read_b32 v224, v11 offset:0
ds_read_b32 v225, v11 offset:256
ds_read_b32 v226, v11 offset:512
ds_read_b32 v227, v11 offset:768
v_add_u32 v11, 65536, v7
s_waitcnt lgkmcnt(0)
v_add_f32 v224, v224, v225
v_add_f32 v226, v226, v227
v_add_f32 v224, v224, v226
ds_write_b32 v11, v224
ds_read_b128 v[192:195], v10 offset:0
ds_read_b128 v[196:199], v10 offset:16
ds_read_b128 v[200:203], v10 offset:64
ds_read_b128 v[204:207], v10 offset:80
ds_read_b128 v[208:211], v10 offset:128
ds_read_b128 v[212:215], v10 offset:144
ds_read_b128 v[216:219], v10 offset:192
ds_read_b128 v[220:223], v10 offset:208
s_waitcnt lgkmcnt(4)
v_pk_fma_f32 v[160:161], v[192:193], v[8:9], v[160:161] op_sel_hi:[1,0,1]
s_add_u32 m0, s96, 67584
s_add_u32 s94, s95, 0
buffer_load_dwordx4 v5, s[32:35], s94 offen lds
v_pk_fma_f32 v[162:163], v[194:195], v[8:9], v[162:163] op_sel_hi:[1,0,1]
v_pk_fma_f32 v[164:165], v[196:197], v[8:9], v[164:165] op_sel_hi:[1,0,1]
v_pk_fma_f32 v[166:167], v[198:199], v[8:9], v[166:167] op_sel_hi:[1,0,1]
v_pk_fma_f32 v[168:169], v[200:201], v[8:9], v[168:169] op_sel_hi:[1,0,1]
v_pk_fma_f32 v[170:171], v[202:203], v[8:9], v[170:171] op_sel_hi:[1,0,1]
v_pk_fma_f32 v[172:173], v[204:205], v[8:9], v[172:173] op_sel_hi:[1,0,1]
v_pk_fma_f32 v[174:175], v[206:207], v[8:9], v[174:175] op_sel_hi:[1,0,1]
v_pk_mul_f32 v[160:161], v[160:161], v[8:9] op_sel:[0,1] op_sel_hi:[1,1]
v_pk_mul_f32 v[162:163], v[162:163], v[8:9] op_sel:[0,1] op_sel_hi:[1,1]
v_pk_mul_f32 v[164:165], v[164:165], v[8:9] op_sel:[0,1] op_sel_hi:[1,1]
v_pk_mul_f32 v[166:167], v[166:167], v[8:9] op_sel:[0,1] op_sel_hi:[1,1]
v_pk_mul_f32 v[168:169], v[168:169], v[8:9] op_sel:[0,1] op_sel_hi:[1,1]
v_pk_mul_f32 v[170:171], v[170:171], v[8:9] op_sel:[0,1] op_sel_hi:[1,1]
v_pk_mul_f32 v[172:173], v[172:173], v[8:9] op_sel:[0,1] op_sel_hi:[1,1]
v_pk_mul_f32 v[174:175], v[174:175], v[8:9] op_sel:[0,1] op_sel_hi:[1,1]
s_waitcnt lgkmcnt(0)
v_pk_fma_f32 v[176:177], v[208:209], v[8:9], v[176:177] op_sel_hi:[1,0,1]
v_pk_fma_f32 v[178:179], v[210:211], v[8:9], v[178:179] op_sel_hi:[1,0,1]
v_pk_fma_f32 v[180:181], v[212:213], v[8:9], v[180:181] op_sel_hi:[1,0,1]
v_pk_fma_f32 v[182:183], v[214:215], v[8:9], v[182:183] op_sel_hi:[1,0,1]
v_pk_fma_f32 v[184:185], v[216:217], v[8:9], v[184:185] op_sel_hi:[1,0,1]
v_pk_fma_f32 v[186:187], v[218:219], v[8:9], v[186:187] op_sel_hi:[1,0,1]
v_pk_fma_f32 v[188:189], v[220:221], v[8:9], v[188:189] op_sel_hi:[1,0,1]
v_pk_fma_f32 v[190:191], v[222:223], v[8:9], v[190:191] op_sel_hi:[1,0,1]
v_pk_mul_f32 v[176:177], v[176:177], v[8:9] op_sel:[0,1] op_sel_hi:[1,1]
v_pk_mul_f32 v[178:179], v[178:179], v[8:9] op_sel:[0,1] op_sel_hi:[1,1]
s_add_u32 m0, s96, 68608
s_add_u32 s94, s95, 49152
buffer_load_dwordx4 v5, s[32:35], s94 offen lds
v_pk_mul_f32 v[180:181], v[180:181], v[8:9] op_sel:[0,1] op_sel_hi:[1,1]
v_pk_mul_f32 v[182:183], v[182:183], v[8:9] op_sel:[0,1] op_sel_hi:[1,1]
v_pk_mul_f32 v[184:185], v[184:185], v[8:9] op_sel:[0,1] op_sel_hi:[1,1]
v_pk_mul_f32 v[186:187], v[186:187], v[8:9] op_sel:[0,1] op_sel_hi:[1,1]
v_pk_mul_f32 v[188:189], v[188:189], v[8:9] op_sel:[0,1] op_sel_hi:[1,1]
v_pk_mul_f32 v[190:191], v[190:191], v[8:9] op_sel:[0,1] op_sel_hi:[1,1]
v_cvt_pk_bf16_f32 v224, v160, v161
v_cvt_pk_bf16_f32 v225, v162, v163
v_cvt_pk_bf16_f32 v226, v164, v165
v_cvt_pk_bf16_f32 v227, v166, v167
v_cvt_pk_bf16_f32 v228, v168, v169
v_cvt_pk_bf16_f32 v229, v170, v171
v_cvt_pk_bf16_f32 v230, v172, v173
v_cvt_pk_bf16_f32 v231, v174, v175
v_mfma_f32_32x32x16_bf16 v[160:175], a[232:235], v[224:227], 0
s_nop 0
v_mfma_f32_32x32x16_bf16 v[240:255], a[236:239], v[228:231], 0
s_add_u32 m0, s96, 69632
s_add_u32 s94, s95, 98304
buffer_load_dwordx4 v5, s[32:35], s94 offen lds
v_cvt_pk_bf16_f32 v232, v176, v177
v_cvt_pk_bf16_f32 v233, v178, v179
v_cvt_pk_bf16_f32 v234, v180, v181
v_cvt_pk_bf16_f32 v235, v182, v183
v_cvt_pk_bf16_f32 v236, v184, v185
v_cvt_pk_bf16_f32 v237, v186, v187
v_cvt_pk_bf16_f32 v238, v188, v189
v_cvt_pk_bf16_f32 v239, v190, v191
v_mfma_f32_32x32x16_bf16 v[176:191], v[232:235], a[224:227], 0
s_nop 0
v_mfma_f32_32x32x16_bf16 v[144:159], v[236:239], a[228:231], 0
v_max3_f32 v192, v160, v161, v162
s_add_u32 m0, s96, 70656
s_add_u32 s94, s95, 147456
buffer_load_dwordx4 v5, s[32:35], s94 offen lds
v_max3_f32 v193, v163, v164, v165
v_max3_f32 v192, v166, v167, v192
v_max_f32 v192, v192, v193
v_max3_f32 v194, v168, v169, v170
v_max3_f32 v195, v171, v172, v173
v_max3_f32 v194, v174, v175, v194
v_max_f32_e64 v194, v194, v195
v_max3_f32 v196, v240, v241, v242
v_max3_f32 v197, v243, v244, v245
v_max3_f32 v196, v246, v247, v196
v_max_f32_e64 v196, v196, v197
v_max3_f32 v198, v248, v249, v250
v_max3_f32 v199, v251, v252, v253
v_max3_f32 v198, v254, v255, v198
v_max_f32 v198, v198, v199
v_permlane32_swap_b32 v192, v194
s_nop 0
v_permlane32_swap_b32 v196, v198
v_max_f32 v192, v192, v194
v_max_f32 v196, v196, v198
v_mov_b32 v194, v192
v_mov_b32 v198, v196
s_nop 0
v_permlane32_swap_b32 v192, v194
s_add_u32 m0, s96, 71680
s_add_u32 s94, s95, 196608
buffer_load_dwordx4 v5, s[32:35], s94 offen lds
v_permlane32_swap_b32_e64 v196, v198
v_mul_f32 v192, 0xbfb8aa3b, v192
v_mul_f32 v194, 0xbfb8aa3b, v194
v_mul_f32 v196, 0xbfb8aa3b, v196
v_mul_f32 v198, 0xbfb8aa3b, v198
v_pk_fma_f32 v[160:161], v[160:161], s[84:85], v[192:193] op_sel_hi:[1,1,0]
v_pk_fma_f32 v[162:163], v[162:163], s[84:85], v[192:193] op_sel_hi:[1,1,0]
v_pk_fma_f32 v[164:165], v[164:165], s[84:85], v[192:193] op_sel_hi:[1,1,0]
v_pk_fma_f32 v[166:167], v[166:167], s[84:85], v[192:193] op_sel_hi:[1,1,0]
v_pk_fma_f32 v[168:169], v[168:169], s[84:85], v[194:195] op_sel_hi:[1,1,0]
v_pk_fma_f32 v[170:171], v[170:171], s[84:85], v[194:195] op_sel_hi:[1,1,0]
v_pk_fma_f32 v[172:173], v[172:173], s[84:85], v[194:195] op_sel_hi:[1,1,0]
v_pk_fma_f32 v[174:175], v[174:175], s[84:85], v[194:195] op_sel_hi:[1,1,0]
v_pk_fma_f32 v[240:241], v[240:241], s[84:85], v[196:197] op_sel_hi:[1,1,0]
v_pk_fma_f32 v[242:243], v[242:243], s[84:85], v[196:197] op_sel_hi:[1,1,0]
v_pk_fma_f32 v[244:245], v[244:245], s[84:85], v[196:197] op_sel_hi:[1,1,0]
v_pk_fma_f32 v[246:247], v[246:247], s[84:85], v[196:197] op_sel_hi:[1,1,0]
v_pk_fma_f32 v[248:249], v[248:249], s[84:85], v[198:199] op_sel_hi:[1,1,0]
v_pk_fma_f32 v[250:251], v[250:251], s[84:85], v[198:199] op_sel_hi:[1,1,0]
v_pk_fma_f32 v[252:253], v[252:253], s[84:85], v[198:199] op_sel_hi:[1,1,0]
v_pk_fma_f32 v[254:255], v[254:255], s[84:85], v[198:199] op_sel_hi:[1,1,0]
v_exp_f32 v160, v160
v_exp_f32 v161, v161
s_add_u32 m0, s96, 72704
s_add_u32 s94, s95, 245760
buffer_load_dwordx4 v5, s[32:35], s94 offen lds
v_exp_f32 v162, v162
v_exp_f32 v163, v163
v_exp_f32 v164, v164
v_exp_f32 v165, v165
v_exp_f32 v166, v166
v_exp_f32 v167, v167
v_exp_f32 v168, v168
v_exp_f32 v169, v169
v_exp_f32 v170, v170
v_exp_f32 v171, v171
v_exp_f32 v172, v172
v_exp_f32 v173, v173
v_exp_f32_e64 v174, v174
s_add_u32 m0, s96, 73728
s_add_u32 s94, s95, 294912
buffer_load_dwordx4 v5, s[32:35], s94 offen lds
v_exp_f32 v175, v175
v_exp_f32 v240, v240
v_exp_f32 v241, v241
v_exp_f32 v242, v242
v_exp_f32 v243, v243
v_exp_f32 v244, v244
v_exp_f32 v245, v245
v_exp_f32 v246, v246
v_exp_f32 v247, v247
v_exp_f32 v248, v248
v_exp_f32 v249, v249
v_exp_f32 v250, v250
v_exp_f32_e64 v251, v251
s_add_u32 m0, s96, 74752
s_add_u32 s94, s95, 344064
buffer_load_dwordx4 v5, s[32:35], s94 offen lds
v_exp_f32 v252, v252
v_exp_f32 v253, v253
v_exp_f32 v254, v254
v_exp_f32 v255, v255
v_pk_add_f32 v[192:193], v[160:161], v[162:163]
v_pk_add_f32 v[200:201], v[164:165], v[166:167]
v_pk_add_f32 v[192:193], v[192:193], v[200:201]
v_add_f32_e64 v192, v192, v193
v_pk_add_f32 v[194:195], v[168:169], v[170:171]
v_pk_add_f32 v[200:201], v[172:173], v[174:175]
v_pk_add_f32 v[194:195], v[194:195], v[200:201]
buffer_load_dword a0, v14, s[48:51], s19 offen
v_add_f32_e64 v194, v194, v195
v_pk_add_f32 v[196:197], v[240:241], v[242:243]
v_pk_add_f32 v[200:201], v[244:245], v[246:247]
v_pk_add_f32 v[196:197], v[196:197], v[200:201]
v_add_f32_e64 v196, v196, v197
v_pk_add_f32 v[198:199], v[248:249], v[250:251]
v_pk_add_f32 v[200:201], v[252:253], v[254:255]
v_pk_add_f32 v[198:199], v[198:199], v[200:201]
v_add_f32 v198, v198, v199
v_permlane32_swap_b32 v192, v194
s_nop 0
v_permlane32_swap_b32 v196, v198
v_add_f32 v192, v192, v194
v_add_f32 v196, v196, v198
v_mov_b32 v194, v192
v_mov_b32 v198, v196
s_nop 0
v_permlane32_swap_b32 v192, v194
v_permlane32_swap_b32 v196, v198
v_rcp_f32 v192, v192
v_rcp_f32 v194, v194
v_rcp_f32 v196, v196
v_rcp_f32_e64 v198, v198
v_pk_mul_f32 v[160:161], v[160:161], v[192:193] op_sel_hi:[1,0]
v_pk_mul_f32 v[162:163], v[162:163], v[192:193] op_sel_hi:[1,0]
v_pk_mul_f32 v[164:165], v[164:165], v[192:193] op_sel_hi:[1,0]
v_pk_mul_f32 v[166:167], v[166:167], v[192:193] op_sel_hi:[1,0]
v_pk_mul_f32 v[168:169], v[168:169], v[194:195] op_sel_hi:[1,0]
v_pk_mul_f32 v[170:171], v[170:171], v[194:195] op_sel_hi:[1,0]
v_pk_mul_f32 v[172:173], v[172:173], v[194:195] op_sel_hi:[1,0]
v_pk_mul_f32 v[174:175], v[174:175], v[194:195] op_sel_hi:[1,0]
v_pk_mul_f32 v[240:241], v[240:241], v[196:197] op_sel_hi:[1,0]
v_pk_mul_f32 v[242:243], v[242:243], v[196:197] op_sel_hi:[1,0]
v_pk_mul_f32 v[244:245], v[244:245], v[196:197] op_sel_hi:[1,0]
v_pk_mul_f32 v[246:247], v[246:247], v[196:197] op_sel_hi:[1,0]
v_pk_mul_f32 v[248:249], v[248:249], v[198:199] op_sel_hi:[1,0]
v_pk_mul_f32 v[250:251], v[250:251], v[198:199] op_sel_hi:[1,0]
v_pk_mul_f32 v[252:253], v[252:253], v[198:199] op_sel_hi:[1,0]
v_pk_mul_f32 v[254:255], v[254:255], v[198:199] op_sel_hi:[1,0]
v_cvt_pk_bf16_f32 v204, v160, v161
v_cvt_pk_bf16_f32 v205, v162, v163
v_cvt_pk_bf16_f32 v206, v164, v165
v_cvt_pk_bf16_f32 v207, v166, v167
v_cvt_pk_bf16_f32 v208, v168, v169
v_cvt_pk_bf16_f32 v209, v170, v171
v_cvt_pk_bf16_f32 v210, v172, v173
v_cvt_pk_bf16_f32 v211, v174, v175
v_cvt_pk_bf16_f32 v212, v240, v241
v_cvt_pk_bf16_f32 v213, v242, v243
v_cvt_pk_bf16_f32 v214, v244, v245
v_cvt_pk_bf16_f32 v215, v246, v247
v_cvt_pk_bf16_f32 v216, v248, v249
v_cvt_pk_bf16_f32 v217, v250, v251
v_cvt_pk_bf16_f32 v218, v252, v253
v_cvt_pk_bf16_f32 v219, v254, v255
v_mfma_f32_32x32x16_bf16 v[160:175], v[204:207], a[224:227], 0
v_mfma_f32_32x32x16_bf16 v[160:175], v[208:211], a[228:231], v[160:175]
v_mfma_f32_32x32x16_bf16 v[240:255], v[212:215], a[224:227], 0
v_mfma_f32_32x32x16_bf16 v[240:255], v[216:219], a[228:231], v[240:255]
v_cvt_pk_bf16_f32 v224, v176, v177
v_cvt_pk_bf16_f32 v225, v178, v179
v_cvt_pk_bf16_f32 v226, v180, v181
v_cvt_pk_bf16_f32 v227, v182, v183
v_cvt_pk_bf16_f32 v228, v184, v185
v_cvt_pk_bf16_f32 v229, v186, v187
v_cvt_pk_bf16_f32 v230, v188, v189
v_cvt_pk_bf16_f32 v231, v190, v191
v_cvt_pk_bf16_f32 v232, v144, v145
v_cvt_pk_bf16_f32 v233, v146, v147
v_cvt_pk_bf16_f32 v234, v148, v149
v_cvt_pk_bf16_f32 v235, v150, v151
v_cvt_pk_bf16_f32 v236, v152, v153
v_cvt_pk_bf16_f32 v237, v154, v155
v_cvt_pk_bf16_f32 v238, v156, v157
v_cvt_pk_bf16_f32 v239, v158, v159
v_cvt_pk_bf16_f32 v204, v160, v161
v_cvt_pk_bf16_f32 v205, v162, v163
v_cvt_pk_bf16_f32 v206, v164, v165
v_cvt_pk_bf16_f32 v207, v166, v167
v_cvt_pk_bf16_f32 v208, v168, v169
v_cvt_pk_bf16_f32 v209, v170, v171
v_cvt_pk_bf16_f32 v210, v172, v173
v_cvt_pk_bf16_f32 v211, v174, v175
v_mfma_f32_32x32x16_bf16 v[176:191], v[204:207], v[224:227], 0
s_nop 0
v_mfma_f32_32x32x16_bf16 v[176:191], v[208:211], v[228:231], v[176:191]
v_cvt_pk_bf16_f32 v212, v240, v241
v_cvt_pk_bf16_f32 v213, v242, v243
v_cvt_pk_bf16_f32 v214, v244, v245
v_cvt_pk_bf16_f32 v215, v246, v247
v_cvt_pk_bf16_f32 v216, v248, v249
v_cvt_pk_bf16_f32 v217, v250, v251
v_cvt_pk_bf16_f32 v218, v252, v253
v_cvt_pk_bf16_f32 v219, v254, v255
v_mfma_f32_32x32x16_bf16 v[176:191], v[212:215], v[232:235], v[176:191]
s_nop 0
v_mfma_f32_32x32x16_bf16 v[176:191], v[216:219], v[236:239], v[176:191]
v_add_f32 v160, v160, v168
v_add_f32 v161, v161, v169
v_add_f32 v162, v162, v170
v_add_f32 v163, v163, v171
v_add_f32 v164, v164, v172
v_add_f32 v165, v165, v173
v_add_f32 v166, v166, v174
v_add_f32 v167, v167, v175
v_add_f32 v240, v240, v248
v_add_f32 v241, v241, v249
v_add_f32 v242, v242, v250
v_add_f32 v243, v243, v251
v_add_f32 v244, v244, v252
v_add_f32 v245, v245, v253
v_add_f32 v246, v246, v254
v_add_f32 v247, v247, v255
v_add_f32 v160, v160, v164
v_add_f32 v161, v161, v165
v_add_f32 v162, v162, v166
v_add_f32 v163, v163, v167
v_add_f32 v240, v240, v244
v_add_f32 v241, v241, v245
v_add_f32 v242, v242, v246
v_add_f32 v243, v243, v247
v_add_f32 v160, v160, v162
v_add_f32 v161, v161, v163
v_add_f32 v240, v240, v242
v_add_f32 v241, v241, v243
v_add_f32 v160, v160, v161
v_add_f32 v240, v240, v241
v_lshl_add_u32 v11, v0, 2, s24
v_lshlrev_b32 v7, 2, v0
v_permlane32_swap_b32 v160, v240
v_add_u32 v12, 112640, v7
v_add_u32 v13, s25, v1
v_add_f32 v160, v160, v240
ds_write_b32 v11, v160
v_add_u32 v11, 100352, v1
s_cmp_ge_u32 s68, 2
s_cbranch_scc1 Lsc_5
Lsc_3:
s_cmp_eq_u32 s68, 1
s_cbranch_scc1 Lsc_4
ds_write_b128 v11, v[180:183] offset:5120
ds_write_b128 v11, v[184:187] offset:7168
ds_write_b128 v11, v[188:191] offset:9216
v_pk_add_f32 v[192:193], v[176:177], 0
v_pk_add_f32 v[194:195], v[178:179], 0
s_branch Lscd_7
Lsc_4:
ds_write_b128 v11, v[176:179] offset:0
ds_write_b128 v11, v[184:187] offset:8192
ds_write_b128 v11, v[188:191] offset:10240
v_pk_add_f32 v[192:193], v[180:181], 0
v_pk_add_f32 v[194:195], v[182:183], 0
s_branch Lscd_7
Lsc_5:
s_cmp_eq_u32 s68, 3
s_cbranch_scc1 Lsc_6
ds_write_b128 v11, v[176:179] offset:1024
ds_write_b128 v11, v[180:183] offset:3072
ds_write_b128 v11, v[188:191] offset:11264
v_pk_add_f32 v[192:193], v[184:185], 0
v_pk_add_f32 v[194:195], v[186:187], 0
s_branch Lscd_7
Lsc_6:
ds_write_b128 v11, v[176:179] offset:2048
ds_write_b128 v11, v[180:183] offset:4096
ds_write_b128 v11, v[184:187] offset:6144
v_pk_add_f32 v[192:193], v[188:189], 0
v_pk_add_f32 v[194:195], v[190:191], 0
Lscd_7:
v_lshlrev_b32 v11, 3, v0
v_bfe_u32 v7, v0, 4, 1
v_bfe_u32 v255, v0, 2, 2
v_lshl_add_u32 v7, v7, 3, v255
v_and_b32 v255, 3, v0
v_lshlrev_b32 v255, 3, v255
v_lshl_add_u32 v255, v7, 7, v255
v_and_b32 v7, 32, v0
s_lshl_b32 s77, s68, 11
s_add_u32 s77, s77, 149504
v_add3_u32 v255, v255, v7, s77
v_lshrrev_b32_e64 v7, 4, v0
v_bfe_u32 v254, v0, 2, 2
v_lshl_add_u32 v7, v7, 3, v254
v_and_b32 v254, 3, v0
v_lshlrev_b32 v254, 3, v254
v_lshl_add_u32 v254, v7, 7, v254
s_lshl_b32 s77, s68, 5
s_add_u32 s77, s77, 133120
v_add_u32 v254, s77, v254
v_lshlrev_b32 v7, 2, v0
s_waitcnt vmcnt(9)
s_waitcnt lgkmcnt(0)
s_barrier
ds_read_b128 v[196:199], v13 offset:0
ds_read_b128 v[200:203], v13 offset:1024
ds_read_b128 v[204:207], v13 offset:2048
ds_read_b32 v208, v12 offset:0
ds_read_b32 v209, v12 offset:256
ds_read_b32 v210, v12 offset:512
ds_read_b32 v211, v12 offset:768
s_waitcnt lgkmcnt(4)
v_pk_add_f32 v[192:193], v[192:193], v[196:197]
v_pk_add_f32 v[200:201], v[200:201], v[204:205]
v_pk_add_f32 v[194:195], v[194:195], v[198:199]
v_pk_add_f32 v[202:203], v[202:203], v[206:207]
v_pk_add_f32 v[192:193], v[192:193], v[200:201]
v_pk_add_f32 v[194:195], v[194:195], v[202:203]
v_cvt_pk_bf16_f32 v192, v192, v193
v_cvt_pk_bf16_f32 v193, v194, v195
s_waitcnt vmcnt(0)
buffer_store_dwordx2 v[192:193], v11, s[36:39], s21 offen sc1
s_waitcnt lgkmcnt(0)
s_cmp_lg_u32 s68, 0
s_cbranch_scc1 Lnoz_8
v_pk_add_f32 v[208:209], v[208:209], v[210:211]
v_add_f32 v208, v208, v209
buffer_store_dword v208, v7, s[36:39], s20 offen offset:2048 sc1
Lnoz_8:
ds_read_b64_tr_b16 v[220:221], v254 offset:0
ds_read_b64_tr_b16 v[222:223], v254 offset:512
ds_read_b64_tr_b16 v[224:225], v254 offset:8192
ds_read_b64_tr_b16 v[226:227], v254 offset:8704
ds_read_b64_tr_b16 v[228:229], v254 offset:4096
ds_read_b64_tr_b16 v[230:231], v254 offset:4608
ds_read_b64_tr_b16 v[232:233], v254 offset:12288
ds_read_b64_tr_b16 v[234:235], v254 offset:12800
ds_read_b64_tr_b16 v[236:237], v255 offset:0
ds_read_b64_tr_b16 v[238:239], v255 offset:512
ds_read_b64_tr_b16 v[240:241], v255 offset:64
ds_read_b64_tr_b16 v[242:243], v255 offset:576
s_lshl_b32 s77, s68, 13
v_add_u32 v12, s77, v4
v_mov_b32 v248, 0
v_mov_b32 v249, 0
ds_read_b64_tr_b16 v[144:145], v12 offset:0
ds_read_b64_tr_b16 v[146:147], v12 offset:256
ds_read_b64_tr_b16 v[148:149], v12 offset:1024
ds_read_b64_tr_b16 v[150:151], v12 offset:1280
ds_read_b64_tr_b16 v[152:153], v12 offset:2048
ds_read_b64_tr_b16 v[154:155], v12 offset:2304
ds_read_b64_tr_b16 v[156:157], v12 offset:3072
ds_read_b64_tr_b16 v[158:159], v12 offset:3328
ds_read_b64_tr_b16 v[160:161], v12 offset:4096
ds_read_b64_tr_b16 v[162:163], v12 offset:4352
ds_read_b64_tr_b16 v[164:165], v12 offset:5120
ds_read_b64_tr_b16 v[166:167], v12 offset:5376
ds_read_b64_tr_b16 v[168:169], v12 offset:6144
ds_read_b64_tr_b16 v[170:171], v12 offset:6400
ds_read_b64_tr_b16 v[172:173], v12 offset:7168
ds_read_b64_tr_b16 v[174:175], v12 offset:7424
v_lshrrev_b32_e64 v7, 3, v0
v_mul_u32_u24 v7, 1024, v7
v_and_b32_e64 v14, 3, v0
v_lshl_add_u32 v7, v14, 4, v7
v_lshrrev_b32 v14, 2, v0
v_lshrrev_b32 v11, 4, v0
v_xor_b32 v14, v14, v11
v_and_b32 v14, 1, v14
v_mul_u32_u24 v14, 64, v14
v_add_u32 v14, v14, v7
s_lshl_b32 s93, s68, 14
s_lshl_b32 s77, s68, 17
s_lshl_b32 s78, s72, 7
s_add_u32 s92, s77, s78
s_sub_u32 s77, s92, 16384
s_and_b32 s97, s77, 0x7ffff
s_waitcnt lgkmcnt(0)
v_dot2c_f32_bf16 v248, s86, v144
v_dot2c_f32_bf16 v249, s86, v145
v_dot2c_f32_bf16 v248, s86, v146
v_dot2c_f32_bf16 v249, s86, v147
v_dot2c_f32_bf16 v248, s86, v148
v_dot2c_f32_bf16 v249, s86, v149
v_dot2c_f32_bf16 v248, s86, v150
v_dot2c_f32_bf16 v249, s86, v151
v_dot2c_f32_bf16 v248, s86, v152
v_dot2c_f32_bf16 v249, s86, v153
v_dot2c_f32_bf16 v248, s86, v154
v_dot2c_f32_bf16 v249, s86, v155
v_dot2c_f32_bf16 v248, s86, v156
v_dot2c_f32_bf16 v249, s86, v157
v_dot2c_f32_bf16 v248, s86, v158
v_dot2c_f32_bf16 v249, s86, v159
v_dot2c_f32_bf16 v248, s86, v160
v_dot2c_f32_bf16 v249, s86, v161
v_dot2c_f32_bf16 v248, s86, v162
v_dot2c_f32_bf16 v249, s86, v163
v_dot2c_f32_bf16 v248, s86, v164
v_dot2c_f32_bf16 v249, s86, v165
v_dot2c_f32_bf16 v248, s86, v166
v_dot2c_f32_bf16 v249, s86, v167
v_dot2c_f32_bf16 v248, s86, v168
v_dot2c_f32_bf16 v249, s86, v169
v_dot2c_f32_bf16 v248, s86, v170
v_dot2c_f32_bf16 v249, s86, v171
v_dot2c_f32_bf16 v248, s86, v172
v_dot2c_f32_bf16 v249, s86, v173
v_dot2c_f32_bf16 v248, s86, v174
v_dot2c_f32_bf16 v249, s86, v175
v_mov_b32 v7, 1
v_mov_b32_e64 v6, s22
s_waitcnt vmcnt(0)
s_mov_b64 exec, 1
buffer_store_dword v7, v6, s[36:39], 0 offen sc1
s_mov_b64 exec, -1
v_and_b32 v7, 19, v0
v_bfe_u32 v11, v0, 2, 1
v_lshl_add_u32 v7, v11, 3, v7
v_bfe_u32 v11, v0, 3, 1
v_lshl_add_u32 v7, v11, 2, v7
v_lshlrev_b32_e64 v11, 2, v7
s_mul_i32 s77, s68, 128
s_add_u32 s77, s77, 66944
v_add_u32 v11, s77, v11
v_add_f32 v248, v248, v249
v_mov_b32 v249, v248
s_nop 1
v_permlane32_swap_b32 v248, v249
v_add_f32 v248, v248, v249
ds_write_b32 v11, v248 offset:0
s_barrier
v_lshlrev_b32 v252, 2, v0
buffer_load_dword v253, v252, s[40:43], 0 offen sc1
v_and_b32 v247, 31, v0
v_lshrrev_b32 v7, 5, v0
v_lshlrev_b32_e64 v7, 10, v7
v_lshl_add_u32 v246, v247, 4, v7
v_lshlrev_b32 v247, 2, v247
v_mov_b32 v244, 0
v_mov_b32 v245, 0
s_add_u32 s11, s10, s11
v_dot2c_f32_bf16 v244, s86, v220
v_dot2c_f32_bf16 v244, s86, v221
v_dot2c_f32_bf16 v244, s86, v222
v_dot2c_f32_bf16 v244, s86, v223
v_dot2c_f32_bf16 v245, s86, v224
v_dot2c_f32_bf16 v245, s86, v225
v_dot2c_f32_bf16 v245, s86, v226
v_dot2c_f32_bf16 v245, s86, v227
v_dot2c_f32_bf16 v244, s86, v228
v_dot2c_f32_bf16 v244, s86, v229
v_dot2c_f32_bf16 v244, s86, v230
v_dot2c_f32_bf16 v244, s86, v231
v_dot2c_f32_bf16 v245, s86, v232
v_dot2c_f32_bf16 v245, s86, v233
v_dot2c_f32_bf16 v245, s86, v234
v_dot2c_f32_bf16 v245, s86, v235
s_nop 2
v_permlane16_swap_b32 v244, v245
v_add_f32 v244, v244, v245
v_mov_b32 v245, v244
s_nop 1
v_permlane32_swap_b32 v244, v245
v_add_f32_e64 v244, v244, v245
buffer_store_dwordx4 v[220:223], v1, s[36:39], s10 offen sc1
buffer_store_dwordx4 v[224:227], v1, s[36:39], s10 offen offset:1024 sc1
ds_read_b64_tr_b16 v[160:161], v4 offset:0
ds_read_b64_tr_b16 v[162:163], v4 offset:256
ds_read_b64_tr_b16 v[164:165], v4 offset:1024
ds_read_b64_tr_b16 v[166:167], v4 offset:1280
ds_read_b64_tr_b16 v[168:169], v4 offset:2048
ds_read_b64_tr_b16 v[170:171], v4 offset:2304
ds_read_b64_tr_b16 v[172:173], v4 offset:3072
ds_read_b64_tr_b16 v[174:175], v4 offset:3328
s_waitcnt lgkmcnt(6)
v_mfma_f32_32x32x16_bf16 v[144:159], v[160:163], v[16:19], 0
v_and_b32 v11, 15, v0
v_lshl_add_u32 v5, v11, 2, s23
ds_read_b64_tr_b16 v[160:161], v4 offset:4096
ds_read_b64_tr_b16 v[162:163], v4 offset:4352
s_waitcnt lgkmcnt(6)
v_mfma_f32_32x32x16_bf16 v[144:159], v[164:167], v[20:23], v[144:159]
buffer_store_dwordx4 v[228:231], v1, s[36:39], s11 offen sc1
v_lshrrev_b32 v7, 4, v0
v_mul_u32_u24 v7, 2304, v7
ds_read_b64_tr_b16 v[164:165], v4 offset:5120
ds_read_b64_tr_b16 v[166:167], v4 offset:5376
s_waitcnt lgkmcnt(6)
v_mfma_f32_32x32x16_bf16 v[144:159], v[168:171], v[24:27], v[144:159]
v_lshl_add_u32 v13, v11, 4, v7
v_lshrrev_b32 v7, 5, v0
ds_read_b64_tr_b16 v[168:169], v4 offset:6144
ds_read_b64_tr_b16 v[170:171], v4 offset:6400
s_waitcnt lgkmcnt(6)
v_mfma_f32_32x32x16_bf16 v[144:159], v[172:175], v[28:31], v[144:159]
buffer_store_dwordx4 v[232:235], v1, s[36:39], s11 offen offset:1024 sc1
v_mul_u32_u24 v7, 2304, v7
v_and_b32 v12, 31, v0
ds_read_b64_tr_b16 v[172:173], v4 offset:7168
ds_read_b64_tr_b16 v[174:175], v4 offset:7424
s_waitcnt lgkmcnt(6)
v_mfma_f32_32x32x16_bf16 v[144:159], v[160:163], v[32:35], v[144:159]
v_lshl_add_u32 v12, v12, 4, v7
s_mul_i32 s79, s70, 36864
ds_read_b64_tr_b16 v[160:161], v4 offset:8192
ds_read_b64_tr_b16 v[162:163], v4 offset:8448
s_waitcnt lgkmcnt(6)
v_mfma_f32_32x32x16_bf16 v[144:159], v[164:167], v[36:39], v[144:159]
buffer_store_dwordx4 v[236:239], v246, s[36:39], s13 offen sc1
s_add_u32 s79, s79, 1048576
s_lshl_b32 s80, s68, 9
ds_read_b64_tr_b16 v[164:165], v4 offset:9216
ds_read_b64_tr_b16 v[166:167], v4 offset:9472
s_waitcnt lgkmcnt(6)
v_mfma_f32_32x32x16_bf16 v[144:159], v[168:171], v[40:43], v[144:159]
s_add_u32 s80, s80, s79
s_lshl_b32 s100, s68, 11
ds_read_b64_tr_b16 v[168:169], v4 offset:10240
ds_read_b64_tr_b16 v[170:171], v4 offset:10496
s_waitcnt lgkmcnt(6)
v_mfma_f32_32x32x16_bf16 v[144:159], v[172:175], v[44:47], v[144:159]
buffer_store_dwordx4 v[240:243], v246, s[36:39], s13 offen offset:2048 sc1
s_mul_i32 s99, s70, 229376
s_add_u32 s99, s99, s100
ds_read_b64_tr_b16 v[172:173], v4 offset:11264
ds_read_b64_tr_b16 v[174:175], v4 offset:11520
s_waitcnt lgkmcnt(6)
v_mfma_f32_32x32x16_bf16 v[144:159], v[160:163], v[48:51], v[144:159]
buffer_store_dword v244, v247, s[36:39], s12 offen sc1
s_add_u32 s99, s99, 18874368
s_mul_i32 s101, s72, 229376
ds_read_b64_tr_b16 v[160:161], v4 offset:12288
ds_read_b64_tr_b16 v[162:163], v4 offset:12544
s_waitcnt lgkmcnt(6)
v_mfma_f32_32x32x16_bf16 v[144:159], v[164:167], v[52:55], v[144:159]
s_mul_i32 s78, s68, 57344
s_add_u32 s101, s101, s78
ds_read_b64_tr_b16 v[164:165], v4 offset:13312
ds_read_b64_tr_b16 v[166:167], v4 offset:13568
s_waitcnt lgkmcnt(6)
v_mfma_f32_32x32x16_bf16 v[144:159], v[168:171], v[56:59], v[144:159]
s_add_u32 m0, s93, 100352
s_add_u32 s94, s92, 0
buffer_load_dwordx4 v14, s[48:51], s94 offen lds
s_add_u32 s101, s101, 23068672
v_mov_b32 v188, 0
ds_read_b64_tr_b16 v[168:169], v4 offset:14336
ds_read_b64_tr_b16 v[170:171], v4 offset:14592
s_waitcnt lgkmcnt(6)
v_mfma_f32_32x32x16_bf16 v[144:159], v[172:175], v[60:63], v[144:159]
v_mov_b32 v189, 0
v_mov_b32_e64 v190, 0
ds_read_b64_tr_b16 v[172:173], v4 offset:15360
ds_read_b64_tr_b16 v[174:175], v4 offset:15616
s_waitcnt lgkmcnt(6)
v_mfma_f32_32x32x16_bf16 v[144:159], v[160:163], v[64:67], v[144:159]
s_add_u32 m0, s93, 101376
s_add_u32 s94, s92, 8192
buffer_load_dwordx4 v14, s[48:51], s94 offen lds
v_mov_b32 v191, 0
v_mov_b32_e64 v192, 0
ds_read_b64_tr_b16 v[160:161], v4 offset:16384
ds_read_b64_tr_b16 v[162:163], v4 offset:16640
s_waitcnt lgkmcnt(6)
v_mfma_f32_32x32x16_bf16 v[144:159], v[164:167], v[68:71], v[144:159]
v_mov_b32 v193, 0
v_mov_b32_e64 v194, 0
ds_read_b64_tr_b16 v[164:165], v4 offset:17408
ds_read_b64_tr_b16 v[166:167], v4 offset:17664
s_waitcnt lgkmcnt(6)
v_mfma_f32_32x32x16_bf16 v[144:159], v[168:171], v[72:75], v[144:159]
s_add_u32 m0, s93, 102400
s_add_u32 s94, s92, 16384
buffer_load_dwordx4 v14, s[48:51], s94 offen lds
v_mov_b32 v195, 0
v_lshlrev_b32_e64 v11, 1, v0
ds_read_b64_tr_b16 v[168:169], v4 offset:18432
ds_read_b64_tr_b16 v[170:171], v4 offset:18688
s_waitcnt lgkmcnt(6)
v_mfma_f32_32x32x16_bf16 v[144:159], v[172:175], v[76:79], v[144:159]
v_lshrrev_b32 v7, 5, v0
v_and_or_b32 v11, v11, 62, v7
ds_read_b64_tr_b16 v[172:173], v4 offset:19456
ds_read_b64_tr_b16 v[174:175], v4 offset:19712
s_waitcnt lgkmcnt(6)
v_mfma_f32_32x32x16_bf16 v[144:159], v[160:163], v[80:83], v[144:159]
s_add_u32 m0, s93, 103424
s_add_u32 s94, s92, 24576
buffer_load_dwordx4 v14, s[48:51], s94 offen lds
v_bfe_u32 v7, v11, 4, 1
v_lshlrev_b32 v7, 11, v7
ds_read_b64_tr_b16 v[160:161], v4 offset:20480
ds_read_b64_tr_b16 v[162:163], v4 offset:20736
s_waitcnt lgkmcnt(6)
v_mfma_f32_32x32x16_bf16 v[144:159], v[164:167], v[84:87], v[144:159]
v_and_b32 v11, 47, v11
v_lshl_add_u32 v7, v11, 4, v7
ds_read_b64_tr_b16 v[164:165], v4 offset:21504
ds_read_b64_tr_b16 v[166:167], v4 offset:21760
s_waitcnt lgkmcnt(6)
v_mfma_f32_32x32x16_bf16 v[144:159], v[168:171], v[88:91], v[144:159]
s_add_u32 m0, s93, 104448
s_add_u32 s94, s92, 32768
buffer_load_dwordx4 v14, s[48:51], s94 offen lds
s_lshl_b32 s77, s74, 10
s_lshl_b32 s78, s75, 3
ds_read_b64_tr_b16 v[168:169], v4 offset:22528
ds_read_b64_tr_b16 v[170:171], v4 offset:22784
s_waitcnt lgkmcnt(6)
v_mfma_f32_32x32x16_bf16 v[144:159], v[172:175], v[92:95], v[144:159]
s_add_u32 s77, s77, s78
s_add_u32 s77, s77, 92160
ds_read_b64_tr_b16 v[172:173], v4 offset:23552
ds_read_b64_tr_b16 v[174:175], v4 offset:23808
s_waitcnt lgkmcnt(6)
v_mfma_f32_32x32x16_bf16 v[144:159], v[160:163], v[96:99], v[144:159]
s_add_u32 m0, s93, 105472
s_add_u32 s94, s92, 40960
buffer_load_dwordx4 v14, s[48:51], s94 offen lds
v_add_u32 v196, s77, v7
v_and_b32 v7, 31, v0
ds_read_b64_tr_b16 v[160:161], v4 offset:24576
ds_read_b64_tr_b16 v[162:163], v4 offset:24832
s_waitcnt lgkmcnt(6)
v_mfma_f32_32x32x16_bf16 v[144:159], v[164:167], v[100:103], v[144:159]
v_min_u32 v7, 16, v7
v_and_b32_e64 v11, 32, v0
ds_read_b64_tr_b16 v[164:165], v4 offset:25600
ds_read_b64_tr_b16 v[166:167], v4 offset:25856
s_waitcnt lgkmcnt(6)
v_mfma_f32_32x32x16_bf16 v[144:159], v[168:171], v[104:107], v[144:159]
s_add_u32 m0, s93, 106496
s_add_u32 s94, s92, 49152
buffer_load_dwordx4 v14, s[48:51], s94 offen lds
v_add_u32 v7, v7, v11
v_lshlrev_b32_e64 v7, 4, v7
ds_read_b64_tr_b16 v[168:169], v4 offset:26624
ds_read_b64_tr_b16 v[170:171], v4 offset:26880
s_waitcnt lgkmcnt(6)
v_mfma_f32_32x32x16_bf16 v[144:159], v[172:175], v[108:111], v[144:159]
v_add_u32 v197, 92160, v7
s_lshl_b32 s77, s71, 15
ds_read_b64_tr_b16 v[172:173], v4 offset:27648
ds_read_b64_tr_b16 v[174:175], v4 offset:27904
s_waitcnt lgkmcnt(6)
v_mfma_f32_32x32x16_bf16 v[144:159], v[160:163], v[112:115], v[144:159]
s_add_u32 m0, s93, 107520
s_add_u32 s94, s92, 57344
buffer_load_dwordx4 v14, s[48:51], s94 offen lds
s_lshl_b32 s78, s70, 11
s_add_u32 s77, s77, s78
ds_read_b64_tr_b16 v[160:161], v4 offset:28672
ds_read_b64_tr_b16 v[162:163], v4 offset:28928
s_waitcnt lgkmcnt(6)
v_mfma_f32_32x32x16_bf16 v[144:159], v[164:167], v[116:119], v[144:159]
s_add_u32 s82, s77, 4194304
v_bfe_u32 v7, v0, 2, 2
ds_read_b64_tr_b16 v[164:165], v4 offset:29696
ds_read_b64_tr_b16 v[166:167], v4 offset:29952
s_waitcnt lgkmcnt(6)
v_mfma_f32_32x32x16_bf16 v[144:159], v[168:171], v[120:123], v[144:159]
s_add_u32 m0, s93, 108544
s_add_u32 s94, s92, 65536
buffer_load_dwordx4 v14, s[48:51], s94 offen lds
v_lshlrev_b32 v7, 10, v7
v_and_b32_e64 v11, 1, v0
ds_read_b64_tr_b16 v[168:169], v4 offset:30720
ds_read_b64_tr_b16 v[170:171], v4 offset:30976
s_waitcnt lgkmcnt(6)
v_mfma_f32_32x32x16_bf16 v[144:159], v[172:175], v[124:127], v[144:159]
v_lshl_add_u32 v7, v11, 9, v7
v_bfe_u32 v11, v0, 1, 1
ds_read_b64_tr_b16 v[172:173], v4 offset:31744
ds_read_b64_tr_b16 v[174:175], v4 offset:32000
s_waitcnt lgkmcnt(6)
v_mfma_f32_32x32x16_bf16 v[144:159], v[160:163], v[128:131], v[144:159]
s_add_u32 m0, s93, 109568
s_add_u32 s94, s92, 73728
buffer_load_dwordx4 v14, s[48:51], s94 offen lds
v_lshl_add_u32 v7, v11, 3, v7
v_add_u32 v198, 92416, v7
s_waitcnt lgkmcnt(4)
v_mfma_f32_32x32x16_bf16 v[144:159], v[164:167], v[132:135], v[144:159]
s_waitcnt lgkmcnt(2)
v_mfma_f32_32x32x16_bf16 v[144:159], v[168:171], v[136:139], v[144:159]
s_add_u32 m0, s93, 110592
s_add_u32 s94, s92, 81920
buffer_load_dwordx4 v14, s[48:51], s94 offen lds
s_waitcnt vmcnt(18)
v_add_u32 v11, 0x7f7f7f7f, v253
v_and_b32 v11, 0x80808080, v11
v_cmp_ne_u32 vcc, 0x80808080, v11
s_nop 0
s_cbranch_vccz Lgo_10
Lpoll_9:
s_sleep 8
buffer_load_dword v253, v252, s[40:43], 0 offen sc1
s_waitcnt vmcnt(0)
v_add_u32 v11, 0x7f7f7f7f, v253
v_and_b32 v11, 0x80808080, v11
v_cmp_ne_u32 vcc, 0x80808080, v11
s_nop 0
s_cbranch_vccz Lgo_10
s_add_u32 s91, s91, 1
s_bitcmp0_b32 s91, 16
s_cbranch_scc1 Lpoll_9
Lgo_10:
v_mov_b32_e64 v11, 0
v_bfe_u32 v7, v253, 0, 4
v_lshlrev_b32 v7, v7, 1
v_or_b32_e64 v11, v11, v7
v_bfe_u32 v7, v253, 8, 4
v_lshlrev_b32 v7, v7, 1
v_or_b32_e64 v11, v11, v7
v_bfe_u32 v7, v253, 16, 4
v_lshlrev_b32 v7, v7, 1
v_or_b32_e64 v11, v11, v7
v_bfe_u32 v7, v253, 24, 4
v_lshlrev_b32 v7, v7, 1
v_or_b32 v11, v11, v7
s_nop 1
v_or_b32_dpp v11, v11, v11 quad_perm:[1,0,3,2] row_mask:0xf bank_mask:0xf
v_cmp_ne_u32 vcc, 0x1fe, v11
s_nop 0
s_cbranch_vccnz L_slow
s_waitcnt lgkmcnt(0)
v_mfma_f32_32x32x16_bf16 v[144:159], v[172:175], v[140:143], v[144:159]
s_add_u32 m0, s93, 111616
s_add_u32 s94, s92, 90112
buffer_load_dwordx4 v14, s[48:51], s94 offen lds
s_add_u32 m0, s93, 112640
s_add_u32 s94, s92, 98304
buffer_load_dwordx4 v14, s[48:51], s94 offen lds
s_add_u32 m0, s93, 113664
s_add_u32 s94, s92, 106496
buffer_load_dwordx4 v14, s[48:51], s94 offen lds
buffer_load_dword v6, v5, s[36:39], 0 offen sc1
s_waitcnt vmcnt(15)
s_waitcnt lgkmcnt(0)
s_barrier
s_cmp_lg_u32 s68, 3
s_cbranch_scc1 Lpd_11
s_lshl_b32 s77, s2, 2
s_add_u32 s77, s77, 12288
v_mov_b32 v7, 1
v_mov_b32 v11, s77
s_mov_b64 exec, 1
buffer_store_dword v7, v11, s[36:39], 0 offen sc1
s_mov_b64 exec, -1
Lpd_11:
v_lshlrev_b32 v7, 2, v0
v_and_b32 v7, 127, v7
v_add_u32 v11, 66944, v7
ds_read_b32 v208, v11 offset:0
ds_read_b32 v209, v11 offset:128
ds_read_b32 v210, v11 offset:256
ds_read_b32 v211, v11 offset:384
v_add_u32 v11, 65792, v7
s_waitcnt lgkmcnt(0)
v_add_f32 v208, v208, v209
v_add_f32 v210, v210, v211
v_add_f32 v208, v208, v210
ds_write_b32 v11, v208
ds_read_b128 v[160:163], v10 offset:256
ds_read_b128 v[164:167], v10 offset:272
ds_read_b128 v[168:171], v10 offset:320
ds_read_b128 v[172:175], v10 offset:336
s_waitcnt lgkmcnt(0)
v_pk_fma_f32 v[144:145], v[160:161], v[8:9], v[144:145] op_sel_hi:[1,0,1]
v_pk_fma_f32 v[146:147], v[162:163], v[8:9], v[146:147] op_sel_hi:[1,0,1]
v_pk_fma_f32 v[148:149], v[164:165], v[8:9], v[148:149] op_sel_hi:[1,0,1]
v_pk_fma_f32 v[150:151], v[166:167], v[8:9], v[150:151] op_sel_hi:[1,0,1]
v_pk_fma_f32 v[152:153], v[168:169], v[8:9], v[152:153] op_sel_hi:[1,0,1]
v_pk_fma_f32 v[154:155], v[170:171], v[8:9], v[154:155] op_sel_hi:[1,0,1]
v_pk_fma_f32 v[156:157], v[172:173], v[8:9], v[156:157] op_sel_hi:[1,0,1]
v_pk_fma_f32 v[158:159], v[174:175], v[8:9], v[158:159] op_sel_hi:[1,0,1]
v_pk_mul_f32 v[144:145], v[144:145], v[8:9] op_sel:[0,1] op_sel_hi:[1,1]
v_pk_mul_f32 v[146:147], v[146:147], v[8:9] op_sel:[0,1] op_sel_hi:[1,1]
v_pk_mul_f32 v[148:149], v[148:149], v[8:9] op_sel:[0,1] op_sel_hi:[1,1]
v_pk_mul_f32 v[150:151], v[150:151], v[8:9] op_sel:[0,1] op_sel_hi:[1,1]
v_pk_mul_f32 v[152:153], v[152:153], v[8:9] op_sel:[0,1] op_sel_hi:[1,1]
v_pk_mul_f32 v[154:155], v[154:155], v[8:9] op_sel:[0,1] op_sel_hi:[1,1]
v_pk_mul_f32 v[156:157], v[156:157], v[8:9] op_sel:[0,1] op_sel_hi:[1,1]
v_pk_mul_f32 v[158:159], v[158:159], v[8:9] op_sel:[0,1] op_sel_hi:[1,1]
v_cvt_pk_bf16_f32 v176, v144, v145
v_cvt_pk_bf16_f32 v177, v146, v147
v_cvt_pk_bf16_f32 v178, v148, v149
v_cvt_pk_bf16_f32 v179, v150, v151
v_cvt_pk_bf16_f32 v180, v152, v153
v_cvt_pk_bf16_f32 v181, v154, v155
v_cvt_pk_bf16_f32 v182, v156, v157
v_cvt_pk_bf16_f32 v183, v158, v159
v_mfma_f32_32x32x16_bf16 v[144:159], a[232:235], v[176:179], 0
s_nop 0
v_mfma_f32_32x32x16_bf16 v[200:215], a[236:239], v[180:183], 0
s_waitcnt vmcnt(0)
v_cmp_gt_u32 vcc, 1, v6
s_nop 0
s_cbranch_vccz Lgo_13
Lpoll_12:
s_sleep 1
buffer_load_dword v6, v5, s[36:39], 0 offen sc1
s_waitcnt vmcnt(0)
v_cmp_gt_u32 vcc, 1, v6
s_nop 0
s_cbranch_vccz Lgo_13
s_add_u32 s91, s91, 1
s_bitcmp0_b32 s91, 16
s_cbranch_scc1 Lpoll_12
Lgo_13:
s_cmp_lg_u32 s68, 0
s_cbranch_scc1 Lzld_14
buffer_load_dwordx4 v[16:19], v13, s[36:39], s79 offen offset:2048 sc1
s_add_u32 s79, s79, 9216
buffer_load_dwordx4 v[20:23], v13, s[36:39], s79 offen offset:2048 sc1
s_add_u32 s79, s79, 9216
buffer_load_dwordx4 v[24:27], v13, s[36:39], s79 offen offset:2048 sc1
s_add_u32 s79, s79, 9216
buffer_load_dwordx4 v[28:31], v13, s[36:39], s79 offen offset:2048 sc1
Lzld_14:
buffer_load_dwordx4 v[220:223], v12, s[36:39], s80 offen sc1
s_add_u32 s80, s80, 4608
buffer_load_dwordx4 v[224:227], v12, s[36:39], s80 offen sc1
s_add_u32 s80, s80, 4608
buffer_load_dwordx4 v[228:231], v12, s[36:39], s80 offen sc1
s_add_u32 s80, s80, 4608
buffer_load_dwordx4 v[232:235], v12, s[36:39], s80 offen sc1
v_max3_f32 v176, v144, v145, v146
v_max3_f32 v177, v147, v148, v149
v_max3_f32 v176, v150, v151, v176
v_max_f32_e64 v176, v176, v177
v_max3_f32 v178, v152, v153, v154
v_max3_f32 v179, v155, v156, v157
v_max3_f32 v178, v158, v159, v178
v_max_f32_e64 v178, v178, v179
v_max3_f32 v180, v200, v201, v202
v_max3_f32 v181, v203, v204, v205
s_add_u32 s80, s80, 4608
buffer_load_dwordx4 v[236:239], v12, s[36:39], s80 offen sc1
v_max3_f32 v180, v206, v207, v180
v_max_f32_e64 v180, v180, v181
v_max3_f32 v182, v208, v209, v210
v_max3_f32 v183, v211, v212, v213
v_max3_f32 v182, v214, v215, v182
v_max_f32 v182, v182, v183
v_permlane32_swap_b32 v176, v178
s_nop 0
v_permlane32_swap_b32 v180, v182
s_add_u32 s80, s80, 4608
buffer_load_dwordx4 v[240:243], v12, s[36:39], s80 offen sc1
v_max_f32 v176, v176, v178
v_max_f32 v180, v180, v182
v_mov_b32 v178, v176
v_mov_b32 v182, v180
s_nop 0
v_permlane32_swap_b32 v176, v178
v_permlane32_swap_b32_e64 v180, v182
v_mul_f32 v176, 0xbfb8aa3b, v176
v_mul_f32 v178, 0xbfb8aa3b, v178
s_add_u32 s80, s80, 4608
buffer_load_dwordx4 v[244:247], v12, s[36:39], s80 offen sc1
v_mul_f32 v180, 0xbfb8aa3b, v180
v_mul_f32 v182, 0xbfb8aa3b, v182
v_pk_fma_f32 v[144:145], v[144:145], s[84:85], v[176:177] op_sel_hi:[1,1,0]
v_pk_fma_f32 v[146:147], v[146:147], s[84:85], v[176:177] op_sel_hi:[1,1,0]
v_pk_fma_f32 v[148:149], v[148:149], s[84:85], v[176:177] op_sel_hi:[1,1,0]
v_pk_fma_f32 v[150:151], v[150:151], s[84:85], v[176:177] op_sel_hi:[1,1,0]
v_pk_fma_f32 v[152:153], v[152:153], s[84:85], v[178:179] op_sel_hi:[1,1,0]
v_pk_fma_f32 v[154:155], v[154:155], s[84:85], v[178:179] op_sel_hi:[1,1,0]
v_pk_fma_f32 v[156:157], v[156:157], s[84:85], v[178:179] op_sel_hi:[1,1,0]
v_pk_fma_f32 v[158:159], v[158:159], s[84:85], v[178:179] op_sel_hi:[1,1,0]
s_add_u32 s80, s80, 4608
buffer_load_dwordx4 v[248:251], v12, s[36:39], s80 offen sc1
v_pk_fma_f32 v[200:201], v[200:201], s[84:85], v[180:181] op_sel_hi:[1,1,0]
v_pk_fma_f32 v[202:203], v[202:203], s[84:85], v[180:181] op_sel_hi:[1,1,0]
v_pk_fma_f32 v[204:205], v[204:205], s[84:85], v[180:181] op_sel_hi:[1,1,0]
v_pk_fma_f32 v[206:207], v[206:207], s[84:85], v[180:181] op_sel_hi:[1,1,0]
v_pk_fma_f32 v[208:209], v[208:209], s[84:85], v[182:183] op_sel_hi:[1,1,0]
v_pk_fma_f32 v[210:211], v[210:211], s[84:85], v[182:183] op_sel_hi:[1,1,0]
v_pk_fma_f32 v[212:213], v[212:213], s[84:85], v[182:183] op_sel_hi:[1,1,0]
v_pk_fma_f32 v[214:215], v[214:215], s[84:85], v[182:183] op_sel_hi:[1,1,0]
v_exp_f32 v144, v144
v_exp_f32 v145, v145
v_exp_f32 v146, v146
v_exp_f32 v147, v147
v_exp_f32_e64 v148, v148
s_add_u32 m0, s93, 98304
s_add_u32 s94, s97, 0
buffer_load_dwordx4 v14, s[48:51], s94 offen lds
v_exp_f32 v149, v149
v_exp_f32 v150, v150
v_exp_f32 v151, v151
v_exp_f32 v152, v152
v_exp_f32 v153, v153
v_exp_f32 v154, v154
v_exp_f32 v155, v155
v_exp_f32 v156, v156
v_exp_f32 v157, v157
s_add_u32 m0, s93, 99328
s_add_u32 s94, s97, 8192
buffer_load_dwordx4 v14, s[48:51], s94 offen lds
v_exp_f32 v158, v158
v_exp_f32 v159, v159
v_exp_f32 v200, v200
v_exp_f32 v201, v201
v_exp_f32 v202, v202
v_exp_f32 v203, v203
v_exp_f32 v204, v204
v_exp_f32 v205, v205
v_exp_f32 v206, v206
v_exp_f32 v207, v207
v_exp_f32 v208, v208
v_exp_f32 v209, v209
v_exp_f32 v210, v210
v_exp_f32 v211, v211
v_exp_f32 v212, v212
v_exp_f32 v213, v213
v_exp_f32 v214, v214
v_exp_f32 v215, v215
v_pk_add_f32 v[176:177], v[144:145], v[146:147]
v_pk_add_f32 v[184:185], v[148:149], v[150:151]
v_pk_add_f32 v[176:177], v[176:177], v[184:185]
v_add_f32_e64 v176, v176, v177
v_pk_add_f32 v[178:179], v[152:153], v[154:155]
v_pk_add_f32 v[184:185], v[156:157], v[158:159]
v_pk_add_f32 v[178:179], v[178:179], v[184:185]
v_add_f32_e64 v178, v178, v179
v_pk_add_f32 v[180:181], v[200:201], v[202:203]
v_pk_add_f32 v[184:185], v[204:205], v[206:207]
v_pk_add_f32 v[180:181], v[180:181], v[184:185]
v_add_f32_e64 v180, v180, v181
v_pk_add_f32 v[182:183], v[208:209], v[210:211]
v_pk_add_f32 v[184:185], v[212:213], v[214:215]
v_pk_add_f32 v[182:183], v[182:183], v[184:185]
v_add_f32 v182, v182, v183
v_permlane32_swap_b32 v176, v178
s_nop 0
v_permlane32_swap_b32 v180, v182
v_add_f32 v176, v176, v178
v_add_f32 v180, v180, v182
v_mov_b32 v178, v176
v_mov_b32 v182, v180
s_nop 0
v_permlane32_swap_b32 v176, v178
v_permlane32_swap_b32 v180, v182
v_rcp_f32 v176, v176
v_rcp_f32 v178, v178
v_rcp_f32 v180, v180
v_rcp_f32_e64 v182, v182
v_pk_mul_f32 v[144:145], v[144:145], v[176:177] op_sel_hi:[1,0]
v_pk_mul_f32 v[146:147], v[146:147], v[176:177] op_sel_hi:[1,0]
v_pk_mul_f32 v[148:149], v[148:149], v[176:177] op_sel_hi:[1,0]
v_pk_mul_f32 v[150:151], v[150:151], v[176:177] op_sel_hi:[1,0]
v_pk_mul_f32 v[152:153], v[152:153], v[178:179] op_sel_hi:[1,0]
v_pk_mul_f32 v[154:155], v[154:155], v[178:179] op_sel_hi:[1,0]
v_pk_mul_f32 v[156:157], v[156:157], v[178:179] op_sel_hi:[1,0]
v_pk_mul_f32 v[158:159], v[158:159], v[178:179] op_sel_hi:[1,0]
v_pk_mul_f32 v[200:201], v[200:201], v[180:181] op_sel_hi:[1,0]
v_pk_mul_f32 v[202:203], v[202:203], v[180:181] op_sel_hi:[1,0]
v_pk_mul_f32 v[204:205], v[204:205], v[180:181] op_sel_hi:[1,0]
v_pk_mul_f32 v[206:207], v[206:207], v[180:181] op_sel_hi:[1,0]
v_pk_mul_f32 v[208:209], v[208:209], v[182:183] op_sel_hi:[1,0]
v_pk_mul_f32 v[210:211], v[210:211], v[182:183] op_sel_hi:[1,0]
v_pk_mul_f32 v[212:213], v[212:213], v[182:183] op_sel_hi:[1,0]
v_pk_mul_f32 v[214:215], v[214:215], v[182:183] op_sel_hi:[1,0]
v_cvt_pk_bf16_f32 v160, v144, v145
v_cvt_pk_bf16_f32 v161, v146, v147
v_cvt_pk_bf16_f32 v162, v148, v149
v_cvt_pk_bf16_f32 v163, v150, v151
v_cvt_pk_bf16_f32 v164, v152, v153
v_cvt_pk_bf16_f32 v165, v154, v155
v_cvt_pk_bf16_f32 v166, v156, v157
v_cvt_pk_bf16_f32 v167, v158, v159
v_cvt_pk_bf16_f32 v168, v200, v201
v_cvt_pk_bf16_f32 v169, v202, v203
v_cvt_pk_bf16_f32 v170, v204, v205
v_cvt_pk_bf16_f32 v171, v206, v207
v_cvt_pk_bf16_f32 v172, v208, v209
v_cvt_pk_bf16_f32 v173, v210, v211
v_cvt_pk_bf16_f32 v174, v212, v213
v_cvt_pk_bf16_f32 v175, v214, v215
s_cmp_lg_u32 s68, 0
s_cbranch_scc1 Lzsum_15
s_waitcnt vmcnt(10)
v_pk_add_f32 v[16:17], v[16:17], v[20:21]
v_pk_add_f32 v[24:25], v[24:25], v[28:29]
v_pk_add_f32 v[18:19], v[18:19], v[22:23]
v_pk_add_f32 v[26:27], v[26:27], v[30:31]
v_pk_add_f32 v[16:17], v[16:17], v[24:25]
v_pk_add_f32 v[18:19], v[18:19], v[26:27]
v_mov_b32 v20, v16
v_mov_b32 v21, v17
v_mov_b32 v22, v18
v_mov_b32 v23, v19
v_permlane16_swap_b32 v16, v20
v_permlane16_swap_b32 v17, v21
v_permlane16_swap_b32 v18, v22
v_permlane16_swap_b32 v19, v23
v_add_f32 v16, v16, v20
v_add_f32 v17, v17, v21
v_add_f32 v18, v18, v22
v_add_f32 v19, v19, v23
v_mov_b32 v20, v16
v_mov_b32 v21, v17
v_mov_b32 v22, v18
v_mov_b32 v23, v19
v_permlane32_swap_b32 v16, v20
v_permlane32_swap_b32 v17, v21
v_permlane32_swap_b32 v18, v22
v_permlane32_swap_b32 v19, v23
v_add_f32 v16, v16, v20
v_add_f32 v17, v17, v21
v_add_f32 v18, v18, v22
v_add_f32_e64 v19, v19, v23
v_cvt_pk_bf16_f32 v16, v16, v17
v_cvt_pk_bf16_f32 v17, v18, v19
ds_write_b64 v198, v[16:17]
Lzsum_15:
s_waitcnt vmcnt(9)
v_dot2c_f32_bf16 v188, s87, v220
v_dot2c_f32_bf16 v189, s88, v220
v_dot2c_f32_bf16 v190, s87, v221
v_dot2c_f32_bf16 v191, s88, v221
v_dot2c_f32_bf16 v192, s87, v222
v_dot2c_f32_bf16 v193, s88, v222
v_dot2c_f32_bf16 v194, s87, v223
v_dot2c_f32_bf16 v195, s88, v223
s_waitcnt vmcnt(8)
v_dot2c_f32_bf16 v188, s87, v224
v_dot2c_f32_bf16 v189, s88, v224
v_dot2c_f32_bf16 v190, s87, v225
v_dot2c_f32_bf16 v191, s88, v225
v_dot2c_f32_bf16 v192, s87, v226
v_dot2c_f32_bf16 v193, s88, v226
v_dot2c_f32_bf16 v194, s87, v227
v_dot2c_f32_bf16 v195, s88, v227
s_waitcnt vmcnt(7)
v_dot2c_f32_bf16 v188, s87, v228
v_dot2c_f32_bf16 v189, s88, v228
v_dot2c_f32_bf16 v190, s87, v229
v_dot2c_f32_bf16 v191, s88, v229
v_dot2c_f32_bf16 v192, s87, v230
v_dot2c_f32_bf16 v193, s88, v230
v_dot2c_f32_bf16 v194, s87, v231
v_dot2c_f32_bf16 v195, s88, v231
s_waitcnt vmcnt(6)
v_dot2c_f32_bf16 v188, s87, v232
v_dot2c_f32_bf16 v189, s88, v232
v_dot2c_f32_bf16 v190, s87, v233
v_dot2c_f32_bf16 v191, s88, v233
v_dot2c_f32_bf16 v192, s87, v234
v_dot2c_f32_bf16 v193, s88, v234
v_dot2c_f32_bf16 v194, s87, v235
v_dot2c_f32_bf16 v195, s88, v235
s_waitcnt vmcnt(5)
v_dot2c_f32_bf16 v188, s87, v236
v_dot2c_f32_bf16 v189, s88, v236
v_dot2c_f32_bf16 v190, s87, v237
v_dot2c_f32_bf16 v191, s88, v237
v_dot2c_f32_bf16 v192, s87, v238
v_dot2c_f32_bf16 v193, s88, v238
v_dot2c_f32_bf16 v194, s87, v239
v_dot2c_f32_bf16 v195, s88, v239
s_waitcnt vmcnt(4)
v_dot2c_f32_bf16 v188, s87, v240
v_dot2c_f32_bf16 v189, s88, v240
v_dot2c_f32_bf16 v190, s87, v241
v_dot2c_f32_bf16 v191, s88, v241
v_dot2c_f32_bf16 v192, s87, v242
v_dot2c_f32_bf16 v193, s88, v242
v_dot2c_f32_bf16 v194, s87, v243
v_dot2c_f32_bf16 v195, s88, v243
s_waitcnt vmcnt(3)
v_dot2c_f32_bf16 v188, s87, v244
v_dot2c_f32_bf16 v189, s88, v244
v_dot2c_f32_bf16 v190, s87, v245
v_dot2c_f32_bf16 v191, s88, v245
v_dot2c_f32_bf16 v192, s87, v246
v_dot2c_f32_bf16 v193, s88, v246
v_dot2c_f32_bf16 v194, s87, v247
v_dot2c_f32_bf16 v195, s88, v247
s_waitcnt vmcnt(2)
v_dot2c_f32_bf16 v188, s87, v248
v_dot2c_f32_bf16 v189, s88, v248
v_dot2c_f32_bf16 v190, s87, v249
v_dot2c_f32_bf16 v191, s88, v249
v_dot2c_f32_bf16 v192, s87, v250
v_dot2c_f32_bf16 v193, s88, v250
v_dot2c_f32_bf16 v194, s87, v251
v_dot2c_f32_bf16 v195, s88, v251
v_permlane32_swap_b32 v188, v192
v_permlane32_swap_b32 v189, v193
v_permlane32_swap_b32 v190, v194
v_permlane32_swap_b32 v191, v195
v_pk_add_f32 v[188:189], v[188:189], v[192:193]
v_pk_add_f32 v[190:191], v[190:191], v[194:195]
v_cvt_pk_bf16_f32 v188, v188, v189
v_cvt_pk_bf16_f32 v189, v190, v191
ds_write_b64 v196, v[188:189]
s_waitcnt vmcnt(0)
s_waitcnt lgkmcnt(0)
s_barrier
ds_read_b128 v[176:179], v197 offset:0
ds_read_b128 v[180:183], v197 offset:1024
ds_read_b128 v[184:187], v197 offset:2048
ds_read_b128 v[188:191], v197 offset:3072
s_waitcnt lgkmcnt(0)
v_mfma_f32_32x32x16_bf16 v[200:215], v[176:179], v[160:163], 0
v_mfma_f32_32x32x16_bf16 v[200:215], v[180:183], v[164:167], v[200:215]
v_mfma_f32_32x32x16_bf16 v[216:231], v[184:187], v[168:171], 0
v_mfma_f32_32x32x16_bf16 v[216:231], v[188:191], v[172:175], v[216:231]
s_nop 9
v_add_f32 v208, 0x358637bd, v208
v_rcp_f32_e64 v208, v208
s_nop 0
v_pk_mul_f32 v[200:201], v[200:201], v[208:209] op_sel_hi:[1,0]
v_pk_mul_f32 v[202:203], v[202:203], v[208:209] op_sel_hi:[1,0]
v_pk_mul_f32 v[204:205], v[204:205], v[208:209] op_sel_hi:[1,0]
v_pk_mul_f32 v[206:207], v[206:207], v[208:209] op_sel_hi:[1,0]
v_cvt_pk_bf16_f32 v212, v200, v201
v_cvt_pk_bf16_f32 v213, v202, v203
v_cvt_pk_bf16_f32 v214, v204, v205
v_cvt_pk_bf16_f32 v215, v206, v207
buffer_store_dwordx4 v[212:215], v1, s[36:39], s82 offen sc1
v_add_f32 v224, 0x358637bd, v224
v_rcp_f32 v224, v224
s_nop 0
v_pk_mul_f32 v[216:217], v[216:217], v[224:225] op_sel_hi:[1,0]
v_pk_mul_f32 v[218:219], v[218:219], v[224:225] op_sel_hi:[1,0]
v_pk_mul_f32 v[220:221], v[220:221], v[224:225] op_sel_hi:[1,0]
v_pk_mul_f32 v[222:223], v[222:223], v[224:225] op_sel_hi:[1,0]
v_cvt_pk_bf16_f32 v228, v216, v217
v_cvt_pk_bf16_f32 v229, v218, v219
v_cvt_pk_bf16_f32 v230, v220, v221
v_cvt_pk_bf16_f32 v231, v222, v223
buffer_store_dwordx4 v[228:231], v1, s[36:39], s82 offen offset:1024 sc1
s_lshl_b32 s77, s74, 15
s_add_u32 s77, s77, 100352
s_mul_i32 s78, s74, 4294934528
s_add_u32 s78, s78, 131072
v_add_u32 v7, s77, v2
v_add_u32_e64 v11, s77, v3
ds_read_b64_tr_b16 v[16:17], v7 offset:0
ds_read_b64_tr_b16 v[18:19], v7 offset:512
ds_read_b64_tr_b16 v[20:21], v11 offset:0
ds_read_b64_tr_b16 v[22:23], v11 offset:512
ds_read_b64_tr_b16 v[24:25], v7 offset:2048
ds_read_b64_tr_b16 v[26:27], v7 offset:2560
ds_read_b64_tr_b16 v[28:29], v11 offset:2048
ds_read_b64_tr_b16 v[30:31], v11 offset:2560
ds_read_b64_tr_b16 v[32:33], v7 offset:4096
ds_read_b64_tr_b16 v[34:35], v7 offset:4608
ds_read_b64_tr_b16 v[36:37], v11 offset:4096
ds_read_b64_tr_b16 v[38:39], v11 offset:4608
s_lshl_b32 s80, s69, 2
s_lshl_b32 s77, s73, 1
s_add_u32 s80, s80, s77
s_add_u32 s80, s80, s75
s_lshl_b32 s81, s80, 12
s_lshl_b32 s77, s72, 9
s_add_u32 s81, s81, s77
s_lshl_b32 s77, s74, 3
s_add_u32 s81, s81, s77
s_lshl_b32 s80, s80, 15
s_lshl_b32 s77, s72, 7
s_lshl_b32 s78, s74, 6
s_add_u32 s77, s77, s78
s_add_u32 s79, s80, s77
s_lshl_b32 s77, s77, 5
s_add_u32 s80, s80, s77
v_and_b32 v7, 31, v0
v_lshrrev_b32 v11, 5, v0
v_lshlrev_b32_e64 v14, 10, v7
v_lshl_add_u32 v14, v11, 4, v14
v_lshlrev_b32_e64 v7, 4, v7
v_lshl_add_u32 v5, v11, 2, v7
s_lshl_b32 s77, s73, 1
s_add_u32 s77, s77, s75
s_lshl_b32 s82, s69, 2
s_add_u32 s82, s82, s77
s_lshl_b32 s77, s82, 6
s_lshl_b32 s78, s74, 5
s_add_u32 s77, s77, s78
v_and_b32 v252, 7, v0
v_lshl_add_u32 v252, v252, 2, s77
s_lshl_b32 s82, s82, 15
s_lshl_b32 s78, s74, 14
s_add_u32 s82, s82, s78
s_add_u32 s89, s82, 4194304
s_xor_b32 s77, s68, 2
s_lshl_b32 s77, s77, 12
s_add_u32 s77, s77, 141312
v_add_u32_e64 v12, s77, v1
s_lshl_b32 s77, s68, 12
s_add_u32 s77, s77, 141312
v_add_u32 v13, s77, v1
v_mov_b32 v7, 1
v_mov_b32_e64 v6, s83
s_waitcnt vmcnt(0)
s_mov_b64 exec, 1
buffer_store_dword v7, v6, s[36:39], 0 offen
s_mov_b64 exec, -1
buffer_load_dwordx4 v[240:243], v14, s[28:31], s79 offen
buffer_load_dwordx4 v[244:247], v14, s[28:31], s79 offen offset:32
s_lshr_b32 s94, s2, 3
s_lshl_b32 s94, s94, 2
s_add_u32 s94, s94, s68
s_lshl_b32 s94, s94, 8
v_and_b32 v254, 1, v0
v_lshl_add_u32 v254, v254, 7, s94
s_lshl_b32 s77, s74, 15
s_add_u32 s77, s77, 100352
s_mul_i32 s78, s74, 4294934528
s_add_u32 s78, s78, 131072
v_add_u32 v7, s77, v2
v_add_u32_e64 v11, s77, v3
ds_read_b64_tr_b16 v[40:41], v7 offset:6144
ds_read_b64_tr_b16 v[42:43], v7 offset:6656
ds_read_b64_tr_b16 v[44:45], v11 offset:6144
ds_read_b64_tr_b16 v[46:47], v11 offset:6656
ds_read_b64_tr_b16 v[48:49], v7 offset:8192
ds_read_b64_tr_b16 v[50:51], v7 offset:8704
ds_read_b64_tr_b16 v[52:53], v11 offset:8192
ds_read_b64_tr_b16 v[54:55], v11 offset:8704
ds_read_b64_tr_b16 v[56:57], v7 offset:10240
ds_read_b64_tr_b16 v[58:59], v7 offset:10752
ds_read_b64_tr_b16 v[60:61], v11 offset:10240
ds_read_b64_tr_b16 v[62:63], v11 offset:10752
ds_read_b64_tr_b16 v[64:65], v7 offset:12288
ds_read_b64_tr_b16 v[66:67], v7 offset:12800
ds_read_b64_tr_b16 v[68:69], v11 offset:12288
ds_read_b64_tr_b16 v[70:71], v11 offset:12800
ds_read_b64_tr_b16 v[72:73], v7 offset:14336
ds_read_b64_tr_b16 v[74:75], v7 offset:14848
ds_read_b64_tr_b16 v[76:77], v11 offset:14336
ds_read_b64_tr_b16 v[78:79], v11 offset:14848
ds_read_b64_tr_b16 v[80:81], v7 offset:16384
ds_read_b64_tr_b16 v[82:83], v7 offset:16896
ds_read_b64_tr_b16 v[84:85], v11 offset:16384
ds_read_b64_tr_b16 v[86:87], v11 offset:16896
buffer_load_dword v6, v252, s[36:39], 0 offen sc1
s_lshl_b32 s77, s74, 15
s_add_u32 s77, s77, 100352
s_mul_i32 s78, s74, 4294934528
s_add_u32 s78, s78, 131072
v_add_u32 v7, s77, v2
v_add_u32_e64 v11, s77, v3
ds_read_b64_tr_b16 v[88:89], v7 offset:18432
ds_read_b64_tr_b16 v[90:91], v7 offset:18944
ds_read_b64_tr_b16 v[92:93], v11 offset:18432
ds_read_b64_tr_b16 v[94:95], v11 offset:18944
ds_read_b64_tr_b16 v[96:97], v7 offset:20480
ds_read_b64_tr_b16 v[98:99], v7 offset:20992
ds_read_b64_tr_b16 v[100:101], v11 offset:20480
ds_read_b64_tr_b16 v[102:103], v11 offset:20992
ds_read_b64_tr_b16 v[104:105], v7 offset:22528
ds_read_b64_tr_b16 v[106:107], v7 offset:23040
ds_read_b64_tr_b16 v[108:109], v11 offset:22528
ds_read_b64_tr_b16 v[110:111], v11 offset:23040
ds_read_b64_tr_b16 v[112:113], v7 offset:24576
ds_read_b64_tr_b16 v[114:115], v7 offset:25088
ds_read_b64_tr_b16 v[116:117], v11 offset:24576
ds_read_b64_tr_b16 v[118:119], v11 offset:25088
ds_read_b64_tr_b16 v[120:121], v7 offset:26624
ds_read_b64_tr_b16 v[122:123], v7 offset:27136
ds_read_b64_tr_b16 v[124:125], v11 offset:26624
ds_read_b64_tr_b16 v[126:127], v11 offset:27136
ds_read_b64_tr_b16 v[128:129], v7 offset:28672
ds_read_b64_tr_b16 v[130:131], v7 offset:29184
ds_read_b64_tr_b16 v[132:133], v11 offset:28672
ds_read_b64_tr_b16 v[134:135], v11 offset:29184
v_add_u32 v7, s78, v2
v_add_u32 v11, s78, v3
ds_read_b64_tr_b16 v[136:137], v7 offset:0
ds_read_b64_tr_b16 v[138:139], v7 offset:512
ds_read_b64_tr_b16 v[140:141], v11 offset:0
ds_read_b64_tr_b16 v[142:143], v11 offset:512
s_waitcnt vmcnt(0)
v_cmp_gt_u32 vcc, 1, v6
s_nop 0
s_cbranch_vccz Lgo_17
Lpoll_16:
buffer_load_dword v6, v252, s[36:39], 0 offen sc1
s_waitcnt vmcnt(0)
v_cmp_gt_u32 vcc, 1, v6
s_nop 0
s_cbranch_vccz Lgo_17
s_add_u32 s91, s91, 1
s_bitcmp0_b32 s91, 16
s_cbranch_scc1 Lpoll_16
Lgo_17:
s_mov_b32 s94, 12288
buffer_load_dwordx4 v[248:251], v1, s[36:39], s94 offen sc1
buffer_load_dwordx4 v[144:147], v1, s[36:39], s89 offen sc1
buffer_load_dwordx4 v[148:151], v1, s[36:39], s89 offen offset:1024 sc1
buffer_load_dwordx4 v[152:155], v1, s[36:39], s89 offen offset:2048 sc1
buffer_load_dwordx4 v[156:159], v1, s[36:39], s89 offen offset:3072 sc1
s_add_u32 s89, s89, 4096
buffer_load_dwordx4 v[160:163], v1, s[36:39], s89 offen sc1
buffer_load_dwordx4 v[164:167], v1, s[36:39], s89 offen offset:1024 sc1
buffer_load_dwordx4 v[168:171], v1, s[36:39], s89 offen offset:2048 sc1
buffer_load_dwordx4 v[172:175], v1, s[36:39], s89 offen offset:3072 sc1
s_add_u32 s89, s89, 4096
buffer_load_dwordx4 v[176:179], v1, s[36:39], s89 offen sc1
buffer_load_dwordx4 v[180:183], v1, s[36:39], s89 offen offset:1024 sc1
buffer_load_dwordx4 v[184:187], v1, s[36:39], s89 offen offset:2048 sc1
buffer_load_dwordx4 v[188:191], v1, s[36:39], s89 offen offset:3072 sc1
s_waitcnt lgkmcnt(0)
s_barrier
s_waitcnt vmcnt(11)
v_mfma_f32_32x32x16_bf16 v[208:223], v[16:19], v[144:147], 0
v_mfma_f32_32x32x16_bf16 v[224:239], v[20:23], v[144:147], 0
s_add_u32 s89, s89, 4096
buffer_load_dwordx4 v[192:195], v1, s[36:39], s89 offen sc1
s_waitcnt vmcnt(11)
v_mfma_f32_32x32x16_bf16 v[208:223], v[24:27], v[148:151], v[208:223]
v_mfma_f32_32x32x16_bf16 v[224:239], v[28:31], v[148:151], v[224:239]
buffer_load_dwordx4 v[196:199], v1, s[36:39], s89 offen offset:1024 sc1
s_waitcnt vmcnt(11)
v_mfma_f32_32x32x16_bf16 v[208:223], v[32:35], v[152:155], v[208:223]
v_mfma_f32_32x32x16_bf16 v[224:239], v[36:39], v[152:155], v[224:239]
buffer_load_dwordx4 v[200:203], v1, s[36:39], s89 offen offset:2048 sc1
s_waitcnt vmcnt(11)
v_mfma_f32_32x32x16_bf16 v[208:223], v[40:43], v[156:159], v[208:223]
v_mfma_f32_32x32x16_bf16 v[224:239], v[44:47], v[156:159], v[224:239]
buffer_load_dwordx4 v[204:207], v1, s[36:39], s89 offen offset:3072 sc1
s_waitcnt vmcnt(11)
v_mfma_f32_32x32x16_bf16 v[208:223], v[48:51], v[160:163], v[208:223]
v_min_u32_e64 v248, v248, v249
v_min3_u32 v248, v248, v250, v251
v_cmp_eq_u32 vcc, 0, v248
s_nop 0
s_cbranch_vccz Lpwok_19
Lpw_18:
s_mov_b32 s94, 12288
buffer_load_dwordx4 v[248:251], v1, s[36:39], s94 offen sc1
s_waitcnt vmcnt(0)
v_min_u32_e64 v248, v248, v249
v_min3_u32 v248, v248, v250, v251
v_cmp_eq_u32 vcc, 0, v248
s_nop 0
s_cbranch_vccz Lpwok_19
s_add_u32 s91, s91, 1
s_bitcmp0_b32 s91, 16
s_cbranch_scc1 Lpw_18
Lpwok_19:
v_mfma_f32_32x32x16_bf16 v[224:239], v[52:55], v[160:163], v[224:239]
s_waitcnt vmcnt(10)
v_mfma_f32_32x32x16_bf16 v[208:223], v[56:59], v[164:167], v[208:223]
s_getpc_b64 s[4:5]
global_load_dword a240, v254, s[4:5]
v_mfma_f32_32x32x16_bf16 v[224:239], v[60:63], v[164:167], v[224:239]
s_waitcnt vmcnt(10)
v_mfma_f32_32x32x16_bf16 v[208:223], v[64:67], v[168:171], v[208:223]
s_add_u32 m0, s100, 67584
s_add_u32 s18, s99, 0
buffer_load_dwordx4 v1, s[36:39], s18 offen lds
v_mfma_f32_32x32x16_bf16 v[224:239], v[68:71], v[168:171], v[224:239]
s_waitcnt vmcnt(10)
v_mfma_f32_32x32x16_bf16 v[208:223], v[72:75], v[172:175], v[208:223]
s_add_u32 m0, s100, 67584
s_add_u32 s18, s99, 0
buffer_load_dwordx4 v1, s[36:39], s18 offen offset:1024 lds
v_mfma_f32_32x32x16_bf16 v[224:239], v[76:79], v[172:175], v[224:239]
s_waitcnt vmcnt(10)
v_mfma_f32_32x32x16_bf16 v[208:223], v[80:83], v[176:179], v[208:223]
s_add_u32 m0, s100, 75776
s_add_u32 s18, s99, 8192
buffer_load_dwordx4 v1, s[36:39], s18 offen lds
v_mfma_f32_32x32x16_bf16 v[224:239], v[84:87], v[176:179], v[224:239]
s_waitcnt vmcnt(10)
v_mfma_f32_32x32x16_bf16 v[208:223], v[88:91], v[180:183], v[208:223]
s_add_u32 m0, s100, 75776
s_add_u32 s18, s99, 8192
buffer_load_dwordx4 v1, s[36:39], s18 offen offset:1024 lds
v_mfma_f32_32x32x16_bf16 v[224:239], v[92:95], v[180:183], v[224:239]
s_waitcnt vmcnt(10)
v_mfma_f32_32x32x16_bf16 v[208:223], v[96:99], v[184:187], v[208:223]
s_add_u32 m0, s100, 83968
s_add_u32 s18, s99, 16384
buffer_load_dwordx4 v1, s[36:39], s18 offen lds
v_mfma_f32_32x32x16_bf16 v[224:239], v[100:103], v[184:187], v[224:239]
s_waitcnt vmcnt(10)
v_mfma_f32_32x32x16_bf16 v[208:223], v[104:107], v[188:191], v[208:223]
s_add_u32 m0, s100, 83968
s_add_u32 s18, s99, 16384
buffer_load_dwordx4 v1, s[36:39], s18 offen offset:1024 lds
v_mfma_f32_32x32x16_bf16 v[224:239], v[108:111], v[188:191], v[224:239]
s_waitcnt vmcnt(10)
v_mfma_f32_32x32x16_bf16 v[208:223], v[112:115], v[192:195], v[208:223]
s_add_u32 m0, s100, 100352
s_add_u32 s18, s99, 24576
buffer_load_dwordx4 v1, s[36:39], s18 offen lds
v_mfma_f32_32x32x16_bf16 v[224:239], v[116:119], v[192:195], v[224:239]
s_waitcnt vmcnt(10)
v_mfma_f32_32x32x16_bf16 v[208:223], v[120:123], v[196:199], v[208:223]
s_add_u32 m0, s100, 100352
s_add_u32 s18, s99, 24576
buffer_load_dwordx4 v1, s[36:39], s18 offen offset:1024 lds
v_mfma_f32_32x32x16_bf16 v[224:239], v[124:127], v[196:199], v[224:239]
s_waitcnt vmcnt(10)
v_mfma_f32_32x32x16_bf16 v[208:223], v[128:131], v[200:203], v[208:223]
s_add_u32 m0, s100, 108544
s_add_u32 s18, s99, 32768
buffer_load_dwordx4 v1, s[36:39], s18 offen lds
v_mfma_f32_32x32x16_bf16 v[224:239], v[132:135], v[200:203], v[224:239]
s_waitcnt vmcnt(10)
v_mfma_f32_32x32x16_bf16 v[208:223], v[136:139], v[204:207], v[208:223]
s_add_u32 m0, s100, 108544
s_add_u32 s18, s99, 32768
buffer_load_dwordx4 v1, s[36:39], s18 offen offset:1024 lds
v_mfma_f32_32x32x16_bf16 v[224:239], v[140:143], v[204:207], v[224:239]
s_add_u32 m0, s100, 116736
s_add_u32 s18, s99, 40960
buffer_load_dwordx4 v1, s[36:39], s18 offen lds
s_add_u32 m0, s100, 116736
s_add_u32 s18, s99, 40960
buffer_load_dwordx4 v1, s[36:39], s18 offen offset:1024 lds
s_add_u32 m0, s100, 124928
s_add_u32 s18, s99, 49152
buffer_load_dwordx4 v1, s[36:39], s18 offen lds
s_add_u32 m0, s100, 124928
s_add_u32 s18, s99, 49152
buffer_load_dwordx4 v1, s[36:39], s18 offen offset:1024 lds
s_add_u32 m0, s100, 133120
s_add_u32 s18, s99, 57344
buffer_load_dwordx4 v1, s[36:39], s18 offen lds
s_add_u32 m0, s100, 133120
s_add_u32 s18, s99, 57344
buffer_load_dwordx4 v1, s[36:39], s18 offen offset:1024 lds
s_cmp_lg_u32 s74, 0
s_cbranch_scc1 Lkhi_20
ds_write_b128 v12, v[224:227] offset:0
ds_write_b128 v12, v[228:231] offset:1024
ds_write_b128 v12, v[232:235] offset:2048
ds_write_b128 v12, v[236:239] offset:3072
s_branch Lkd_21
Lkhi_20:
ds_write_b128 v12, v[208:211] offset:0
ds_write_b128 v12, v[212:215] offset:1024
ds_write_b128 v12, v[216:219] offset:2048
ds_write_b128 v12, v[220:223] offset:3072
v_pk_add_f32 v[208:209], v[224:225], 0
v_pk_add_f32 v[210:211], v[226:227], 0
v_pk_add_f32 v[212:213], v[228:229], 0
v_pk_add_f32 v[214:215], v[230:231], 0
v_pk_add_f32 v[216:217], v[232:233], 0
v_pk_add_f32 v[218:219], v[234:235], 0
v_pk_add_f32 v[220:221], v[236:237], 0
v_pk_add_f32 v[222:223], v[238:239], 0
Lkd_21:
v_dot2c_f32_bf16 v208, s87, v240
v_dot2c_f32_bf16 v209, s88, v240
v_dot2c_f32_bf16 v210, s87, v241
v_dot2c_f32_bf16 v211, s88, v241
v_dot2c_f32_bf16 v212, s87, v242
v_dot2c_f32_bf16 v213, s88, v242
v_dot2c_f32_bf16 v214, s87, v243
v_dot2c_f32_bf16 v215, s88, v243
v_dot2c_f32_bf16 v216, s87, v244
v_dot2c_f32_bf16 v217, s88, v244
v_dot2c_f32_bf16 v218, s87, v245
v_dot2c_f32_bf16 v219, s88, v245
v_dot2c_f32_bf16 v220, s87, v246
v_dot2c_f32_bf16 v221, s88, v246
v_dot2c_f32_bf16 v222, s87, v247
v_dot2c_f32_bf16 v223, s88, v247
s_waitcnt lgkmcnt(0)
s_barrier
ds_read_b128 v[224:227], v13 offset:0
ds_read_b128 v[228:231], v13 offset:1024
ds_read_b128 v[232:235], v13 offset:2048
ds_read_b128 v[236:239], v13 offset:3072
s_waitcnt lgkmcnt(0)
v_pk_add_f32 v[208:209], v[208:209], v[224:225]
v_pk_add_f32 v[210:211], v[210:211], v[226:227]
v_pk_add_f32 v[212:213], v[212:213], v[228:229]
v_pk_add_f32 v[214:215], v[214:215], v[230:231]
v_pk_add_f32 v[216:217], v[216:217], v[232:233]
v_pk_add_f32 v[218:219], v[218:219], v[234:235]
v_pk_add_f32 v[220:221], v[220:221], v[236:237]
v_pk_add_f32 v[222:223], v[222:223], v[238:239]
v_cvt_pk_bf16_f32 v240, v208, v209
v_cvt_pk_bf16_f32 v241, v210, v211
v_cvt_pk_bf16_f32 v242, v212, v213
v_cvt_pk_bf16_f32 v243, v214, v215
v_cvt_pk_bf16_f32 v244, v216, v217
v_cvt_pk_bf16_f32 v245, v218, v219
v_cvt_pk_bf16_f32 v246, v220, v221
v_cvt_pk_bf16_f32 v247, v222, v223
s_add_u32 s77, s80, 6291456
buffer_store_dwordx4 v[240:243], v1, s[36:39], s77 offen sc1
buffer_store_dwordx4 v[244:247], v1, s[36:39], s77 offen offset:1024 sc1
v_mov_b32 v208, 0
v_mov_b32 v209, 0
v_dot2c_f32_bf16 v208, s86, v240
v_dot2c_f32_bf16 v209, v240, v240
v_dot2c_f32_bf16 v208, s86, v241
v_dot2c_f32_bf16 v209, v241, v241
v_dot2c_f32_bf16 v208, s86, v242
v_dot2c_f32_bf16 v209, v242, v242
v_dot2c_f32_bf16 v208, s86, v243
v_dot2c_f32_bf16 v209, v243, v243
v_dot2c_f32_bf16 v208, s86, v244
v_dot2c_f32_bf16 v209, v244, v244
v_dot2c_f32_bf16 v208, s86, v245
v_dot2c_f32_bf16 v209, v245, v245
v_dot2c_f32_bf16 v208, s86, v246
v_dot2c_f32_bf16 v209, v246, v246
v_dot2c_f32_bf16 v208, s86, v247
v_dot2c_f32_bf16 v209, v247, v247
s_add_u32 s77, s81, 262144
s_nop 1
v_permlane32_swap_b32 v208, v209
v_add_f32_e64 v208, v208, v209
buffer_store_dword v208, v5, s[36:39], s77 offen
s_lshl_b32 s97, s71, 12
s_add_u32 s97, s97, 262144
v_and_b32 v7, 31, v0
v_lshlrev_b32 v7, 4, v7
v_lshrrev_b32 v5, 5, v0
v_lshl_add_u32 v5, v5, 11, v7
s_lshl_b32 s89, s71, 15
s_add_u32 s89, s89, 6291456
s_lshr_b32 s94, s2, 3
s_lshl_b32 s94, s94, 2
s_add_u32 s94, s94, s68
s_lshl_b32 s94, s94, 8
v_and_b32 v238, 1, v0
v_lshl_add_u32 v238, v238, 7, s94
v_lshrrev_b32 v7, 4, v0
v_and_b32 v14, 15, v0
v_lshlrev_b32_e64 v14, 4, v14
v_lshl_add_u32 v14, v7, 9, v14
v_add_u32 v12, 67584, v1
v_add_u32 v13, 133120, v1
s_mul_i32 s90, s71, 114688
s_mul_i32 s77, s70, 7168
s_add_u32 s90, s90, s77
s_add_u32 s90, s90, 10485760
s_lshl_b32 s77, s69, 8
s_lshl_b32 s78, s75, 6
s_add_u32 s77, s77, s78
s_lshl_b32 s78, s74, 5
s_add_u32 s77, s77, s78
v_and_b32_e64 v7, 7, v0
v_bfe_u32 v11, v0, 3, 1
v_lshlrev_b32_e64 v11, 7, v11
v_lshl_add_u32 v11, v7, 2, v11
v_add_u32 v11, s77, v11
v_mov_b32 v7, 2
v_mov_b32_e64 v6, s83
s_waitcnt vmcnt(0)
s_mov_b64 exec, 1
buffer_store_dword v7, v6, s[36:39], 0 offen
s_mov_b64 exec, -1
s_barrier
ds_read_b128 a[240:243], v12 offset:0
ds_read_b128 a[244:247], v12 offset:1024
ds_read_b128 a[248:251], v12 offset:2048
ds_read_b128 a[252:255], v12 offset:3072
Lpoll_22:
buffer_load_dword v6, v11, s[36:39], 0 offen sc1
s_waitcnt vmcnt(0)
v_cmp_gt_u32 vcc, 2, v6
s_nop 0
s_cbranch_vccz Lgo_23
s_add_u32 s91, s91, 1
s_bitcmp0_b32 s91, 16
s_cbranch_scc1 Lpoll_22
Lgo_23:
buffer_load_dwordx4 v[16:19], v14, s[36:39], s89 offen sc1
buffer_load_dwordx4 v[20:23], v14, s[36:39], s89 offen offset:256 sc1
buffer_load_dwordx4 v[24:27], v14, s[36:39], s89 offen offset:2048 sc1
buffer_load_dwordx4 v[28:31], v14, s[36:39], s89 offen offset:2304 sc1
s_mul_i32 s77, s70, 896
s_mul_i32 s78, s68, 28672
s_add_u32 s77, s77, s78
s_add_u32 s16, s77, 131072
s_add_u32 s17, s16, 14336
s_waitcnt vmcnt(2) lgkmcnt(3)
v_mfma_f32_16x16x32_bf16 v[144:147], a[240:243], v[16:19], 0
s_add_u32 s89, s89, 4096
buffer_load_dwordx4 v[32:35], v14, s[36:39], s89 offen sc1
v_mfma_f32_16x16x32_bf16 v[148:151], a[240:243], v[20:23], 0
ds_read_b128 a[240:243], v12 offset:4096
s_waitcnt lgkmcnt(3)
v_mfma_f32_16x16x32_bf16 v[152:155], a[244:247], v[16:19], 0
buffer_load_dwordx4 v[36:39], v14, s[36:39], s89 offen offset:256 sc1
v_mfma_f32_16x16x32_bf16 v[156:159], a[244:247], v[20:23], 0
ds_read_b128 a[244:247], v12 offset:5120
s_waitcnt lgkmcnt(3)
v_mfma_f32_16x16x32_bf16 v[160:163], a[248:251], v[16:19], 0
buffer_load_dwordx4 v[40:43], v14, s[36:39], s89 offen offset:2048 sc1
v_mfma_f32_16x16x32_bf16 v[164:167], a[248:251], v[20:23], 0
ds_read_b128 a[248:251], v12 offset:6144
s_waitcnt lgkmcnt(3)
v_mfma_f32_16x16x32_bf16 v[168:171], a[252:255], v[16:19], 0
buffer_load_dwordx4 v[44:47], v14, s[36:39], s89 offen offset:2304 sc1
v_mfma_f32_16x16x32_bf16 v[172:175], a[252:255], v[20:23], 0
ds_read_b128 a[252:255], v12 offset:7168
s_waitcnt lgkmcnt(3)
v_mfma_f32_16x16x32_bf16 v[176:179], a[240:243], v[16:19], 0
s_add_u32 s89, s89, 4096
buffer_load_dwordx4 v[48:51], v14, s[36:39], s89 offen sc1
v_mfma_f32_16x16x32_bf16 v[180:183], a[240:243], v[20:23], 0
ds_read_b128 a[240:243], v12 offset:8192
s_waitcnt lgkmcnt(3)
v_mfma_f32_16x16x32_bf16 v[184:187], a[244:247], v[16:19], 0
s_getpc_b64 s[4:5]
global_load_dword v239, v238, s[4:5]
v_mfma_f32_16x16x32_bf16 v[188:191], a[244:247], v[20:23], 0
ds_read_b128 a[244:247], v12 offset:9216
s_waitcnt lgkmcnt(3)
v_mfma_f32_16x16x32_bf16 v[192:195], a[248:251], v[16:19], 0
buffer_load_dwordx4 v[240:243], v5, s[36:39], s97 offen sc1
v_mfma_f32_16x16x32_bf16 v[196:199], a[248:251], v[20:23], 0
ds_read_b128 a[248:251], v12 offset:10240
s_waitcnt lgkmcnt(3)
v_mfma_f32_16x16x32_bf16 v[200:203], a[252:255], v[16:19], 0
v_mfma_f32_16x16x32_bf16 v[204:207], a[252:255], v[20:23], 0
ds_read_b128 a[252:255], v12 offset:11264
s_waitcnt lgkmcnt(3)
v_mfma_f32_16x16x32_bf16 v[208:211], a[240:243], v[16:19], 0
buffer_load_dwordx4 v[244:247], v5, s[36:39], s97 offen offset:512 sc1
v_mfma_f32_16x16x32_bf16 v[212:215], a[240:243], v[20:23], 0
ds_read_b128 a[240:243], v12 offset:12288
s_waitcnt lgkmcnt(3)
v_mfma_f32_16x16x32_bf16 v[216:219], a[244:247], v[16:19], 0
v_mfma_f32_16x16x32_bf16 v[220:223], a[244:247], v[20:23], 0
ds_read_b128 a[244:247], v12 offset:13312
s_waitcnt vmcnt(8) lgkmcnt(3)
v_mfma_f32_16x16x32_bf16 v[144:147], a[248:251], v[24:27], v[144:147]
buffer_load_dwordx4 v[248:251], v5, s[36:39], s97 offen offset:1024 sc1
v_mfma_f32_16x16x32_bf16 v[148:151], a[248:251], v[28:31], v[148:151]
ds_read_b128 a[248:251], v12 offset:14336
s_waitcnt lgkmcnt(3)
v_mfma_f32_16x16x32_bf16 v[152:155], a[252:255], v[24:27], v[152:155]
v_mfma_f32_16x16x32_bf16 v[156:159], a[252:255], v[28:31], v[156:159]
ds_read_b128 a[252:255], v12 offset:15360
s_waitcnt lgkmcnt(3)
v_mfma_f32_16x16x32_bf16 v[160:163], a[240:243], v[24:27], v[160:163]
buffer_load_dwordx4 v[252:255], v5, s[36:39], s97 offen offset:1536 sc1
v_mfma_f32_16x16x32_bf16 v[164:167], a[240:243], v[28:31], v[164:167]
s_barrier
ds_read_b128 a[240:243], v12 offset:16384
s_waitcnt lgkmcnt(3)
v_mfma_f32_16x16x32_bf16 v[168:171], a[244:247], v[24:27], v[168:171]
v_mfma_f32_16x16x32_bf16 v[172:175], a[244:247], v[28:31], v[172:175]
ds_read_b128 a[244:247], v12 offset:17408
s_waitcnt lgkmcnt(3)
v_mfma_f32_16x16x32_bf16 v[176:179], a[248:251], v[24:27], v[176:179]
buffer_load_dwordx4 v[224:227], v1, s[36:39], s16 offen sc1
v_mfma_f32_16x16x32_bf16 v[180:183], a[248:251], v[28:31], v[180:183]
ds_read_b128 a[248:251], v12 offset:18432
s_waitcnt lgkmcnt(3)
v_mfma_f32_16x16x32_bf16 v[184:187], a[252:255], v[24:27], v[184:187]
v_mfma_f32_16x16x32_bf16 v[188:191], a[252:255], v[28:31], v[188:191]
ds_read_b128 a[252:255], v12 offset:19456
s_waitcnt lgkmcnt(3)
v_mfma_f32_16x16x32_bf16 v[192:195], a[240:243], v[24:27], v[192:195]
buffer_load_dwordx4 v[228:231], v1, s[36:39], s17 offen sc1
v_mfma_f32_16x16x32_bf16 v[196:199], a[240:243], v[28:31], v[196:199]
ds_read_b128 a[240:243], v12 offset:20480
s_waitcnt lgkmcnt(3)
v_mfma_f32_16x16x32_bf16 v[200:203], a[244:247], v[24:27], v[200:203]
v_mfma_f32_16x16x32_bf16 v[204:207], a[244:247], v[28:31], v[204:207]
ds_read_b128 a[244:247], v12 offset:21504
s_waitcnt lgkmcnt(3)
v_mfma_f32_16x16x32_bf16 v[208:211], a[248:251], v[24:27], v[208:211]
buffer_load_dwordx4 v[52:55], v14, s[36:39], s89 offen offset:256 sc1
v_mfma_f32_16x16x32_bf16 v[212:215], a[248:251], v[28:31], v[212:215]
ds_read_b128 a[248:251], v12 offset:22528
s_waitcnt lgkmcnt(3)
v_mfma_f32_16x16x32_bf16 v[216:219], a[252:255], v[24:27], v[216:219]
v_mfma_f32_16x16x32_bf16 v[220:223], a[252:255], v[28:31], v[220:223]
ds_read_b128 a[252:255], v12 offset:23552
s_waitcnt vmcnt(11) lgkmcnt(3)
v_mfma_f32_16x16x32_bf16 v[144:147], a[240:243], v[32:35], v[144:147]
buffer_load_dwordx4 v[56:59], v14, s[36:39], s89 offen offset:2048 sc1
v_mfma_f32_16x16x32_bf16 v[148:151], a[240:243], v[36:39], v[148:151]
ds_read_b128 a[240:243], v12 offset:32768
s_waitcnt lgkmcnt(3)
v_mfma_f32_16x16x32_bf16 v[152:155], a[244:247], v[32:35], v[152:155]
v_mfma_f32_16x16x32_bf16 v[156:159], a[244:247], v[36:39], v[156:159]
ds_read_b128 a[244:247], v12 offset:33792
s_waitcnt lgkmcnt(3)
v_mfma_f32_16x16x32_bf16 v[160:163], a[248:251], v[32:35], v[160:163]
buffer_load_dwordx4 v[60:63], v14, s[36:39], s89 offen offset:2304 sc1
v_mfma_f32_16x16x32_bf16 v[164:167], a[248:251], v[36:39], v[164:167]
ds_read_b128 a[248:251], v12 offset:34816
s_waitcnt lgkmcnt(3)
v_mfma_f32_16x16x32_bf16 v[168:171], a[252:255], v[32:35], v[168:171]
v_mfma_f32_16x16x32_bf16 v[172:175], a[252:255], v[36:39], v[172:175]
ds_read_b128 a[252:255], v12 offset:35840
s_waitcnt lgkmcnt(3)
v_mfma_f32_16x16x32_bf16 v[176:179], a[240:243], v[32:35], v[176:179]
s_add_u32 s89, s89, 4096
buffer_load_dwordx4 v[64:67], v14, s[36:39], s89 offen sc1
v_mfma_f32_16x16x32_bf16 v[180:183], a[240:243], v[36:39], v[180:183]
ds_read_b128 a[240:243], v12 offset:36864
s_waitcnt lgkmcnt(3)
v_mfma_f32_16x16x32_bf16 v[184:187], a[244:247], v[32:35], v[184:187]
v_mfma_f32_16x16x32_bf16 v[188:191], a[244:247], v[36:39], v[188:191]
ds_read_b128 a[244:247], v12 offset:37888
s_waitcnt lgkmcnt(3)
v_mfma_f32_16x16x32_bf16 v[192:195], a[248:251], v[32:35], v[192:195]
s_add_u32 m0, s100, 141312
s_add_u32 s18, s99, 65536
buffer_load_dwordx4 v1, s[36:39], s18 offen lds
v_mfma_f32_16x16x32_bf16 v[196:199], a[248:251], v[36:39], v[196:199]
ds_read_b128 a[248:251], v12 offset:38912
s_waitcnt lgkmcnt(3)
v_mfma_f32_16x16x32_bf16 v[200:203], a[252:255], v[32:35], v[200:203]
v_mfma_f32_16x16x32_bf16 v[204:207], a[252:255], v[36:39], v[204:207]
ds_read_b128 a[252:255], v12 offset:39936
s_waitcnt lgkmcnt(3)
v_mfma_f32_16x16x32_bf16 v[208:211], a[240:243], v[32:35], v[208:211]
buffer_load_dwordx4 v1, s[36:39], s18 offen offset:1024 lds
v_mfma_f32_16x16x32_bf16 v[212:215], a[240:243], v[36:39], v[212:215]
s_barrier
ds_read_b128 a[240:243], v12 offset:40960
s_waitcnt lgkmcnt(3)
v_mfma_f32_16x16x32_bf16 v[216:219], a[244:247], v[32:35], v[216:219]
v_mfma_f32_16x16x32_bf16 v[220:223], a[244:247], v[36:39], v[220:223]
ds_read_b128 a[244:247], v12 offset:41984
s_waitcnt vmcnt(14) lgkmcnt(3)
v_mfma_f32_16x16x32_bf16 v[144:147], a[248:251], v[40:43], v[144:147]
s_add_u32 m0, s100, 149504
s_add_u32 s18, s99, 73728
buffer_load_dwordx4 v1, s[36:39], s18 offen lds
v_mfma_f32_16x16x32_bf16 v[148:151], a[248:251], v[44:47], v[148:151]
ds_read_b128 a[248:251], v12 offset:43008
s_waitcnt vmcnt(9)
s_waitcnt lgkmcnt(3)
v_mfma_f32_16x16x32_bf16 v[152:155], a[252:255], v[40:43], v[152:155]
v_add_f32 v240, v240, v248
v_add_f32 v241, v241, v249
v_mfma_f32_16x16x32_bf16 v[156:159], a[252:255], v[44:47], v[156:159]
ds_read_b128 a[252:255], v12 offset:44032
s_waitcnt lgkmcnt(3)
v_mfma_f32_16x16x32_bf16 v[160:163], a[240:243], v[40:43], v[160:163]
buffer_load_dwordx4 v1, s[36:39], s18 offen offset:1024 lds
v_add_f32 v242, v242, v250
v_mfma_f32_16x16x32_bf16 v[164:167], a[240:243], v[44:47], v[164:167]
ds_read_b128 a[240:243], v12 offset:45056
v_add_f32 v243, v243, v251
s_waitcnt lgkmcnt(3)
v_mfma_f32_16x16x32_bf16 v[168:171], a[244:247], v[40:43], v[168:171]
v_add_f32 v244, v244, v252
v_add_f32 v245, v245, v253
v_mfma_f32_16x16x32_bf16 v[172:175], a[244:247], v[44:47], v[172:175]
ds_read_b128 a[244:247], v12 offset:46080
s_waitcnt lgkmcnt(3)
v_mfma_f32_16x16x32_bf16 v[176:179], a[248:251], v[40:43], v[176:179]
buffer_load_dwordx4 v[68:71], v14, s[36:39], s89 offen offset:256 sc1
v_add_f32 v246, v246, v254
v_mfma_f32_16x16x32_bf16 v[180:183], a[248:251], v[44:47], v[180:183]
ds_read_b128 a[248:251], v12 offset:47104
v_add_f32 v247, v247, v255
s_waitcnt lgkmcnt(3)
v_mfma_f32_16x16x32_bf16 v[184:187], a[252:255], v[40:43], v[184:187]
v_add_f32 v240, v240, v244
v_add_f32 v241, v241, v245
v_mfma_f32_16x16x32_bf16 v[188:191], a[252:255], v[44:47], v[188:191]
ds_read_b128 a[252:255], v12 offset:48128
s_waitcnt lgkmcnt(3)
v_mfma_f32_16x16x32_bf16 v[192:195], a[240:243], v[40:43], v[192:195]
buffer_load_dwordx4 v[72:75], v14, s[36:39], s89 offen offset:2048 sc1
v_add_f32 v242, v242, v246
v_mfma_f32_16x16x32_bf16 v[196:199], a[240:243], v[44:47], v[196:199]
ds_read_b128 a[240:243], v12 offset:49152
v_add_f32 v243, v243, v247
s_waitcnt lgkmcnt(3)
v_mfma_f32_16x16x32_bf16 v[200:203], a[244:247], v[40:43], v[200:203]
v_add_f32 v240, v240, v242
v_add_f32 v241, v241, v243
v_mfma_f32_16x16x32_bf16 v[204:207], a[244:247], v[44:47], v[204:207]
ds_read_b128 a[244:247], v12 offset:50176
s_waitcnt lgkmcnt(3)
v_mfma_f32_16x16x32_bf16 v[208:211], a[248:251], v[40:43], v[208:211]
buffer_load_dwordx4 v[76:79], v14, s[36:39], s89 offen offset:2304 sc1
v_permlane32_swap_b32 v240, v241
v_mfma_f32_16x16x32_bf16 v[212:215], a[248:251], v[44:47], v[212:215]
ds_read_b128 a[248:251], v12 offset:51200
v_add_f32 v240, v240, v241
s_waitcnt lgkmcnt(3)
v_mfma_f32_16x16x32_bf16 v[216:219], a[252:255], v[40:43], v[216:219]
v_mov_b32 v241, v240
s_nop 1
v_permlane32_swap_b32_e64 v240, v241
v_mfma_f32_16x16x32_bf16 v[220:223], a[252:255], v[44:47], v[220:223]
ds_read_b128 a[252:255], v12 offset:52224
s_waitcnt vmcnt(10) lgkmcnt(3)
v_mfma_f32_16x16x32_bf16 v[144:147], a[240:243], v[48:51], v[144:147]
s_add_u32 s89, s89, 4096
buffer_load_dwordx4 v[80:83], v14, s[36:39], s89 offen sc1
v_mul_f32 v8, -0.001953125, v240
v_mfma_f32_16x16x32_bf16 v[148:151], a[240:243], v[52:55], v[148:151]
ds_read_b128 a[240:243], v12 offset:53248
v_mul_f32 v241, 0.001953125, v241
s_waitcnt lgkmcnt(3)
v_mfma_f32_16x16x32_bf16 v[152:155], a[244:247], v[48:51], v[152:155]
v_fma_f32 v241, -v8, v8, v241
v_max_f32_e64 v241, 0, v241
v_mfma_f32_16x16x32_bf16 v[156:159], a[244:247], v[52:55], v[156:159]
ds_read_b128 a[244:247], v12 offset:54272
s_waitcnt lgkmcnt(3)
v_mfma_f32_16x16x32_bf16 v[160:163], a[248:251], v[48:51], v[160:163]
s_add_u32 m0, s100, 92160
s_add_u32 s18, s99, 81920
buffer_load_dwordx4 v1, s[36:39], s18 offen lds
v_mfma_f32_16x16x32_bf16 v[164:167], a[248:251], v[52:55], v[164:167]
ds_read_b128 a[248:251], v12 offset:55296
v_add_f32 v241, 0x3727c5ac, v241
s_waitcnt lgkmcnt(3)
v_mfma_f32_16x16x32_bf16 v[168:171], a[252:255], v[48:51], v[168:171]
v_rsq_f32 v9, v241
s_nop 0
v_mul_f32_e64 v9, v9, v9
v_mfma_f32_16x16x32_bf16 v[172:175], a[252:255], v[52:55], v[172:175]
ds_read_b128 a[252:255], v12 offset:56320
s_waitcnt lgkmcnt(3)
v_mfma_f32_16x16x32_bf16 v[176:179], a[240:243], v[48:51], v[176:179]
buffer_load_dwordx4 v1, s[36:39], s18 offen offset:1024 lds
v_mov_b32 v242, v8
v_mfma_f32_16x16x32_bf16 v[180:183], a[240:243], v[52:55], v[180:183]
s_barrier
ds_read_b128 a[240:243], v12 offset:57344
v_and_b32_e64 v241, 31, v0
s_waitcnt lgkmcnt(3)
v_mfma_f32_16x16x32_bf16 v[184:187], a[244:247], v[48:51], v[184:187]
s_lshl_b32 s77, s68, 7
s_add_u32 s77, s77, 66944
v_lshl_add_u32 v241, v241, 2, s77
v_mfma_f32_16x16x32_bf16 v[188:191], a[244:247], v[52:55], v[188:191]
ds_read_b128 a[244:247], v12 offset:58368
s_waitcnt lgkmcnt(3)
v_mfma_f32_16x16x32_bf16 v[192:195], a[248:251], v[48:51], v[192:195]
s_add_u32 m0, s100, 67584
s_add_u32 s18, s99, 90112
buffer_load_dwordx4 v1, s[36:39], s18 offen lds
v_mfma_f32_16x16x32_bf16 v[196:199], a[248:251], v[52:55], v[196:199]
ds_read_b128 a[248:251], v12 offset:59392
v_permlane16_swap_b32 v8, v242
s_waitcnt lgkmcnt(3)
v_mfma_f32_16x16x32_bf16 v[200:203], a[252:255], v[48:51], v[200:203]
v_and_b32_e64 v240, 48, v0
v_add_u32 v240, 66048, v240
v_mfma_f32_16x16x32_bf16 v[204:207], a[252:255], v[52:55], v[204:207]
ds_read_b128 a[252:255], v12 offset:60416
s_waitcnt lgkmcnt(3)
v_mfma_f32_16x16x32_bf16 v[208:211], a[240:243], v[48:51], v[208:211]
buffer_load_dwordx4 v1, s[36:39], s18 offen offset:1024 lds
ds_write_b32 v241, v9
v_mfma_f32_16x16x32_bf16 v[212:215], a[240:243], v[52:55], v[212:215]
ds_read_b128 a[240:243], v12 offset:61440
s_waitcnt lgkmcnt(4)
v_mfma_f32_16x16x32_bf16 v[216:219], a[244:247], v[48:51], v[216:219]
v_add_f32 v224, v224, v228
v_add_f32 v225, v225, v229
v_mfma_f32_16x16x32_bf16 v[220:223], a[244:247], v[52:55], v[220:223]
ds_read_b128 a[244:247], v12 offset:62464
s_waitcnt vmcnt(13) lgkmcnt(4)
v_mfma_f32_16x16x32_bf16 v[144:147], a[248:251], v[56:59], v[144:147]
buffer_load_dwordx4 v[84:87], v14, s[36:39], s89 offen offset:256 sc1
v_add_f32 v226, v226, v230
v_mfma_f32_16x16x32_bf16 v[148:151], a[248:251], v[60:63], v[148:151]
ds_read_b128 a[248:251], v12 offset:63488
v_add_f32 v227, v227, v231
s_waitcnt lgkmcnt(4)
v_mfma_f32_16x16x32_bf16 v[152:155], a[252:255], v[56:59], v[152:155]
s_lshl_b32 s77, s68, 10
s_add_u32 s77, s77, 157696
v_add_u32 v228, s77, v1
v_mfma_f32_16x16x32_bf16 v[156:159], a[252:255], v[60:63], v[156:159]
ds_read_b128 a[252:255], v12 offset:64512
s_waitcnt lgkmcnt(3)
v_mfma_f32_16x16x32_bf16 v[160:163], a[240:243], v[56:59], v[160:163]
buffer_load_dwordx4 v[88:91], v14, s[36:39], s89 offen offset:2048 sc1
v_add_u32 v229, 157696, v1
v_mfma_f32_16x16x32_bf16 v[164:167], a[240:243], v[60:63], v[164:167]
ds_read_b128 a[240:243], v13 offset:0
ds_write_b128 v228, v[224:227]
s_waitcnt lgkmcnt(4)
v_mfma_f32_16x16x32_bf16 v[168:171], a[244:247], v[56:59], v[168:171]
v_mfma_f32_16x16x32_bf16 v[172:175], a[244:247], v[60:63], v[172:175]
ds_read_b128 a[244:247], v13 offset:1024
s_waitcnt lgkmcnt(4)
v_mfma_f32_16x16x32_bf16 v[176:179], a[248:251], v[56:59], v[176:179]
buffer_load_dwordx4 v[92:95], v14, s[36:39], s89 offen offset:2304 sc1
v_mfma_f32_16x16x32_bf16 v[180:183], a[248:251], v[60:63], v[180:183]
ds_read_b128 a[248:251], v13 offset:2048
s_waitcnt lgkmcnt(4)
v_mfma_f32_16x16x32_bf16 v[184:187], a[252:255], v[56:59], v[184:187]
v_mfma_f32_16x16x32_bf16 v[188:191], a[252:255], v[60:63], v[188:191]
ds_read_b128 a[252:255], v13 offset:3072
s_waitcnt lgkmcnt(4)
v_mfma_f32_16x16x32_bf16 v[192:195], a[240:243], v[56:59], v[192:195]
s_add_u32 m0, s100, 75776
s_add_u32 s18, s99, 98304
buffer_load_dwordx4 v1, s[36:39], s18 offen lds
v_mfma_f32_16x16x32_bf16 v[196:199], a[240:243], v[60:63], v[196:199]
ds_read_b128 a[240:243], v13 offset:4096
s_waitcnt lgkmcnt(3)
v_mfma_f32_16x16x32_bf16 v[200:203], a[244:247], v[56:59], v[200:203]
v_mfma_f32_16x16x32_bf16 v[204:207], a[244:247], v[60:63], v[204:207]
ds_read_b128 a[244:247], v13 offset:5120
s_waitcnt lgkmcnt(3)
v_mfma_f32_16x16x32_bf16 v[208:211], a[248:251], v[56:59], v[208:211]
buffer_load_dwordx4 v1, s[36:39], s18 offen offset:1024 lds
v_mfma_f32_16x16x32_bf16 v[212:215], a[248:251], v[60:63], v[212:215]
ds_read_b128 a[248:251], v13 offset:6144
s_waitcnt lgkmcnt(3)
v_mfma_f32_16x16x32_bf16 v[216:219], a[252:255], v[56:59], v[216:219]
v_mfma_f32_16x16x32_bf16 v[220:223], a[252:255], v[60:63], v[220:223]
ds_read_b128 a[252:255], v13 offset:7168
s_waitcnt vmcnt(12) lgkmcnt(3)
v_mfma_f32_16x16x32_bf16 v[144:147], a[240:243], v[64:67], v[144:147]
s_add_u32 m0, s100, 83968
s_add_u32 s18, s99, 106496
buffer_load_dwordx4 v1, s[36:39], s18 offen lds
v_mfma_f32_16x16x32_bf16 v[148:151], a[240:243], v[68:71], v[148:151]
s_barrier
ds_read_b128 a[240:243], v13 offset:8192
s_waitcnt lgkmcnt(3)
v_mfma_f32_16x16x32_bf16 v[152:155], a[244:247], v[64:67], v[152:155]
v_mfma_f32_16x16x32_bf16 v[156:159], a[244:247], v[68:71], v[156:159]
ds_read_b128 a[244:247], v13 offset:9216
s_waitcnt lgkmcnt(3)
v_mfma_f32_16x16x32_bf16 v[160:163], a[248:251], v[64:67], v[160:163]
buffer_load_dwordx4 v1, s[36:39], s18 offen offset:1024 lds
v_mfma_f32_16x16x32_bf16 v[164:167], a[248:251], v[68:71], v[164:167]
ds_read_b128 a[248:251], v13 offset:10240
s_waitcnt lgkmcnt(3)
v_mfma_f32_16x16x32_bf16 v[168:171], a[252:255], v[64:67], v[168:171]
v_mfma_f32_16x16x32_bf16 v[172:175], a[252:255], v[68:71], v[172:175]
ds_read_b128 a[252:255], v13 offset:11264
s_waitcnt lgkmcnt(3)
v_mfma_f32_16x16x32_bf16 v[176:179], a[240:243], v[64:67], v[176:179]
s_add_u32 s89, s89, 4096
buffer_load_dwordx4 v[96:99], v14, s[36:39], s89 offen sc1
v_mfma_f32_16x16x32_bf16 v[180:183], a[240:243], v[68:71], v[180:183]
ds_read_b128 a[240:243], v13 offset:12288
s_waitcnt lgkmcnt(3)
v_mfma_f32_16x16x32_bf16 v[184:187], a[244:247], v[64:67], v[184:187]
v_mfma_f32_16x16x32_bf16 v[188:191], a[244:247], v[68:71], v[188:191]
ds_read_b128 a[244:247], v13 offset:13312
s_waitcnt lgkmcnt(3)
v_mfma_f32_16x16x32_bf16 v[192:195], a[248:251], v[64:67], v[192:195]
buffer_load_dwordx4 v[100:103], v14, s[36:39], s89 offen offset:256 sc1
v_mfma_f32_16x16x32_bf16 v[196:199], a[248:251], v[68:71], v[196:199]
ds_read_b128 a[248:251], v13 offset:14336
s_waitcnt lgkmcnt(3)
v_mfma_f32_16x16x32_bf16 v[200:203], a[252:255], v[64:67], v[200:203]
v_mfma_f32_16x16x32_bf16 v[204:207], a[252:255], v[68:71], v[204:207]
ds_read_b128 a[252:255], v13 offset:15360
s_waitcnt lgkmcnt(3)
v_mfma_f32_16x16x32_bf16 v[208:211], a[240:243], v[64:67], v[208:211]
buffer_load_dwordx4 v[104:107], v14, s[36:39], s89 offen offset:2048 sc1
v_mfma_f32_16x16x32_bf16 v[212:215], a[240:243], v[68:71], v[212:215]
ds_read_b128 a[240:243], v13 offset:16384
s_waitcnt lgkmcnt(3)
v_mfma_f32_16x16x32_bf16 v[216:219], a[244:247], v[64:67], v[216:219]
v_mfma_f32_16x16x32_bf16 v[220:223], a[244:247], v[68:71], v[220:223]
ds_read_b128 a[244:247], v13 offset:17408
s_waitcnt vmcnt(15) lgkmcnt(3)
v_mfma_f32_16x16x32_bf16 v[144:147], a[248:251], v[72:75], v[144:147]
s_add_u32 m0, s100, 100352
s_add_u32 s18, s99, 114688
buffer_load_dwordx4 v1, s[36:39], s18 offen lds
v_mfma_f32_16x16x32_bf16 v[148:151], a[248:251], v[76:79], v[148:151]
ds_read_b128 a[248:251], v13 offset:18432
s_waitcnt lgkmcnt(3)
v_mfma_f32_16x16x32_bf16 v[152:155], a[252:255], v[72:75], v[152:155]
v_mfma_f32_16x16x32_bf16 v[156:159], a[252:255], v[76:79], v[156:159]
ds_read_b128 a[252:255], v13 offset:19456
s_waitcnt lgkmcnt(3)
v_mfma_f32_16x16x32_bf16 v[160:163], a[240:243], v[72:75], v[160:163]
buffer_load_dwordx4 v1, s[36:39], s18 offen offset:1024 lds
v_mfma_f32_16x16x32_bf16 v[164:167], a[240:243], v[76:79], v[164:167]
ds_read_b128 a[240:243], v13 offset:20480
s_waitcnt lgkmcnt(3)
v_mfma_f32_16x16x32_bf16 v[168:171], a[244:247], v[72:75], v[168:171]
v_mfma_f32_16x16x32_bf16 v[172:175], a[244:247], v[76:79], v[172:175]
ds_read_b128 a[244:247], v13 offset:21504
s_waitcnt lgkmcnt(3)
v_mfma_f32_16x16x32_bf16 v[176:179], a[248:251], v[72:75], v[176:179]
s_add_u32 m0, s100, 108544
s_add_u32 s18, s99, 122880
buffer_load_dwordx4 v1, s[36:39], s18 offen lds
v_mfma_f32_16x16x32_bf16 v[180:183], a[248:251], v[76:79], v[180:183]
ds_read_b128 a[248:251], v13 offset:22528
s_waitcnt lgkmcnt(3)
v_mfma_f32_16x16x32_bf16 v[184:187], a[252:255], v[72:75], v[184:187]
v_mfma_f32_16x16x32_bf16 v[188:191], a[252:255], v[76:79], v[188:191]
ds_read_b128 a[252:255], v13 offset:23552
s_waitcnt lgkmcnt(3)
v_mfma_f32_16x16x32_bf16 v[192:195], a[240:243], v[72:75], v[192:195]
buffer_load_dwordx4 v1, s[36:39], s18 offen offset:1024 lds
v_mfma_f32_16x16x32_bf16 v[196:199], a[240:243], v[76:79], v[196:199]
s_waitcnt vmcnt(14)
s_barrier
ds_read_b128 a[240:243], v12 offset:24576
s_waitcnt lgkmcnt(3)
v_mfma_f32_16x16x32_bf16 v[200:203], a[244:247], v[72:75], v[200:203]
ds_read_b128 v[236:239], v229 offset:3072
ds_read_b128 v[232:235], v229 offset:2048
ds_read_b128 v[224:227], v229 offset:0
ds_read_b128 v[228:231], v229 offset:1024
v_mfma_f32_16x16x32_bf16 v[204:207], a[244:247], v[76:79], v[204:207]
ds_read_b128 a[244:247], v12 offset:25600
s_waitcnt lgkmcnt(7)
v_mfma_f32_16x16x32_bf16 v[208:211], a[248:251], v[72:75], v[208:211]
buffer_load_dwordx4 v[108:111], v14, s[36:39], s89 offen offset:2304 sc1
v_mfma_f32_16x16x32_bf16 v[212:215], a[248:251], v[76:79], v[212:215]
ds_read_b128 a[248:251], v12 offset:26624
s_waitcnt lgkmcnt(7)
v_mfma_f32_16x16x32_bf16 v[216:219], a[252:255], v[72:75], v[216:219]
s_waitcnt lgkmcnt(2)
v_add_f32 v224, v224, v232
v_add_f32 v228, v228, v236
v_mfma_f32_16x16x32_bf16 v[220:223], a[252:255], v[76:79], v[220:223]
ds_read_b128 a[252:255], v12 offset:27648
s_waitcnt vmcnt(14)
v_mfma_f32_16x16x32_bf16 v[144:147], a[240:243], v[80:83], v[144:147]
s_add_u32 s89, s89, 4096
buffer_load_dwordx4 v[112:115], v14, s[36:39], s89 offen sc1
v_add_f32 v225, v225, v233
v_mfma_f32_16x16x32_bf16 v[148:151], a[240:243], v[84:87], v[148:151]
ds_read_b128 a[240:243], v12 offset:28672
v_add_f32 v229, v229, v237
s_waitcnt lgkmcnt(3)
v_mfma_f32_16x16x32_bf16 v[152:155], a[244:247], v[80:83], v[152:155]
v_add_f32 v226, v226, v234
v_add_f32 v230, v230, v238
v_mfma_f32_16x16x32_bf16 v[156:159], a[244:247], v[84:87], v[156:159]
ds_read_b128 a[244:247], v12 offset:29696
s_waitcnt lgkmcnt(3)
v_mfma_f32_16x16x32_bf16 v[160:163], a[248:251], v[80:83], v[160:163]
buffer_load_dwordx4 v[116:119], v14, s[36:39], s89 offen offset:256 sc1
v_add_f32 v227, v227, v235
v_mfma_f32_16x16x32_bf16 v[164:167], a[248:251], v[84:87], v[164:167]
ds_read_b128 a[248:251], v12 offset:30720
v_add_f32 v231, v231, v239
s_waitcnt lgkmcnt(3)
v_mfma_f32_16x16x32_bf16 v[168:171], a[252:255], v[80:83], v[168:171]
v_add_f32 v224, v224, v228
v_add_f32 v225, v225, v229
v_mfma_f32_16x16x32_bf16 v[172:175], a[252:255], v[84:87], v[172:175]
ds_read_b128 a[252:255], v12 offset:31744
s_waitcnt lgkmcnt(3)
v_mfma_f32_16x16x32_bf16 v[176:179], a[240:243], v[80:83], v[176:179]
s_add_u32 m0, s100, 116736
s_add_u32 s18, s99, 131072
buffer_load_dwordx4 v1, s[36:39], s18 offen lds
v_mfma_f32_16x16x32_bf16 v[180:183], a[240:243], v[84:87], v[180:183]
ds_read_b128 a[240:243], v12 offset:0
v_add_f32_e64 v226, v226, v230
s_waitcnt lgkmcnt(3)
v_mfma_f32_16x16x32_bf16 v[184:187], a[244:247], v[80:83], v[184:187]
v_add_f32_e64 v227, v227, v231
v_add_u32 v228, 66048, v1
v_mfma_f32_16x16x32_bf16 v[188:191], a[244:247], v[84:87], v[188:191]
ds_read_b128 a[244:247], v12 offset:1024
s_waitcnt lgkmcnt(3)
v_mfma_f32_16x16x32_bf16 v[192:195], a[248:251], v[80:83], v[192:195]
buffer_load_dwordx4 v1, s[36:39], s18 offen offset:1024 lds
s_mov_b32 exec_hi, 0x00ffffff
ds_write_b128 v228, v[224:227]
s_mov_b64 exec, -1
v_mfma_f32_16x16x32_bf16 v[196:199], a[248:251], v[84:87], v[196:199]
ds_read_b128 a[248:251], v12 offset:2048
s_waitcnt lgkmcnt(4)
v_mfma_f32_16x16x32_bf16 v[200:203], a[252:255], v[80:83], v[200:203]
v_mfma_f32_16x16x32_bf16 v[204:207], a[252:255], v[84:87], v[204:207]
ds_read_b128 a[252:255], v12 offset:3072
s_waitcnt lgkmcnt(4)
v_mfma_f32_16x16x32_bf16 v[208:211], a[240:243], v[80:83], v[208:211]
s_add_u32 m0, s100, 124928
s_add_u32 s18, s99, 139264
buffer_load_dwordx4 v1, s[36:39], s18 offen lds
v_mfma_f32_16x16x32_bf16 v[212:215], a[240:243], v[84:87], v[212:215]
ds_read_b128 a[240:243], v12 offset:4096
s_waitcnt lgkmcnt(4)
v_mfma_f32_16x16x32_bf16 v[216:219], a[244:247], v[80:83], v[216:219]
v_mfma_f32_16x16x32_bf16 v[220:223], a[244:247], v[84:87], v[220:223]
ds_read_b128 a[244:247], v12 offset:5120
s_waitcnt vmcnt(17) lgkmcnt(3)
v_mfma_f32_16x16x32_bf16 v[144:147], a[248:251], v[88:91], v[144:147]
buffer_load_dwordx4 v1, s[36:39], s18 offen offset:1024 lds
ds_read_b128 v[244:247], v240 offset:640
ds_read_b128 v[248:251], v240 offset:704
v_mfma_f32_16x16x32_bf16 v[148:151], a[248:251], v[92:95], v[148:151]
ds_read_b128 a[248:251], v12 offset:6144
s_waitcnt lgkmcnt(5)
v_mfma_f32_16x16x32_bf16 v[152:155], a[252:255], v[88:91], v[152:155]
v_mfma_f32_16x16x32_bf16 v[156:159], a[252:255], v[92:95], v[156:159]
ds_read_b128 a[252:255], v12 offset:7168
s_waitcnt lgkmcnt(5)
v_mfma_f32_16x16x32_bf16 v[160:163], a[240:243], v[88:91], v[160:163]
buffer_load_dwordx4 v[120:123], v14, s[36:39], s89 offen offset:2048 sc1
s_waitcnt lgkmcnt(2)
v_mul_f32 v224, v8, v244
v_mul_f32_e64 v225, v8, v245
v_mfma_f32_16x16x32_bf16 v[164:167], a[240:243], v[92:95], v[164:167]
s_waitcnt vmcnt(15)
s_barrier
ds_read_b128 a[240:243], v12 offset:8192
v_mul_f32_e64 v226, v8, v246
v_mfma_f32_16x16x32_bf16 v[168:171], a[244:247], v[88:91], v[168:171]
v_mul_f32 v227, v8, v247
v_mul_f32 v228, v242, v244
v_mfma_f32_16x16x32_bf16 v[172:175], a[244:247], v[92:95], v[172:175]
ds_read_b128 a[244:247], v12 offset:9216
s_waitcnt lgkmcnt(3)
v_mfma_f32_16x16x32_bf16 v[176:179], a[248:251], v[88:91], v[176:179]
buffer_load_dwordx4 v[124:127], v14, s[36:39], s89 offen offset:2304 sc1
v_mul_f32 v229, v242, v245
v_mul_f32_e64 v230, v242, v246
v_mfma_f32_16x16x32_bf16 v[180:183], a[248:251], v[92:95], v[180:183]
ds_read_b128 a[248:251], v12 offset:10240
v_mul_f32 v231, v242, v247
s_waitcnt lgkmcnt(3)
v_mfma_f32_16x16x32_bf16 v[184:187], a[252:255], v[88:91], v[184:187]
v_mul_f32 v232, v8, v248
v_mul_f32 v233, v8, v249
v_mfma_f32_16x16x32_bf16 v[188:191], a[252:255], v[92:95], v[188:191]
ds_read_b128 a[252:255], v12 offset:11264
s_waitcnt lgkmcnt(3)
v_mfma_f32_16x16x32_bf16 v[192:195], a[240:243], v[88:91], v[192:195]
s_add_u32 s89, s89, 4096
buffer_load_dwordx4 v[128:131], v14, s[36:39], s89 offen sc1
v_mul_f32 v234, v8, v250
v_mul_f32_e64 v235, v8, v251
v_mfma_f32_16x16x32_bf16 v[196:199], a[240:243], v[92:95], v[196:199]
ds_read_b128 a[240:243], v12 offset:12288
v_mul_f32 v236, v242, v248
s_waitcnt lgkmcnt(3)
v_mfma_f32_16x16x32_bf16 v[200:203], a[244:247], v[88:91], v[200:203]
v_mul_f32 v237, v242, v249
v_mul_f32 v238, v242, v250
v_mfma_f32_16x16x32_bf16 v[204:207], a[244:247], v[92:95], v[204:207]
ds_read_b128 a[244:247], v12 offset:13312
s_waitcnt lgkmcnt(3)
v_mfma_f32_16x16x32_bf16 v[208:211], a[248:251], v[88:91], v[208:211]
s_add_u32 m0, s100, 133120
s_add_u32 s18, s99, 147456
buffer_load_dwordx4 v1, s[36:39], s18 offen lds
v_mul_f32 v239, v242, v251
v_mfma_f32_16x16x32_bf16 v[212:215], a[248:251], v[92:95], v[212:215]
ds_read_b128 a[248:251], v12 offset:14336
ds_read_b128 v[244:247], v240 offset:0
ds_read_b128 v[248:251], v240 offset:64
s_waitcnt lgkmcnt(5)
v_mfma_f32_16x16x32_bf16 v[216:219], a[252:255], v[88:91], v[216:219]
v_mfma_f32_16x16x32_bf16 v[220:223], a[252:255], v[92:95], v[220:223]
ds_read_b128 a[252:255], v12 offset:15360
s_waitcnt vmcnt(16) lgkmcnt(5)
v_mfma_f32_16x16x32_bf16 v[144:147], a[240:243], v[96:99], v[144:147]
buffer_load_dwordx4 v1, s[36:39], s18 offen offset:1024 lds
v_mfma_f32_16x16x32_bf16 v[148:151], a[240:243], v[100:103], v[148:151]
ds_read_b128 a[240:243], v12 offset:16384
s_waitcnt lgkmcnt(5)
v_mfma_f32_16x16x32_bf16 v[152:155], a[244:247], v[96:99], v[152:155]
v_mfma_f32_16x16x32_bf16 v[156:159], a[244:247], v[100:103], v[156:159]
ds_read_b128 a[244:247], v12 offset:17408
s_waitcnt lgkmcnt(5)
v_mfma_f32_16x16x32_bf16 v[160:163], a[248:251], v[96:99], v[160:163]
s_add_u32 m0, s100, 141312
s_add_u32 s18, s99, 155648
buffer_load_dwordx4 v1, s[36:39], s18 offen lds
s_waitcnt lgkmcnt(3)
v_fmac_f32 v144, v8, v244
v_mfma_f32_16x16x32_bf16 v[164:167], a[248:251], v[100:103], v[164:167]
ds_read_b128 a[248:251], v12 offset:18432
v_fmac_f32 v145, v8, v245
s_waitcnt lgkmcnt(3)
v_mfma_f32_16x16x32_bf16 v[168:171], a[252:255], v[96:99], v[168:171]
v_fmac_f32 v146, v8, v246
v_fmac_f32 v147, v8, v247
v_mfma_f32_16x16x32_bf16 v[172:175], a[252:255], v[100:103], v[172:175]
ds_read_b128 a[252:255], v12 offset:19456
s_waitcnt lgkmcnt(3)
v_mfma_f32_16x16x32_bf16 v[176:179], a[240:243], v[96:99], v[176:179]
buffer_load_dwordx4 v1, s[36:39], s18 offen offset:1024 lds
v_fmac_f32 v148, v242, v244
v_fmac_f32_e64 v149, v242, v245
v_mfma_f32_16x16x32_bf16 v[180:183], a[240:243], v[100:103], v[180:183]
ds_read_b128 a[240:243], v12 offset:20480
v_fmac_f32 v150, v242, v246
s_waitcnt lgkmcnt(3)
v_mfma_f32_16x16x32_bf16 v[184:187], a[244:247], v[96:99], v[184:187]
v_fmac_f32 v151, v242, v247
v_fmac_f32 v152, v8, v248
v_mfma_f32_16x16x32_bf16 v[188:191], a[244:247], v[100:103], v[188:191]
ds_read_b128 a[244:247], v12 offset:21504
s_waitcnt lgkmcnt(3)
v_mfma_f32_16x16x32_bf16 v[192:195], a[248:251], v[96:99], v[192:195]
buffer_load_dwordx4 v[132:135], v14, s[36:39], s89 offen offset:256 sc1
v_fmac_f32 v153, v8, v249
v_fmac_f32_e64 v154, v8, v250
v_mfma_f32_16x16x32_bf16 v[196:199], a[248:251], v[100:103], v[196:199]
ds_read_b128 a[248:251], v12 offset:22528
v_fmac_f32 v155, v8, v251
s_waitcnt lgkmcnt(3)
v_mfma_f32_16x16x32_bf16 v[200:203], a[252:255], v[96:99], v[200:203]
v_fmac_f32 v156, v242, v248
v_fmac_f32 v157, v242, v249
v_mfma_f32_16x16x32_bf16 v[204:207], a[252:255], v[100:103], v[204:207]
ds_read_b128 a[252:255], v12 offset:23552
s_waitcnt lgkmcnt(3)
v_mfma_f32_16x16x32_bf16 v[208:211], a[240:243], v[96:99], v[208:211]
buffer_load_dwordx4 v[136:139], v14, s[36:39], s89 offen offset:2048 sc1
v_fmac_f32 v158, v242, v250
v_fmac_f32_e64 v159, v242, v251
v_mfma_f32_16x16x32_bf16 v[212:215], a[240:243], v[100:103], v[212:215]
s_waitcnt vmcnt(16)
s_barrier
ds_read_b128 a[240:243], v12 offset:32768
ds_read_b128 v[244:247], v240 offset:128
ds_read_b128 v[248:251], v240 offset:192
s_waitcnt lgkmcnt(5)
v_mfma_f32_16x16x32_bf16 v[216:219], a[244:247], v[96:99], v[216:219]
v_mfma_f32_16x16x32_bf16 v[220:223], a[244:247], v[100:103], v[220:223]
ds_read_b128 a[244:247], v12 offset:33792
s_waitcnt vmcnt(15) lgkmcnt(5)
v_mfma_f32_16x16x32_bf16 v[144:147], a[248:251], v[104:107], v[144:147]
buffer_load_dwordx4 v[140:143], v14, s[36:39], s89 offen offset:2304 sc1
v_mfma_f32_16x16x32_bf16 v[148:151], a[248:251], v[108:111], v[148:151]
ds_read_b128 a[248:251], v12 offset:34816
s_waitcnt lgkmcnt(5)
v_mfma_f32_16x16x32_bf16 v[152:155], a[252:255], v[104:107], v[152:155]
v_mfma_f32_16x16x32_bf16 v[156:159], a[252:255], v[108:111], v[156:159]
ds_read_b128 a[252:255], v12 offset:35840
s_waitcnt lgkmcnt(5)
v_mfma_f32_16x16x32_bf16 v[160:163], a[240:243], v[104:107], v[160:163]
s_add_u32 m0, s100, 149504
s_add_u32 s18, s99, 163840
buffer_load_dwordx4 v1, s[36:39], s18 offen lds
v_mfma_f32_16x16x32_bf16 v[164:167], a[240:243], v[108:111], v[164:167]
ds_read_b128 a[240:243], v12 offset:36864
s_waitcnt lgkmcnt(3)
v_mfma_f32_16x16x32_bf16 v[168:171], a[244:247], v[104:107], v[168:171]
v_mfma_f32_16x16x32_bf16 v[172:175], a[244:247], v[108:111], v[172:175]
ds_read_b128 a[244:247], v12 offset:37888
s_waitcnt lgkmcnt(3)
v_mfma_f32_16x16x32_bf16 v[176:179], a[248:251], v[104:107], v[176:179]
buffer_load_dwordx4 v1, s[36:39], s18 offen offset:1024 lds
v_fmac_f32 v160, v8, v244
v_fmac_f32 v161, v8, v245
v_mfma_f32_16x16x32_bf16 v[180:183], a[248:251], v[108:111], v[180:183]
ds_read_b128 a[248:251], v12 offset:38912
v_fmac_f32 v162, v8, v246
s_waitcnt lgkmcnt(3)
v_mfma_f32_16x16x32_bf16 v[184:187], a[252:255], v[104:107], v[184:187]
v_fmac_f32 v163, v8, v247
v_fmac_f32 v164, v242, v244
v_mfma_f32_16x16x32_bf16 v[188:191], a[252:255], v[108:111], v[188:191]
ds_read_b128 a[252:255], v12 offset:39936
s_waitcnt lgkmcnt(3)
v_mfma_f32_16x16x32_bf16 v[192:195], a[240:243], v[104:107], v[192:195]
s_add_u32 m0, s100, 92160
s_add_u32 s18, s99, 172032
buffer_load_dwordx4 v1, s[36:39], s18 offen lds
v_fmac_f32 v165, v242, v245
v_mfma_f32_16x16x32_bf16 v[196:199], a[240:243], v[108:111], v[196:199]
ds_read_b128 a[240:243], v12 offset:40960
v_fmac_f32 v166, v242, v246
s_waitcnt lgkmcnt(3)
v_mfma_f32_16x16x32_bf16 v[200:203], a[244:247], v[104:107], v[200:203]
v_fmac_f32 v167, v242, v247
v_fmac_f32 v168, v8, v248
v_mfma_f32_16x16x32_bf16 v[204:207], a[244:247], v[108:111], v[204:207]
ds_read_b128 a[244:247], v12 offset:41984
s_waitcnt lgkmcnt(3)
v_mfma_f32_16x16x32_bf16 v[208:211], a[248:251], v[104:107], v[208:211]
buffer_load_dwordx4 v1, s[36:39], s18 offen offset:1024 lds
v_fmac_f32 v169, v8, v249
v_fmac_f32_e64 v170, v8, v250
v_mfma_f32_16x16x32_bf16 v[212:215], a[248:251], v[108:111], v[212:215]
ds_read_b128 a[248:251], v12 offset:43008
v_fmac_f32 v171, v8, v251
s_waitcnt lgkmcnt(3)
v_mfma_f32_16x16x32_bf16 v[216:219], a[252:255], v[104:107], v[216:219]
v_fmac_f32 v172, v242, v248
v_fmac_f32 v173, v242, v249
v_mfma_f32_16x16x32_bf16 v[220:223], a[252:255], v[108:111], v[220:223]
ds_read_b128 a[252:255], v12 offset:44032
s_waitcnt vmcnt(18) lgkmcnt(3)
v_mfma_f32_16x16x32_bf16 v[144:147], a[240:243], v[112:115], v[144:147]
s_add_u32 m0, s100, 67584
s_add_u32 s18, s99, 180224
buffer_load_dwordx4 v1, s[36:39], s18 offen lds
v_fmac_f32 v174, v242, v250
v_mfma_f32_16x16x32_bf16 v[148:151], a[240:243], v[116:119], v[148:151]
ds_read_b128 a[240:243], v12 offset:45056
v_fmac_f32 v175, v242, v251
s_waitcnt lgkmcnt(3)
v_mfma_f32_16x16x32_bf16 v[152:155], a[244:247], v[112:115], v[152:155]
ds_read_b128 v[244:247], v240 offset:256
ds_read_b128 v[248:251], v240 offset:320
v_mfma_f32_16x16x32_bf16 v[156:159], a[244:247], v[116:119], v[156:159]
ds_read_b128 a[244:247], v12 offset:46080
s_waitcnt lgkmcnt(5)
v_mfma_f32_16x16x32_bf16 v[160:163], a[248:251], v[112:115], v[160:163]
buffer_load_dwordx4 v1, s[36:39], s18 offen offset:1024 lds
v_mfma_f32_16x16x32_bf16 v[164:167], a[248:251], v[116:119], v[164:167]
ds_read_b128 a[248:251], v12 offset:47104
s_waitcnt lgkmcnt(5)
v_mfma_f32_16x16x32_bf16 v[168:171], a[252:255], v[112:115], v[168:171]
v_mfma_f32_16x16x32_bf16 v[172:175], a[252:255], v[116:119], v[172:175]
ds_read_b128 a[252:255], v12 offset:48128
s_waitcnt lgkmcnt(5)
v_mfma_f32_16x16x32_bf16 v[176:179], a[240:243], v[112:115], v[176:179]
s_add_u32 m0, s100, 75776
s_add_u32 s18, s99, 188416
buffer_load_dwordx4 v1, s[36:39], s18 offen lds
v_mfma_f32_16x16x32_bf16 v[180:183], a[240:243], v[116:119], v[180:183]
s_waitcnt vmcnt(17)
s_barrier
ds_read_b128 a[240:243], v12 offset:49152
s_waitcnt lgkmcnt(3)
v_mfma_f32_16x16x32_bf16 v[184:187], a[244:247], v[112:115], v[184:187]
v_mfma_f32_16x16x32_bf16 v[188:191], a[244:247], v[116:119], v[188:191]
ds_read_b128 a[244:247], v12 offset:50176
s_waitcnt lgkmcnt(3)
v_mfma_f32_16x16x32_bf16 v[192:195], a[248:251], v[112:115], v[192:195]
buffer_load_dwordx4 v1, s[36:39], s18 offen offset:1024 lds
v_fmac_f32 v176, v8, v244
v_fmac_f32_e64 v177, v8, v245
v_mfma_f32_16x16x32_bf16 v[196:199], a[248:251], v[116:119], v[196:199]
ds_read_b128 a[248:251], v12 offset:51200
v_fmac_f32 v178, v8, v246
s_waitcnt lgkmcnt(3)
v_mfma_f32_16x16x32_bf16 v[200:203], a[252:255], v[112:115], v[200:203]
v_fmac_f32 v179, v8, v247
v_fmac_f32 v180, v242, v244
v_mfma_f32_16x16x32_bf16 v[204:207], a[252:255], v[116:119], v[204:207]
ds_read_b128 a[252:255], v12 offset:52224
s_waitcnt lgkmcnt(3)
v_mfma_f32_16x16x32_bf16 v[208:211], a[240:243], v[112:115], v[208:211]
s_add_u32 m0, s100, 83968
s_add_u32 s18, s99, 196608
buffer_load_dwordx4 v1, s[36:39], s18 offen lds
v_fmac_f32 v181, v242, v245
v_mfma_f32_16x16x32_bf16 v[212:215], a[240:243], v[116:119], v[212:215]
ds_read_b128 a[240:243], v12 offset:53248
v_fmac_f32 v182, v242, v246
s_waitcnt lgkmcnt(3)
v_mfma_f32_16x16x32_bf16 v[216:219], a[244:247], v[112:115], v[216:219]
v_fmac_f32 v183, v242, v247
v_fmac_f32 v184, v8, v248
v_mfma_f32_16x16x32_bf16 v[220:223], a[244:247], v[116:119], v[220:223]
ds_read_b128 a[244:247], v12 offset:54272
s_waitcnt vmcnt(17) lgkmcnt(3)
v_mfma_f32_16x16x32_bf16 v[144:147], a[248:251], v[120:123], v[144:147]
buffer_load_dwordx4 v1, s[36:39], s18 offen offset:1024 lds
v_fmac_f32 v185, v8, v249
v_fmac_f32_e64 v186, v8, v250
v_mfma_f32_16x16x32_bf16 v[148:151], a[248:251], v[124:127], v[148:151]
ds_read_b128 a[248:251], v12 offset:55296
v_fmac_f32 v187, v8, v251
s_waitcnt lgkmcnt(3)
v_mfma_f32_16x16x32_bf16 v[152:155], a[252:255], v[120:123], v[152:155]
v_fmac_f32 v188, v242, v248
v_fmac_f32 v189, v242, v249
v_mfma_f32_16x16x32_bf16 v[156:159], a[252:255], v[124:127], v[156:159]
ds_read_b128 a[252:255], v12 offset:56320
s_waitcnt lgkmcnt(3)
v_mfma_f32_16x16x32_bf16 v[160:163], a[240:243], v[120:123], v[160:163]
s_add_u32 m0, s100, 100352
s_add_u32 s18, s99, 204800
buffer_load_dwordx4 v1, s[36:39], s18 offen lds
v_fmac_f32 v190, v242, v250
v_mfma_f32_16x16x32_bf16 v[164:167], a[240:243], v[124:127], v[164:167]
ds_read_b128 a[240:243], v12 offset:57344
v_fmac_f32 v191, v242, v251
s_waitcnt lgkmcnt(3)
v_mfma_f32_16x16x32_bf16 v[168:171], a[244:247], v[120:123], v[168:171]
ds_read_b128 v[244:247], v240 offset:384
ds_read_b128 v[248:251], v240 offset:448
v_mfma_f32_16x16x32_bf16 v[172:175], a[244:247], v[124:127], v[172:175]
ds_read_b128 a[244:247], v12 offset:58368
s_waitcnt lgkmcnt(5)
v_mfma_f32_16x16x32_bf16 v[176:179], a[248:251], v[120:123], v[176:179]
buffer_load_dwordx4 v1, s[36:39], s18 offen offset:1024 lds
v_mfma_f32_16x16x32_bf16 v[180:183], a[248:251], v[124:127], v[180:183]
ds_read_b128 a[248:251], v12 offset:59392
s_waitcnt lgkmcnt(5)
v_mfma_f32_16x16x32_bf16 v[184:187], a[252:255], v[120:123], v[184:187]
v_mfma_f32_16x16x32_bf16 v[188:191], a[252:255], v[124:127], v[188:191]
ds_read_b128 a[252:255], v12 offset:60416
s_waitcnt lgkmcnt(5)
v_mfma_f32_16x16x32_bf16 v[192:195], a[240:243], v[120:123], v[192:195]
s_add_u32 s15, s101, 0
buffer_load_dwordx4 a[0:3], v1, s[36:39], s15 offen
v_mfma_f32_16x16x32_bf16 v[196:199], a[240:243], v[124:127], v[196:199]
ds_read_b128 a[240:243], v12 offset:61440
s_waitcnt lgkmcnt(3)
v_mfma_f32_16x16x32_bf16 v[200:203], a[244:247], v[120:123], v[200:203]
v_mfma_f32_16x16x32_bf16 v[204:207], a[244:247], v[124:127], v[204:207]
ds_read_b128 a[244:247], v12 offset:62464
s_waitcnt lgkmcnt(3)
v_mfma_f32_16x16x32_bf16 v[208:211], a[248:251], v[120:123], v[208:211]
buffer_load_dwordx4 a[4:7], v1, s[36:39], s15 offen offset:1024
v_fmac_f32 v192, v8, v244
v_fmac_f32 v193, v8, v245
v_mfma_f32_16x16x32_bf16 v[212:215], a[248:251], v[124:127], v[212:215]
ds_read_b128 a[248:251], v12 offset:63488
v_fmac_f32 v194, v8, v246
s_waitcnt lgkmcnt(3)
v_mfma_f32_16x16x32_bf16 v[216:219], a[252:255], v[120:123], v[216:219]
v_fmac_f32 v195, v8, v247
v_fmac_f32 v196, v242, v244
v_mfma_f32_16x16x32_bf16 v[220:223], a[252:255], v[124:127], v[220:223]
ds_read_b128 a[252:255], v12 offset:64512
s_waitcnt vmcnt(16) lgkmcnt(3)
v_mfma_f32_16x16x32_bf16 v[144:147], a[240:243], v[128:131], v[144:147]
buffer_load_dwordx4 a[8:11], v1, s[36:39], s15 offen offset:2048
v_fmac_f32 v197, v242, v245
v_fmac_f32_e64 v198, v242, v246
v_mfma_f32_16x16x32_bf16 v[148:151], a[240:243], v[132:135], v[148:151]
s_barrier
ds_read_b128 a[240:243], v13 offset:0
v_fmac_f32_e64 v199, v242, v247
s_waitcnt lgkmcnt(3)
v_mfma_f32_16x16x32_bf16 v[152:155], a[244:247], v[128:131], v[152:155]
v_fmac_f32 v200, v8, v248
v_fmac_f32 v201, v8, v249
v_mfma_f32_16x16x32_bf16 v[156:159], a[244:247], v[132:135], v[156:159]
ds_read_b128 a[244:247], v13 offset:1024
s_waitcnt lgkmcnt(3)
v_mfma_f32_16x16x32_bf16 v[160:163], a[248:251], v[128:131], v[160:163]
s_add_u32 m0, s100, 108544
s_add_u32 s18, s99, 212992
buffer_load_dwordx4 v1, s[36:39], s18 offen lds
v_fmac_f32 v202, v8, v250
v_mfma_f32_16x16x32_bf16 v[164:167], a[248:251], v[132:135], v[164:167]
ds_read_b128 a[248:251], v13 offset:2048
v_fmac_f32 v203, v8, v251
s_waitcnt lgkmcnt(3)
v_mfma_f32_16x16x32_bf16 v[168:171], a[252:255], v[128:131], v[168:171]
v_fmac_f32 v204, v242, v248
v_fmac_f32 v205, v242, v249
v_mfma_f32_16x16x32_bf16 v[172:175], a[252:255], v[132:135], v[172:175]
ds_read_b128 a[252:255], v13 offset:3072
s_waitcnt lgkmcnt(3)
v_mfma_f32_16x16x32_bf16 v[176:179], a[240:243], v[128:131], v[176:179]
buffer_load_dwordx4 v1, s[36:39], s18 offen offset:1024 lds
v_fmac_f32 v206, v242, v250
v_fmac_f32_e64 v207, v242, v251
v_mfma_f32_16x16x32_bf16 v[180:183], a[240:243], v[132:135], v[180:183]
ds_read_b128 a[240:243], v13 offset:4096
ds_read_b128 v[244:247], v240 offset:512
ds_read_b128 v[248:251], v240 offset:576
s_waitcnt lgkmcnt(5)
v_mfma_f32_16x16x32_bf16 v[184:187], a[244:247], v[128:131], v[184:187]
v_mfma_f32_16x16x32_bf16 v[188:191], a[244:247], v[132:135], v[188:191]
ds_read_b128 a[244:247], v13 offset:5120
s_waitcnt lgkmcnt(5)
v_mfma_f32_16x16x32_bf16 v[192:195], a[248:251], v[128:131], v[192:195]
s_add_u32 m0, s100, 116736
s_add_u32 s18, s99, 221184
buffer_load_dwordx4 v1, s[36:39], s18 offen lds
v_mfma_f32_16x16x32_bf16 v[196:199], a[248:251], v[132:135], v[196:199]
ds_read_b128 a[248:251], v13 offset:6144
s_waitcnt lgkmcnt(5)
v_mfma_f32_16x16x32_bf16 v[200:203], a[252:255], v[128:131], v[200:203]
v_mfma_f32_16x16x32_bf16 v[204:207], a[252:255], v[132:135], v[204:207]
ds_read_b128 a[252:255], v13 offset:7168
s_waitcnt lgkmcnt(5)
v_mfma_f32_16x16x32_bf16 v[208:211], a[240:243], v[128:131], v[208:211]
buffer_load_dwordx4 v1, s[36:39], s18 offen offset:1024 lds
v_mfma_f32_16x16x32_bf16 v[212:215], a[240:243], v[132:135], v[212:215]
ds_read_b128 a[240:243], v13 offset:8192
s_waitcnt lgkmcnt(3)
v_mfma_f32_16x16x32_bf16 v[216:219], a[244:247], v[128:131], v[216:219]
v_mfma_f32_16x16x32_bf16 v[220:223], a[244:247], v[132:135], v[220:223]
ds_read_b128 a[244:247], v13 offset:9216
s_waitcnt vmcnt(19) lgkmcnt(3)
v_mfma_f32_16x16x32_bf16 v[144:147], a[248:251], v[136:139], v[144:147]
buffer_load_dwordx4 a[12:15], v1, s[36:39], s15 offen offset:3072
v_fmac_f32 v208, v8, v244
v_fmac_f32 v209, v8, v245
v_mfma_f32_16x16x32_bf16 v[148:151], a[248:251], v[140:143], v[148:151]
ds_read_b128 a[248:251], v13 offset:10240
v_fmac_f32 v210, v8, v246
s_waitcnt lgkmcnt(3)
v_mfma_f32_16x16x32_bf16 v[152:155], a[252:255], v[136:139], v[152:155]
v_fmac_f32 v211, v8, v247
v_fmac_f32 v212, v242, v244
v_mfma_f32_16x16x32_bf16 v[156:159], a[252:255], v[140:143], v[156:159]
ds_read_b128 a[252:255], v13 offset:11264
s_waitcnt lgkmcnt(3)
v_mfma_f32_16x16x32_bf16 v[160:163], a[240:243], v[136:139], v[160:163]
s_add_u32 s15, s101, 4096
buffer_load_dwordx4 a[16:19], v1, s[36:39], s15 offen
v_fmac_f32 v213, v242, v245
v_fmac_f32_e64 v214, v242, v246
v_mfma_f32_16x16x32_bf16 v[164:167], a[240:243], v[140:143], v[164:167]
ds_read_b128 a[240:243], v13 offset:12288
v_fmac_f32 v215, v242, v247
s_waitcnt lgkmcnt(3)
v_mfma_f32_16x16x32_bf16 v[168:171], a[244:247], v[136:139], v[168:171]
v_fmac_f32 v216, v8, v248
v_fmac_f32 v217, v8, v249
v_mfma_f32_16x16x32_bf16 v[172:175], a[244:247], v[140:143], v[172:175]
ds_read_b128 a[244:247], v13 offset:13312
s_waitcnt lgkmcnt(3)
v_mfma_f32_16x16x32_bf16 v[176:179], a[248:251], v[136:139], v[176:179]
buffer_load_dwordx4 a[20:23], v1, s[36:39], s15 offen offset:1024
v_fmac_f32 v218, v8, v250
v_fmac_f32_e64 v219, v8, v251
v_mfma_f32_16x16x32_bf16 v[180:183], a[248:251], v[140:143], v[180:183]
ds_read_b128 a[248:251], v13 offset:14336
v_fmac_f32 v220, v242, v248
s_waitcnt lgkmcnt(3)
v_mfma_f32_16x16x32_bf16 v[184:187], a[252:255], v[136:139], v[184:187]
v_fmac_f32 v221, v242, v249
v_fmac_f32 v222, v242, v250
v_mfma_f32_16x16x32_bf16 v[188:191], a[252:255], v[140:143], v[188:191]
ds_read_b128 a[252:255], v13 offset:15360
s_waitcnt lgkmcnt(3)
v_mfma_f32_16x16x32_bf16 v[192:195], a[240:243], v[136:139], v[192:195]
buffer_load_dwordx4 a[24:27], v1, s[36:39], s15 offen offset:2048
v_fmac_f32 v223, v242, v251
ds_read_b128 v[244:247], v240 offset:768
ds_read_b128 v[248:251], v240 offset:832
v_mfma_f32_16x16x32_bf16 v[196:199], a[240:243], v[140:143], v[196:199]
s_waitcnt vmcnt(19)
s_barrier
ds_read_b128 a[240:243], v13 offset:16384
s_waitcnt lgkmcnt(5)
v_mfma_f32_16x16x32_bf16 v[200:203], a[244:247], v[136:139], v[200:203]
v_mfma_f32_16x16x32_bf16 v[204:207], a[244:247], v[140:143], v[204:207]
ds_read_b128 a[244:247], v13 offset:17408
s_waitcnt lgkmcnt(5)
v_mfma_f32_16x16x32_bf16 v[208:211], a[248:251], v[136:139], v[208:211]
buffer_load_dwordx4 a[28:31], v1, s[36:39], s15 offen offset:3072
v_mfma_f32_16x16x32_bf16 v[212:215], a[248:251], v[140:143], v[212:215]
ds_read_b128 a[248:251], v13 offset:18432
s_waitcnt lgkmcnt(5)
v_mfma_f32_16x16x32_bf16 v[216:219], a[252:255], v[136:139], v[216:219]
v_mfma_f32_16x16x32_bf16 v[220:223], a[252:255], v[140:143], v[220:223]
ds_read_b128 a[252:255], v13 offset:19456
s_waitcnt lgkmcnt(3)
v_mfma_f32_16x16x32_bf16 v[224:227], a[240:243], v[16:19], v[224:227]
s_add_u32 s15, s101, 8192
buffer_load_dwordx4 a[32:35], v1, s[36:39], s15 offen
v_mfma_f32_16x16x32_bf16 v[228:231], a[240:243], v[20:23], v[228:231]
ds_read_b128 a[240:243], v13 offset:20480
s_waitcnt lgkmcnt(3)
v_mfma_f32_16x16x32_bf16 v[232:235], a[244:247], v[16:19], v[232:235]
v_mul_f32 v144, v144, v152
v_mul_f32_e64 v145, v145, v153
v_mfma_f32_16x16x32_bf16 v[236:239], a[244:247], v[20:23], v[236:239]
ds_read_b128 a[244:247], v13 offset:21504
s_waitcnt lgkmcnt(3)
v_mfma_f32_16x16x32_bf16 v[224:227], a[248:251], v[24:27], v[224:227]
buffer_load_dwordx4 a[36:39], v1, s[36:39], s15 offen offset:1024
v_mul_f32 v146, v146, v154
v_mfma_f32_16x16x32_bf16 v[228:231], a[248:251], v[28:31], v[228:231]
ds_read_b128 a[248:251], v13 offset:22528
v_mul_f32 v147, v147, v155
s_waitcnt lgkmcnt(3)
v_mfma_f32_16x16x32_bf16 v[232:235], a[252:255], v[24:27], v[232:235]
v_mul_f32 v148, v148, v156
v_mul_f32 v149, v149, v157
v_mfma_f32_16x16x32_bf16 v[236:239], a[252:255], v[28:31], v[236:239]
ds_read_b128 a[252:255], v13 offset:23552
s_waitcnt lgkmcnt(3)
v_mfma_f32_16x16x32_bf16 v[224:227], a[240:243], v[32:35], v[224:227]
buffer_load_dwordx4 a[40:43], v1, s[36:39], s15 offen offset:2048
v_mul_f32 v150, v150, v158
v_mfma_f32_16x16x32_bf16 v[228:231], a[240:243], v[36:39], v[228:231]
ds_read_b128 a[240:243], v12 offset:24576
v_mul_f32 v151, v151, v159
s_waitcnt lgkmcnt(3)
v_mfma_f32_16x16x32_bf16 v[232:235], a[244:247], v[32:35], v[232:235]
v_cvt_pk_bf16_f32 v152, v144, v145
v_cvt_pk_bf16_f32 v154, v148, v149
v_mfma_f32_16x16x32_bf16 v[236:239], a[244:247], v[36:39], v[236:239]
ds_read_b128 a[244:247], v12 offset:25600
s_waitcnt lgkmcnt(3)
v_mfma_f32_16x16x32_bf16 v[224:227], a[248:251], v[40:43], v[224:227]
buffer_load_dwordx4 a[44:47], v1, s[36:39], s15 offen offset:3072
v_cvt_pk_bf16_f32 v153, v146, v147
v_mfma_f32_16x16x32_bf16 v[228:231], a[248:251], v[44:47], v[228:231]
ds_read_b128 a[248:251], v12 offset:26624
v_cvt_pk_bf16_f32 v155, v150, v151
s_waitcnt lgkmcnt(3)
v_mfma_f32_16x16x32_bf16 v[232:235], a[252:255], v[40:43], v[232:235]
v_permlane16_swap_b32 v152, v154
v_permlane16_swap_b32 v153, v155
v_mfma_f32_16x16x32_bf16 v[236:239], a[252:255], v[44:47], v[236:239]
ds_read_b128 a[252:255], v12 offset:27648
s_waitcnt lgkmcnt(3)
v_mfma_f32_16x16x32_bf16 v[224:227], a[240:243], v[48:51], v[224:227]
s_add_u32 s15, s101, 12288
buffer_load_dwordx4 a[48:51], v1, s[36:39], s15 offen
buffer_store_dwordx4 v[152:155], v1, s[36:39], s90 offen sc1
v_mfma_f32_16x16x32_bf16 v[228:231], a[240:243], v[52:55], v[228:231]
ds_read_b128 a[240:243], v12 offset:28672
v_mul_f32_e64 v160, v160, v168
s_waitcnt lgkmcnt(3)
v_mfma_f32_16x16x32_bf16 v[232:235], a[244:247], v[48:51], v[232:235]
v_mul_f32 v161, v161, v169
v_mul_f32 v162, v162, v170
v_mfma_f32_16x16x32_bf16 v[236:239], a[244:247], v[52:55], v[236:239]
ds_read_b128 a[244:247], v12 offset:29696
s_waitcnt lgkmcnt(3)
v_mfma_f32_16x16x32_bf16 v[224:227], a[248:251], v[56:59], v[224:227]
buffer_load_dwordx4 a[52:55], v1, s[36:39], s15 offen offset:1024
v_mul_f32 v163, v163, v171
v_mfma_f32_16x16x32_bf16 v[228:231], a[248:251], v[60:63], v[228:231]
ds_read_b128 a[248:251], v12 offset:30720
v_mul_f32 v164, v164, v172
s_waitcnt lgkmcnt(3)
v_mfma_f32_16x16x32_bf16 v[232:235], a[252:255], v[56:59], v[232:235]
v_mul_f32 v165, v165, v173
v_mul_f32 v166, v166, v174
v_mfma_f32_16x16x32_bf16 v[236:239], a[252:255], v[60:63], v[236:239]
ds_read_b128 a[252:255], v12 offset:31744
s_waitcnt lgkmcnt(3)
v_mfma_f32_16x16x32_bf16 v[224:227], a[240:243], v[64:67], v[224:227]
buffer_load_dwordx4 a[56:59], v1, s[36:39], s15 offen offset:2048
v_mul_f32 v167, v167, v175
v_mfma_f32_16x16x32_bf16 v[228:231], a[240:243], v[68:71], v[228:231]
s_waitcnt vmcnt(24)
s_barrier
ds_read_b128 a[240:243], v12 offset:0
v_cvt_pk_bf16_f32 v168, v160, v161
s_waitcnt lgkmcnt(3)
v_mfma_f32_16x16x32_bf16 v[232:235], a[244:247], v[64:67], v[232:235]
v_cvt_pk_bf16_f32 v170, v164, v165
v_cvt_pk_bf16_f32 v169, v162, v163
v_mfma_f32_16x16x32_bf16 v[236:239], a[244:247], v[68:71], v[236:239]
ds_read_b128 a[244:247], v12 offset:1024
s_waitcnt lgkmcnt(3)
v_mfma_f32_16x16x32_bf16 v[224:227], a[248:251], v[72:75], v[224:227]
buffer_load_dwordx4 a[60:63], v1, s[36:39], s15 offen offset:3072
v_cvt_pk_bf16_f32 v171, v166, v167
v_mfma_f32_16x16x32_bf16 v[228:231], a[248:251], v[76:79], v[228:231]
ds_read_b128 a[248:251], v12 offset:2048
v_permlane16_swap_b32 v168, v170
s_waitcnt lgkmcnt(3)
v_mfma_f32_16x16x32_bf16 v[232:235], a[252:255], v[72:75], v[232:235]
v_permlane16_swap_b32_e64 v169, v171
buffer_store_dwordx4 v[168:171], v1, s[36:39], s90 offen offset:1024 sc1
v_mfma_f32_16x16x32_bf16 v[236:239], a[252:255], v[76:79], v[236:239]
ds_read_b128 a[252:255], v12 offset:3072
s_waitcnt lgkmcnt(3)
v_mfma_f32_16x16x32_bf16 v[224:227], a[240:243], v[80:83], v[224:227]
s_add_u32 s15, s101, 16384
buffer_load_dwordx4 a[64:67], v1, s[36:39], s15 offen
v_mul_f32 v176, v176, v184
v_mfma_f32_16x16x32_bf16 v[228:231], a[240:243], v[84:87], v[228:231]
ds_read_b128 a[240:243], v12 offset:4096
v_mul_f32 v177, v177, v185
s_waitcnt lgkmcnt(3)
v_mfma_f32_16x16x32_bf16 v[232:235], a[244:247], v[80:83], v[232:235]
v_mul_f32 v178, v178, v186
v_mul_f32 v179, v179, v187
v_mfma_f32_16x16x32_bf16 v[236:239], a[244:247], v[84:87], v[236:239]
ds_read_b128 a[244:247], v12 offset:5120
s_waitcnt lgkmcnt(3)
v_mfma_f32_16x16x32_bf16 v[224:227], a[248:251], v[88:91], v[224:227]
buffer_load_dwordx4 a[68:71], v1, s[36:39], s15 offen offset:1024
v_mul_f32 v180, v180, v188
v_mfma_f32_16x16x32_bf16 v[228:231], a[248:251], v[92:95], v[228:231]
ds_read_b128 a[248:251], v12 offset:6144
v_mul_f32 v181, v181, v189
s_waitcnt lgkmcnt(3)
v_mfma_f32_16x16x32_bf16 v[232:235], a[252:255], v[88:91], v[232:235]
v_mul_f32 v182, v182, v190
v_mul_f32 v183, v183, v191
v_mfma_f32_16x16x32_bf16 v[236:239], a[252:255], v[92:95], v[236:239]
ds_read_b128 a[252:255], v12 offset:7168
s_waitcnt lgkmcnt(3)
v_mfma_f32_16x16x32_bf16 v[224:227], a[240:243], v[96:99], v[224:227]
buffer_load_dwordx4 a[72:75], v1, s[36:39], s15 offen offset:2048
v_cvt_pk_bf16_f32 v184, v176, v177
v_mfma_f32_16x16x32_bf16 v[228:231], a[240:243], v[100:103], v[228:231]
ds_read_b128 a[240:243], v12 offset:8192
v_cvt_pk_bf16_f32 v186, v180, v181
s_waitcnt lgkmcnt(3)
v_mfma_f32_16x16x32_bf16 v[232:235], a[244:247], v[96:99], v[232:235]
v_cvt_pk_bf16_f32 v185, v178, v179
v_cvt_pk_bf16_f32 v187, v182, v183
v_mfma_f32_16x16x32_bf16 v[236:239], a[244:247], v[100:103], v[236:239]
ds_read_b128 a[244:247], v12 offset:9216
s_waitcnt lgkmcnt(3)
v_mfma_f32_16x16x32_bf16 v[224:227], a[248:251], v[104:107], v[224:227]
buffer_load_dwordx4 a[76:79], v1, s[36:39], s15 offen offset:3072
v_permlane16_swap_b32 v184, v186
v_mfma_f32_16x16x32_bf16 v[228:231], a[248:251], v[108:111], v[228:231]
ds_read_b128 a[248:251], v12 offset:10240
v_permlane16_swap_b32 v185, v187
s_waitcnt lgkmcnt(3)
v_mfma_f32_16x16x32_bf16 v[232:235], a[252:255], v[104:107], v[232:235]
buffer_store_dwordx4 v[184:187], v1, s[36:39], s90 offen offset:2048 sc1
v_mul_f32_e64 v192, v192, v200
v_mfma_f32_16x16x32_bf16 v[236:239], a[252:255], v[108:111], v[236:239]
ds_read_b128 a[252:255], v12 offset:11264
s_waitcnt lgkmcnt(3)
v_mfma_f32_16x16x32_bf16 v[224:227], a[240:243], v[112:115], v[224:227]
s_add_u32 s15, s101, 20480
buffer_load_dwordx4 a[80:83], v1, s[36:39], s15 offen
v_mul_f32 v193, v193, v201
v_mfma_f32_16x16x32_bf16 v[228:231], a[240:243], v[116:119], v[228:231]
ds_read_b128 a[240:243], v12 offset:12288
v_mul_f32 v194, v194, v202
s_waitcnt lgkmcnt(3)
v_mfma_f32_16x16x32_bf16 v[232:235], a[244:247], v[112:115], v[232:235]
v_mul_f32 v195, v195, v203
v_mul_f32 v196, v196, v204
v_mfma_f32_16x16x32_bf16 v[236:239], a[244:247], v[116:119], v[236:239]
ds_read_b128 a[244:247], v12 offset:13312
s_waitcnt lgkmcnt(3)
v_mfma_f32_16x16x32_bf16 v[224:227], a[248:251], v[120:123], v[224:227]
buffer_load_dwordx4 a[84:87], v1, s[36:39], s15 offen offset:1024
v_mul_f32 v197, v197, v205
v_mfma_f32_16x16x32_bf16 v[228:231], a[248:251], v[124:127], v[228:231]
ds_read_b128 a[248:251], v12 offset:14336
v_mul_f32 v198, v198, v206
s_waitcnt lgkmcnt(3)
v_mfma_f32_16x16x32_bf16 v[232:235], a[252:255], v[120:123], v[232:235]
v_mul_f32_e64 v199, v199, v207
v_cvt_pk_bf16_f32 v200, v192, v193
v_mfma_f32_16x16x32_bf16 v[236:239], a[252:255], v[124:127], v[236:239]
ds_read_b128 a[252:255], v12 offset:15360
s_waitcnt lgkmcnt(3)
v_mfma_f32_16x16x32_bf16 v[224:227], a[240:243], v[128:131], v[224:227]
buffer_load_dwordx4 a[88:91], v1, s[36:39], s15 offen offset:2048
v_cvt_pk_bf16_f32 v202, v196, v197
v_mfma_f32_16x16x32_bf16 v[228:231], a[240:243], v[132:135], v[228:231]
s_waitcnt vmcnt(30)
s_barrier
ds_read_b128 a[240:243], v12 offset:16384
v_cvt_pk_bf16_f32 v201, v194, v195
s_waitcnt lgkmcnt(3)
v_mfma_f32_16x16x32_bf16 v[232:235], a[244:247], v[128:131], v[232:235]
v_cvt_pk_bf16_f32 v203, v198, v199
v_permlane16_swap_b32_e64 v200, v202
v_mfma_f32_16x16x32_bf16 v[236:239], a[244:247], v[132:135], v[236:239]
ds_read_b128 a[244:247], v12 offset:17408
s_waitcnt lgkmcnt(3)
v_mfma_f32_16x16x32_bf16 v[224:227], a[248:251], v[136:139], v[224:227]
buffer_load_dwordx4 a[92:95], v1, s[36:39], s15 offen offset:3072
v_permlane16_swap_b32 v201, v203
v_mfma_f32_16x16x32_bf16 v[228:231], a[248:251], v[140:143], v[228:231]
ds_read_b128 a[248:251], v12 offset:18432
buffer_store_dwordx4 v[200:203], v1, s[36:39], s90 offen offset:3072 sc1
s_waitcnt lgkmcnt(3)
v_mfma_f32_16x16x32_bf16 v[232:235], a[252:255], v[136:139], v[232:235]
v_mul_f32 v208, v208, v216
v_mul_f32_e64 v209, v209, v217
v_mfma_f32_16x16x32_bf16 v[236:239], a[252:255], v[140:143], v[236:239]
ds_read_b128 a[252:255], v12 offset:19456
s_waitcnt lgkmcnt(3)
v_mfma_f32_16x16x32_bf16 v[144:147], a[240:243], v[16:19], 0
s_add_u32 s15, s101, 24576
buffer_load_dwordx4 a[96:99], v1, s[36:39], s15 offen
v_mul_f32 v210, v210, v218
v_mfma_f32_16x16x32_bf16 v[148:151], a[240:243], v[20:23], 0
ds_read_b128 a[240:243], v12 offset:20480
v_mul_f32 v211, v211, v219
s_waitcnt lgkmcnt(3)
v_mfma_f32_16x16x32_bf16 v[152:155], a[244:247], v[16:19], 0
v_mul_f32 v212, v212, v220
v_mul_f32 v213, v213, v221
v_mfma_f32_16x16x32_bf16 v[156:159], a[244:247], v[20:23], 0
ds_read_b128 a[244:247], v12 offset:21504
s_waitcnt lgkmcnt(3)
v_mfma_f32_16x16x32_bf16 v[144:147], a[248:251], v[24:27], v[144:147]
buffer_load_dwordx4 a[100:103], v1, s[36:39], s15 offen offset:1024
v_mul_f32 v214, v214, v222
v_mfma_f32_16x16x32_bf16 v[148:151], a[248:251], v[28:31], v[148:151]
ds_read_b128 a[248:251], v12 offset:22528
v_mul_f32 v215, v215, v223
s_waitcnt lgkmcnt(3)
v_mfma_f32_16x16x32_bf16 v[152:155], a[252:255], v[24:27], v[152:155]
v_cvt_pk_bf16_f32 v216, v208, v209
v_cvt_pk_bf16_f32 v218, v212, v213
v_mfma_f32_16x16x32_bf16 v[156:159], a[252:255], v[28:31], v[156:159]
ds_read_b128 a[252:255], v12 offset:23552
s_waitcnt lgkmcnt(3)
v_mfma_f32_16x16x32_bf16 v[144:147], a[240:243], v[32:35], v[144:147]
buffer_load_dwordx4 a[104:107], v1, s[36:39], s15 offen offset:2048
v_cvt_pk_bf16_f32 v217, v210, v211
v_mfma_f32_16x16x32_bf16 v[148:151], a[240:243], v[36:39], v[148:151]
ds_read_b128 a[240:243], v12 offset:32768
v_cvt_pk_bf16_f32 v219, v214, v215
s_waitcnt lgkmcnt(3)
v_mfma_f32_16x16x32_bf16 v[152:155], a[244:247], v[32:35], v[152:155]
v_permlane16_swap_b32 v216, v218
v_permlane16_swap_b32 v217, v219
v_mfma_f32_16x16x32_bf16 v[156:159], a[244:247], v[36:39], v[156:159]
ds_read_b128 a[244:247], v12 offset:33792
s_waitcnt lgkmcnt(3)
v_mfma_f32_16x16x32_bf16 v[144:147], a[248:251], v[40:43], v[144:147]
buffer_load_dwordx4 a[108:111], v1, s[36:39], s15 offen offset:3072
s_add_u32 s90, s90, 4096
buffer_store_dwordx4 v[216:219], v1, s[36:39], s90 offen sc1
v_mfma_f32_16x16x32_bf16 v[148:151], a[248:251], v[44:47], v[148:151]
ds_read_b128 a[248:251], v12 offset:34816
s_lshl_b32 s80, s69, 2
s_waitcnt lgkmcnt(3)
v_mfma_f32_16x16x32_bf16 v[152:155], a[252:255], v[40:43], v[152:155]
s_lshl_b32 s77, s73, 1
s_add_u32 s80, s80, s77
s_add_u32 s80, s80, s75
s_lshl_b32 s81, s80, 12
v_mfma_f32_16x16x32_bf16 v[156:159], a[252:255], v[44:47], v[156:159]
ds_read_b128 a[252:255], v12 offset:35840
s_waitcnt lgkmcnt(3)
v_mfma_f32_16x16x32_bf16 v[144:147], a[240:243], v[48:51], v[144:147]
s_add_u32 s15, s101, 28672
buffer_load_dwordx4 a[112:115], v1, s[36:39], s15 offen
s_lshl_b32 s77, s72, 9
v_mfma_f32_16x16x32_bf16 v[148:151], a[240:243], v[52:55], v[148:151]
ds_read_b128 a[240:243], v12 offset:36864
s_add_u32 s81, s81, s77
s_waitcnt lgkmcnt(3)
v_mfma_f32_16x16x32_bf16 v[152:155], a[244:247], v[48:51], v[152:155]
s_lshl_b32 s77, s74, 3
s_add_u32 s81, s81, s77
s_lshl_b32 s80, s80, 15
s_lshl_b32 s77, s72, 7
v_mfma_f32_16x16x32_bf16 v[156:159], a[244:247], v[52:55], v[156:159]
ds_read_b128 a[244:247], v12 offset:37888
s_waitcnt lgkmcnt(3)
v_mfma_f32_16x16x32_bf16 v[144:147], a[248:251], v[56:59], v[144:147]
buffer_load_dwordx4 a[116:119], v1, s[36:39], s15 offen offset:1024
s_lshl_b32 s78, s74, 6
s_add_u32 s77, s77, s78
v_mfma_f32_16x16x32_bf16 v[148:151], a[248:251], v[60:63], v[148:151]
ds_read_b128 a[248:251], v12 offset:38912
s_add_u32 s79, s80, s77
s_waitcnt lgkmcnt(3)
v_mfma_f32_16x16x32_bf16 v[152:155], a[252:255], v[56:59], v[152:155]
s_lshl_b32 s77, s77, 5
s_add_u32 s80, s80, s77
v_and_b32_e64 v7, 31, v0
v_mfma_f32_16x16x32_bf16 v[156:159], a[252:255], v[60:63], v[156:159]
ds_read_b128 a[252:255], v12 offset:39936
s_waitcnt lgkmcnt(3)
v_mfma_f32_16x16x32_bf16 v[144:147], a[240:243], v[64:67], v[144:147]
buffer_load_dwordx4 a[120:123], v1, s[36:39], s15 offen offset:2048
v_mov_b32 v243, 3
v_mov_b32_e64 v6, s83
s_waitcnt vmcnt(8)
s_mov_b64 exec, 1
buffer_store_dword v243, v6, s[36:39], 0 offen
s_mov_b64 exec, -1
v_mfma_f32_16x16x32_bf16 v[148:151], a[240:243], v[68:71], v[148:151]
s_barrier
ds_read_b128 a[240:243], v12 offset:40960
v_lshrrev_b32 v11, 5, v0
s_waitcnt lgkmcnt(3)
v_mfma_f32_16x16x32_bf16 v[152:155], a[244:247], v[64:67], v[152:155]
v_lshlrev_b32_e64 v7, 4, v7
v_lshl_add_u32 v5, v11, 2, v7
v_mfma_f32_16x16x32_bf16 v[156:159], a[244:247], v[68:71], v[156:159]
ds_read_b128 a[244:247], v12 offset:41984
s_waitcnt lgkmcnt(3)
v_mfma_f32_16x16x32_bf16 v[144:147], a[248:251], v[72:75], v[144:147]
buffer_load_dwordx4 a[124:127], v1, s[36:39], s15 offen offset:3072
s_lshl_b32 s77, s69, 8
s_lshl_b32 s78, s73, 7
v_mfma_f32_16x16x32_bf16 v[148:151], a[248:251], v[76:79], v[148:151]
ds_read_b128 a[248:251], v12 offset:43008
s_add_u32 s77, s77, s78
s_waitcnt lgkmcnt(3)
v_mfma_f32_16x16x32_bf16 v[152:155], a[252:255], v[72:75], v[152:155]
s_lshl_b32 s78, s68, 4
s_add_u32 s77, s77, s78
v_and_b32 v7, 3, v0
v_mfma_f32_16x16x32_bf16 v[156:159], a[252:255], v[76:79], v[156:159]
ds_read_b128 a[252:255], v12 offset:44032
s_waitcnt lgkmcnt(3)
v_mfma_f32_16x16x32_bf16 v[144:147], a[240:243], v[80:83], v[144:147]
s_add_u32 s15, s101, 32768
buffer_load_dwordx4 a[128:131], v1, s[36:39], s15 offen
v_bfe_u32 v11, v0, 2, 1
v_mfma_f32_16x16x32_bf16 v[148:151], a[240:243], v[84:87], v[148:151]
ds_read_b128 a[240:243], v12 offset:45056
v_lshlrev_b32_e64 v11, 6, v11
s_waitcnt lgkmcnt(3)
v_mfma_f32_16x16x32_bf16 v[152:155], a[244:247], v[80:83], v[152:155]
v_lshl_add_u32 v11, v7, 2, v11
v_add_u32_e64 v11, s77, v11
v_mfma_f32_16x16x32_bf16 v[156:159], a[244:247], v[84:87], v[156:159]
ds_read_b128 a[244:247], v12 offset:46080
s_waitcnt lgkmcnt(3)
v_mfma_f32_16x16x32_bf16 v[144:147], a[248:251], v[88:91], v[144:147]
buffer_load_dwordx4 a[132:135], v1, s[36:39], s15 offen offset:1024
s_lshl_b32 s77, s69, 2
s_lshl_b32 s78, s73, 1
v_mfma_f32_16x16x32_bf16 v[148:151], a[248:251], v[92:95], v[148:151]
ds_read_b128 a[248:251], v12 offset:47104
s_add_u32 s77, s77, s78
s_waitcnt lgkmcnt(3)
v_mfma_f32_16x16x32_bf16 v[152:155], a[252:255], v[88:91], v[152:155]
s_mul_i32 s92, s77, 114688
s_mul_i32 s78, s68, 28672
s_add_u32 s92, s92, s78
s_add_u32 s92, s92, 10485760
v_mfma_f32_16x16x32_bf16 v[156:159], a[252:255], v[92:95], v[156:159]
ds_read_b128 a[252:255], v12 offset:48128
s_waitcnt lgkmcnt(3)
v_mfma_f32_16x16x32_bf16 v[144:147], a[240:243], v[96:99], v[144:147]
buffer_load_dwordx4 a[136:139], v1, s[36:39], s15 offen offset:2048
s_add_u32 s93, s92, 114688
v_mul_f32 v224, v224, v232
v_mfma_f32_16x16x32_bf16 v[148:151], a[240:243], v[100:103], v[148:151]
ds_read_b128 a[240:243], v12 offset:49152
v_mul_f32 v225, v225, v233
s_waitcnt lgkmcnt(3)
v_mfma_f32_16x16x32_bf16 v[152:155], a[244:247], v[96:99], v[152:155]
v_mul_f32 v226, v226, v234
v_mul_f32 v227, v227, v235
v_mfma_f32_16x16x32_bf16 v[156:159], a[244:247], v[100:103], v[156:159]
ds_read_b128 a[244:247], v12 offset:50176
s_waitcnt lgkmcnt(3)
v_mfma_f32_16x16x32_bf16 v[144:147], a[248:251], v[104:107], v[144:147]
buffer_load_dwordx4 a[140:143], v1, s[36:39], s15 offen offset:3072
v_mul_f32 v228, v228, v236
v_mfma_f32_16x16x32_bf16 v[148:151], a[248:251], v[108:111], v[148:151]
ds_read_b128 a[248:251], v12 offset:51200
v_mul_f32 v229, v229, v237
s_waitcnt lgkmcnt(3)
v_mfma_f32_16x16x32_bf16 v[152:155], a[252:255], v[104:107], v[152:155]
v_mul_f32 v230, v230, v238
v_mul_f32 v231, v231, v239
v_mfma_f32_16x16x32_bf16 v[156:159], a[252:255], v[108:111], v[156:159]
ds_read_b128 a[252:255], v12 offset:52224
s_waitcnt lgkmcnt(3)
v_mfma_f32_16x16x32_bf16 v[144:147], a[240:243], v[112:115], v[144:147]
s_add_u32 s15, s101, 36864
buffer_load_dwordx4 a[144:147], v1, s[36:39], s15 offen
v_cvt_pk_bf16_f32 v232, v224, v225
v_mfma_f32_16x16x32_bf16 v[148:151], a[240:243], v[116:119], v[148:151]
ds_read_b128 a[240:243], v12 offset:53248
v_cvt_pk_bf16_f32 v234, v228, v229
s_waitcnt lgkmcnt(3)
v_mfma_f32_16x16x32_bf16 v[152:155], a[244:247], v[112:115], v[152:155]
v_cvt_pk_bf16_f32 v233, v226, v227
v_cvt_pk_bf16_f32 v235, v230, v231
v_mfma_f32_16x16x32_bf16 v[156:159], a[244:247], v[116:119], v[156:159]
ds_read_b128 a[244:247], v12 offset:54272
s_waitcnt lgkmcnt(3)
v_mfma_f32_16x16x32_bf16 v[144:147], a[248:251], v[120:123], v[144:147]
buffer_load_dwordx4 a[148:151], v1, s[36:39], s15 offen offset:1024
v_permlane16_swap_b32 v232, v234
v_mfma_f32_16x16x32_bf16 v[148:151], a[248:251], v[124:127], v[148:151]
ds_read_b128 a[248:251], v12 offset:55296
v_permlane16_swap_b32 v233, v235
s_waitcnt lgkmcnt(3)
v_mfma_f32_16x16x32_bf16 v[152:155], a[252:255], v[120:123], v[152:155]
buffer_store_dwordx4 v[232:235], v1, s[36:39], s90 offen offset:1024 sc1
v_mfma_f32_16x16x32_bf16 v[156:159], a[252:255], v[124:127], v[156:159]
ds_read_b128 a[252:255], v12 offset:56320
buffer_load_dword v6, v11, s[36:39], 0 offen sc1
s_waitcnt lgkmcnt(3)
v_mfma_f32_16x16x32_bf16 v[144:147], a[240:243], v[128:131], v[144:147]
buffer_load_dwordx4 a[152:155], v1, s[36:39], s15 offen offset:2048
v_mfma_f32_16x16x32_bf16 v[148:151], a[240:243], v[132:135], v[148:151]
s_waitcnt lgkmcnt(2)
v_mfma_f32_16x16x32_bf16 v[152:155], a[244:247], v[128:131], v[152:155]
v_mfma_f32_16x16x32_bf16 v[156:159], a[244:247], v[132:135], v[156:159]
s_waitcnt lgkmcnt(1)
v_mfma_f32_16x16x32_bf16 v[144:147], a[248:251], v[136:139], v[144:147]
buffer_load_dwordx4 a[156:159], v1, s[36:39], s15 offen offset:3072
v_mfma_f32_16x16x32_bf16 v[148:151], a[248:251], v[140:143], v[148:151]
s_waitcnt lgkmcnt(0)
v_mfma_f32_16x16x32_bf16 v[152:155], a[252:255], v[136:139], v[152:155]
v_mfma_f32_16x16x32_bf16 v[156:159], a[252:255], v[140:143], v[156:159]
s_barrier
s_nop 1
v_fmac_f32 v144, v8, v244
v_fmac_f32 v145, v8, v245
v_fmac_f32 v146, v8, v246
v_fmac_f32 v147, v8, v247
v_fmac_f32 v148, v242, v244
v_fmac_f32 v149, v242, v245
v_fmac_f32 v150, v242, v246
v_fmac_f32 v151, v242, v247
v_fmac_f32 v152, v8, v248
v_fmac_f32 v153, v8, v249
v_fmac_f32 v154, v8, v250
v_fmac_f32 v155, v8, v251
v_fmac_f32 v156, v242, v248
v_fmac_f32 v157, v242, v249
v_fmac_f32 v158, v242, v250
v_fmac_f32 v159, v242, v251
v_mul_f32 v144, v144, v152
v_mul_f32 v145, v145, v153
v_mul_f32 v146, v146, v154
v_mul_f32 v147, v147, v155
v_mul_f32 v148, v148, v156
v_mul_f32 v149, v149, v157
v_mul_f32 v150, v150, v158
v_mul_f32 v151, v151, v159
v_cvt_pk_bf16_f32 v152, v144, v145
v_cvt_pk_bf16_f32 v154, v148, v149
v_cvt_pk_bf16_f32 v153, v146, v147
v_cvt_pk_bf16_f32 v155, v150, v151
v_permlane16_swap_b32 v152, v154
s_nop 0
v_permlane16_swap_b32_e64 v153, v155
buffer_store_dwordx4 v[152:155], v1, s[36:39], s90 offen offset:2048 sc1
s_waitcnt vmcnt(3)
v_cmp_gt_u32 vcc, 3, v6
s_nop 0
s_cbranch_vccz Lgo_25
Lpoll_24:
buffer_load_dword v6, v11, s[36:39], 0 offen sc1
s_waitcnt vmcnt(0)
v_cmp_gt_u32 vcc, 3, v6
s_nop 0
s_cbranch_vccz Lgo_25
s_add_u32 s91, s91, 1
s_bitcmp0_b32 s91, 16
s_cbranch_scc1 Lpoll_24
Lgo_25:
s_add_u32 s77, s92, 0
buffer_load_dwordx4 v[80:83], v14, s[36:39], s77 offen sc1
buffer_load_dwordx4 v[84:87], v14, s[36:39], s77 offen offset:256 sc1
s_add_u32 s77, s93, 0
buffer_load_dwordx4 v[88:91], v14, s[36:39], s77 offen sc1
buffer_load_dwordx4 v[92:95], v14, s[36:39], s77 offen offset:256 sc1
v_mov_b32 v7, 4
v_mov_b32_e64 v6, s83
s_waitcnt vmcnt(4)
s_mov_b64 exec, 1
buffer_store_dword v7, v6, s[36:39], 0 offen
s_mov_b64 exec, -1
s_add_u32 s77, s92, 7168
buffer_load_dwordx4 v[96:99], v14, s[36:39], s77 offen sc1
buffer_load_dwordx4 v[100:103], v14, s[36:39], s77 offen offset:256 sc1
s_add_u32 s77, s93, 7168
buffer_load_dwordx4 v[104:107], v14, s[36:39], s77 offen sc1
buffer_load_dwordx4 v[108:111], v14, s[36:39], s77 offen offset:256 sc1
s_add_u32 s77, s92, 14336
buffer_load_dwordx4 v[112:115], v14, s[36:39], s77 offen sc1
buffer_load_dwordx4 v[116:119], v14, s[36:39], s77 offen offset:256 sc1
s_add_u32 s77, s93, 14336
buffer_load_dwordx4 v[120:123], v14, s[36:39], s77 offen sc1
buffer_load_dwordx4 v[124:127], v14, s[36:39], s77 offen offset:256 sc1
s_waitcnt vmcnt(12)
v_mfma_f32_16x16x32_bf16 v[16:19], a[0:3], v[80:83], 0
s_add_u32 s77, s92, 21504
buffer_load_dwordx4 v[128:131], v14, s[36:39], s77 offen sc1
v_mfma_f32_16x16x32_bf16 v[24:27], a[4:7], v[80:83], 0
v_lshrrev_b32_e64 v7, 5, v0
v_mul_u32_u24 v7, 6144, v7
v_mfma_f32_16x16x32_bf16 v[48:51], a[8:11], v[80:83], 0
v_mfma_f32_16x16x32_bf16 v[56:59], a[12:15], v[80:83], 0
s_waitcnt vmcnt(12)
v_mfma_f32_16x16x32_bf16 v[20:23], a[0:3], v[84:87], 0
buffer_load_dwordx4 v[132:135], v14, s[36:39], s77 offen offset:256 sc1
v_mfma_f32_16x16x32_bf16 v[28:31], a[4:7], v[84:87], 0
v_add_u32_e64 v250, v7, v14
s_sub_u32 s78, s68, 1
v_mfma_f32_16x16x32_bf16 v[52:55], a[8:11], v[84:87], 0
v_mfma_f32_16x16x32_bf16 v[60:63], a[12:15], v[84:87], 0
s_waitcnt vmcnt(12)
v_mfma_f32_16x16x32_bf16 v[32:35], a[0:3], v[88:91], 0
s_add_u32 s77, s93, 21504
buffer_load_dwordx4 v[136:139], v14, s[36:39], s77 offen sc1
v_mfma_f32_16x16x32_bf16 v[40:43], a[4:7], v[88:91], 0
s_and_b32 s78, s78, 3
s_lshl_b32 s78, s78, 12
v_mfma_f32_16x16x32_bf16 v[64:67], a[8:11], v[88:91], 0
s_add_u32 s15, s101, 40960
buffer_load_dwordx4 a[160:163], v1, s[36:39], s15 offen
v_mfma_f32_16x16x32_bf16 v[72:75], a[12:15], v[88:91], 0
s_waitcnt vmcnt(13)
v_mfma_f32_16x16x32_bf16 v[36:39], a[0:3], v[92:95], 0
buffer_load_dwordx4 v[140:143], v14, s[36:39], s77 offen offset:256 sc1
v_mfma_f32_16x16x32_bf16 v[44:47], a[4:7], v[92:95], 0
s_add_u32 s78, s78, 67584
v_add_u32_e64 v12, s78, v1
v_mfma_f32_16x16x32_bf16 v[68:71], a[8:11], v[92:95], 0
buffer_load_dwordx4 a[164:167], v1, s[36:39], s15 offen offset:1024
v_mfma_f32_16x16x32_bf16 v[76:79], a[12:15], v[92:95], 0
s_waitcnt vmcnt(13)
v_mfma_f32_16x16x32_bf16 v[16:19], a[16:19], v[96:99], v[16:19]
s_add_u32 s77, s92, 2048
buffer_load_dwordx4 v[160:163], v14, s[36:39], s77 offen sc1
v_mfma_f32_16x16x32_bf16 v[24:27], a[20:23], v[96:99], v[24:27]
s_sub_u32 s78, s68, 3
s_and_b32 s78, s78, 3
v_mfma_f32_16x16x32_bf16 v[48:51], a[24:27], v[96:99], v[48:51]
buffer_load_dwordx4 a[168:171], v1, s[36:39], s15 offen offset:2048
v_mfma_f32_16x16x32_bf16 v[56:59], a[28:31], v[96:99], v[56:59]
s_waitcnt vmcnt(14)
v_mfma_f32_16x16x32_bf16 v[20:23], a[16:19], v[100:103], v[20:23]
buffer_load_dwordx4 v[164:167], v14, s[36:39], s77 offen offset:256 sc1
v_mfma_f32_16x16x32_bf16 v[28:31], a[20:23], v[100:103], v[28:31]
s_lshl_b32 s78, s78, 12
s_add_u32 s78, s78, 100352
v_mfma_f32_16x16x32_bf16 v[52:55], a[24:27], v[100:103], v[52:55]
buffer_load_dwordx4 a[172:175], v1, s[36:39], s15 offen offset:3072
v_mfma_f32_16x16x32_bf16 v[60:63], a[28:31], v[100:103], v[60:63]
s_waitcnt vmcnt(15)
v_mfma_f32_16x16x32_bf16 v[32:35], a[16:19], v[104:107], v[32:35]
s_add_u32 s77, s93, 2048
buffer_load_dwordx4 v[168:171], v14, s[36:39], s77 offen sc1
v_mfma_f32_16x16x32_bf16 v[40:43], a[20:23], v[104:107], v[40:43]
v_add_u32 v13, s78, v1
s_lshl_b32 s78, s68, 14
v_mfma_f32_16x16x32_bf16 v[64:67], a[24:27], v[104:107], v[64:67]
s_add_u32 s15, s101, 45056
buffer_load_dwordx4 a[176:179], v1, s[36:39], s15 offen
v_mfma_f32_16x16x32_bf16 v[72:75], a[28:31], v[104:107], v[72:75]
s_waitcnt vmcnt(16)
v_mfma_f32_16x16x32_bf16 v[36:39], a[16:19], v[108:111], v[36:39]
buffer_load_dwordx4 v[172:175], v14, s[36:39], s77 offen offset:256 sc1
v_mfma_f32_16x16x32_bf16 v[44:47], a[20:23], v[108:111], v[44:47]
s_add_u32 s78, s78, 67584
v_add_u32 v248, s78, v1
v_mfma_f32_16x16x32_bf16 v[68:71], a[24:27], v[108:111], v[68:71]
buffer_load_dwordx4 a[180:183], v1, s[36:39], s15 offen offset:1024
v_mfma_f32_16x16x32_bf16 v[76:79], a[28:31], v[108:111], v[76:79]
s_waitcnt vmcnt(17)
v_mfma_f32_16x16x32_bf16 v[16:19], a[32:35], v[112:115], v[16:19]
buffer_load_dword v6, v11, s[36:39], 0 offen sc1
s_add_u32 s77, s92, 9216
buffer_load_dwordx4 v[176:179], v14, s[36:39], s77 offen sc1
v_mfma_f32_16x16x32_bf16 v[24:27], a[36:39], v[112:115], v[24:27]
s_lshl_b32 s78, s73, 1
s_add_u32 s78, s78, s75
v_mfma_f32_16x16x32_bf16 v[48:51], a[40:43], v[112:115], v[48:51]
buffer_load_dwordx4 a[184:187], v1, s[36:39], s15 offen offset:2048
v_mfma_f32_16x16x32_bf16 v[56:59], a[44:47], v[112:115], v[56:59]
s_waitcnt vmcnt(19)
v_mfma_f32_16x16x32_bf16 v[20:23], a[32:35], v[116:119], v[20:23]
buffer_load_dwordx4 v[180:183], v14, s[36:39], s77 offen offset:256 sc1
v_mfma_f32_16x16x32_bf16 v[28:31], a[36:39], v[116:119], v[28:31]
s_lshl_b32 s78, s78, 7
s_add_u32 s78, s78, 66944
v_mfma_f32_16x16x32_bf16 v[52:55], a[40:43], v[116:119], v[52:55]
buffer_load_dwordx4 a[188:191], v1, s[36:39], s15 offen offset:3072
v_mfma_f32_16x16x32_bf16 v[60:63], a[44:47], v[116:119], v[60:63]
s_waitcnt vmcnt(20)
v_mfma_f32_16x16x32_bf16 v[32:35], a[32:35], v[120:123], v[32:35]
s_add_u32 s77, s93, 9216
buffer_load_dwordx4 v[184:187], v14, s[36:39], s77 offen sc1
v_mfma_f32_16x16x32_bf16 v[40:43], a[36:39], v[120:123], v[40:43]
v_and_b32_e64 v7, 15, v0
v_lshl_add_u32 v249, v7, 2, s78
v_mfma_f32_16x16x32_bf16 v[64:67], a[40:43], v[120:123], v[64:67]
s_add_u32 s15, s101, 49152
buffer_load_dwordx4 a[192:195], v1, s[36:39], s15 offen
v_mfma_f32_16x16x32_bf16 v[72:75], a[44:47], v[120:123], v[72:75]
s_waitcnt vmcnt(21)
v_mfma_f32_16x16x32_bf16 v[36:39], a[32:35], v[124:127], v[36:39]
buffer_load_dwordx4 v[188:191], v14, s[36:39], s77 offen offset:256 sc1
v_mfma_f32_16x16x32_bf16 v[44:47], a[36:39], v[124:127], v[44:47]
s_add_u32 s16, s80, 4194304
s_add_u32 s17, s81, 262144
v_mfma_f32_16x16x32_bf16 v[68:71], a[40:43], v[124:127], v[68:71]
buffer_load_dwordx4 a[196:199], v1, s[36:39], s15 offen offset:1024
v_mfma_f32_16x16x32_bf16 v[76:79], a[44:47], v[124:127], v[76:79]
s_waitcnt vmcnt(22)
v_mfma_f32_16x16x32_bf16 v[16:19], a[48:51], v[128:131], v[16:19]
s_add_u32 s77, s92, 16384
buffer_load_dwordx4 v[192:195], v14, s[36:39], s77 offen sc1
v_mfma_f32_16x16x32_bf16 v[24:27], a[52:55], v[128:131], v[24:27]
s_sub_u32 s17, s16, s17
v_and_b32 v251, 15, v0
v_mfma_f32_16x16x32_bf16 v[48:51], a[56:59], v[128:131], v[48:51]
buffer_load_dwordx4 a[200:203], v1, s[36:39], s15 offen offset:2048
v_mfma_f32_16x16x32_bf16 v[56:59], a[60:63], v[128:131], v[56:59]
s_waitcnt vmcnt(23)
v_mfma_f32_16x16x32_bf16 v[20:23], a[48:51], v[132:135], v[20:23]
buffer_load_dwordx4 v[196:199], v14, s[36:39], s77 offen offset:256 sc1
v_mfma_f32_16x16x32_bf16 v[28:31], a[52:55], v[132:135], v[28:31]
v_lshlrev_b32 v251, 7, v251
v_bfe_i32 v252, v0, 5, 1
v_mfma_f32_16x16x32_bf16 v[52:55], a[56:59], v[132:135], v[52:55]
buffer_load_dwordx4 a[204:207], v1, s[36:39], s15 offen offset:3072
v_mfma_f32_16x16x32_bf16 v[60:63], a[60:63], v[132:135], v[60:63]
s_waitcnt vmcnt(24)
v_mfma_f32_16x16x32_bf16 v[32:35], a[48:51], v[136:139], v[32:35]
s_add_u32 s77, s93, 16384
buffer_load_dwordx4 v[200:203], v14, s[36:39], s77 offen sc1
v_mfma_f32_16x16x32_bf16 v[40:43], a[52:55], v[136:139], v[40:43]
v_and_b32 v253, 0x600, v251
v_add_u32 v253, s17, v253
v_mfma_f32_16x16x32_bf16 v[64:67], a[56:59], v[136:139], v[64:67]
s_add_u32 s15, s101, 53248
buffer_load_dwordx4 a[208:211], v1, s[36:39], s15 offen
v_mfma_f32_16x16x32_bf16 v[72:75], a[60:63], v[136:139], v[72:75]
s_waitcnt vmcnt(24)
v_mfma_f32_16x16x32_bf16 v[36:39], a[48:51], v[140:143], v[36:39]
buffer_load_dwordx4 v[204:207], v14, s[36:39], s77 offen offset:256 sc1
v_mfma_f32_16x16x32_bf16 v[44:47], a[52:55], v[140:143], v[44:47]
v_and_b32_e64 v253, v252, v253
v_sub_u32 v251, v251, v253
v_mfma_f32_16x16x32_bf16 v[68:71], a[56:59], v[140:143], v[68:71]
buffer_load_dwordx4 a[212:215], v1, s[36:39], s15 offen offset:1024
v_mfma_f32_16x16x32_bf16 v[76:79], a[60:63], v[140:143], v[76:79]
s_waitcnt vmcnt(24)
v_mfma_f32_16x16x32_bf16 v[16:19], a[64:67], v[160:163], v[16:19]
s_add_u32 s77, s92, 23552
buffer_load_dwordx4 v[208:211], v14, s[36:39], s77 offen sc1
v_mfma_f32_16x16x32_bf16 v[24:27], a[68:71], v[160:163], v[24:27]
v_add_u32 v251, s16, v251
v_mfma_f32_16x16x32_bf16 v[48:51], a[72:75], v[160:163], v[48:51]
buffer_load_dwordx4 a[216:219], v1, s[36:39], s15 offen offset:2048
v_mfma_f32_16x16x32_bf16 v[56:59], a[76:79], v[160:163], v[56:59]
s_waitcnt vmcnt(24)
v_mfma_f32_16x16x32_bf16 v[20:23], a[64:67], v[164:167], v[20:23]
buffer_load_dwordx4 v[212:215], v14, s[36:39], s77 offen offset:256 sc1
v_mfma_f32_16x16x32_bf16 v[28:31], a[68:71], v[164:167], v[28:31]
v_mfma_f32_16x16x32_bf16 v[52:55], a[72:75], v[164:167], v[52:55]
buffer_load_dwordx4 a[220:223], v1, s[36:39], s15 offen offset:3072
v_mfma_f32_16x16x32_bf16 v[60:63], a[76:79], v[164:167], v[60:63]
s_waitcnt vmcnt(24)
v_mfma_f32_16x16x32_bf16 v[32:35], a[64:67], v[168:171], v[32:35]
s_add_u32 s77, s93, 23552
buffer_load_dwordx4 v[216:219], v14, s[36:39], s77 offen sc1
v_mfma_f32_16x16x32_bf16 v[40:43], a[68:71], v[168:171], v[40:43]
v_mfma_f32_16x16x32_bf16 v[64:67], a[72:75], v[168:171], v[64:67]
v_mfma_f32_16x16x32_bf16 v[72:75], a[76:79], v[168:171], v[72:75]
s_waitcnt vmcnt(23)
v_mfma_f32_16x16x32_bf16 v[36:39], a[64:67], v[172:175], v[36:39]
buffer_load_dwordx4 v[220:223], v14, s[36:39], s77 offen offset:256 sc1
v_mfma_f32_16x16x32_bf16 v[44:47], a[68:71], v[172:175], v[44:47]
v_mfma_f32_16x16x32_bf16 v[68:71], a[72:75], v[172:175], v[68:71]
v_mfma_f32_16x16x32_bf16 v[76:79], a[76:79], v[172:175], v[76:79]
s_waitcnt vmcnt(21)
v_mfma_f32_16x16x32_bf16 v[16:19], a[80:83], v[176:179], v[16:19]
v_cmp_gt_u32 vcc, 4, v6
s_nop 0
s_cbranch_vccz Lgo_27
Lpoll_26:
buffer_load_dword v6, v11, s[36:39], 0 offen sc1
s_waitcnt vmcnt(0)
v_cmp_gt_u32 vcc, 4, v6
s_nop 0
s_cbranch_vccz Lgo_27
s_add_u32 s91, s91, 1
s_bitcmp0_b32 s91, 16
s_cbranch_scc1 Lpoll_26
Lgo_27:
s_add_u32 s77, s92, 4096
buffer_load_dwordx4 v[224:227], v14, s[36:39], s77 offen sc1
v_mfma_f32_16x16x32_bf16 v[24:27], a[84:87], v[176:179], v[24:27]
v_mfma_f32_16x16x32_bf16 v[48:51], a[88:91], v[176:179], v[48:51]
v_mfma_f32_16x16x32_bf16 v[56:59], a[92:95], v[176:179], v[56:59]
s_waitcnt vmcnt(20)
v_mfma_f32_16x16x32_bf16 v[20:23], a[80:83], v[180:183], v[20:23]
buffer_load_dwordx4 v[228:231], v14, s[36:39], s77 offen offset:256 sc1
v_mfma_f32_16x16x32_bf16 v[28:31], a[84:87], v[180:183], v[28:31]
v_mfma_f32_16x16x32_bf16 v[52:55], a[88:91], v[180:183], v[52:55]
v_mfma_f32_16x16x32_bf16 v[60:63], a[92:95], v[180:183], v[60:63]
s_waitcnt vmcnt(19)
v_mfma_f32_16x16x32_bf16 v[32:35], a[80:83], v[184:187], v[32:35]
s_add_u32 s77, s92, 11264
buffer_load_dwordx4 v[232:235], v14, s[36:39], s77 offen sc1
v_mfma_f32_16x16x32_bf16 v[40:43], a[84:87], v[184:187], v[40:43]
v_mfma_f32_16x16x32_bf16 v[64:67], a[88:91], v[184:187], v[64:67]
v_mfma_f32_16x16x32_bf16 v[72:75], a[92:95], v[184:187], v[72:75]
s_waitcnt vmcnt(18)
v_mfma_f32_16x16x32_bf16 v[36:39], a[80:83], v[188:191], v[36:39]
buffer_load_dwordx4 v[236:239], v14, s[36:39], s77 offen offset:256 sc1
v_mfma_f32_16x16x32_bf16 v[44:47], a[84:87], v[188:191], v[44:47]
v_mfma_f32_16x16x32_bf16 v[68:71], a[88:91], v[188:191], v[68:71]
v_mfma_f32_16x16x32_bf16 v[76:79], a[92:95], v[188:191], v[76:79]
s_waitcnt vmcnt(17)
v_mfma_f32_16x16x32_bf16 v[16:19], a[96:99], v[192:195], v[16:19]
s_add_u32 s77, s92, 18432
buffer_load_dwordx4 v[80:83], v14, s[36:39], s77 offen sc1
v_mfma_f32_16x16x32_bf16 v[24:27], a[100:103], v[192:195], v[24:27]
v_mfma_f32_16x16x32_bf16 v[48:51], a[104:107], v[192:195], v[48:51]
v_mfma_f32_16x16x32_bf16 v[56:59], a[108:111], v[192:195], v[56:59]
s_waitcnt vmcnt(16)
v_mfma_f32_16x16x32_bf16 v[20:23], a[96:99], v[196:199], v[20:23]
buffer_load_dwordx4 v[84:87], v14, s[36:39], s77 offen offset:256 sc1
v_mfma_f32_16x16x32_bf16 v[28:31], a[100:103], v[196:199], v[28:31]
v_mfma_f32_16x16x32_bf16 v[52:55], a[104:107], v[196:199], v[52:55]
v_mfma_f32_16x16x32_bf16 v[60:63], a[108:111], v[196:199], v[60:63]
s_waitcnt vmcnt(15)
v_mfma_f32_16x16x32_bf16 v[32:35], a[96:99], v[200:203], v[32:35]
s_add_u32 s77, s92, 25600
buffer_load_dwordx4 v[88:91], v14, s[36:39], s77 offen sc1
v_mfma_f32_16x16x32_bf16 v[40:43], a[100:103], v[200:203], v[40:43]
v_mfma_f32_16x16x32_bf16 v[64:67], a[104:107], v[200:203], v[64:67]
v_mfma_f32_16x16x32_bf16 v[72:75], a[108:111], v[200:203], v[72:75]
s_waitcnt vmcnt(14)
v_mfma_f32_16x16x32_bf16 v[36:39], a[96:99], v[204:207], v[36:39]
buffer_load_dwordx4 v[92:95], v14, s[36:39], s77 offen offset:256 sc1
v_mfma_f32_16x16x32_bf16 v[44:47], a[100:103], v[204:207], v[44:47]
v_mfma_f32_16x16x32_bf16 v[68:71], a[104:107], v[204:207], v[68:71]
v_mfma_f32_16x16x32_bf16 v[76:79], a[108:111], v[204:207], v[76:79]
s_waitcnt vmcnt(13)
v_mfma_f32_16x16x32_bf16 v[16:19], a[112:115], v[208:211], v[16:19]
s_add_u32 s77, s92, 6144
buffer_load_dwordx4 v[96:99], v250, s[36:39], s77 offen sc1
v_mfma_f32_16x16x32_bf16 v[24:27], a[116:119], v[208:211], v[24:27]
v_mfma_f32_16x16x32_bf16 v[48:51], a[120:123], v[208:211], v[48:51]
v_mfma_f32_16x16x32_bf16 v[56:59], a[124:127], v[208:211], v[56:59]
s_waitcnt vmcnt(12)
v_mfma_f32_16x16x32_bf16 v[20:23], a[112:115], v[212:215], v[20:23]
buffer_load_dwordx4 v[100:103], v250, s[36:39], s77 offen offset:256 sc1
v_mfma_f32_16x16x32_bf16 v[28:31], a[116:119], v[212:215], v[28:31]
v_mfma_f32_16x16x32_bf16 v[52:55], a[120:123], v[212:215], v[52:55]
v_mfma_f32_16x16x32_bf16 v[60:63], a[124:127], v[212:215], v[60:63]
s_waitcnt vmcnt(11)
v_mfma_f32_16x16x32_bf16 v[32:35], a[112:115], v[216:219], v[32:35]
s_add_u32 s77, s92, 20480
buffer_load_dwordx4 v[104:107], v250, s[36:39], s77 offen sc1
v_mfma_f32_16x16x32_bf16 v[40:43], a[116:119], v[216:219], v[40:43]
v_mfma_f32_16x16x32_bf16 v[64:67], a[120:123], v[216:219], v[64:67]
v_mfma_f32_16x16x32_bf16 v[72:75], a[124:127], v[216:219], v[72:75]
s_waitcnt vmcnt(11)
v_mfma_f32_16x16x32_bf16 v[36:39], a[112:115], v[220:223], v[36:39]
buffer_load_dwordx4 v[108:111], v250, s[36:39], s77 offen offset:256 sc1
v_mfma_f32_16x16x32_bf16 v[44:47], a[116:119], v[220:223], v[44:47]
v_mfma_f32_16x16x32_bf16 v[68:71], a[120:123], v[220:223], v[68:71]
v_mfma_f32_16x16x32_bf16 v[76:79], a[124:127], v[220:223], v[76:79]
s_waitcnt vmcnt(11)
v_mfma_f32_16x16x32_bf16 v[16:19], a[128:131], v[224:227], v[16:19]
s_add_u32 s77, s93, 4096
buffer_load_dwordx4 v[112:115], v14, s[36:39], s77 offen sc1
v_mfma_f32_16x16x32_bf16 v[24:27], a[132:135], v[224:227], v[24:27]
v_mfma_f32_16x16x32_bf16 v[48:51], a[136:139], v[224:227], v[48:51]
v_mfma_f32_16x16x32_bf16 v[56:59], a[140:143], v[224:227], v[56:59]
s_waitcnt vmcnt(11)
v_mfma_f32_16x16x32_bf16 v[20:23], a[128:131], v[228:231], v[20:23]
buffer_load_dwordx4 v[116:119], v14, s[36:39], s77 offen offset:256 sc1
v_mfma_f32_16x16x32_bf16 v[28:31], a[132:135], v[228:231], v[28:31]
v_mfma_f32_16x16x32_bf16 v[52:55], a[136:139], v[228:231], v[52:55]
v_mfma_f32_16x16x32_bf16 v[60:63], a[140:143], v[228:231], v[60:63]
s_waitcnt vmcnt(11)
v_mfma_f32_16x16x32_bf16 v[16:19], a[144:147], v[232:235], v[16:19]
s_add_u32 s77, s93, 11264
buffer_load_dwordx4 v[120:123], v14, s[36:39], s77 offen sc1
v_mfma_f32_16x16x32_bf16 v[24:27], a[148:151], v[232:235], v[24:27]
v_mfma_f32_16x16x32_bf16 v[48:51], a[152:155], v[232:235], v[48:51]
v_mfma_f32_16x16x32_bf16 v[56:59], a[156:159], v[232:235], v[56:59]
s_waitcnt vmcnt(11)
v_mfma_f32_16x16x32_bf16 v[20:23], a[144:147], v[236:239], v[20:23]
buffer_load_dwordx4 v[124:127], v14, s[36:39], s77 offen offset:256 sc1
v_mfma_f32_16x16x32_bf16 v[28:31], a[148:151], v[236:239], v[28:31]
v_mfma_f32_16x16x32_bf16 v[52:55], a[152:155], v[236:239], v[52:55]
v_mfma_f32_16x16x32_bf16 v[60:63], a[156:159], v[236:239], v[60:63]
s_waitcnt vmcnt(11)
v_mfma_f32_16x16x32_bf16 v[16:19], a[160:163], v[80:83], v[16:19]
s_add_u32 s77, s93, 18432
buffer_load_dwordx4 v[128:131], v14, s[36:39], s77 offen sc1
v_mfma_f32_16x16x32_bf16 v[24:27], a[164:167], v[80:83], v[24:27]
v_mfma_f32_16x16x32_bf16 v[48:51], a[168:171], v[80:83], v[48:51]
v_mfma_f32_16x16x32_bf16 v[56:59], a[172:175], v[80:83], v[56:59]
s_waitcnt vmcnt(11)
v_mfma_f32_16x16x32_bf16 v[20:23], a[160:163], v[84:87], v[20:23]
buffer_load_dwordx4 v[132:135], v14, s[36:39], s77 offen offset:256 sc1
v_mfma_f32_16x16x32_bf16 v[28:31], a[164:167], v[84:87], v[28:31]
v_mfma_f32_16x16x32_bf16 v[52:55], a[168:171], v[84:87], v[52:55]
v_mfma_f32_16x16x32_bf16 v[60:63], a[172:175], v[84:87], v[60:63]
s_waitcnt vmcnt(11)
v_mfma_f32_16x16x32_bf16 v[16:19], a[176:179], v[88:91], v[16:19]
s_add_u32 s77, s93, 25600
buffer_load_dwordx4 v[136:139], v14, s[36:39], s77 offen sc1
v_mfma_f32_16x16x32_bf16 v[24:27], a[180:183], v[88:91], v[24:27]
v_mfma_f32_16x16x32_bf16 v[48:51], a[184:187], v[88:91], v[48:51]
v_mfma_f32_16x16x32_bf16 v[56:59], a[188:191], v[88:91], v[56:59]
s_waitcnt vmcnt(11)
v_mfma_f32_16x16x32_bf16 v[20:23], a[176:179], v[92:95], v[20:23]
buffer_load_dwordx4 v[140:143], v14, s[36:39], s77 offen offset:256 sc1
v_mfma_f32_16x16x32_bf16 v[28:31], a[180:183], v[92:95], v[28:31]
v_mfma_f32_16x16x32_bf16 v[52:55], a[184:187], v[92:95], v[52:55]
v_mfma_f32_16x16x32_bf16 v[60:63], a[188:191], v[92:95], v[60:63]
s_waitcnt vmcnt(11)
v_mfma_f32_16x16x32_bf16 v[16:19], a[192:195], v[96:99], v[16:19]
s_add_u32 s77, s93, 6144
buffer_load_dwordx4 v[160:163], v250, s[36:39], s77 offen sc1
v_mfma_f32_16x16x32_bf16 v[24:27], a[196:199], v[96:99], v[24:27]
v_mfma_f32_16x16x32_bf16 v[48:51], a[200:203], v[96:99], v[48:51]
v_mfma_f32_16x16x32_bf16 v[56:59], a[204:207], v[96:99], v[56:59]
s_waitcnt vmcnt(11)
v_mfma_f32_16x16x32_bf16 v[20:23], a[192:195], v[100:103], v[20:23]
buffer_load_dwordx4 v[164:167], v250, s[36:39], s77 offen offset:256 sc1
v_mfma_f32_16x16x32_bf16 v[28:31], a[196:199], v[100:103], v[28:31]
v_mfma_f32_16x16x32_bf16 v[52:55], a[200:203], v[100:103], v[52:55]
v_mfma_f32_16x16x32_bf16 v[60:63], a[204:207], v[100:103], v[60:63]
s_waitcnt vmcnt(11)
v_mfma_f32_16x16x32_bf16 v[16:19], a[208:211], v[104:107], v[16:19]
s_add_u32 s77, s93, 20480
buffer_load_dwordx4 v[168:171], v250, s[36:39], s77 offen sc1
v_mfma_f32_16x16x32_bf16 v[24:27], a[212:215], v[104:107], v[24:27]
v_mfma_f32_16x16x32_bf16 v[48:51], a[216:219], v[104:107], v[48:51]
v_mfma_f32_16x16x32_bf16 v[56:59], a[220:223], v[104:107], v[56:59]
s_waitcnt vmcnt(11)
v_mfma_f32_16x16x32_bf16 v[20:23], a[208:211], v[108:111], v[20:23]
buffer_load_dwordx4 v[172:175], v250, s[36:39], s77 offen offset:256 sc1
v_mfma_f32_16x16x32_bf16 v[28:31], a[212:215], v[108:111], v[28:31]
v_mfma_f32_16x16x32_bf16 v[52:55], a[216:219], v[108:111], v[52:55]
v_mfma_f32_16x16x32_bf16 v[60:63], a[220:223], v[108:111], v[60:63]
s_waitcnt vmcnt(11)
v_mfma_f32_16x16x32_bf16 v[32:35], a[128:131], v[112:115], v[32:35]
s_add_u32 s94, s80, 6291456
buffer_load_dwordx4 v[240:243], v1, s[36:39], s94 offen sc1
buffer_load_dwordx4 v[244:247], v1, s[36:39], s94 offen offset:1024 sc1
v_mfma_f32_16x16x32_bf16 v[40:43], a[132:135], v[112:115], v[40:43]
v_mfma_f32_16x16x32_bf16 v[64:67], a[136:139], v[112:115], v[64:67]
v_mfma_f32_16x16x32_bf16 v[72:75], a[140:143], v[112:115], v[72:75]
s_waitcnt vmcnt(12)
v_mfma_f32_16x16x32_bf16 v[36:39], a[128:131], v[116:119], v[36:39]
buffer_load_dword a240, v251, s[36:39], 0 offen
v_mfma_f32_16x16x32_bf16 v[44:47], a[132:135], v[116:119], v[44:47]
v_mfma_f32_16x16x32_bf16 v[68:71], a[136:139], v[116:119], v[68:71]
v_mfma_f32_16x16x32_bf16 v[76:79], a[140:143], v[116:119], v[76:79]
s_waitcnt vmcnt(12)
v_mfma_f32_16x16x32_bf16 v[32:35], a[144:147], v[120:123], v[32:35]
v_mfma_f32_16x16x32_bf16 v[40:43], a[148:151], v[120:123], v[40:43]
v_mfma_f32_16x16x32_bf16 v[64:67], a[152:155], v[120:123], v[64:67]
v_mfma_f32_16x16x32_bf16 v[72:75], a[156:159], v[120:123], v[72:75]
ds_read2_b32 v[8:9], v249 offset0:0 offset1:16
s_waitcnt vmcnt(11)
v_mfma_f32_16x16x32_bf16 v[36:39], a[144:147], v[124:127], v[36:39]
v_mfma_f32_16x16x32_bf16 v[44:47], a[148:151], v[124:127], v[44:47]
v_mfma_f32_16x16x32_bf16 v[68:71], a[152:155], v[124:127], v[68:71]
v_mfma_f32_16x16x32_bf16 v[76:79], a[156:159], v[124:127], v[76:79]
ds_write_b128 v12, v[16:19] offset:0
s_waitcnt vmcnt(10)
v_mfma_f32_16x16x32_bf16 v[32:35], a[160:163], v[128:131], v[32:35]
v_mfma_f32_16x16x32_bf16 v[40:43], a[164:167], v[128:131], v[40:43]
v_mfma_f32_16x16x32_bf16 v[64:67], a[168:171], v[128:131], v[64:67]
v_mfma_f32_16x16x32_bf16 v[72:75], a[172:175], v[128:131], v[72:75]
ds_write_b128 v12, v[20:23] offset:1024
s_waitcnt vmcnt(9)
v_mfma_f32_16x16x32_bf16 v[36:39], a[160:163], v[132:135], v[36:39]
v_mfma_f32_16x16x32_bf16 v[44:47], a[164:167], v[132:135], v[44:47]
v_mfma_f32_16x16x32_bf16 v[68:71], a[168:171], v[132:135], v[68:71]
v_mfma_f32_16x16x32_bf16 v[76:79], a[172:175], v[132:135], v[76:79]
ds_write_b128 v12, v[24:27] offset:2048
s_waitcnt vmcnt(8)
v_mfma_f32_16x16x32_bf16 v[32:35], a[176:179], v[136:139], v[32:35]
v_mfma_f32_16x16x32_bf16 v[40:43], a[180:183], v[136:139], v[40:43]
v_mfma_f32_16x16x32_bf16 v[64:67], a[184:187], v[136:139], v[64:67]
v_mfma_f32_16x16x32_bf16 v[72:75], a[188:191], v[136:139], v[72:75]
ds_write_b128 v12, v[28:31] offset:3072
s_waitcnt vmcnt(7)
v_mfma_f32_16x16x32_bf16 v[36:39], a[176:179], v[140:143], v[36:39]
v_mfma_f32_16x16x32_bf16 v[44:47], a[180:183], v[140:143], v[44:47]
v_mfma_f32_16x16x32_bf16 v[68:71], a[184:187], v[140:143], v[68:71]
v_mfma_f32_16x16x32_bf16 v[76:79], a[188:191], v[140:143], v[76:79]
ds_write_b128 v13, v[48:51] offset:0
s_waitcnt vmcnt(6)
v_mfma_f32_16x16x32_bf16 v[32:35], a[192:195], v[160:163], v[32:35]
v_mfma_f32_16x16x32_bf16 v[40:43], a[196:199], v[160:163], v[40:43]
v_mfma_f32_16x16x32_bf16 v[64:67], a[200:203], v[160:163], v[64:67]
v_mfma_f32_16x16x32_bf16 v[72:75], a[204:207], v[160:163], v[72:75]
ds_write_b128 v13, v[52:55] offset:1024
s_waitcnt vmcnt(5)
v_mfma_f32_16x16x32_bf16 v[36:39], a[192:195], v[164:167], v[36:39]
v_mfma_f32_16x16x32_bf16 v[44:47], a[196:199], v[164:167], v[44:47]
v_mfma_f32_16x16x32_bf16 v[68:71], a[200:203], v[164:167], v[68:71]
v_mfma_f32_16x16x32_bf16 v[76:79], a[204:207], v[164:167], v[76:79]
ds_write_b128 v13, v[56:59] offset:2048
s_waitcnt vmcnt(4)
v_mfma_f32_16x16x32_bf16 v[32:35], a[208:211], v[168:171], v[32:35]
v_mfma_f32_16x16x32_bf16 v[40:43], a[212:215], v[168:171], v[40:43]
v_mfma_f32_16x16x32_bf16 v[64:67], a[216:219], v[168:171], v[64:67]
v_mfma_f32_16x16x32_bf16 v[72:75], a[220:223], v[168:171], v[72:75]
ds_write_b128 v13, v[60:63] offset:3072
s_waitcnt vmcnt(3)
v_mfma_f32_16x16x32_bf16 v[36:39], a[208:211], v[172:175], v[36:39]
v_mfma_f32_16x16x32_bf16 v[44:47], a[212:215], v[172:175], v[44:47]
v_mfma_f32_16x16x32_bf16 v[68:71], a[216:219], v[172:175], v[68:71]
v_mfma_f32_16x16x32_bf16 v[76:79], a[220:223], v[172:175], v[76:79]
v_add_u32 v11, 67584, v1
s_cmp_ge_u32 s68, 2
s_cbranch_scc1 Lsc_30
Lsc_28:
s_cmp_eq_u32 s68, 1
s_cbranch_scc1 Lsc_29
ds_write_b128 v11, v[32:35] offset:24576
ds_write_b128 v11, v[36:39] offset:25600
ds_write_b128 v11, v[40:43] offset:26624
ds_write_b128 v11, v[44:47] offset:27648
ds_write_b128 v11, v[64:67] offset:49152
ds_write_b128 v11, v[68:71] offset:50176
ds_write_b128 v11, v[72:75] offset:51200
ds_write_b128 v11, v[76:79] offset:52224
v_pk_add_f32 v[144:145], v[16:17], 0
v_pk_add_f32 v[146:147], v[18:19], 0
v_pk_add_f32 v[148:149], v[20:21], 0
v_pk_add_f32 v[150:151], v[22:23], 0
v_pk_add_f32 v[152:153], v[24:25], 0
v_pk_add_f32 v[154:155], v[26:27], 0
v_pk_add_f32 v[156:157], v[28:29], 0
v_pk_add_f32 v[158:159], v[30:31], 0
s_branch Lscd_32
Lsc_29:
ds_write_b128 v11, v[64:67] offset:53248
s_nop 0
ds_write_b128 v11, v[68:71] offset:54272
ds_write_b128 v11, v[72:75] offset:55296
ds_write_b128 v11, v[76:79] offset:56320
v_pk_add_f32 v[144:145], v[32:33], 0
v_pk_add_f32 v[146:147], v[34:35], 0
v_pk_add_f32 v[148:149], v[36:37], 0
v_pk_add_f32 v[150:151], v[38:39], 0
v_pk_add_f32 v[152:153], v[40:41], 0
v_pk_add_f32 v[154:155], v[42:43], 0
v_pk_add_f32 v[156:157], v[44:45], 0
v_pk_add_f32 v[158:159], v[46:47], 0
s_branch Lscd_32
Lsc_30:
s_cmp_eq_u32 s68, 3
s_cbranch_scc1 Lsc_31
ds_write_b128 v11, v[32:35] offset:16384
ds_write_b128 v11, v[36:39] offset:17408
ds_write_b128 v11, v[40:43] offset:18432
ds_write_b128 v11, v[44:47] offset:19456
ds_write_b128 v11, v[64:67] offset:57344
ds_write_b128 v11, v[68:71] offset:58368
ds_write_b128 v11, v[72:75] offset:59392
ds_write_b128 v11, v[76:79] offset:60416
v_pk_add_f32 v[144:145], v[48:49], 0
v_pk_add_f32 v[146:147], v[50:51], 0
v_pk_add_f32 v[148:149], v[52:53], 0
v_pk_add_f32 v[150:151], v[54:55], 0
v_pk_add_f32 v[152:153], v[56:57], 0
v_pk_add_f32 v[154:155], v[58:59], 0
v_pk_add_f32 v[156:157], v[60:61], 0
v_pk_add_f32 v[158:159], v[62:63], 0
s_branch Lscd_32
Lsc_31:
ds_write_b128 v11, v[32:35] offset:20480
ds_write_b128 v11, v[36:39] offset:21504
ds_write_b128 v11, v[40:43] offset:22528
ds_write_b128 v11, v[44:47] offset:23552
v_pk_add_f32 v[144:145], v[64:65], 0
v_pk_add_f32 v[146:147], v[66:67], 0
v_pk_add_f32 v[148:149], v[68:69], 0
v_pk_add_f32 v[150:151], v[70:71], 0
v_pk_add_f32 v[152:153], v[72:73], 0
v_pk_add_f32 v[154:155], v[74:75], 0
v_pk_add_f32 v[156:157], v[76:77], 0
v_pk_add_f32 v[158:159], v[78:79], 0
Lscd_32:
s_waitcnt lgkmcnt(0)
s_barrier
ds_read_b128 v[16:19], v248 offset:0
ds_read_b128 v[20:23], v248 offset:1024
ds_read_b128 v[24:27], v248 offset:2048
ds_read_b128 v[28:31], v248 offset:3072
ds_read_b128 v[32:35], v248 offset:4096
ds_read_b128 v[36:39], v248 offset:5120
ds_read_b128 v[40:43], v248 offset:6144
ds_read_b128 v[44:47], v248 offset:7168
ds_read_b128 v[48:51], v248 offset:8192
ds_read_b128 v[52:55], v248 offset:9216
ds_read_b128 v[56:59], v248 offset:10240
ds_read_b128 v[60:63], v248 offset:11264
s_waitcnt vmcnt(1)
v_permlane16_swap_b32 v240, v242
v_permlane16_swap_b32 v241, v243
v_permlane16_swap_b32 v244, v246
v_permlane16_swap_b32_e64 v245, v247
s_waitcnt lgkmcnt(8)
v_pk_add_f32 v[144:145], v[144:145], v[16:17]
v_pk_add_f32 v[146:147], v[146:147], v[18:19]
v_pk_add_f32 v[148:149], v[148:149], v[20:21]
v_pk_add_f32 v[150:151], v[150:151], v[22:23]
v_pk_add_f32 v[152:153], v[152:153], v[24:25]
v_pk_add_f32 v[154:155], v[154:155], v[26:27]
v_pk_add_f32 v[156:157], v[156:157], v[28:29]
v_pk_add_f32 v[158:159], v[158:159], v[30:31]
s_waitcnt lgkmcnt(4)
v_pk_add_f32 v[144:145], v[144:145], v[32:33]
v_pk_add_f32 v[146:147], v[146:147], v[34:35]
v_pk_add_f32 v[148:149], v[148:149], v[36:37]
v_pk_add_f32 v[150:151], v[150:151], v[38:39]
v_pk_add_f32 v[152:153], v[152:153], v[40:41]
v_pk_add_f32 v[154:155], v[154:155], v[42:43]
v_pk_add_f32 v[156:157], v[156:157], v[44:45]
v_pk_add_f32 v[158:159], v[158:159], v[46:47]
s_waitcnt lgkmcnt(0)
v_pk_add_f32 v[144:145], v[144:145], v[48:49]
v_pk_add_f32 v[146:147], v[146:147], v[50:51]
v_pk_add_f32 v[148:149], v[148:149], v[52:53]
v_pk_add_f32 v[150:151], v[150:151], v[54:55]
v_pk_add_f32 v[152:153], v[152:153], v[56:57]
v_pk_add_f32 v[154:155], v[154:155], v[58:59]
v_pk_add_f32 v[156:157], v[156:157], v[60:61]
v_pk_add_f32 v[158:159], v[158:159], v[62:63]
v_pk_mul_f32 v[144:145], v[144:145], v[8:9] op_sel_hi:[1,0]
v_pk_mul_f32 v[146:147], v[146:147], v[8:9] op_sel_hi:[1,0]
v_pk_mul_f32 v[148:149], v[148:149], v[8:9] op_sel:[0,1] op_sel_hi:[1,1]
v_pk_mul_f32 v[150:151], v[150:151], v[8:9] op_sel:[0,1] op_sel_hi:[1,1]
v_pk_mul_f32 v[152:153], v[152:153], v[8:9] op_sel_hi:[1,0]
v_pk_mul_f32 v[154:155], v[154:155], v[8:9] op_sel_hi:[1,0]
v_pk_mul_f32 v[156:157], v[156:157], v[8:9] op_sel:[0,1] op_sel_hi:[1,1]
v_pk_mul_f32 v[158:159], v[158:159], v[8:9] op_sel:[0,1] op_sel_hi:[1,1]
v_dot2c_f32_bf16 v144, s87, v240
v_dot2c_f32_bf16 v145, s88, v240
v_dot2c_f32_bf16 v146, s87, v241
v_dot2c_f32_bf16 v147, s88, v241
v_dot2c_f32_bf16 v148, s87, v242
v_dot2c_f32_bf16 v149, s88, v242
v_dot2c_f32_bf16 v150, s87, v243
v_dot2c_f32_bf16 v151, s88, v243
v_dot2c_f32_bf16 v152, s87, v244
v_dot2c_f32_bf16 v153, s88, v244
v_dot2c_f32_bf16 v154, s87, v245
v_dot2c_f32_bf16 v155, s88, v245
v_dot2c_f32_bf16 v156, s87, v246
v_dot2c_f32_bf16 v157, s88, v246
v_dot2c_f32_bf16 v158, s87, v247
v_dot2c_f32_bf16 v159, s88, v247
v_cvt_pk_bf16_f32 v240, v144, v145
v_cvt_pk_bf16_f32 v241, v146, v147
v_cvt_pk_bf16_f32 v242, v148, v149
v_cvt_pk_bf16_f32 v243, v150, v151
v_cvt_pk_bf16_f32 v244, v152, v153
v_cvt_pk_bf16_f32 v245, v154, v155
v_cvt_pk_bf16_f32 v246, v156, v157
v_cvt_pk_bf16_f32 v247, v158, v159
v_permlane16_swap_b32 v240, v242
v_permlane16_swap_b32 v241, v243
v_permlane16_swap_b32 v244, v246
v_permlane16_swap_b32 v245, v247
s_add_u32 s77, s80, 4194304
buffer_store_dwordx4 v[240:243], v1, s[36:39], s77 offen
buffer_store_dwordx4 v[244:247], v1, s[36:39], s77 offen offset:1024
v_mov_b32 v144, 0
v_mov_b32 v145, 0
v_dot2c_f32_bf16 v144, s86, v240
v_dot2c_f32_bf16 v145, v240, v240
v_dot2c_f32_bf16 v144, s86, v241
v_dot2c_f32_bf16 v145, v241, v241
v_dot2c_f32_bf16 v144, s86, v242
v_dot2c_f32_bf16 v145, v242, v242
v_dot2c_f32_bf16 v144, s86, v243
v_dot2c_f32_bf16 v145, v243, v243
v_dot2c_f32_bf16 v144, s86, v244
v_dot2c_f32_bf16 v145, v244, v244
v_dot2c_f32_bf16 v144, s86, v245
v_dot2c_f32_bf16 v145, v245, v245
v_dot2c_f32_bf16 v144, s86, v246
v_dot2c_f32_bf16 v145, v246, v246
v_dot2c_f32_bf16 v144, s86, v247
v_dot2c_f32_bf16 v145, v247, v247
s_add_u32 s77, s81, 262144
s_nop 1
v_permlane32_swap_b32 v144, v145
v_add_f32_e64 v144, v144, v145
buffer_store_dword v144, v5, s[36:39], s77 offen
s_lshl_b32 s97, s71, 12
s_add_u32 s97, s97, 262144
v_and_b32 v7, 31, v0
v_lshlrev_b32 v7, 4, v7
v_lshrrev_b32 v12, 5, v0
v_lshl_add_u32 v12, v12, 11, v7
s_lshr_b32 s94, s2, 3
s_lshl_b32 s94, s94, 2
s_add_u32 s94, s94, s68
s_lshl_b32 s94, s94, 8
v_and_b32_e64 v244, 1, v0
v_lshl_add_u32 v244, v244, 7, s94
v_lshrrev_b32_e64 v7, 2, v0
v_mul_u32_u24 v7, 3072, v7
v_and_b32_e64 v5, 3, v0
v_lshl_add_u32 v5, v5, 4, v7
s_mul_i32 s95, s68, 393216
s_lshl_b32 s78, s70, 6
s_add_u32 s95, s95, s78
s_lshl_b32 s96, s68, 13
s_lshl_b32 s89, s71, 15
s_add_u32 s89, s89, 4194304
s_lshl_b32 s77, s69, 8
s_lshl_b32 s78, s75, 6
s_add_u32 s77, s77, s78
s_lshl_b32 s78, s74, 5
s_add_u32 s77, s77, s78
v_and_b32 v7, 7, v0
v_bfe_u32 v11, v0, 3, 1
v_lshlrev_b32_e64 v11, 7, v11
v_lshl_add_u32 v11, v7, 2, v11
v_add_u32 v11, s77, v11
v_mov_b32 v7, 5
v_mov_b32_e64 v6, s83
s_waitcnt vmcnt(0)
s_mov_b64 exec, 1
buffer_store_dword v7, v6, s[36:39], 0 offen
s_mov_b64 exec, -1
s_barrier
Lpoll_33:
buffer_load_dword v6, v11, s[36:39], 0 offen sc1
s_waitcnt vmcnt(0)
v_cmp_gt_u32 vcc, 5, v6
s_nop 0
s_cbranch_vccz Lgo_34
s_add_u32 s91, s91, 1
s_bitcmp0_b32 s91, 16
s_cbranch_scc1 Lpoll_33
Lgo_34:
buffer_load_dwordx4 v[16:19], v1, s[36:39], s89 offen sc1
buffer_load_dwordx4 v[20:23], v1, s[36:39], s89 offen offset:1024 sc1
buffer_load_dwordx4 v[24:27], v1, s[36:39], s89 offen offset:2048 sc1
buffer_load_dwordx4 v[28:31], v1, s[36:39], s89 offen offset:3072 sc1
s_add_u32 s89, s89, 4096
buffer_load_dwordx4 v[32:35], v1, s[36:39], s89 offen sc1
buffer_load_dwordx4 v[36:39], v1, s[36:39], s89 offen offset:1024 sc1
buffer_load_dwordx4 v[40:43], v1, s[36:39], s89 offen offset:2048 sc1
buffer_load_dwordx4 v[44:47], v1, s[36:39], s89 offen offset:3072 sc1
s_add_u32 s89, s89, 4096
buffer_load_dwordx4 v[48:51], v1, s[36:39], s89 offen sc1
buffer_load_dwordx4 v[52:55], v1, s[36:39], s89 offen offset:1024 sc1
buffer_load_dwordx4 v[56:59], v1, s[36:39], s89 offen offset:2048 sc1
buffer_load_dwordx4 v[60:63], v1, s[36:39], s89 offen offset:3072 sc1
ds_read_b64_tr_b16 v[192:193], v2 offset:0
ds_read_b64_tr_b16 v[194:195], v2 offset:512
ds_read_b64_tr_b16 v[196:197], v3 offset:0
ds_read_b64_tr_b16 v[198:199], v3 offset:512
ds_read_b64_tr_b16 v[200:201], v2 offset:2048
ds_read_b64_tr_b16 v[202:203], v2 offset:2560
ds_read_b64_tr_b16 v[204:205], v3 offset:2048
ds_read_b64_tr_b16 v[206:207], v3 offset:2560
s_waitcnt vmcnt(11) lgkmcnt(4)
v_mfma_f32_32x32x16_bf16 v[160:175], v[192:195], v[16:19], 0
ds_read_b64_tr_b16 v[208:209], v2 offset:4096
ds_read_b64_tr_b16 v[210:211], v2 offset:4608
v_mfma_f32_32x32x16_bf16 v[176:191], v[196:199], v[16:19], 0
s_add_u32 s89, s89, 4096
buffer_load_dwordx4 v[64:67], v1, s[36:39], s89 offen sc1
ds_read_b64_tr_b16 v[212:213], v3 offset:4096
ds_read_b64_tr_b16 v[214:215], v3 offset:4608
s_waitcnt vmcnt(11) lgkmcnt(4)
v_mfma_f32_32x32x16_bf16 v[160:175], v[200:203], v[20:23], v[160:175]
ds_read_b64_tr_b16 v[192:193], v2 offset:6144
ds_read_b64_tr_b16 v[194:195], v2 offset:6656
v_mfma_f32_32x32x16_bf16 v[176:191], v[204:207], v[20:23], v[176:191]
buffer_load_dwordx4 v[68:71], v1, s[36:39], s89 offen offset:1024 sc1
ds_read_b64_tr_b16 v[196:197], v3 offset:6144
ds_read_b64_tr_b16 v[198:199], v3 offset:6656
s_waitcnt vmcnt(11) lgkmcnt(4)
v_mfma_f32_32x32x16_bf16 v[160:175], v[208:211], v[24:27], v[160:175]
ds_read_b64_tr_b16 v[200:201], v2 offset:8192
ds_read_b64_tr_b16 v[202:203], v2 offset:8704
v_mfma_f32_32x32x16_bf16 v[176:191], v[212:215], v[24:27], v[176:191]
buffer_load_dwordx4 v[72:75], v1, s[36:39], s89 offen offset:2048 sc1
ds_read_b64_tr_b16 v[204:205], v3 offset:8192
ds_read_b64_tr_b16 v[206:207], v3 offset:8704
s_waitcnt vmcnt(11) lgkmcnt(4)
v_mfma_f32_32x32x16_bf16 v[160:175], v[192:195], v[28:31], v[160:175]
ds_read_b64_tr_b16 v[208:209], v2 offset:10240
ds_read_b64_tr_b16 v[210:211], v2 offset:10752
v_mfma_f32_32x32x16_bf16 v[176:191], v[196:199], v[28:31], v[176:191]
buffer_load_dwordx4 v[76:79], v1, s[36:39], s89 offen offset:3072 sc1
ds_read_b64_tr_b16 v[212:213], v3 offset:10240
ds_read_b64_tr_b16 v[214:215], v3 offset:10752
s_waitcnt vmcnt(11) lgkmcnt(4)
v_mfma_f32_32x32x16_bf16 v[160:175], v[200:203], v[32:35], v[160:175]
ds_read_b64_tr_b16 v[192:193], v2 offset:12288
ds_read_b64_tr_b16 v[194:195], v2 offset:12800
v_mfma_f32_32x32x16_bf16 v[176:191], v[204:207], v[32:35], v[176:191]
s_add_u32 s89, s89, 4096
buffer_load_dwordx4 v[80:83], v1, s[36:39], s89 offen sc1
ds_read_b64_tr_b16 v[196:197], v3 offset:12288
ds_read_b64_tr_b16 v[198:199], v3 offset:12800
s_waitcnt vmcnt(11) lgkmcnt(4)
v_mfma_f32_32x32x16_bf16 v[160:175], v[208:211], v[36:39], v[160:175]
ds_read_b64_tr_b16 v[200:201], v2 offset:14336
ds_read_b64_tr_b16 v[202:203], v2 offset:14848
v_mfma_f32_32x32x16_bf16 v[176:191], v[212:215], v[36:39], v[176:191]
buffer_load_dwordx4 v[84:87], v1, s[36:39], s89 offen offset:1024 sc1
ds_read_b64_tr_b16 v[204:205], v3 offset:14336
ds_read_b64_tr_b16 v[206:207], v3 offset:14848
s_waitcnt vmcnt(11) lgkmcnt(4)
v_mfma_f32_32x32x16_bf16 v[160:175], v[192:195], v[40:43], v[160:175]
ds_read_b64_tr_b16 v[208:209], v2 offset:16384
ds_read_b64_tr_b16 v[210:211], v2 offset:16896
v_mfma_f32_32x32x16_bf16 v[176:191], v[196:199], v[40:43], v[176:191]
buffer_load_dwordx4 v[88:91], v1, s[36:39], s89 offen offset:2048 sc1
ds_read_b64_tr_b16 v[212:213], v3 offset:16384
ds_read_b64_tr_b16 v[214:215], v3 offset:16896
s_waitcnt vmcnt(11) lgkmcnt(4)
v_mfma_f32_32x32x16_bf16 v[160:175], v[200:203], v[44:47], v[160:175]
ds_read_b64_tr_b16 v[192:193], v2 offset:18432
ds_read_b64_tr_b16 v[194:195], v2 offset:18944
v_mfma_f32_32x32x16_bf16 v[176:191], v[204:207], v[44:47], v[176:191]
buffer_load_dwordx4 v[92:95], v1, s[36:39], s89 offen offset:3072 sc1
ds_read_b64_tr_b16 v[196:197], v3 offset:18432
ds_read_b64_tr_b16 v[198:199], v3 offset:18944
s_waitcnt vmcnt(11) lgkmcnt(4)
v_mfma_f32_32x32x16_bf16 v[160:175], v[208:211], v[48:51], v[160:175]
ds_read_b64_tr_b16 v[200:201], v2 offset:20480
ds_read_b64_tr_b16 v[202:203], v2 offset:20992
v_mfma_f32_32x32x16_bf16 v[176:191], v[212:215], v[48:51], v[176:191]
buffer_load_dwordx4 v[224:227], v12, s[36:39], s97 offen sc1
ds_read_b64_tr_b16 v[204:205], v3 offset:20480
ds_read_b64_tr_b16 v[206:207], v3 offset:20992
s_waitcnt vmcnt(11) lgkmcnt(4)
v_mfma_f32_32x32x16_bf16 v[160:175], v[192:195], v[52:55], v[160:175]
ds_read_b64_tr_b16 v[208:209], v2 offset:22528
ds_read_b64_tr_b16 v[210:211], v2 offset:23040
v_mfma_f32_32x32x16_bf16 v[176:191], v[196:199], v[52:55], v[176:191]
buffer_load_dwordx4 v[228:231], v12, s[36:39], s97 offen offset:512 sc1
ds_read_b64_tr_b16 v[212:213], v3 offset:22528
ds_read_b64_tr_b16 v[214:215], v3 offset:23040
s_waitcnt vmcnt(11) lgkmcnt(4)
v_mfma_f32_32x32x16_bf16 v[160:175], v[200:203], v[56:59], v[160:175]
ds_read_b64_tr_b16 v[192:193], v2 offset:24576
ds_read_b64_tr_b16 v[194:195], v2 offset:25088
v_mfma_f32_32x32x16_bf16 v[176:191], v[204:207], v[56:59], v[176:191]
buffer_load_dwordx4 v[232:235], v12, s[36:39], s97 offen offset:1024 sc1
ds_read_b64_tr_b16 v[196:197], v3 offset:24576
ds_read_b64_tr_b16 v[198:199], v3 offset:25088
s_waitcnt vmcnt(11) lgkmcnt(4)
v_mfma_f32_32x32x16_bf16 v[160:175], v[208:211], v[60:63], v[160:175]
ds_read_b64_tr_b16 v[200:201], v2 offset:26624
ds_read_b64_tr_b16 v[202:203], v2 offset:27136
v_mfma_f32_32x32x16_bf16 v[176:191], v[212:215], v[60:63], v[176:191]
buffer_load_dwordx4 v[236:239], v12, s[36:39], s97 offen offset:1536 sc1
ds_read_b64_tr_b16 v[204:205], v3 offset:26624
ds_read_b64_tr_b16 v[206:207], v3 offset:27136
s_waitcnt vmcnt(11) lgkmcnt(4)
v_mfma_f32_32x32x16_bf16 v[160:175], v[192:195], v[64:67], v[160:175]
ds_read_b64_tr_b16 v[208:209], v2 offset:28672
ds_read_b64_tr_b16 v[210:211], v2 offset:29184
v_mfma_f32_32x32x16_bf16 v[176:191], v[196:199], v[64:67], v[176:191]
s_add_u32 s89, s89, 4096
buffer_load_dwordx4 v[96:99], v1, s[36:39], s89 offen sc1
ds_read_b64_tr_b16 v[212:213], v3 offset:28672
ds_read_b64_tr_b16 v[214:215], v3 offset:29184
s_waitcnt vmcnt(11) lgkmcnt(4)
v_mfma_f32_32x32x16_bf16 v[160:175], v[200:203], v[68:71], v[160:175]
ds_read_b64_tr_b16 v[192:193], v2 offset:30720
ds_read_b64_tr_b16 v[194:195], v2 offset:31232
v_mfma_f32_32x32x16_bf16 v[176:191], v[204:207], v[68:71], v[176:191]
buffer_load_dwordx4 v[100:103], v1, s[36:39], s89 offen offset:1024 sc1
ds_read_b64_tr_b16 v[196:197], v3 offset:30720
ds_read_b64_tr_b16 v[198:199], v3 offset:31232
s_waitcnt vmcnt(11) lgkmcnt(4)
v_mfma_f32_32x32x16_bf16 v[160:175], v[208:211], v[72:75], v[160:175]
ds_read_b64_tr_b16 v[200:201], v2 offset:32768
ds_read_b64_tr_b16 v[202:203], v2 offset:33280
v_mfma_f32_32x32x16_bf16 v[176:191], v[212:215], v[72:75], v[176:191]
buffer_load_dwordx4 v[104:107], v1, s[36:39], s89 offen offset:2048 sc1
ds_read_b64_tr_b16 v[204:205], v3 offset:32768
ds_read_b64_tr_b16 v[206:207], v3 offset:33280
s_waitcnt vmcnt(11) lgkmcnt(4)
v_mfma_f32_32x32x16_bf16 v[160:175], v[192:195], v[76:79], v[160:175]
ds_read_b64_tr_b16 v[208:209], v2 offset:34816
ds_read_b64_tr_b16 v[210:211], v2 offset:35328
v_mfma_f32_32x32x16_bf16 v[176:191], v[196:199], v[76:79], v[176:191]
buffer_load_dwordx4 v[108:111], v1, s[36:39], s89 offen offset:3072 sc1
ds_read_b64_tr_b16 v[212:213], v3 offset:34816
ds_read_b64_tr_b16 v[214:215], v3 offset:35328
s_waitcnt vmcnt(11) lgkmcnt(4)
v_mfma_f32_32x32x16_bf16 v[160:175], v[200:203], v[80:83], v[160:175]
ds_read_b64_tr_b16 v[192:193], v2 offset:36864
ds_read_b64_tr_b16 v[194:195], v2 offset:37376
v_mfma_f32_32x32x16_bf16 v[176:191], v[204:207], v[80:83], v[176:191]
s_add_u32 s89, s89, 4096
buffer_load_dwordx4 v[112:115], v1, s[36:39], s89 offen sc1
ds_read_b64_tr_b16 v[196:197], v3 offset:36864
ds_read_b64_tr_b16 v[198:199], v3 offset:37376
s_waitcnt vmcnt(11) lgkmcnt(4)
v_mfma_f32_32x32x16_bf16 v[160:175], v[208:211], v[84:87], v[160:175]
ds_read_b64_tr_b16 v[200:201], v2 offset:38912
ds_read_b64_tr_b16 v[202:203], v2 offset:39424
v_mfma_f32_32x32x16_bf16 v[176:191], v[212:215], v[84:87], v[176:191]
buffer_load_dwordx4 v[116:119], v1, s[36:39], s89 offen offset:1024 sc1
ds_read_b64_tr_b16 v[204:205], v3 offset:38912
ds_read_b64_tr_b16 v[206:207], v3 offset:39424
s_waitcnt vmcnt(11) lgkmcnt(4)
v_mfma_f32_32x32x16_bf16 v[160:175], v[192:195], v[88:91], v[160:175]
ds_read_b64_tr_b16 v[208:209], v2 offset:40960
ds_read_b64_tr_b16 v[210:211], v2 offset:41472
v_mfma_f32_32x32x16_bf16 v[176:191], v[196:199], v[88:91], v[176:191]
buffer_load_dwordx4 v[120:123], v1, s[36:39], s89 offen offset:2048 sc1
ds_read_b64_tr_b16 v[212:213], v3 offset:40960
ds_read_b64_tr_b16 v[214:215], v3 offset:41472
s_waitcnt vmcnt(11) lgkmcnt(4)
v_mfma_f32_32x32x16_bf16 v[160:175], v[200:203], v[92:95], v[160:175]
ds_read_b64_tr_b16 v[192:193], v2 offset:43008
ds_read_b64_tr_b16 v[194:195], v2 offset:43520
v_mfma_f32_32x32x16_bf16 v[176:191], v[204:207], v[92:95], v[176:191]
buffer_load_dwordx4 v[124:127], v1, s[36:39], s89 offen offset:3072 sc1
ds_read_b64_tr_b16 v[196:197], v3 offset:43008
ds_read_b64_tr_b16 v[198:199], v3 offset:43520
s_waitcnt vmcnt(7) lgkmcnt(4)
v_mfma_f32_32x32x16_bf16 v[160:175], v[208:211], v[96:99], v[160:175]
ds_read_b64_tr_b16 v[200:201], v2 offset:45056
ds_read_b64_tr_b16 v[202:203], v2 offset:45568
v_mfma_f32_32x32x16_bf16 v[176:191], v[212:215], v[96:99], v[176:191]
s_add_u32 s89, s89, 4096
buffer_load_dwordx4 v[128:131], v1, s[36:39], s89 offen sc1
ds_read_b64_tr_b16 v[204:205], v3 offset:45056
ds_read_b64_tr_b16 v[206:207], v3 offset:45568
s_waitcnt vmcnt(7) lgkmcnt(4)
v_mfma_f32_32x32x16_bf16 v[160:175], v[192:195], v[100:103], v[160:175]
ds_read_b64_tr_b16 v[208:209], v2 offset:47104
ds_read_b64_tr_b16 v[210:211], v2 offset:47616
v_mfma_f32_32x32x16_bf16 v[176:191], v[196:199], v[100:103], v[176:191]
buffer_load_dwordx4 v[132:135], v1, s[36:39], s89 offen offset:1024 sc1
ds_read_b64_tr_b16 v[212:213], v3 offset:47104
ds_read_b64_tr_b16 v[214:215], v3 offset:47616
s_waitcnt vmcnt(7) lgkmcnt(4)
v_mfma_f32_32x32x16_bf16 v[160:175], v[200:203], v[104:107], v[160:175]
ds_read_b64_tr_b16 v[192:193], v2 offset:49152
ds_read_b64_tr_b16 v[194:195], v2 offset:49664
v_add_f32 v224, v224, v232
v_add_f32 v225, v225, v233
v_add_f32_e64 v226, v226, v234
v_mfma_f32_32x32x16_bf16 v[176:191], v[204:207], v[104:107], v[176:191]
buffer_load_dwordx4 v[136:139], v1, s[36:39], s89 offen offset:2048 sc1
ds_read_b64_tr_b16 v[196:197], v3 offset:49152
ds_read_b64_tr_b16 v[198:199], v3 offset:49664
v_add_f32 v227, v227, v235
v_add_f32 v228, v228, v236
v_add_f32 v229, v229, v237
s_waitcnt vmcnt(7) lgkmcnt(4)
v_mfma_f32_32x32x16_bf16 v[160:175], v[208:211], v[108:111], v[160:175]
ds_read_b64_tr_b16 v[200:201], v2 offset:51200
ds_read_b64_tr_b16 v[202:203], v2 offset:51712
v_add_f32 v230, v230, v238
v_add_f32 v231, v231, v239
v_add_f32_e64 v224, v224, v228
v_mfma_f32_32x32x16_bf16 v[176:191], v[212:215], v[108:111], v[176:191]
buffer_load_dwordx4 v[140:143], v1, s[36:39], s89 offen offset:3072 sc1
ds_read_b64_tr_b16 v[204:205], v3 offset:51200
ds_read_b64_tr_b16 v[206:207], v3 offset:51712
v_add_f32 v225, v225, v229
v_add_f32 v226, v226, v230
v_add_f32 v227, v227, v231
s_waitcnt vmcnt(7) lgkmcnt(4)
v_mfma_f32_32x32x16_bf16 v[160:175], v[192:195], v[112:115], v[160:175]
ds_read_b64_tr_b16 v[208:209], v2 offset:53248
ds_read_b64_tr_b16 v[210:211], v2 offset:53760
v_add_f32 v224, v224, v226
v_add_f32 v225, v225, v227
s_nop 1
v_permlane32_swap_b32 v224, v225
v_mfma_f32_32x32x16_bf16 v[176:191], v[196:199], v[112:115], v[176:191]
s_getpc_b64 s[4:5]
global_load_dword a240, v244, s[4:5]
ds_read_b64_tr_b16 v[212:213], v3 offset:53248
ds_read_b64_tr_b16 v[214:215], v3 offset:53760
v_add_f32 v224, v224, v225
v_mov_b32 v225, v224
s_nop 1
v_permlane32_swap_b32 v224, v225
s_waitcnt vmcnt(7) lgkmcnt(4)
v_mfma_f32_32x32x16_bf16 v[160:175], v[200:203], v[116:119], v[160:175]
ds_read_b64_tr_b16 v[192:193], v2 offset:55296
ds_read_b64_tr_b16 v[194:195], v2 offset:55808
v_mul_f32 v8, -0.001953125, v224
v_mul_f32 v225, 0.001953125, v225
v_fma_f32 v225, -v8, v8, v225
v_mfma_f32_32x32x16_bf16 v[176:191], v[204:207], v[116:119], v[176:191]
ds_read_b64_tr_b16 v[196:197], v3 offset:55296
ds_read_b64_tr_b16 v[198:199], v3 offset:55808
v_max_f32_e64 v225, 0, v225
v_add_f32 v225, 0x3727c5ac, v225
v_rsq_f32 v9, v225
s_waitcnt vmcnt(6) lgkmcnt(4)
v_mfma_f32_32x32x16_bf16 v[160:175], v[208:211], v[120:123], v[160:175]
ds_read_b64_tr_b16 v[200:201], v2 offset:57344
ds_read_b64_tr_b16 v[202:203], v2 offset:57856
s_lshl_b32 s77, s70, 4
s_add_u32 s77, s77, s69
s_mul_i32 s77, s77, 2304
v_mfma_f32_32x32x16_bf16 v[176:191], v[212:215], v[120:123], v[176:191]
ds_read_b64_tr_b16 v[204:205], v3 offset:57344
ds_read_b64_tr_b16 v[206:207], v3 offset:57856
s_add_u32 s20, s77, 1638400
s_lshl_b32 s78, s68, 9
s_add_u32 s21, s78, s20
s_waitcnt vmcnt(5) lgkmcnt(4)
v_mfma_f32_32x32x16_bf16 v[160:175], v[192:195], v[124:127], v[160:175]
s_add_u32 m0, s96, 67584
s_add_u32 s94, s95, 0
buffer_load_dwordx4 v5, s[32:35], s94 offen lds
ds_read_b64_tr_b16 v[208:209], v2 offset:59392
ds_read_b64_tr_b16 v[210:211], v2 offset:59904
s_lshl_b32 s77, s70, 8
s_lshl_b32 s78, s68, 6
s_add_u32 s77, s77, s78
v_mfma_f32_32x32x16_bf16 v[176:191], v[196:199], v[124:127], v[176:191]
ds_read_b64_tr_b16 v[212:213], v3 offset:59392
ds_read_b64_tr_b16 v[214:215], v3 offset:59904
s_add_u32 s23, s77, 8192
s_lshl_b32 s78, s69, 2
s_add_u32 s22, s23, s78
s_waitcnt vmcnt(5) lgkmcnt(4)
v_mfma_f32_32x32x16_bf16 v[160:175], v[200:203], v[128:131], v[160:175]
ds_read_b64_tr_b16 v[192:193], v2 offset:61440
ds_read_b64_tr_b16 v[194:195], v2 offset:61952
s_lshl_b32 s24, s68, 8
s_add_u32 s24, s24, 112640
s_mul_i32 s25, s68, 3072
v_mfma_f32_32x32x16_bf16 v[176:191], v[204:207], v[128:131], v[176:191]
ds_read_b64_tr_b16 v[196:197], v3 offset:61440
ds_read_b64_tr_b16 v[198:199], v3 offset:61952
s_add_u32 s25, s25, 100352
s_waitcnt vmcnt(4) lgkmcnt(4)
v_mfma_f32_32x32x16_bf16 v[160:175], v[208:211], v[132:135], v[160:175]
ds_read_b64_tr_b16 v[200:201], v2 offset:63488
ds_read_b64_tr_b16 v[202:203], v2 offset:64000
v_mfma_f32_32x32x16_bf16 v[176:191], v[212:215], v[132:135], v[176:191]
s_add_u32 m0, s96, 68608
s_add_u32 s94, s95, 49152
buffer_load_dwordx4 v5, s[32:35], s94 offen lds
ds_read_b64_tr_b16 v[204:205], v3 offset:63488
ds_read_b64_tr_b16 v[206:207], v3 offset:64000
s_waitcnt vmcnt(4) lgkmcnt(4)
v_mfma_f32_32x32x16_bf16 v[160:175], v[192:195], v[136:139], v[160:175]
v_mfma_f32_32x32x16_bf16 v[176:191], v[196:199], v[136:139], v[176:191]
s_waitcnt vmcnt(3) lgkmcnt(0)
v_mfma_f32_32x32x16_bf16 v[160:175], v[200:203], v[140:143], v[160:175]
v_mfma_f32_32x32x16_bf16 v[176:191], v[204:207], v[140:143], v[176:191]
ds_read_b128 v[192:195], v10 offset:0
ds_read_b128 v[196:199], v10 offset:16
ds_read_b128 v[200:203], v10 offset:64
ds_read_b128 v[204:207], v10 offset:80
ds_read_b128 v[208:211], v10 offset:128
ds_read_b128 v[212:215], v10 offset:144
ds_read_b128 v[216:219], v10 offset:192
ds_read_b128 v[220:223], v10 offset:208
s_waitcnt lgkmcnt(4)
s_nop 1
v_pk_fma_f32 v[160:161], v[192:193], v[8:9], v[160:161] op_sel_hi:[1,0,1]
v_pk_fma_f32 v[162:163], v[194:195], v[8:9], v[162:163] op_sel_hi:[1,0,1]
v_pk_fma_f32 v[164:165], v[196:197], v[8:9], v[164:165] op_sel_hi:[1,0,1]
s_add_u32 m0, s96, 69632
s_add_u32 s94, s95, 98304
buffer_load_dwordx4 v5, s[32:35], s94 offen lds
v_pk_fma_f32 v[166:167], v[198:199], v[8:9], v[166:167] op_sel_hi:[1,0,1]
v_pk_fma_f32 v[168:169], v[200:201], v[8:9], v[168:169] op_sel_hi:[1,0,1]
v_pk_fma_f32 v[170:171], v[202:203], v[8:9], v[170:171] op_sel_hi:[1,0,1]
v_pk_fma_f32 v[172:173], v[204:205], v[8:9], v[172:173] op_sel_hi:[1,0,1]
v_pk_fma_f32 v[174:175], v[206:207], v[8:9], v[174:175] op_sel_hi:[1,0,1]
v_pk_mul_f32 v[160:161], v[160:161], v[8:9] op_sel:[0,1] op_sel_hi:[1,1]
v_pk_mul_f32 v[162:163], v[162:163], v[8:9] op_sel:[0,1] op_sel_hi:[1,1]
v_pk_mul_f32 v[164:165], v[164:165], v[8:9] op_sel:[0,1] op_sel_hi:[1,1]
v_pk_mul_f32 v[166:167], v[166:167], v[8:9] op_sel:[0,1] op_sel_hi:[1,1]
v_pk_mul_f32 v[168:169], v[168:169], v[8:9] op_sel:[0,1] op_sel_hi:[1,1]
v_pk_mul_f32 v[170:171], v[170:171], v[8:9] op_sel:[0,1] op_sel_hi:[1,1]
v_pk_mul_f32 v[172:173], v[172:173], v[8:9] op_sel:[0,1] op_sel_hi:[1,1]
v_pk_mul_f32 v[174:175], v[174:175], v[8:9] op_sel:[0,1] op_sel_hi:[1,1]
s_waitcnt lgkmcnt(0)
v_pk_fma_f32 v[176:177], v[208:209], v[8:9], v[176:177] op_sel_hi:[1,0,1]
v_pk_fma_f32 v[178:179], v[210:211], v[8:9], v[178:179] op_sel_hi:[1,0,1]
v_pk_fma_f32 v[180:181], v[212:213], v[8:9], v[180:181] op_sel_hi:[1,0,1]
v_pk_fma_f32 v[182:183], v[214:215], v[8:9], v[182:183] op_sel_hi:[1,0,1]
v_pk_fma_f32 v[184:185], v[216:217], v[8:9], v[184:185] op_sel_hi:[1,0,1]
v_pk_fma_f32 v[186:187], v[218:219], v[8:9], v[186:187] op_sel_hi:[1,0,1]
v_pk_fma_f32 v[188:189], v[220:221], v[8:9], v[188:189] op_sel_hi:[1,0,1]
v_pk_fma_f32 v[190:191], v[222:223], v[8:9], v[190:191] op_sel_hi:[1,0,1]
v_pk_mul_f32 v[176:177], v[176:177], v[8:9] op_sel:[0,1] op_sel_hi:[1,1]
v_pk_mul_f32 v[178:179], v[178:179], v[8:9] op_sel:[0,1] op_sel_hi:[1,1]
v_pk_mul_f32 v[180:181], v[180:181], v[8:9] op_sel:[0,1] op_sel_hi:[1,1]
v_pk_mul_f32 v[182:183], v[182:183], v[8:9] op_sel:[0,1] op_sel_hi:[1,1]
v_pk_mul_f32 v[184:185], v[184:185], v[8:9] op_sel:[0,1] op_sel_hi:[1,1]
v_pk_mul_f32 v[186:187], v[186:187], v[8:9] op_sel:[0,1] op_sel_hi:[1,1]
v_pk_mul_f32 v[188:189], v[188:189], v[8:9] op_sel:[0,1] op_sel_hi:[1,1]
v_pk_mul_f32 v[190:191], v[190:191], v[8:9] op_sel:[0,1] op_sel_hi:[1,1]
v_cvt_pk_bf16_f32 v224, v160, v161
v_cvt_pk_bf16_f32 v225, v162, v163
v_cvt_pk_bf16_f32 v226, v164, v165
v_cvt_pk_bf16_f32 v227, v166, v167
v_cvt_pk_bf16_f32 v228, v168, v169
v_cvt_pk_bf16_f32 v229, v170, v171
s_add_u32 m0, s96, 70656
s_add_u32 s94, s95, 147456
buffer_load_dwordx4 v5, s[32:35], s94 offen lds
v_cvt_pk_bf16_f32 v230, v172, v173
v_cvt_pk_bf16_f32 v231, v174, v175
v_mfma_f32_32x32x16_bf16 v[160:175], a[232:235], v[224:227], 0
s_nop 0
v_mfma_f32_32x32x16_bf16 v[240:255], a[236:239], v[228:231], 0
v_cvt_pk_bf16_f32 v232, v176, v177
v_cvt_pk_bf16_f32 v233, v178, v179
v_cvt_pk_bf16_f32 v234, v180, v181
v_cvt_pk_bf16_f32 v235, v182, v183
v_cvt_pk_bf16_f32 v236, v184, v185
v_cvt_pk_bf16_f32 v237, v186, v187
v_cvt_pk_bf16_f32 v238, v188, v189
v_cvt_pk_bf16_f32 v239, v190, v191
v_mfma_f32_32x32x16_bf16 v[176:191], v[232:235], a[224:227], 0
s_nop 0
v_mfma_f32_32x32x16_bf16 v[144:159], v[236:239], a[228:231], 0
s_add_u32 m0, s96, 71680
s_add_u32 s94, s95, 196608
buffer_load_dwordx4 v5, s[32:35], s94 offen lds
v_max3_f32 v192, v160, v161, v162
v_max3_f32 v193, v163, v164, v165
v_max3_f32 v192, v166, v167, v192
v_max_f32 v192, v192, v193
v_max3_f32 v194, v168, v169, v170
v_max3_f32 v195, v171, v172, v173
v_max3_f32 v194, v174, v175, v194
v_max_f32_e64 v194, v194, v195
v_max3_f32 v196, v240, v241, v242
v_max3_f32 v197, v243, v244, v245
v_max3_f32 v196, v246, v247, v196
v_max_f32_e64 v196, v196, v197
v_max3_f32 v198, v248, v249, v250
v_max3_f32 v199, v251, v252, v253
v_max3_f32 v198, v254, v255, v198
v_max_f32 v198, v198, v199
v_permlane32_swap_b32 v192, v194
s_nop 0
v_permlane32_swap_b32 v196, v198
v_max_f32 v192, v192, v194
v_max_f32 v196, v196, v198
v_mov_b32 v194, v192
v_mov_b32 v198, v196
s_nop 0
v_permlane32_swap_b32 v192, v194
v_permlane32_swap_b32_e64 v196, v198
v_mul_f32 v192, 0xbfb8aa3b, v192
v_mul_f32 v194, 0xbfb8aa3b, v194
v_mul_f32 v196, 0xbfb8aa3b, v196
v_mul_f32 v198, 0xbfb8aa3b, v198
v_pk_fma_f32 v[160:161], v[160:161], s[84:85], v[192:193] op_sel_hi:[1,1,0]
v_pk_fma_f32 v[162:163], v[162:163], s[84:85], v[192:193] op_sel_hi:[1,1,0]
v_pk_fma_f32 v[164:165], v[164:165], s[84:85], v[192:193] op_sel_hi:[1,1,0]
s_add_u32 m0, s96, 72704
s_add_u32 s94, s95, 245760
buffer_load_dwordx4 v5, s[32:35], s94 offen lds
v_pk_fma_f32 v[166:167], v[166:167], s[84:85], v[192:193] op_sel_hi:[1,1,0]
v_pk_fma_f32 v[168:169], v[168:169], s[84:85], v[194:195] op_sel_hi:[1,1,0]
v_pk_fma_f32 v[170:171], v[170:171], s[84:85], v[194:195] op_sel_hi:[1,1,0]
v_pk_fma_f32 v[172:173], v[172:173], s[84:85], v[194:195] op_sel_hi:[1,1,0]
v_pk_fma_f32 v[174:175], v[174:175], s[84:85], v[194:195] op_sel_hi:[1,1,0]
v_pk_fma_f32 v[240:241], v[240:241], s[84:85], v[196:197] op_sel_hi:[1,1,0]
v_pk_fma_f32 v[242:243], v[242:243], s[84:85], v[196:197] op_sel_hi:[1,1,0]
v_pk_fma_f32 v[244:245], v[244:245], s[84:85], v[196:197] op_sel_hi:[1,1,0]
v_pk_fma_f32 v[246:247], v[246:247], s[84:85], v[196:197] op_sel_hi:[1,1,0]
v_pk_fma_f32 v[248:249], v[248:249], s[84:85], v[198:199] op_sel_hi:[1,1,0]
v_pk_fma_f32 v[250:251], v[250:251], s[84:85], v[198:199] op_sel_hi:[1,1,0]
v_pk_fma_f32 v[252:253], v[252:253], s[84:85], v[198:199] op_sel_hi:[1,1,0]
v_pk_fma_f32 v[254:255], v[254:255], s[84:85], v[198:199] op_sel_hi:[1,1,0]
v_exp_f32 v160, v160
v_exp_f32 v161, v161
v_exp_f32 v162, v162
v_exp_f32 v163, v163
v_exp_f32 v164, v164
v_exp_f32 v165, v165
v_exp_f32 v166, v166
v_exp_f32 v167, v167
v_exp_f32 v168, v168
v_exp_f32 v169, v169
v_exp_f32_e64 v170, v170
s_add_u32 m0, s96, 73728
s_add_u32 s94, s95, 294912
buffer_load_dwordx4 v5, s[32:35], s94 offen lds
v_exp_f32 v171, v171
v_exp_f32 v172, v172
v_exp_f32 v173, v173
v_exp_f32 v174, v174
v_exp_f32 v175, v175
v_exp_f32 v240, v240
v_exp_f32 v241, v241
v_exp_f32 v242, v242
v_exp_f32 v243, v243
v_exp_f32 v244, v244
v_exp_f32 v245, v245
v_exp_f32 v246, v246
v_exp_f32 v247, v247
v_exp_f32 v248, v248
v_exp_f32 v249, v249
v_exp_f32 v250, v250
v_exp_f32 v251, v251
v_exp_f32 v252, v252
s_add_u32 m0, s96, 74752
s_add_u32 s94, s95, 344064
buffer_load_dwordx4 v5, s[32:35], s94 offen lds
v_exp_f32 v253, v253
v_exp_f32 v254, v254
v_exp_f32_e64 v255, v255
v_pk_add_f32 v[192:193], v[160:161], v[162:163]
v_pk_add_f32 v[200:201], v[164:165], v[166:167]
v_pk_add_f32 v[192:193], v[192:193], v[200:201]
v_add_f32_e64 v192, v192, v193
v_pk_add_f32 v[194:195], v[168:169], v[170:171]
v_pk_add_f32 v[200:201], v[172:173], v[174:175]
v_pk_add_f32 v[194:195], v[194:195], v[200:201]
v_add_f32_e64 v194, v194, v195
v_pk_add_f32 v[196:197], v[240:241], v[242:243]
v_pk_add_f32 v[200:201], v[244:245], v[246:247]
v_pk_add_f32 v[196:197], v[196:197], v[200:201]
v_add_f32_e64 v196, v196, v197
v_pk_add_f32 v[198:199], v[248:249], v[250:251]
v_pk_add_f32 v[200:201], v[252:253], v[254:255]
v_pk_add_f32 v[198:199], v[198:199], v[200:201]
v_add_f32 v198, v198, v199
v_permlane32_swap_b32 v192, v194
s_nop 0
v_permlane32_swap_b32 v196, v198
v_add_f32 v192, v192, v194
v_add_f32 v196, v196, v198
v_mov_b32 v194, v192
v_mov_b32 v198, v196
s_nop 0
v_permlane32_swap_b32 v192, v194
v_permlane32_swap_b32 v196, v198
v_rcp_f32 v192, v192
v_rcp_f32 v194, v194
v_rcp_f32 v196, v196
v_rcp_f32_e64 v198, v198
v_pk_mul_f32 v[160:161], v[160:161], v[192:193] op_sel_hi:[1,0]
v_pk_mul_f32 v[162:163], v[162:163], v[192:193] op_sel_hi:[1,0]
v_pk_mul_f32 v[164:165], v[164:165], v[192:193] op_sel_hi:[1,0]
v_pk_mul_f32 v[166:167], v[166:167], v[192:193] op_sel_hi:[1,0]
v_pk_mul_f32 v[168:169], v[168:169], v[194:195] op_sel_hi:[1,0]
v_pk_mul_f32 v[170:171], v[170:171], v[194:195] op_sel_hi:[1,0]
v_pk_mul_f32 v[172:173], v[172:173], v[194:195] op_sel_hi:[1,0]
v_pk_mul_f32 v[174:175], v[174:175], v[194:195] op_sel_hi:[1,0]
v_pk_mul_f32 v[240:241], v[240:241], v[196:197] op_sel_hi:[1,0]
v_pk_mul_f32 v[242:243], v[242:243], v[196:197] op_sel_hi:[1,0]
v_pk_mul_f32 v[244:245], v[244:245], v[196:197] op_sel_hi:[1,0]
v_pk_mul_f32 v[246:247], v[246:247], v[196:197] op_sel_hi:[1,0]
v_pk_mul_f32 v[248:249], v[248:249], v[198:199] op_sel_hi:[1,0]
v_pk_mul_f32 v[250:251], v[250:251], v[198:199] op_sel_hi:[1,0]
v_pk_mul_f32 v[252:253], v[252:253], v[198:199] op_sel_hi:[1,0]
v_pk_mul_f32 v[254:255], v[254:255], v[198:199] op_sel_hi:[1,0]
v_cvt_pk_bf16_f32 v204, v160, v161
v_cvt_pk_bf16_f32 v205, v162, v163
v_cvt_pk_bf16_f32 v206, v164, v165
v_cvt_pk_bf16_f32 v207, v166, v167
v_cvt_pk_bf16_f32 v208, v168, v169
v_cvt_pk_bf16_f32 v209, v170, v171
v_cvt_pk_bf16_f32 v210, v172, v173
v_cvt_pk_bf16_f32 v211, v174, v175
v_cvt_pk_bf16_f32 v212, v240, v241
v_cvt_pk_bf16_f32 v213, v242, v243
v_cvt_pk_bf16_f32 v214, v244, v245
v_cvt_pk_bf16_f32 v215, v246, v247
v_cvt_pk_bf16_f32 v216, v248, v249
v_cvt_pk_bf16_f32 v217, v250, v251
v_cvt_pk_bf16_f32 v218, v252, v253
v_cvt_pk_bf16_f32 v219, v254, v255
v_mfma_f32_32x32x16_bf16 v[160:175], v[204:207], a[224:227], 0
v_mfma_f32_32x32x16_bf16 v[160:175], v[208:211], a[228:231], v[160:175]
v_mfma_f32_32x32x16_bf16 v[240:255], v[212:215], a[224:227], 0
v_mfma_f32_32x32x16_bf16 v[240:255], v[216:219], a[228:231], v[240:255]
v_cvt_pk_bf16_f32 v224, v176, v177
v_cvt_pk_bf16_f32 v225, v178, v179
v_cvt_pk_bf16_f32 v226, v180, v181
v_cvt_pk_bf16_f32 v227, v182, v183
v_cvt_pk_bf16_f32 v228, v184, v185
v_cvt_pk_bf16_f32 v229, v186, v187
v_cvt_pk_bf16_f32 v230, v188, v189
v_cvt_pk_bf16_f32 v231, v190, v191
v_cvt_pk_bf16_f32 v232, v144, v145
v_cvt_pk_bf16_f32 v233, v146, v147
v_cvt_pk_bf16_f32 v234, v148, v149
v_cvt_pk_bf16_f32 v235, v150, v151
v_cvt_pk_bf16_f32 v236, v152, v153
v_cvt_pk_bf16_f32 v237, v154, v155
v_cvt_pk_bf16_f32 v238, v156, v157
v_cvt_pk_bf16_f32 v239, v158, v159
v_cvt_pk_bf16_f32 v204, v160, v161
v_cvt_pk_bf16_f32 v205, v162, v163
v_cvt_pk_bf16_f32 v206, v164, v165
v_cvt_pk_bf16_f32 v207, v166, v167
v_cvt_pk_bf16_f32 v208, v168, v169
v_cvt_pk_bf16_f32 v209, v170, v171
v_cvt_pk_bf16_f32 v210, v172, v173
v_cvt_pk_bf16_f32 v211, v174, v175
v_mfma_f32_32x32x16_bf16 v[176:191], v[204:207], v[224:227], 0
s_nop 0
v_mfma_f32_32x32x16_bf16 v[176:191], v[208:211], v[228:231], v[176:191]
v_cvt_pk_bf16_f32 v212, v240, v241
v_cvt_pk_bf16_f32 v213, v242, v243
v_cvt_pk_bf16_f32 v214, v244, v245
v_cvt_pk_bf16_f32 v215, v246, v247
v_cvt_pk_bf16_f32 v216, v248, v249
v_cvt_pk_bf16_f32 v217, v250, v251
v_cvt_pk_bf16_f32 v218, v252, v253
v_cvt_pk_bf16_f32 v219, v254, v255
v_mfma_f32_32x32x16_bf16 v[176:191], v[212:215], v[232:235], v[176:191]
s_nop 0
v_mfma_f32_32x32x16_bf16 v[176:191], v[216:219], v[236:239], v[176:191]
v_add_f32 v160, v160, v168
v_add_f32 v161, v161, v169
v_add_f32 v162, v162, v170
v_add_f32 v163, v163, v171
v_add_f32 v164, v164, v172
v_add_f32 v165, v165, v173
v_add_f32 v166, v166, v174
v_add_f32 v167, v167, v175
v_add_f32 v240, v240, v248
v_add_f32 v241, v241, v249
v_add_f32 v242, v242, v250
v_add_f32 v243, v243, v251
v_add_f32 v244, v244, v252
v_add_f32 v245, v245, v253
v_add_f32 v246, v246, v254
v_add_f32 v247, v247, v255
v_add_f32 v160, v160, v164
v_add_f32 v161, v161, v165
v_add_f32 v162, v162, v166
v_add_f32 v163, v163, v167
v_add_f32 v240, v240, v244
v_add_f32 v241, v241, v245
v_add_f32 v242, v242, v246
v_add_f32 v243, v243, v247
v_add_f32 v160, v160, v162
v_add_f32 v161, v161, v163
v_add_f32 v240, v240, v242
v_add_f32 v241, v241, v243
v_add_f32 v160, v160, v161
v_add_f32 v240, v240, v241
v_lshl_add_u32 v11, v0, 2, s24
v_lshlrev_b32 v7, 2, v0
v_permlane32_swap_b32 v160, v240
v_add_u32 v12, 112640, v7
v_add_u32 v13, s25, v1
v_add_f32 v160, v160, v240
ds_write_b32 v11, v160
v_add_u32 v11, 100352, v1
s_cmp_ge_u32 s68, 2
s_cbranch_scc1 Lsc_37
Lsc_35:
s_cmp_eq_u32 s68, 1
s_cbranch_scc1 Lsc_36
ds_write_b128 v11, v[180:183] offset:5120
ds_write_b128 v11, v[184:187] offset:7168
ds_write_b128 v11, v[188:191] offset:9216
v_pk_add_f32 v[192:193], v[176:177], 0
v_pk_add_f32 v[194:195], v[178:179], 0
s_branch Lscd_39
Lsc_36:
ds_write_b128 v11, v[176:179] offset:0
ds_write_b128 v11, v[184:187] offset:8192
ds_write_b128 v11, v[188:191] offset:10240
v_pk_add_f32 v[192:193], v[180:181], 0
v_pk_add_f32 v[194:195], v[182:183], 0
s_branch Lscd_39
Lsc_37:
s_cmp_eq_u32 s68, 3
s_cbranch_scc1 Lsc_38
ds_write_b128 v11, v[176:179] offset:1024
ds_write_b128 v11, v[180:183] offset:3072
ds_write_b128 v11, v[188:191] offset:11264
v_pk_add_f32 v[192:193], v[184:185], 0
v_pk_add_f32 v[194:195], v[186:187], 0
s_branch Lscd_39
Lsc_38:
ds_write_b128 v11, v[176:179] offset:2048
ds_write_b128 v11, v[180:183] offset:4096
ds_write_b128 v11, v[184:187] offset:6144
v_pk_add_f32 v[192:193], v[188:189], 0
v_pk_add_f32 v[194:195], v[190:191], 0
Lscd_39:
v_lshlrev_b32 v11, 3, v0
s_waitcnt lgkmcnt(0)
s_barrier
ds_read_b128 v[196:199], v13 offset:0
ds_read_b128 v[200:203], v13 offset:1024
ds_read_b128 v[204:207], v13 offset:2048
ds_read_b32 v208, v12 offset:0
ds_read_b32 v209, v12 offset:256
ds_read_b32 v210, v12 offset:512
ds_read_b32 v211, v12 offset:768
s_waitcnt lgkmcnt(4)
v_pk_add_f32 v[192:193], v[192:193], v[196:197]
v_pk_add_f32 v[200:201], v[200:201], v[204:205]
v_pk_add_f32 v[194:195], v[194:195], v[198:199]
v_pk_add_f32 v[202:203], v[202:203], v[206:207]
v_pk_add_f32 v[192:193], v[192:193], v[200:201]
v_pk_add_f32 v[194:195], v[194:195], v[202:203]
v_cvt_pk_bf16_f32 v192, v192, v193
v_cvt_pk_bf16_f32 v193, v194, v195
buffer_store_dwordx2 v[192:193], v11, s[36:39], s21 offen sc1
s_waitcnt lgkmcnt(0)
s_cmp_lg_u32 s68, 0
s_cbranch_scc1 Lnoz_40
v_pk_add_f32 v[208:209], v[208:209], v[210:211]
v_add_f32_e64 v208, v208, v209
buffer_store_dword v208, v7, s[36:39], s20 offen offset:2048 sc1
Lnoz_40:
v_lshrrev_b32_e64 v7, 3, v0
v_mul_u32_u24 v7, 1024, v7
v_and_b32_e64 v14, 3, v0
v_lshl_add_u32 v7, v14, 4, v7
v_lshrrev_b32 v14, 2, v0
v_lshrrev_b32 v11, 4, v0
v_xor_b32 v14, v14, v11
v_and_b32 v14, 1, v14
v_mul_u32_u24 v14, 64, v14
v_add_u32 v14, v14, v7
s_lshl_b32 s93, s68, 14
s_lshl_b32 s77, s68, 17
s_lshl_b32 s78, s72, 7
s_add_u32 s92, s77, s78
s_sub_u32 s77, s92, 16384
s_and_b32 s97, s77, 0x7ffff
v_and_b32_e64 v11, 15, v0
v_lshl_add_u32 v5, v11, 2, s23
v_lshrrev_b32_e64 v7, 4, v0
v_mul_u32_u24 v7, 2304, v7
v_lshl_add_u32 v13, v11, 4, v7
v_lshrrev_b32_e64 v7, 5, v0
v_mul_u32_u24 v7, 2304, v7
v_and_b32_e64 v12, 31, v0
v_lshl_add_u32 v12, v12, 4, v7
s_mul_i32 s79, s70, 36864
s_add_u32 s79, s79, 1638400
s_lshl_b32 s80, s68, 9
s_add_u32 s80, s80, s79
s_lshl_b32 s100, s68, 11
s_mul_i32 s99, s70, 229376
s_add_u32 s99, s99, s100
s_add_u32 s99, s99, 18874368
v_mov_b32 v188, 0
v_mov_b32 v189, 0
v_mov_b32 v190, 0
v_mov_b32 v191, 0
v_mov_b32 v192, 0
v_mov_b32 v193, 0
v_mov_b32 v194, 0
v_mov_b32 v7, 1
v_mov_b32_e64 v6, s22
s_waitcnt vmcnt(0)
s_mov_b64 exec, 1
buffer_store_dword v7, v6, s[36:39], 0 offen sc1
s_mov_b64 exec, -1
s_barrier
s_add_u32 m0, s93, 100352
s_add_u32 s94, s92, 0
buffer_load_dwordx4 v14, s[48:51], s94 offen lds
s_add_u32 m0, s93, 101376
s_add_u32 s94, s92, 8192
buffer_load_dwordx4 v14, s[48:51], s94 offen lds
ds_read_b64_tr_b16 v[160:161], v4 offset:0
ds_read_b64_tr_b16 v[162:163], v4 offset:256
ds_read_b64_tr_b16 v[164:165], v4 offset:1024
ds_read_b64_tr_b16 v[166:167], v4 offset:1280
ds_read_b64_tr_b16 v[168:169], v4 offset:2048
ds_read_b64_tr_b16 v[170:171], v4 offset:2304
ds_read_b64_tr_b16 v[172:173], v4 offset:3072
ds_read_b64_tr_b16 v[174:175], v4 offset:3328
s_waitcnt lgkmcnt(6)
v_mfma_f32_32x32x16_bf16 v[144:159], v[160:163], v[16:19], 0
v_mov_b32 v195, 0
v_lshlrev_b32 v11, 1, v0
ds_read_b64_tr_b16 v[160:161], v4 offset:4096
ds_read_b64_tr_b16 v[162:163], v4 offset:4352
s_waitcnt lgkmcnt(6)
v_mfma_f32_32x32x16_bf16 v[144:159], v[164:167], v[20:23], v[144:159]
s_add_u32 m0, s93, 102400
s_add_u32 s94, s92, 16384
buffer_load_dwordx4 v14, s[48:51], s94 offen lds
v_lshrrev_b32 v7, 5, v0
v_and_or_b32 v11, v11, 62, v7
ds_read_b64_tr_b16 v[164:165], v4 offset:5120
ds_read_b64_tr_b16 v[166:167], v4 offset:5376
s_waitcnt lgkmcnt(6)
v_mfma_f32_32x32x16_bf16 v[144:159], v[168:171], v[24:27], v[144:159]
v_bfe_u32 v7, v11, 4, 1
v_lshlrev_b32 v7, 11, v7
ds_read_b64_tr_b16 v[168:169], v4 offset:6144
ds_read_b64_tr_b16 v[170:171], v4 offset:6400
s_waitcnt lgkmcnt(6)
v_mfma_f32_32x32x16_bf16 v[144:159], v[172:175], v[28:31], v[144:159]
s_add_u32 m0, s93, 103424
s_add_u32 s94, s92, 24576
buffer_load_dwordx4 v14, s[48:51], s94 offen lds
v_and_b32 v11, 47, v11
v_lshl_add_u32 v7, v11, 4, v7
ds_read_b64_tr_b16 v[172:173], v4 offset:7168
ds_read_b64_tr_b16 v[174:175], v4 offset:7424
s_waitcnt lgkmcnt(6)
v_mfma_f32_32x32x16_bf16 v[144:159], v[160:163], v[32:35], v[144:159]
s_lshl_b32 s77, s74, 10
s_lshl_b32 s78, s75, 3
ds_read_b64_tr_b16 v[160:161], v4 offset:8192
ds_read_b64_tr_b16 v[162:163], v4 offset:8448
s_waitcnt lgkmcnt(6)
v_mfma_f32_32x32x16_bf16 v[144:159], v[164:167], v[36:39], v[144:159]
s_add_u32 m0, s93, 104448
s_add_u32 s94, s92, 32768
buffer_load_dwordx4 v14, s[48:51], s94 offen lds
s_add_u32 s77, s77, s78
s_add_u32 s77, s77, 92160
ds_read_b64_tr_b16 v[164:165], v4 offset:9216
ds_read_b64_tr_b16 v[166:167], v4 offset:9472
s_waitcnt lgkmcnt(6)
v_mfma_f32_32x32x16_bf16 v[144:159], v[168:171], v[40:43], v[144:159]
v_add_u32 v196, s77, v7
v_and_b32 v7, 31, v0
ds_read_b64_tr_b16 v[168:169], v4 offset:10240
ds_read_b64_tr_b16 v[170:171], v4 offset:10496
s_waitcnt lgkmcnt(6)
v_mfma_f32_32x32x16_bf16 v[144:159], v[172:175], v[44:47], v[144:159]
s_add_u32 m0, s93, 105472
s_add_u32 s94, s92, 40960
buffer_load_dwordx4 v14, s[48:51], s94 offen lds
v_min_u32 v7, 16, v7
v_and_b32_e64 v11, 32, v0
ds_read_b64_tr_b16 v[172:173], v4 offset:11264
ds_read_b64_tr_b16 v[174:175], v4 offset:11520
s_waitcnt lgkmcnt(6)
v_mfma_f32_32x32x16_bf16 v[144:159], v[160:163], v[48:51], v[144:159]
v_add_u32 v7, v7, v11
v_lshlrev_b32_e64 v7, 4, v7
ds_read_b64_tr_b16 v[160:161], v4 offset:12288
ds_read_b64_tr_b16 v[162:163], v4 offset:12544
s_waitcnt lgkmcnt(6)
v_mfma_f32_32x32x16_bf16 v[144:159], v[164:167], v[52:55], v[144:159]
s_add_u32 m0, s93, 106496
s_add_u32 s94, s92, 49152
buffer_load_dwordx4 v14, s[48:51], s94 offen lds
v_add_u32 v197, 92160, v7
s_lshl_b32 s77, s71, 15
ds_read_b64_tr_b16 v[164:165], v4 offset:13312
ds_read_b64_tr_b16 v[166:167], v4 offset:13568
s_waitcnt lgkmcnt(6)
v_mfma_f32_32x32x16_bf16 v[144:159], v[168:171], v[56:59], v[144:159]
s_lshl_b32 s78, s70, 11
s_add_u32 s77, s77, s78
ds_read_b64_tr_b16 v[168:169], v4 offset:14336
ds_read_b64_tr_b16 v[170:171], v4 offset:14592
s_waitcnt lgkmcnt(6)
v_mfma_f32_32x32x16_bf16 v[144:159], v[172:175], v[60:63], v[144:159]
s_add_u32 m0, s93, 107520
s_add_u32 s94, s92, 57344
buffer_load_dwordx4 v14, s[48:51], s94 offen lds
s_add_u32 s82, s77, 6291456
v_bfe_u32 v7, v0, 2, 2
ds_read_b64_tr_b16 v[172:173], v4 offset:15360
ds_read_b64_tr_b16 v[174:175], v4 offset:15616
s_waitcnt lgkmcnt(6)
v_mfma_f32_32x32x16_bf16 v[144:159], v[160:163], v[64:67], v[144:159]
v_lshlrev_b32 v7, 10, v7
v_and_b32_e64 v11, 1, v0
ds_read_b64_tr_b16 v[160:161], v4 offset:16384
ds_read_b64_tr_b16 v[162:163], v4 offset:16640
s_waitcnt lgkmcnt(6)
v_mfma_f32_32x32x16_bf16 v[144:159], v[164:167], v[68:71], v[144:159]
s_add_u32 m0, s93, 108544
s_add_u32 s94, s92, 65536
buffer_load_dwordx4 v14, s[48:51], s94 offen lds
v_lshl_add_u32 v7, v11, 9, v7
v_bfe_u32 v11, v0, 1, 1
ds_read_b64_tr_b16 v[164:165], v4 offset:17408
ds_read_b64_tr_b16 v[166:167], v4 offset:17664
s_waitcnt lgkmcnt(6)
v_mfma_f32_32x32x16_bf16 v[144:159], v[168:171], v[72:75], v[144:159]
v_lshl_add_u32 v7, v11, 3, v7
v_add_u32 v198, 92416, v7
ds_read_b64_tr_b16 v[168:169], v4 offset:18432
ds_read_b64_tr_b16 v[170:171], v4 offset:18688
s_waitcnt lgkmcnt(6)
v_mfma_f32_32x32x16_bf16 v[144:159], v[172:175], v[76:79], v[144:159]
s_add_u32 m0, s93, 109568
s_add_u32 s94, s92, 73728
buffer_load_dwordx4 v14, s[48:51], s94 offen lds
ds_read_b64_tr_b16 v[172:173], v4 offset:19456
ds_read_b64_tr_b16 v[174:175], v4 offset:19712
s_waitcnt lgkmcnt(6)
v_mfma_f32_32x32x16_bf16 v[144:159], v[160:163], v[80:83], v[144:159]
ds_read_b64_tr_b16 v[160:161], v4 offset:20480
ds_read_b64_tr_b16 v[162:163], v4 offset:20736
s_waitcnt lgkmcnt(6)
v_mfma_f32_32x32x16_bf16 v[144:159], v[164:167], v[84:87], v[144:159]
s_add_u32 m0, s93, 110592
s_add_u32 s94, s92, 81920
buffer_load_dwordx4 v14, s[48:51], s94 offen lds
ds_read_b64_tr_b16 v[164:165], v4 offset:21504
ds_read_b64_tr_b16 v[166:167], v4 offset:21760
s_waitcnt lgkmcnt(6)
v_mfma_f32_32x32x16_bf16 v[144:159], v[168:171], v[88:91], v[144:159]
ds_read_b64_tr_b16 v[168:169], v4 offset:22528
ds_read_b64_tr_b16 v[170:171], v4 offset:22784
s_waitcnt lgkmcnt(6)
v_mfma_f32_32x32x16_bf16 v[144:159], v[172:175], v[92:95], v[144:159]
s_add_u32 m0, s93, 111616
s_add_u32 s94, s92, 90112
buffer_load_dwordx4 v14, s[48:51], s94 offen lds
ds_read_b64_tr_b16 v[172:173], v4 offset:23552
ds_read_b64_tr_b16 v[174:175], v4 offset:23808
s_waitcnt lgkmcnt(6)
v_mfma_f32_32x32x16_bf16 v[144:159], v[160:163], v[96:99], v[144:159]
ds_read_b64_tr_b16 v[160:161], v4 offset:24576
ds_read_b64_tr_b16 v[162:163], v4 offset:24832
s_waitcnt lgkmcnt(6)
v_mfma_f32_32x32x16_bf16 v[144:159], v[164:167], v[100:103], v[144:159]
s_add_u32 m0, s93, 112640
s_add_u32 s94, s92, 98304
buffer_load_dwordx4 v14, s[48:51], s94 offen lds
ds_read_b64_tr_b16 v[164:165], v4 offset:25600
ds_read_b64_tr_b16 v[166:167], v4 offset:25856
s_waitcnt lgkmcnt(6)
v_mfma_f32_32x32x16_bf16 v[144:159], v[168:171], v[104:107], v[144:159]
ds_read_b64_tr_b16 v[168:169], v4 offset:26624
ds_read_b64_tr_b16 v[170:171], v4 offset:26880
s_waitcnt lgkmcnt(6)
v_mfma_f32_32x32x16_bf16 v[144:159], v[172:175], v[108:111], v[144:159]
s_add_u32 m0, s93, 113664
s_add_u32 s94, s92, 106496
buffer_load_dwordx4 v14, s[48:51], s94 offen lds
ds_read_b64_tr_b16 v[172:173], v4 offset:27648
ds_read_b64_tr_b16 v[174:175], v4 offset:27904
s_waitcnt lgkmcnt(6)
v_mfma_f32_32x32x16_bf16 v[144:159], v[160:163], v[112:115], v[144:159]
ds_read_b64_tr_b16 v[160:161], v4 offset:28672
ds_read_b64_tr_b16 v[162:163], v4 offset:28928
s_waitcnt lgkmcnt(6)
v_mfma_f32_32x32x16_bf16 v[144:159], v[164:167], v[116:119], v[144:159]
buffer_load_dword v6, v5, s[36:39], 0 offen sc1
ds_read_b64_tr_b16 v[164:165], v4 offset:29696
ds_read_b64_tr_b16 v[166:167], v4 offset:29952
s_waitcnt lgkmcnt(6)
v_mfma_f32_32x32x16_bf16 v[144:159], v[168:171], v[120:123], v[144:159]
ds_read_b64_tr_b16 v[168:169], v4 offset:30720
ds_read_b64_tr_b16 v[170:171], v4 offset:30976
s_waitcnt lgkmcnt(6)
v_mfma_f32_32x32x16_bf16 v[144:159], v[172:175], v[124:127], v[144:159]
ds_read_b64_tr_b16 v[172:173], v4 offset:31744
ds_read_b64_tr_b16 v[174:175], v4 offset:32000
s_waitcnt lgkmcnt(6)
v_mfma_f32_32x32x16_bf16 v[144:159], v[160:163], v[128:131], v[144:159]
s_waitcnt lgkmcnt(4)
v_mfma_f32_32x32x16_bf16 v[144:159], v[164:167], v[132:135], v[144:159]
s_waitcnt lgkmcnt(2)
v_mfma_f32_32x32x16_bf16 v[144:159], v[168:171], v[136:139], v[144:159]
s_waitcnt lgkmcnt(0)
v_mfma_f32_32x32x16_bf16 v[144:159], v[172:175], v[140:143], v[144:159]
s_waitcnt lgkmcnt(0)
s_barrier
ds_read_b128 v[160:163], v10 offset:256
ds_read_b128 v[164:167], v10 offset:272
ds_read_b128 v[168:171], v10 offset:320
ds_read_b128 v[172:175], v10 offset:336
s_waitcnt vmcnt(0)
v_cmp_gt_u32 vcc, 1, v6
s_nop 0
s_cbranch_vccz Lgo_42
Lpoll_41:
s_sleep 1
buffer_load_dword v6, v5, s[36:39], 0 offen sc1
s_waitcnt vmcnt(0)
v_cmp_gt_u32 vcc, 1, v6
s_nop 0
s_cbranch_vccz Lgo_42
s_add_u32 s91, s91, 1
s_bitcmp0_b32 s91, 16
s_cbranch_scc1 Lpoll_41
Lgo_42:
s_cmp_lg_u32 s68, 0
s_cbranch_scc1 Lzld_43
buffer_load_dwordx4 v[16:19], v13, s[36:39], s79 offen offset:2048 sc1
s_add_u32 s79, s79, 9216
buffer_load_dwordx4 v[20:23], v13, s[36:39], s79 offen offset:2048 sc1
s_add_u32 s79, s79, 9216
buffer_load_dwordx4 v[24:27], v13, s[36:39], s79 offen offset:2048 sc1
s_add_u32 s79, s79, 9216
buffer_load_dwordx4 v[28:31], v13, s[36:39], s79 offen offset:2048 sc1
Lzld_43:
buffer_load_dwordx4 v[220:223], v12, s[36:39], s80 offen sc1
s_add_u32 s80, s80, 4608
buffer_load_dwordx4 v[224:227], v12, s[36:39], s80 offen sc1
s_add_u32 s80, s80, 4608
buffer_load_dwordx4 v[228:231], v12, s[36:39], s80 offen sc1
s_add_u32 s80, s80, 4608
buffer_load_dwordx4 v[232:235], v12, s[36:39], s80 offen sc1
s_waitcnt lgkmcnt(0)
v_pk_fma_f32 v[144:145], v[160:161], v[8:9], v[144:145] op_sel_hi:[1,0,1]
v_pk_fma_f32 v[146:147], v[162:163], v[8:9], v[146:147] op_sel_hi:[1,0,1]
v_pk_fma_f32 v[148:149], v[164:165], v[8:9], v[148:149] op_sel_hi:[1,0,1]
v_pk_fma_f32 v[150:151], v[166:167], v[8:9], v[150:151] op_sel_hi:[1,0,1]
v_pk_fma_f32 v[152:153], v[168:169], v[8:9], v[152:153] op_sel_hi:[1,0,1]
v_pk_fma_f32 v[154:155], v[170:171], v[8:9], v[154:155] op_sel_hi:[1,0,1]
v_pk_fma_f32 v[156:157], v[172:173], v[8:9], v[156:157] op_sel_hi:[1,0,1]
v_pk_fma_f32 v[158:159], v[174:175], v[8:9], v[158:159] op_sel_hi:[1,0,1]
v_pk_mul_f32 v[144:145], v[144:145], v[8:9] op_sel:[0,1] op_sel_hi:[1,1]
v_pk_mul_f32 v[146:147], v[146:147], v[8:9] op_sel:[0,1] op_sel_hi:[1,1]
s_add_u32 s80, s80, 4608
buffer_load_dwordx4 v[236:239], v12, s[36:39], s80 offen sc1
v_pk_mul_f32 v[148:149], v[148:149], v[8:9] op_sel:[0,1] op_sel_hi:[1,1]
v_pk_mul_f32 v[150:151], v[150:151], v[8:9] op_sel:[0,1] op_sel_hi:[1,1]
v_pk_mul_f32 v[152:153], v[152:153], v[8:9] op_sel:[0,1] op_sel_hi:[1,1]
v_pk_mul_f32 v[154:155], v[154:155], v[8:9] op_sel:[0,1] op_sel_hi:[1,1]
v_pk_mul_f32 v[156:157], v[156:157], v[8:9] op_sel:[0,1] op_sel_hi:[1,1]
v_pk_mul_f32 v[158:159], v[158:159], v[8:9] op_sel:[0,1] op_sel_hi:[1,1]
v_cvt_pk_bf16_f32 v176, v144, v145
v_cvt_pk_bf16_f32 v177, v146, v147
v_cvt_pk_bf16_f32 v178, v148, v149
v_cvt_pk_bf16_f32 v179, v150, v151
s_add_u32 s80, s80, 4608
buffer_load_dwordx4 v[240:243], v12, s[36:39], s80 offen sc1
v_cvt_pk_bf16_f32 v180, v152, v153
v_cvt_pk_bf16_f32 v181, v154, v155
v_cvt_pk_bf16_f32 v182, v156, v157
v_cvt_pk_bf16_f32 v183, v158, v159
v_mfma_f32_32x32x16_bf16 v[144:159], a[232:235], v[176:179], 0
s_add_u32 s80, s80, 4608
buffer_load_dwordx4 v[244:247], v12, s[36:39], s80 offen sc1
v_mfma_f32_32x32x16_bf16 v[200:215], a[236:239], v[180:183], 0
s_nop 8
v_max3_f32 v176, v144, v145, v146
v_max3_f32 v177, v147, v148, v149
s_add_u32 s80, s80, 4608
buffer_load_dwordx4 v[248:251], v12, s[36:39], s80 offen sc1
v_max3_f32 v176, v150, v151, v176
v_max_f32 v176, v176, v177
v_max3_f32 v178, v152, v153, v154
v_max3_f32 v179, v155, v156, v157
v_max3_f32 v178, v158, v159, v178
v_max_f32_e64 v178, v178, v179
v_max3_f32 v180, v200, v201, v202
v_max3_f32 v181, v203, v204, v205
v_max3_f32 v180, v206, v207, v180
v_max_f32_e64 v180, v180, v181
v_max3_f32 v182, v208, v209, v210
v_max3_f32 v183, v211, v212, v213
v_max3_f32 v182, v214, v215, v182
v_max_f32 v182, v182, v183
v_permlane32_swap_b32 v176, v178
s_nop 0
v_permlane32_swap_b32 v180, v182
s_add_u32 m0, s93, 98304
s_add_u32 s94, s97, 0
buffer_load_dwordx4 v14, s[48:51], s94 offen lds
v_max_f32 v176, v176, v178
v_max_f32 v180, v180, v182
v_mov_b32 v178, v176
v_mov_b32 v182, v180
s_nop 0
v_permlane32_swap_b32 v176, v178
v_permlane32_swap_b32 v180, v182
v_mul_f32 v176, 0xbfb8aa3b, v176
v_mul_f32 v178, 0xbfb8aa3b, v178
v_mul_f32 v180, 0xbfb8aa3b, v180
v_mul_f32 v182, 0xbfb8aa3b, v182
v_pk_fma_f32 v[144:145], v[144:145], s[84:85], v[176:177] op_sel_hi:[1,1,0]
v_pk_fma_f32 v[146:147], v[146:147], s[84:85], v[176:177] op_sel_hi:[1,1,0]
v_pk_fma_f32 v[148:149], v[148:149], s[84:85], v[176:177] op_sel_hi:[1,1,0]
v_pk_fma_f32 v[150:151], v[150:151], s[84:85], v[176:177] op_sel_hi:[1,1,0]
v_pk_fma_f32 v[152:153], v[152:153], s[84:85], v[178:179] op_sel_hi:[1,1,0]
v_pk_fma_f32 v[154:155], v[154:155], s[84:85], v[178:179] op_sel_hi:[1,1,0]
s_add_u32 m0, s93, 99328
s_add_u32 s94, s97, 8192
buffer_load_dwordx4 v14, s[48:51], s94 offen lds
v_pk_fma_f32 v[156:157], v[156:157], s[84:85], v[178:179] op_sel_hi:[1,1,0]
v_pk_fma_f32 v[158:159], v[158:159], s[84:85], v[178:179] op_sel_hi:[1,1,0]
v_pk_fma_f32 v[200:201], v[200:201], s[84:85], v[180:181] op_sel_hi:[1,1,0]
v_pk_fma_f32 v[202:203], v[202:203], s[84:85], v[180:181] op_sel_hi:[1,1,0]
v_pk_fma_f32 v[204:205], v[204:205], s[84:85], v[180:181] op_sel_hi:[1,1,0]
v_pk_fma_f32 v[206:207], v[206:207], s[84:85], v[180:181] op_sel_hi:[1,1,0]
v_pk_fma_f32 v[208:209], v[208:209], s[84:85], v[182:183] op_sel_hi:[1,1,0]
v_pk_fma_f32 v[210:211], v[210:211], s[84:85], v[182:183] op_sel_hi:[1,1,0]
v_pk_fma_f32 v[212:213], v[212:213], s[84:85], v[182:183] op_sel_hi:[1,1,0]
v_pk_fma_f32 v[214:215], v[214:215], s[84:85], v[182:183] op_sel_hi:[1,1,0]
v_exp_f32 v144, v144
v_exp_f32 v145, v145
v_exp_f32 v146, v146
v_exp_f32 v147, v147
v_exp_f32 v148, v148
v_exp_f32 v149, v149
v_exp_f32 v150, v150
v_exp_f32 v151, v151
s_add_u32 m0, s100, 67584
s_add_u32 s18, s99, 0
buffer_load_dwordx4 v1, s[36:39], s18 offen lds
v_exp_f32 v152, v152
v_exp_f32 v153, v153
v_exp_f32 v154, v154
v_exp_f32 v155, v155
v_exp_f32 v156, v156
v_exp_f32 v157, v157
v_exp_f32 v158, v158
v_exp_f32 v159, v159
v_exp_f32 v200, v200
v_exp_f32 v201, v201
v_exp_f32 v202, v202
v_exp_f32 v203, v203
v_exp_f32 v204, v204
s_add_u32 m0, s100, 67584
s_add_u32 s18, s99, 0
buffer_load_dwordx4 v1, s[36:39], s18 offen offset:1024 lds
v_exp_f32 v205, v205
v_exp_f32 v206, v206
v_exp_f32 v207, v207
v_exp_f32 v208, v208
v_exp_f32 v209, v209
v_exp_f32 v210, v210
v_exp_f32 v211, v211
v_exp_f32 v212, v212
v_exp_f32 v213, v213
v_exp_f32 v214, v214
v_exp_f32 v215, v215
v_pk_add_f32 v[176:177], v[144:145], v[146:147]
v_pk_add_f32 v[184:185], v[148:149], v[150:151]
v_pk_add_f32 v[176:177], v[176:177], v[184:185]
s_add_u32 m0, s100, 75776
s_add_u32 s18, s99, 8192
buffer_load_dwordx4 v1, s[36:39], s18 offen lds
v_add_f32_e64 v176, v176, v177
v_pk_add_f32 v[178:179], v[152:153], v[154:155]
v_pk_add_f32 v[184:185], v[156:157], v[158:159]
v_pk_add_f32 v[178:179], v[178:179], v[184:185]
v_add_f32_e64 v178, v178, v179
v_pk_add_f32 v[180:181], v[200:201], v[202:203]
v_pk_add_f32 v[184:185], v[204:205], v[206:207]
v_pk_add_f32 v[180:181], v[180:181], v[184:185]
v_add_f32_e64 v180, v180, v181
v_pk_add_f32 v[182:183], v[208:209], v[210:211]
v_pk_add_f32 v[184:185], v[212:213], v[214:215]
v_pk_add_f32 v[182:183], v[182:183], v[184:185]
v_add_f32 v182, v182, v183
v_permlane32_swap_b32 v176, v178
s_nop 0
v_permlane32_swap_b32 v180, v182
v_add_f32 v176, v176, v178
v_add_f32 v180, v180, v182
v_mov_b32 v178, v176
v_mov_b32 v182, v180
s_nop 0
v_permlane32_swap_b32 v176, v178
v_permlane32_swap_b32_e64 v180, v182
s_add_u32 m0, s100, 75776
s_add_u32 s18, s99, 8192
buffer_load_dwordx4 v1, s[36:39], s18 offen offset:1024 lds
v_rcp_f32 v176, v176
v_rcp_f32 v178, v178
v_rcp_f32 v180, v180
v_rcp_f32 v182, v182
v_pk_mul_f32 v[144:145], v[144:145], v[176:177] op_sel_hi:[1,0]
v_pk_mul_f32 v[146:147], v[146:147], v[176:177] op_sel_hi:[1,0]
v_pk_mul_f32 v[148:149], v[148:149], v[176:177] op_sel_hi:[1,0]
v_pk_mul_f32 v[150:151], v[150:151], v[176:177] op_sel_hi:[1,0]
v_pk_mul_f32 v[152:153], v[152:153], v[178:179] op_sel_hi:[1,0]
v_pk_mul_f32 v[154:155], v[154:155], v[178:179] op_sel_hi:[1,0]
v_pk_mul_f32 v[156:157], v[156:157], v[178:179] op_sel_hi:[1,0]
v_pk_mul_f32 v[158:159], v[158:159], v[178:179] op_sel_hi:[1,0]
v_pk_mul_f32 v[200:201], v[200:201], v[180:181] op_sel_hi:[1,0]
v_pk_mul_f32 v[202:203], v[202:203], v[180:181] op_sel_hi:[1,0]
v_pk_mul_f32 v[204:205], v[204:205], v[180:181] op_sel_hi:[1,0]
v_pk_mul_f32 v[206:207], v[206:207], v[180:181] op_sel_hi:[1,0]
v_pk_mul_f32 v[208:209], v[208:209], v[182:183] op_sel_hi:[1,0]
v_pk_mul_f32 v[210:211], v[210:211], v[182:183] op_sel_hi:[1,0]
v_pk_mul_f32 v[212:213], v[212:213], v[182:183] op_sel_hi:[1,0]
v_pk_mul_f32 v[214:215], v[214:215], v[182:183] op_sel_hi:[1,0]
v_cvt_pk_bf16_f32 v160, v144, v145
s_add_u32 m0, s100, 83968
s_add_u32 s18, s99, 16384
buffer_load_dwordx4 v1, s[36:39], s18 offen lds
v_cvt_pk_bf16_f32 v161, v146, v147
v_cvt_pk_bf16_f32 v162, v148, v149
v_cvt_pk_bf16_f32 v163, v150, v151
v_cvt_pk_bf16_f32 v164, v152, v153
v_cvt_pk_bf16_f32 v165, v154, v155
v_cvt_pk_bf16_f32 v166, v156, v157
v_cvt_pk_bf16_f32 v167, v158, v159
v_cvt_pk_bf16_f32 v168, v200, v201
v_cvt_pk_bf16_f32 v169, v202, v203
v_cvt_pk_bf16_f32 v170, v204, v205
v_cvt_pk_bf16_f32 v171, v206, v207
v_cvt_pk_bf16_f32 v172, v208, v209
v_cvt_pk_bf16_f32 v173, v210, v211
v_cvt_pk_bf16_f32 v174, v212, v213
v_cvt_pk_bf16_f32 v175, v214, v215
s_add_u32 m0, s100, 83968
s_add_u32 s18, s99, 16384
buffer_load_dwordx4 v1, s[36:39], s18 offen offset:1024 lds
s_cmp_lg_u32 s68, 0
s_cbranch_scc1 Lzsum_44
s_waitcnt vmcnt(16)
v_pk_add_f32 v[16:17], v[16:17], v[20:21]
v_pk_add_f32 v[24:25], v[24:25], v[28:29]
v_pk_add_f32 v[18:19], v[18:19], v[22:23]
v_pk_add_f32 v[26:27], v[26:27], v[30:31]
v_pk_add_f32 v[16:17], v[16:17], v[24:25]
v_pk_add_f32 v[18:19], v[18:19], v[26:27]
v_mov_b32 v20, v16
v_mov_b32 v21, v17
v_mov_b32 v22, v18
v_mov_b32 v23, v19
v_permlane16_swap_b32 v16, v20
v_permlane16_swap_b32 v17, v21
v_permlane16_swap_b32 v18, v22
v_permlane16_swap_b32 v19, v23
v_add_f32 v16, v16, v20
v_add_f32 v17, v17, v21
v_add_f32 v18, v18, v22
v_add_f32 v19, v19, v23
v_mov_b32 v20, v16
v_mov_b32 v21, v17
v_mov_b32 v22, v18
v_mov_b32 v23, v19
v_permlane32_swap_b32 v16, v20
v_permlane32_swap_b32 v17, v21
v_permlane32_swap_b32 v18, v22
v_permlane32_swap_b32 v19, v23
v_add_f32 v16, v16, v20
v_add_f32 v17, v17, v21
v_add_f32 v18, v18, v22
v_add_f32_e64 v19, v19, v23
v_cvt_pk_bf16_f32 v16, v16, v17
v_cvt_pk_bf16_f32 v17, v18, v19
ds_write_b64 v198, v[16:17]
Lzsum_44:
s_waitcnt vmcnt(15)
v_dot2c_f32_bf16 v188, s87, v220
v_dot2c_f32_bf16 v189, s88, v220
v_dot2c_f32_bf16 v190, s87, v221
v_dot2c_f32_bf16 v191, s88, v221
v_dot2c_f32_bf16 v192, s87, v222
v_dot2c_f32_bf16 v193, s88, v222
v_dot2c_f32_bf16 v194, s87, v223
v_dot2c_f32_bf16 v195, s88, v223
s_waitcnt vmcnt(14)
v_dot2c_f32_bf16 v188, s87, v224
v_dot2c_f32_bf16 v189, s88, v224
v_dot2c_f32_bf16 v190, s87, v225
v_dot2c_f32_bf16 v191, s88, v225
v_dot2c_f32_bf16 v192, s87, v226
v_dot2c_f32_bf16 v193, s88, v226
v_dot2c_f32_bf16 v194, s87, v227
v_dot2c_f32_bf16 v195, s88, v227
s_waitcnt vmcnt(13)
v_dot2c_f32_bf16 v188, s87, v228
v_dot2c_f32_bf16 v189, s88, v228
v_dot2c_f32_bf16 v190, s87, v229
v_dot2c_f32_bf16 v191, s88, v229
v_dot2c_f32_bf16 v192, s87, v230
v_dot2c_f32_bf16 v193, s88, v230
v_dot2c_f32_bf16 v194, s87, v231
v_dot2c_f32_bf16 v195, s88, v231
s_waitcnt vmcnt(12)
v_dot2c_f32_bf16 v188, s87, v232
v_dot2c_f32_bf16 v189, s88, v232
v_dot2c_f32_bf16 v190, s87, v233
v_dot2c_f32_bf16 v191, s88, v233
v_dot2c_f32_bf16 v192, s87, v234
v_dot2c_f32_bf16 v193, s88, v234
v_dot2c_f32_bf16 v194, s87, v235
v_dot2c_f32_bf16 v195, s88, v235
s_waitcnt vmcnt(11)
v_dot2c_f32_bf16 v188, s87, v236
v_dot2c_f32_bf16 v189, s88, v236
v_dot2c_f32_bf16 v190, s87, v237
v_dot2c_f32_bf16 v191, s88, v237
v_dot2c_f32_bf16 v192, s87, v238
v_dot2c_f32_bf16 v193, s88, v238
v_dot2c_f32_bf16 v194, s87, v239
v_dot2c_f32_bf16 v195, s88, v239
s_waitcnt vmcnt(10)
v_dot2c_f32_bf16 v188, s87, v240
v_dot2c_f32_bf16 v189, s88, v240
v_dot2c_f32_bf16 v190, s87, v241
v_dot2c_f32_bf16 v191, s88, v241
v_dot2c_f32_bf16 v192, s87, v242
v_dot2c_f32_bf16 v193, s88, v242
v_dot2c_f32_bf16 v194, s87, v243
v_dot2c_f32_bf16 v195, s88, v243
s_waitcnt vmcnt(9)
v_dot2c_f32_bf16 v188, s87, v244
v_dot2c_f32_bf16 v189, s88, v244
v_dot2c_f32_bf16 v190, s87, v245
v_dot2c_f32_bf16 v191, s88, v245
v_dot2c_f32_bf16 v192, s87, v246
v_dot2c_f32_bf16 v193, s88, v246
v_dot2c_f32_bf16 v194, s87, v247
v_dot2c_f32_bf16 v195, s88, v247
s_waitcnt vmcnt(8)
v_dot2c_f32_bf16 v188, s87, v248
v_dot2c_f32_bf16 v189, s88, v248
v_dot2c_f32_bf16 v190, s87, v249
v_dot2c_f32_bf16 v191, s88, v249
v_dot2c_f32_bf16 v192, s87, v250
v_dot2c_f32_bf16 v193, s88, v250
v_dot2c_f32_bf16 v194, s87, v251
v_dot2c_f32_bf16 v195, s88, v251
v_permlane32_swap_b32 v188, v192
v_permlane32_swap_b32 v189, v193
v_permlane32_swap_b32 v190, v194
v_permlane32_swap_b32 v191, v195
v_pk_add_f32 v[188:189], v[188:189], v[192:193]
v_pk_add_f32 v[190:191], v[190:191], v[194:195]
v_cvt_pk_bf16_f32 v188, v188, v189
v_cvt_pk_bf16_f32 v189, v190, v191
ds_write_b64 v196, v[188:189]
s_waitcnt vmcnt(6)
s_waitcnt lgkmcnt(0)
s_barrier
ds_read_b128 v[176:179], v197 offset:0
ds_read_b128 v[180:183], v197 offset:1024
ds_read_b128 v[184:187], v197 offset:2048
ds_read_b128 v[188:191], v197 offset:3072
s_waitcnt lgkmcnt(0)
v_mfma_f32_32x32x16_bf16 v[200:215], v[176:179], v[160:163], 0
v_mfma_f32_32x32x16_bf16 v[200:215], v[180:183], v[164:167], v[200:215]
v_mfma_f32_32x32x16_bf16 v[216:231], v[184:187], v[168:171], 0
v_mfma_f32_32x32x16_bf16 v[216:231], v[188:191], v[172:175], v[216:231]
s_nop 9
v_add_f32 v208, 0x358637bd, v208
v_rcp_f32_e64 v208, v208
s_nop 0
v_pk_mul_f32 v[200:201], v[200:201], v[208:209] op_sel_hi:[1,0]
v_pk_mul_f32 v[202:203], v[202:203], v[208:209] op_sel_hi:[1,0]
v_pk_mul_f32 v[204:205], v[204:205], v[208:209] op_sel_hi:[1,0]
v_pk_mul_f32 v[206:207], v[206:207], v[208:209] op_sel_hi:[1,0]
v_cvt_pk_bf16_f32 v212, v200, v201
v_cvt_pk_bf16_f32 v213, v202, v203
v_cvt_pk_bf16_f32 v214, v204, v205
v_cvt_pk_bf16_f32 v215, v206, v207
buffer_store_dwordx4 v[212:215], v1, s[36:39], s82 offen
v_add_f32 v224, 0x358637bd, v224
v_rcp_f32 v224, v224
s_nop 0
v_pk_mul_f32 v[216:217], v[216:217], v[224:225] op_sel_hi:[1,0]
v_pk_mul_f32 v[218:219], v[218:219], v[224:225] op_sel_hi:[1,0]
v_pk_mul_f32 v[220:221], v[220:221], v[224:225] op_sel_hi:[1,0]
v_pk_mul_f32 v[222:223], v[222:223], v[224:225] op_sel_hi:[1,0]
v_cvt_pk_bf16_f32 v228, v216, v217
v_cvt_pk_bf16_f32 v229, v218, v219
v_cvt_pk_bf16_f32 v230, v220, v221
v_cvt_pk_bf16_f32 v231, v222, v223
buffer_store_dwordx4 v[228:231], v1, s[36:39], s82 offen offset:1024
s_lshl_b32 s77, s74, 15
s_add_u32 s77, s77, 100352
s_mul_i32 s78, s74, 4294934528
s_add_u32 s78, s78, 131072
v_add_u32 v7, s77, v2
v_add_u32_e64 v11, s77, v3
ds_read_b64_tr_b16 v[16:17], v7 offset:0
ds_read_b64_tr_b16 v[18:19], v7 offset:512
ds_read_b64_tr_b16 v[20:21], v11 offset:0
ds_read_b64_tr_b16 v[22:23], v11 offset:512
ds_read_b64_tr_b16 v[24:25], v7 offset:2048
ds_read_b64_tr_b16 v[26:27], v7 offset:2560
ds_read_b64_tr_b16 v[28:29], v11 offset:2048
ds_read_b64_tr_b16 v[30:31], v11 offset:2560
ds_read_b64_tr_b16 v[32:33], v7 offset:4096
ds_read_b64_tr_b16 v[34:35], v7 offset:4608
ds_read_b64_tr_b16 v[36:37], v11 offset:4096
ds_read_b64_tr_b16 v[38:39], v11 offset:4608
s_lshl_b32 s80, s69, 2
s_lshl_b32 s77, s73, 1
s_add_u32 s80, s80, s77
s_add_u32 s80, s80, s75
s_lshl_b32 s81, s80, 12
s_lshl_b32 s77, s72, 9
s_add_u32 s81, s81, s77
s_lshl_b32 s77, s74, 3
s_add_u32 s81, s81, s77
s_lshl_b32 s80, s80, 15
s_lshl_b32 s77, s72, 7
s_lshl_b32 s78, s74, 6
s_add_u32 s77, s77, s78
s_add_u32 s79, s80, s77
s_lshl_b32 s77, s77, 5
s_add_u32 s80, s80, s77
v_and_b32 v7, 31, v0
v_lshrrev_b32 v11, 5, v0
v_lshlrev_b32_e64 v14, 10, v7
v_lshl_add_u32 v14, v11, 4, v14
v_lshlrev_b32_e64 v7, 4, v7
v_lshl_add_u32 v5, v11, 2, v7
s_lshl_b32 s77, s73, 1
s_add_u32 s77, s77, s75
s_lshl_b32 s82, s69, 2
s_add_u32 s82, s82, s77
s_lshl_b32 s77, s82, 6
s_lshl_b32 s78, s74, 5
s_add_u32 s77, s77, s78
v_and_b32 v252, 7, v0
v_lshl_add_u32 v252, v252, 2, s77
s_lshl_b32 s82, s82, 15
s_lshl_b32 s78, s74, 14
s_add_u32 s82, s82, s78
s_add_u32 s89, s82, 6291456
s_xor_b32 s77, s68, 2
s_lshl_b32 s77, s77, 12
s_add_u32 s77, s77, 141312
v_add_u32_e64 v12, s77, v1
s_lshl_b32 s77, s68, 12
s_add_u32 s77, s77, 141312
v_add_u32 v13, s77, v1
v_mov_b32 v7, 6
v_mov_b32_e64 v6, s83
s_waitcnt vmcnt(0)
s_mov_b64 exec, 1
buffer_store_dword v7, v6, s[36:39], 0 offen
s_mov_b64 exec, -1
s_lshr_b32 s94, s2, 3
s_lshl_b32 s94, s94, 2
s_add_u32 s94, s94, s68
s_lshl_b32 s94, s94, 8
v_and_b32 v254, 1, v0
v_lshl_add_u32 v254, v254, 7, s94
s_lshl_b32 s77, s74, 15
s_add_u32 s77, s77, 100352
s_mul_i32 s78, s74, 4294934528
s_add_u32 s78, s78, 131072
v_add_u32 v7, s77, v2
v_add_u32_e64 v11, s77, v3
ds_read_b64_tr_b16 v[40:41], v7 offset:6144
ds_read_b64_tr_b16 v[42:43], v7 offset:6656
ds_read_b64_tr_b16 v[44:45], v11 offset:6144
ds_read_b64_tr_b16 v[46:47], v11 offset:6656
ds_read_b64_tr_b16 v[48:49], v7 offset:8192
ds_read_b64_tr_b16 v[50:51], v7 offset:8704
ds_read_b64_tr_b16 v[52:53], v11 offset:8192
ds_read_b64_tr_b16 v[54:55], v11 offset:8704
ds_read_b64_tr_b16 v[56:57], v7 offset:10240
ds_read_b64_tr_b16 v[58:59], v7 offset:10752
ds_read_b64_tr_b16 v[60:61], v11 offset:10240
ds_read_b64_tr_b16 v[62:63], v11 offset:10752
ds_read_b64_tr_b16 v[64:65], v7 offset:12288
ds_read_b64_tr_b16 v[66:67], v7 offset:12800
ds_read_b64_tr_b16 v[68:69], v11 offset:12288
ds_read_b64_tr_b16 v[70:71], v11 offset:12800
ds_read_b64_tr_b16 v[72:73], v7 offset:14336
ds_read_b64_tr_b16 v[74:75], v7 offset:14848
ds_read_b64_tr_b16 v[76:77], v11 offset:14336
ds_read_b64_tr_b16 v[78:79], v11 offset:14848
ds_read_b64_tr_b16 v[80:81], v7 offset:16384
ds_read_b64_tr_b16 v[82:83], v7 offset:16896
ds_read_b64_tr_b16 v[84:85], v11 offset:16384
ds_read_b64_tr_b16 v[86:87], v11 offset:16896
buffer_load_dword v6, v252, s[36:39], 0 offen sc1
s_lshl_b32 s77, s74, 15
s_add_u32 s77, s77, 100352
s_mul_i32 s78, s74, 4294934528
s_add_u32 s78, s78, 131072
v_add_u32 v7, s77, v2
v_add_u32_e64 v11, s77, v3
ds_read_b64_tr_b16 v[88:89], v7 offset:18432
ds_read_b64_tr_b16 v[90:91], v7 offset:18944
ds_read_b64_tr_b16 v[92:93], v11 offset:18432
ds_read_b64_tr_b16 v[94:95], v11 offset:18944
ds_read_b64_tr_b16 v[96:97], v7 offset:20480
ds_read_b64_tr_b16 v[98:99], v7 offset:20992
ds_read_b64_tr_b16 v[100:101], v11 offset:20480
ds_read_b64_tr_b16 v[102:103], v11 offset:20992
ds_read_b64_tr_b16 v[104:105], v7 offset:22528
ds_read_b64_tr_b16 v[106:107], v7 offset:23040
ds_read_b64_tr_b16 v[108:109], v11 offset:22528
ds_read_b64_tr_b16 v[110:111], v11 offset:23040
ds_read_b64_tr_b16 v[112:113], v7 offset:24576
ds_read_b64_tr_b16 v[114:115], v7 offset:25088
ds_read_b64_tr_b16 v[116:117], v11 offset:24576
ds_read_b64_tr_b16 v[118:119], v11 offset:25088
ds_read_b64_tr_b16 v[120:121], v7 offset:26624
ds_read_b64_tr_b16 v[122:123], v7 offset:27136
ds_read_b64_tr_b16 v[124:125], v11 offset:26624
ds_read_b64_tr_b16 v[126:127], v11 offset:27136
ds_read_b64_tr_b16 v[128:129], v7 offset:28672
ds_read_b64_tr_b16 v[130:131], v7 offset:29184
ds_read_b64_tr_b16 v[132:133], v11 offset:28672
ds_read_b64_tr_b16 v[134:135], v11 offset:29184
v_add_u32 v7, s78, v2
v_add_u32 v11, s78, v3
ds_read_b64_tr_b16 v[136:137], v7 offset:0
ds_read_b64_tr_b16 v[138:139], v7 offset:512
ds_read_b64_tr_b16 v[140:141], v11 offset:0
ds_read_b64_tr_b16 v[142:143], v11 offset:512
s_waitcnt vmcnt(0)
v_cmp_gt_u32 vcc, 6, v6
s_nop 0
s_cbranch_vccz Lgo_46
Lpoll_45:
buffer_load_dword v6, v252, s[36:39], 0 offen sc1
s_waitcnt vmcnt(0)
v_cmp_gt_u32 vcc, 6, v6
s_nop 0
s_cbranch_vccz Lgo_46
s_add_u32 s91, s91, 1
s_bitcmp0_b32 s91, 16
s_cbranch_scc1 Lpoll_45
Lgo_46:
buffer_load_dwordx4 v[144:147], v1, s[36:39], s89 offen sc1
buffer_load_dwordx4 v[148:151], v1, s[36:39], s89 offen offset:1024 sc1
buffer_load_dwordx4 v[152:155], v1, s[36:39], s89 offen offset:2048 sc1
buffer_load_dwordx4 v[156:159], v1, s[36:39], s89 offen offset:3072 sc1
s_add_u32 s89, s89, 4096
buffer_load_dwordx4 v[160:163], v1, s[36:39], s89 offen sc1
buffer_load_dwordx4 v[164:167], v1, s[36:39], s89 offen offset:1024 sc1
buffer_load_dwordx4 v[168:171], v1, s[36:39], s89 offen offset:2048 sc1
buffer_load_dwordx4 v[172:175], v1, s[36:39], s89 offen offset:3072 sc1
s_add_u32 s89, s89, 4096
buffer_load_dwordx4 v[176:179], v1, s[36:39], s89 offen sc1
buffer_load_dwordx4 v[180:183], v1, s[36:39], s89 offen offset:1024 sc1
buffer_load_dwordx4 v[184:187], v1, s[36:39], s89 offen offset:2048 sc1
buffer_load_dwordx4 v[188:191], v1, s[36:39], s89 offen offset:3072 sc1
s_waitcnt lgkmcnt(0)
s_barrier
s_waitcnt vmcnt(11)
v_mfma_f32_32x32x16_bf16 v[208:223], v[16:19], v[144:147], 0
v_mfma_f32_32x32x16_bf16 v[224:239], v[20:23], v[144:147], 0
s_add_u32 s89, s89, 4096
buffer_load_dwordx4 v[192:195], v1, s[36:39], s89 offen sc1
s_waitcnt vmcnt(11)
v_mfma_f32_32x32x16_bf16 v[208:223], v[24:27], v[148:151], v[208:223]
v_mfma_f32_32x32x16_bf16 v[224:239], v[28:31], v[148:151], v[224:239]
buffer_load_dwordx4 v[196:199], v1, s[36:39], s89 offen offset:1024 sc1
s_waitcnt vmcnt(11)
v_mfma_f32_32x32x16_bf16 v[208:223], v[32:35], v[152:155], v[208:223]
v_mfma_f32_32x32x16_bf16 v[224:239], v[36:39], v[152:155], v[224:239]
buffer_load_dwordx4 v[200:203], v1, s[36:39], s89 offen offset:2048 sc1
s_waitcnt vmcnt(11)
v_mfma_f32_32x32x16_bf16 v[208:223], v[40:43], v[156:159], v[208:223]
v_mfma_f32_32x32x16_bf16 v[224:239], v[44:47], v[156:159], v[224:239]
buffer_load_dwordx4 v[204:207], v1, s[36:39], s89 offen offset:3072 sc1
s_waitcnt vmcnt(11)
v_mfma_f32_32x32x16_bf16 v[208:223], v[48:51], v[160:163], v[208:223]
v_mfma_f32_32x32x16_bf16 v[224:239], v[52:55], v[160:163], v[224:239]
s_add_u32 s94, s80, 4194304
buffer_load_dwordx4 v[240:243], v1, s[36:39], s94 offen sc1
buffer_load_dwordx4 v[244:247], v1, s[36:39], s94 offen offset:1024 sc1
s_waitcnt vmcnt(12)
v_mfma_f32_32x32x16_bf16 v[208:223], v[56:59], v[164:167], v[208:223]
v_mfma_f32_32x32x16_bf16 v[224:239], v[60:63], v[164:167], v[224:239]
s_getpc_b64 s[4:5]
global_load_dword a240, v254, s[4:5]
s_waitcnt vmcnt(12)
v_mfma_f32_32x32x16_bf16 v[208:223], v[64:67], v[168:171], v[208:223]
v_mfma_f32_32x32x16_bf16 v[224:239], v[68:71], v[168:171], v[224:239]
s_add_u32 m0, s100, 100352
s_add_u32 s18, s99, 24576
buffer_load_dwordx4 v1, s[36:39], s18 offen lds
s_waitcnt vmcnt(12)
v_mfma_f32_32x32x16_bf16 v[208:223], v[72:75], v[172:175], v[208:223]
v_mfma_f32_32x32x16_bf16 v[224:239], v[76:79], v[172:175], v[224:239]
s_add_u32 m0, s100, 100352
s_add_u32 s18, s99, 24576
buffer_load_dwordx4 v1, s[36:39], s18 offen offset:1024 lds
s_waitcnt vmcnt(12)
v_mfma_f32_32x32x16_bf16 v[208:223], v[80:83], v[176:179], v[208:223]
v_mfma_f32_32x32x16_bf16 v[224:239], v[84:87], v[176:179], v[224:239]
s_add_u32 m0, s100, 108544
s_add_u32 s18, s99, 32768
buffer_load_dwordx4 v1, s[36:39], s18 offen lds
s_waitcnt vmcnt(12)
v_mfma_f32_32x32x16_bf16 v[208:223], v[88:91], v[180:183], v[208:223]
v_mfma_f32_32x32x16_bf16 v[224:239], v[92:95], v[180:183], v[224:239]
s_add_u32 m0, s100, 108544
s_add_u32 s18, s99, 32768
buffer_load_dwordx4 v1, s[36:39], s18 offen offset:1024 lds
s_waitcnt vmcnt(12)
v_mfma_f32_32x32x16_bf16 v[208:223], v[96:99], v[184:187], v[208:223]
v_mfma_f32_32x32x16_bf16 v[224:239], v[100:103], v[184:187], v[224:239]
s_add_u32 m0, s100, 116736
s_add_u32 s18, s99, 40960
buffer_load_dwordx4 v1, s[36:39], s18 offen lds
s_waitcnt vmcnt(12)
v_mfma_f32_32x32x16_bf16 v[208:223], v[104:107], v[188:191], v[208:223]
v_mfma_f32_32x32x16_bf16 v[224:239], v[108:111], v[188:191], v[224:239]
s_add_u32 m0, s100, 116736
s_add_u32 s18, s99, 40960
buffer_load_dwordx4 v1, s[36:39], s18 offen offset:1024 lds
s_waitcnt vmcnt(12)
v_mfma_f32_32x32x16_bf16 v[208:223], v[112:115], v[192:195], v[208:223]
v_mfma_f32_32x32x16_bf16 v[224:239], v[116:119], v[192:195], v[224:239]
s_add_u32 m0, s100, 124928
s_add_u32 s18, s99, 49152
buffer_load_dwordx4 v1, s[36:39], s18 offen lds
s_waitcnt vmcnt(12)
v_mfma_f32_32x32x16_bf16 v[208:223], v[120:123], v[196:199], v[208:223]
v_mfma_f32_32x32x16_bf16 v[224:239], v[124:127], v[196:199], v[224:239]
s_add_u32 m0, s100, 124928
s_add_u32 s18, s99, 49152
buffer_load_dwordx4 v1, s[36:39], s18 offen offset:1024 lds
s_waitcnt vmcnt(12)
v_mfma_f32_32x32x16_bf16 v[208:223], v[128:131], v[200:203], v[208:223]
v_mfma_f32_32x32x16_bf16 v[224:239], v[132:135], v[200:203], v[224:239]
s_add_u32 m0, s100, 133120
s_add_u32 s18, s99, 57344
buffer_load_dwordx4 v1, s[36:39], s18 offen lds
s_waitcnt vmcnt(12)
v_mfma_f32_32x32x16_bf16 v[208:223], v[136:139], v[204:207], v[208:223]
v_mfma_f32_32x32x16_bf16 v[224:239], v[140:143], v[204:207], v[224:239]
s_add_u32 m0, s100, 133120
s_add_u32 s18, s99, 57344
buffer_load_dwordx4 v1, s[36:39], s18 offen offset:1024 lds
s_cmp_lg_u32 s74, 0
s_cbranch_scc1 Lkhi_47
s_nop 6
ds_write_b128 v12, v[224:227] offset:0
ds_write_b128 v12, v[228:231] offset:1024
ds_write_b128 v12, v[232:235] offset:2048
ds_write_b128 v12, v[236:239] offset:3072
s_branch Lkd_48
Lkhi_47:
s_nop 5
ds_write_b128 v12, v[208:211] offset:0
ds_write_b128 v12, v[212:215] offset:1024
ds_write_b128 v12, v[216:219] offset:2048
ds_write_b128 v12, v[220:223] offset:3072
v_pk_add_f32 v[208:209], v[224:225], 0
v_pk_add_f32 v[210:211], v[226:227], 0
v_pk_add_f32 v[212:213], v[228:229], 0
v_pk_add_f32 v[214:215], v[230:231], 0
v_pk_add_f32 v[216:217], v[232:233], 0
v_pk_add_f32 v[218:219], v[234:235], 0
v_pk_add_f32 v[220:221], v[236:237], 0
v_pk_add_f32 v[222:223], v[238:239], 0
Lkd_48:
s_waitcnt vmcnt(11)
v_dot2c_f32_bf16 v208, s87, v240
v_dot2c_f32_bf16 v209, s88, v240
v_dot2c_f32_bf16 v210, s87, v241
v_dot2c_f32_bf16 v211, s88, v241
v_dot2c_f32_bf16 v212, s87, v242
v_dot2c_f32_bf16 v213, s88, v242
v_dot2c_f32_bf16 v214, s87, v243
v_dot2c_f32_bf16 v215, s88, v243
v_dot2c_f32_bf16 v216, s87, v244
v_dot2c_f32_bf16 v217, s88, v244
v_dot2c_f32_bf16 v218, s87, v245
v_dot2c_f32_bf16 v219, s88, v245
v_dot2c_f32_bf16 v220, s87, v246
v_dot2c_f32_bf16 v221, s88, v246
v_dot2c_f32_bf16 v222, s87, v247
v_dot2c_f32_bf16 v223, s88, v247
s_waitcnt lgkmcnt(0)
s_barrier
ds_read_b128 v[224:227], v13 offset:0
ds_read_b128 v[228:231], v13 offset:1024
ds_read_b128 v[232:235], v13 offset:2048
ds_read_b128 v[236:239], v13 offset:3072
s_waitcnt lgkmcnt(0)
v_pk_add_f32 v[208:209], v[208:209], v[224:225]
v_pk_add_f32 v[210:211], v[210:211], v[226:227]
v_pk_add_f32 v[212:213], v[212:213], v[228:229]
v_pk_add_f32 v[214:215], v[214:215], v[230:231]
v_pk_add_f32 v[216:217], v[216:217], v[232:233]
v_pk_add_f32 v[218:219], v[218:219], v[234:235]
v_pk_add_f32 v[220:221], v[220:221], v[236:237]
v_pk_add_f32 v[222:223], v[222:223], v[238:239]
v_cvt_pk_bf16_f32 v240, v208, v209
v_cvt_pk_bf16_f32 v241, v210, v211
v_cvt_pk_bf16_f32 v242, v212, v213
v_cvt_pk_bf16_f32 v243, v214, v215
v_cvt_pk_bf16_f32 v244, v216, v217
v_cvt_pk_bf16_f32 v245, v218, v219
v_cvt_pk_bf16_f32 v246, v220, v221
v_cvt_pk_bf16_f32 v247, v222, v223
s_add_u32 s77, s80, 4194304
buffer_store_dwordx4 v[240:243], v1, s[36:39], s77 offen
buffer_store_dwordx4 v[244:247], v1, s[36:39], s77 offen offset:1024
v_mov_b32 v208, 0
v_mov_b32_e64 v209, 0
v_dot2c_f32_bf16 v208, s86, v240
v_dot2c_f32_bf16 v209, v240, v240
v_dot2c_f32_bf16 v208, s86, v241
v_dot2c_f32_bf16 v209, v241, v241
v_dot2c_f32_bf16 v208, s86, v242
v_dot2c_f32_bf16 v209, v242, v242
v_dot2c_f32_bf16 v208, s86, v243
v_dot2c_f32_bf16 v209, v243, v243
v_dot2c_f32_bf16 v208, s86, v244
v_dot2c_f32_bf16 v209, v244, v244
v_dot2c_f32_bf16 v208, s86, v245
v_dot2c_f32_bf16 v209, v245, v245
v_dot2c_f32_bf16 v208, s86, v246
v_dot2c_f32_bf16 v209, v246, v246
v_dot2c_f32_bf16 v208, s86, v247
v_dot2c_f32_bf16 v209, v247, v247
s_add_u32 s77, s81, 262144
s_nop 1
v_permlane32_swap_b32 v208, v209
v_add_f32_e64 v208, v208, v209
buffer_store_dword v208, v5, s[36:39], s77 offen
s_lshl_b32 s97, s71, 12
s_add_u32 s97, s97, 262144
v_and_b32 v7, 31, v0
v_lshlrev_b32 v7, 4, v7
v_lshrrev_b32 v5, 5, v0
v_lshl_add_u32 v5, v5, 11, v7
s_lshl_b32 s89, s71, 15
s_add_u32 s89, s89, 4194304
s_lshr_b32 s94, s2, 3
s_lshl_b32 s94, s94, 2
s_add_u32 s94, s94, s68
s_lshl_b32 s94, s94, 8
v_and_b32 v238, 1, v0
v_lshl_add_u32 v238, v238, 7, s94
v_lshrrev_b32 v7, 4, v0
v_and_b32 v14, 15, v0
v_lshlrev_b32_e64 v14, 4, v14
v_lshl_add_u32 v14, v7, 9, v14
v_add_u32 v12, 67584, v1
v_add_u32 v13, 133120, v1
s_mul_i32 s90, s71, 114688
s_mul_i32 s77, s70, 7168
s_add_u32 s90, s90, s77
s_add_u32 s90, s90, 10485760
s_lshl_b32 s77, s69, 8
s_lshl_b32 s78, s75, 6
s_add_u32 s77, s77, s78
s_lshl_b32 s78, s74, 5
s_add_u32 s77, s77, s78
v_and_b32_e64 v7, 7, v0
v_bfe_u32 v11, v0, 3, 1
v_lshlrev_b32_e64 v11, 7, v11
v_lshl_add_u32 v11, v7, 2, v11
v_add_u32 v11, s77, v11
v_mov_b32 v7, 7
v_mov_b32_e64 v6, s83
s_waitcnt vmcnt(0)
s_mov_b64 exec, 1
buffer_store_dword v7, v6, s[36:39], 0 offen
s_mov_b64 exec, -1
s_barrier
ds_read_b128 a[240:243], v12 offset:0
ds_read_b128 a[244:247], v12 offset:1024
ds_read_b128 a[248:251], v12 offset:2048
ds_read_b128 a[252:255], v12 offset:3072
Lpoll_49:
buffer_load_dword v6, v11, s[36:39], 0 offen sc1
s_waitcnt vmcnt(0)
v_cmp_gt_u32 vcc, 7, v6
s_nop 0
s_cbranch_vccz Lgo_50
s_add_u32 s91, s91, 1
s_bitcmp0_b32 s91, 16
s_cbranch_scc1 Lpoll_49
Lgo_50:
buffer_load_dwordx4 v[16:19], v14, s[36:39], s89 offen sc1
buffer_load_dwordx4 v[20:23], v14, s[36:39], s89 offen offset:256 sc1
buffer_load_dwordx4 v[24:27], v14, s[36:39], s89 offen offset:2048 sc1
buffer_load_dwordx4 v[28:31], v14, s[36:39], s89 offen offset:2304 sc1
s_waitcnt vmcnt(2) lgkmcnt(3)
v_mfma_f32_16x16x32_bf16 v[144:147], a[240:243], v[16:19], 0
s_add_u32 s89, s89, 4096
buffer_load_dwordx4 v[32:35], v14, s[36:39], s89 offen sc1
v_mfma_f32_16x16x32_bf16 v[148:151], a[240:243], v[20:23], 0
ds_read_b128 a[240:243], v12 offset:4096
s_waitcnt lgkmcnt(3)
v_mfma_f32_16x16x32_bf16 v[152:155], a[244:247], v[16:19], 0
buffer_load_dwordx4 v[36:39], v14, s[36:39], s89 offen offset:256 sc1
v_mfma_f32_16x16x32_bf16 v[156:159], a[244:247], v[20:23], 0
ds_read_b128 a[244:247], v12 offset:5120
s_waitcnt lgkmcnt(3)
v_mfma_f32_16x16x32_bf16 v[160:163], a[248:251], v[16:19], 0
buffer_load_dwordx4 v[40:43], v14, s[36:39], s89 offen offset:2048 sc1
v_mfma_f32_16x16x32_bf16 v[164:167], a[248:251], v[20:23], 0
ds_read_b128 a[248:251], v12 offset:6144
s_waitcnt lgkmcnt(3)
v_mfma_f32_16x16x32_bf16 v[168:171], a[252:255], v[16:19], 0
buffer_load_dwordx4 v[44:47], v14, s[36:39], s89 offen offset:2304 sc1
v_mfma_f32_16x16x32_bf16 v[172:175], a[252:255], v[20:23], 0
ds_read_b128 a[252:255], v12 offset:7168
s_waitcnt lgkmcnt(3)
v_mfma_f32_16x16x32_bf16 v[176:179], a[240:243], v[16:19], 0
s_add_u32 s89, s89, 4096
buffer_load_dwordx4 v[48:51], v14, s[36:39], s89 offen sc1
v_mfma_f32_16x16x32_bf16 v[180:183], a[240:243], v[20:23], 0
ds_read_b128 a[240:243], v12 offset:8192
s_waitcnt lgkmcnt(3)
v_mfma_f32_16x16x32_bf16 v[184:187], a[244:247], v[16:19], 0
s_getpc_b64 s[4:5]
global_load_dword v239, v238, s[4:5]
v_mfma_f32_16x16x32_bf16 v[188:191], a[244:247], v[20:23], 0
ds_read_b128 a[244:247], v12 offset:9216
s_waitcnt lgkmcnt(3)
v_mfma_f32_16x16x32_bf16 v[192:195], a[248:251], v[16:19], 0
buffer_load_dwordx4 v[240:243], v5, s[36:39], s97 offen sc1
v_mfma_f32_16x16x32_bf16 v[196:199], a[248:251], v[20:23], 0
ds_read_b128 a[248:251], v12 offset:10240
s_waitcnt lgkmcnt(3)
v_mfma_f32_16x16x32_bf16 v[200:203], a[252:255], v[16:19], 0
v_mfma_f32_16x16x32_bf16 v[204:207], a[252:255], v[20:23], 0
ds_read_b128 a[252:255], v12 offset:11264
s_waitcnt lgkmcnt(3)
v_mfma_f32_16x16x32_bf16 v[208:211], a[240:243], v[16:19], 0
buffer_load_dwordx4 v[244:247], v5, s[36:39], s97 offen offset:512 sc1
v_mfma_f32_16x16x32_bf16 v[212:215], a[240:243], v[20:23], 0
ds_read_b128 a[240:243], v12 offset:12288
s_waitcnt lgkmcnt(3)
v_mfma_f32_16x16x32_bf16 v[216:219], a[244:247], v[16:19], 0
v_mfma_f32_16x16x32_bf16 v[220:223], a[244:247], v[20:23], 0
ds_read_b128 a[244:247], v12 offset:13312
s_waitcnt vmcnt(8) lgkmcnt(3)
v_mfma_f32_16x16x32_bf16 v[144:147], a[248:251], v[24:27], v[144:147]
buffer_load_dwordx4 v[248:251], v5, s[36:39], s97 offen offset:1024 sc1
v_mfma_f32_16x16x32_bf16 v[148:151], a[248:251], v[28:31], v[148:151]
ds_read_b128 a[248:251], v12 offset:14336
s_waitcnt lgkmcnt(3)
v_mfma_f32_16x16x32_bf16 v[152:155], a[252:255], v[24:27], v[152:155]
v_mfma_f32_16x16x32_bf16 v[156:159], a[252:255], v[28:31], v[156:159]
ds_read_b128 a[252:255], v12 offset:15360
s_waitcnt lgkmcnt(3)
v_mfma_f32_16x16x32_bf16 v[160:163], a[240:243], v[24:27], v[160:163]
buffer_load_dwordx4 v[252:255], v5, s[36:39], s97 offen offset:1536 sc1
v_mfma_f32_16x16x32_bf16 v[164:167], a[240:243], v[28:31], v[164:167]
s_barrier
ds_read_b128 a[240:243], v12 offset:16384
s_waitcnt lgkmcnt(3)
v_mfma_f32_16x16x32_bf16 v[168:171], a[244:247], v[24:27], v[168:171]
v_mfma_f32_16x16x32_bf16 v[172:175], a[244:247], v[28:31], v[172:175]
ds_read_b128 a[244:247], v12 offset:17408
s_waitcnt lgkmcnt(3)
v_mfma_f32_16x16x32_bf16 v[176:179], a[248:251], v[24:27], v[176:179]
buffer_load_dwordx4 v[52:55], v14, s[36:39], s89 offen offset:256 sc1
v_mfma_f32_16x16x32_bf16 v[180:183], a[248:251], v[28:31], v[180:183]
ds_read_b128 a[248:251], v12 offset:18432
s_waitcnt lgkmcnt(3)
v_mfma_f32_16x16x32_bf16 v[184:187], a[252:255], v[24:27], v[184:187]
v_mfma_f32_16x16x32_bf16 v[188:191], a[252:255], v[28:31], v[188:191]
ds_read_b128 a[252:255], v12 offset:19456
s_waitcnt lgkmcnt(3)
v_mfma_f32_16x16x32_bf16 v[192:195], a[240:243], v[24:27], v[192:195]
buffer_load_dwordx4 v[56:59], v14, s[36:39], s89 offen offset:2048 sc1
v_mfma_f32_16x16x32_bf16 v[196:199], a[240:243], v[28:31], v[196:199]
ds_read_b128 a[240:243], v12 offset:20480
s_waitcnt lgkmcnt(3)
v_mfma_f32_16x16x32_bf16 v[200:203], a[244:247], v[24:27], v[200:203]
v_mfma_f32_16x16x32_bf16 v[204:207], a[244:247], v[28:31], v[204:207]
ds_read_b128 a[244:247], v12 offset:21504
s_waitcnt lgkmcnt(3)
v_mfma_f32_16x16x32_bf16 v[208:211], a[248:251], v[24:27], v[208:211]
buffer_load_dwordx4 v[60:63], v14, s[36:39], s89 offen offset:2304 sc1
v_mfma_f32_16x16x32_bf16 v[212:215], a[248:251], v[28:31], v[212:215]
ds_read_b128 a[248:251], v12 offset:22528
s_waitcnt lgkmcnt(3)
v_mfma_f32_16x16x32_bf16 v[216:219], a[252:255], v[24:27], v[216:219]
v_mfma_f32_16x16x32_bf16 v[220:223], a[252:255], v[28:31], v[220:223]
ds_read_b128 a[252:255], v12 offset:23552
s_waitcnt vmcnt(11) lgkmcnt(3)
v_mfma_f32_16x16x32_bf16 v[144:147], a[240:243], v[32:35], v[144:147]
s_add_u32 s89, s89, 4096
buffer_load_dwordx4 v[64:67], v14, s[36:39], s89 offen sc1
v_mfma_f32_16x16x32_bf16 v[148:151], a[240:243], v[36:39], v[148:151]
ds_read_b128 a[240:243], v12 offset:32768
s_waitcnt lgkmcnt(3)
v_mfma_f32_16x16x32_bf16 v[152:155], a[244:247], v[32:35], v[152:155]
v_mfma_f32_16x16x32_bf16 v[156:159], a[244:247], v[36:39], v[156:159]
ds_read_b128 a[244:247], v12 offset:33792
s_waitcnt lgkmcnt(3)
v_mfma_f32_16x16x32_bf16 v[160:163], a[248:251], v[32:35], v[160:163]
s_add_u32 m0, s100, 141312
s_add_u32 s18, s99, 65536
buffer_load_dwordx4 v1, s[36:39], s18 offen lds
v_mfma_f32_16x16x32_bf16 v[164:167], a[248:251], v[36:39], v[164:167]
ds_read_b128 a[248:251], v12 offset:34816
s_waitcnt lgkmcnt(3)
v_mfma_f32_16x16x32_bf16 v[168:171], a[252:255], v[32:35], v[168:171]
v_mfma_f32_16x16x32_bf16 v[172:175], a[252:255], v[36:39], v[172:175]
ds_read_b128 a[252:255], v12 offset:35840
s_waitcnt lgkmcnt(3)
v_mfma_f32_16x16x32_bf16 v[176:179], a[240:243], v[32:35], v[176:179]
buffer_load_dwordx4 v1, s[36:39], s18 offen offset:1024 lds
v_mfma_f32_16x16x32_bf16 v[180:183], a[240:243], v[36:39], v[180:183]
ds_read_b128 a[240:243], v12 offset:36864
s_waitcnt lgkmcnt(3)
v_mfma_f32_16x16x32_bf16 v[184:187], a[244:247], v[32:35], v[184:187]
v_mfma_f32_16x16x32_bf16 v[188:191], a[244:247], v[36:39], v[188:191]
ds_read_b128 a[244:247], v12 offset:37888
s_waitcnt lgkmcnt(3)
v_mfma_f32_16x16x32_bf16 v[192:195], a[248:251], v[32:35], v[192:195]
s_add_u32 m0, s100, 149504
s_add_u32 s18, s99, 73728
buffer_load_dwordx4 v1, s[36:39], s18 offen lds
v_mfma_f32_16x16x32_bf16 v[196:199], a[248:251], v[36:39], v[196:199]
ds_read_b128 a[248:251], v12 offset:38912
s_waitcnt lgkmcnt(3)
v_mfma_f32_16x16x32_bf16 v[200:203], a[252:255], v[32:35], v[200:203]
v_mfma_f32_16x16x32_bf16 v[204:207], a[252:255], v[36:39], v[204:207]
ds_read_b128 a[252:255], v12 offset:39936
s_waitcnt lgkmcnt(3)
v_mfma_f32_16x16x32_bf16 v[208:211], a[240:243], v[32:35], v[208:211]
buffer_load_dwordx4 v1, s[36:39], s18 offen offset:1024 lds
v_mfma_f32_16x16x32_bf16 v[212:215], a[240:243], v[36:39], v[212:215]
s_barrier
ds_read_b128 a[240:243], v12 offset:40960
s_waitcnt lgkmcnt(3)
v_mfma_f32_16x16x32_bf16 v[216:219], a[244:247], v[32:35], v[216:219]
v_mfma_f32_16x16x32_bf16 v[220:223], a[244:247], v[36:39], v[220:223]
ds_read_b128 a[244:247], v12 offset:41984
s_waitcnt vmcnt(14) lgkmcnt(3)
v_mfma_f32_16x16x32_bf16 v[144:147], a[248:251], v[40:43], v[144:147]
buffer_load_dwordx4 v[68:71], v14, s[36:39], s89 offen offset:256 sc1
s_waitcnt vmcnt(9)
v_add_f32_e64 v240, v240, v248
v_mfma_f32_16x16x32_bf16 v[148:151], a[248:251], v[44:47], v[148:151]
ds_read_b128 a[248:251], v12 offset:43008
s_waitcnt lgkmcnt(3)
v_mfma_f32_16x16x32_bf16 v[152:155], a[252:255], v[40:43], v[152:155]
v_add_f32 v241, v241, v249
v_add_f32_e64 v242, v242, v250
v_mfma_f32_16x16x32_bf16 v[156:159], a[252:255], v[44:47], v[156:159]
ds_read_b128 a[252:255], v12 offset:44032
s_waitcnt lgkmcnt(3)
v_mfma_f32_16x16x32_bf16 v[160:163], a[240:243], v[40:43], v[160:163]
buffer_load_dwordx4 v[72:75], v14, s[36:39], s89 offen offset:2048 sc1
v_add_f32 v243, v243, v251
v_mfma_f32_16x16x32_bf16 v[164:167], a[240:243], v[44:47], v[164:167]
ds_read_b128 a[240:243], v12 offset:45056
s_waitcnt lgkmcnt(3)
v_mfma_f32_16x16x32_bf16 v[168:171], a[244:247], v[40:43], v[168:171]
v_add_f32 v244, v244, v252
v_add_f32_e64 v245, v245, v253
v_mfma_f32_16x16x32_bf16 v[172:175], a[244:247], v[44:47], v[172:175]
ds_read_b128 a[244:247], v12 offset:46080
s_waitcnt lgkmcnt(3)
v_mfma_f32_16x16x32_bf16 v[176:179], a[248:251], v[40:43], v[176:179]
buffer_load_dwordx4 v[76:79], v14, s[36:39], s89 offen offset:2304 sc1
v_add_f32 v246, v246, v254
v_mfma_f32_16x16x32_bf16 v[180:183], a[248:251], v[44:47], v[180:183]
ds_read_b128 a[248:251], v12 offset:47104
s_waitcnt lgkmcnt(3)
v_mfma_f32_16x16x32_bf16 v[184:187], a[252:255], v[40:43], v[184:187]
v_add_f32 v247, v247, v255
v_add_f32_e64 v240, v240, v244
v_mfma_f32_16x16x32_bf16 v[188:191], a[252:255], v[44:47], v[188:191]
ds_read_b128 a[252:255], v12 offset:48128
s_waitcnt lgkmcnt(3)
v_mfma_f32_16x16x32_bf16 v[192:195], a[240:243], v[40:43], v[192:195]
s_add_u32 s89, s89, 4096
buffer_load_dwordx4 v[80:83], v14, s[36:39], s89 offen sc1
v_add_f32 v241, v241, v245
v_mfma_f32_16x16x32_bf16 v[196:199], a[240:243], v[44:47], v[196:199]
ds_read_b128 a[240:243], v12 offset:49152
s_waitcnt lgkmcnt(3)
v_mfma_f32_16x16x32_bf16 v[200:203], a[244:247], v[40:43], v[200:203]
v_add_f32 v242, v242, v246
v_add_f32_e64 v243, v243, v247
v_mfma_f32_16x16x32_bf16 v[204:207], a[244:247], v[44:47], v[204:207]
ds_read_b128 a[244:247], v12 offset:50176
s_waitcnt lgkmcnt(3)
v_mfma_f32_16x16x32_bf16 v[208:211], a[248:251], v[40:43], v[208:211]
s_add_u32 m0, s100, 92160
s_add_u32 s18, s99, 81920
buffer_load_dwordx4 v1, s[36:39], s18 offen lds
v_mfma_f32_16x16x32_bf16 v[212:215], a[248:251], v[44:47], v[212:215]
ds_read_b128 a[248:251], v12 offset:51200
s_waitcnt lgkmcnt(3)
v_mfma_f32_16x16x32_bf16 v[216:219], a[252:255], v[40:43], v[216:219]
v_add_f32 v240, v240, v242
v_add_f32 v241, v241, v243
v_mfma_f32_16x16x32_bf16 v[220:223], a[252:255], v[44:47], v[220:223]
ds_read_b128 a[252:255], v12 offset:52224
s_waitcnt vmcnt(12) lgkmcnt(3)
v_mfma_f32_16x16x32_bf16 v[144:147], a[240:243], v[48:51], v[144:147]
buffer_load_dwordx4 v1, s[36:39], s18 offen offset:1024 lds
v_permlane32_swap_b32 v240, v241
v_mfma_f32_16x16x32_bf16 v[148:151], a[240:243], v[52:55], v[148:151]
ds_read_b128 a[240:243], v12 offset:53248
s_waitcnt lgkmcnt(3)
v_mfma_f32_16x16x32_bf16 v[152:155], a[244:247], v[48:51], v[152:155]
v_add_f32 v240, v240, v241
v_mov_b32_e64 v241, v240
v_mfma_f32_16x16x32_bf16 v[156:159], a[244:247], v[52:55], v[156:159]
ds_read_b128 a[244:247], v12 offset:54272
s_waitcnt lgkmcnt(3)
v_mfma_f32_16x16x32_bf16 v[160:163], a[248:251], v[48:51], v[160:163]
s_add_u32 m0, s100, 67584
s_add_u32 s18, s99, 90112
buffer_load_dwordx4 v1, s[36:39], s18 offen lds
v_mfma_f32_16x16x32_bf16 v[164:167], a[248:251], v[52:55], v[164:167]
ds_read_b128 a[248:251], v12 offset:55296
s_waitcnt lgkmcnt(3)
v_mfma_f32_16x16x32_bf16 v[168:171], a[252:255], v[48:51], v[168:171]
v_permlane32_swap_b32_e64 v240, v241
v_mul_f32 v8, -0.001953125, v240
v_mfma_f32_16x16x32_bf16 v[172:175], a[252:255], v[52:55], v[172:175]
ds_read_b128 a[252:255], v12 offset:56320
s_waitcnt lgkmcnt(3)
v_mfma_f32_16x16x32_bf16 v[176:179], a[240:243], v[48:51], v[176:179]
buffer_load_dwordx4 v1, s[36:39], s18 offen offset:1024 lds
v_mul_f32 v241, 0.001953125, v241
v_mfma_f32_16x16x32_bf16 v[180:183], a[240:243], v[52:55], v[180:183]
s_barrier
ds_read_b128 a[240:243], v12 offset:57344
s_waitcnt lgkmcnt(3)
v_mfma_f32_16x16x32_bf16 v[184:187], a[244:247], v[48:51], v[184:187]
v_fma_f32 v241, -v8, v8, v241
v_max_f32 v241, 0, v241
v_mfma_f32_16x16x32_bf16 v[188:191], a[244:247], v[52:55], v[188:191]
ds_read_b128 a[244:247], v12 offset:58368
s_waitcnt lgkmcnt(3)
v_mfma_f32_16x16x32_bf16 v[192:195], a[248:251], v[48:51], v[192:195]
buffer_load_dwordx4 v[84:87], v14, s[36:39], s89 offen offset:256 sc1
v_add_f32 v241, 0x3727c5ac, v241
v_mfma_f32_16x16x32_bf16 v[196:199], a[248:251], v[52:55], v[196:199]
ds_read_b128 a[248:251], v12 offset:59392
s_waitcnt lgkmcnt(3)
v_mfma_f32_16x16x32_bf16 v[200:203], a[252:255], v[48:51], v[200:203]
v_rsq_f32 v9, v241
s_nop 0
v_mul_f32_e64 v9, v9, v9
v_mfma_f32_16x16x32_bf16 v[204:207], a[252:255], v[52:55], v[204:207]
ds_read_b128 a[252:255], v12 offset:60416
s_waitcnt lgkmcnt(3)
v_mfma_f32_16x16x32_bf16 v[208:211], a[240:243], v[48:51], v[208:211]
buffer_load_dwordx4 v[88:91], v14, s[36:39], s89 offen offset:2048 sc1
v_mov_b32 v242, v8
v_mfma_f32_16x16x32_bf16 v[212:215], a[240:243], v[52:55], v[212:215]
ds_read_b128 a[240:243], v12 offset:61440
s_waitcnt lgkmcnt(3)
v_mfma_f32_16x16x32_bf16 v[216:219], a[244:247], v[48:51], v[216:219]
v_and_b32_e64 v241, 31, v0
s_lshl_b32 s77, s68, 7
s_add_u32 s77, s77, 66944
v_mfma_f32_16x16x32_bf16 v[220:223], a[244:247], v[52:55], v[220:223]
ds_read_b128 a[244:247], v12 offset:62464
s_waitcnt vmcnt(15) lgkmcnt(3)
v_mfma_f32_16x16x32_bf16 v[144:147], a[248:251], v[56:59], v[144:147]
buffer_load_dwordx4 v[92:95], v14, s[36:39], s89 offen offset:2304 sc1
v_lshl_add_u32 v241, v241, 2, s77
v_mfma_f32_16x16x32_bf16 v[148:151], a[248:251], v[60:63], v[148:151]
ds_read_b128 a[248:251], v12 offset:63488
s_waitcnt lgkmcnt(3)
v_mfma_f32_16x16x32_bf16 v[152:155], a[252:255], v[56:59], v[152:155]
v_permlane16_swap_b32 v8, v242
v_and_b32 v240, 48, v0
v_mfma_f32_16x16x32_bf16 v[156:159], a[252:255], v[60:63], v[156:159]
ds_read_b128 a[252:255], v12 offset:64512
s_waitcnt lgkmcnt(3)
v_mfma_f32_16x16x32_bf16 v[160:163], a[240:243], v[56:59], v[160:163]
s_add_u32 m0, s100, 75776
s_add_u32 s18, s99, 98304
buffer_load_dwordx4 v1, s[36:39], s18 offen lds
v_mfma_f32_16x16x32_bf16 v[164:167], a[240:243], v[60:63], v[164:167]
ds_read_b128 a[240:243], v13 offset:0
s_waitcnt lgkmcnt(3)
v_mfma_f32_16x16x32_bf16 v[168:171], a[244:247], v[56:59], v[168:171]
v_add_u32 v240, 66048, v240
ds_write_b32 v241, v9
v_mfma_f32_16x16x32_bf16 v[172:175], a[244:247], v[60:63], v[172:175]
ds_read_b128 a[244:247], v13 offset:1024
s_waitcnt lgkmcnt(4)
v_mfma_f32_16x16x32_bf16 v[176:179], a[248:251], v[56:59], v[176:179]
buffer_load_dwordx4 v1, s[36:39], s18 offen offset:1024 lds
s_lshl_b32 s80, s69, 2
s_lshl_b32 s77, s73, 1
v_mfma_f32_16x16x32_bf16 v[180:183], a[248:251], v[60:63], v[180:183]
ds_read_b128 a[248:251], v13 offset:2048
s_waitcnt lgkmcnt(4)
v_mfma_f32_16x16x32_bf16 v[184:187], a[252:255], v[56:59], v[184:187]
s_add_u32 s80, s80, s77
s_add_u32 s80, s80, s75
s_lshl_b32 s81, s80, 12
s_lshl_b32 s77, s72, 9
v_mfma_f32_16x16x32_bf16 v[188:191], a[252:255], v[60:63], v[188:191]
ds_read_b128 a[252:255], v13 offset:3072
s_waitcnt lgkmcnt(4)
v_mfma_f32_16x16x32_bf16 v[192:195], a[240:243], v[56:59], v[192:195]
s_add_u32 m0, s100, 83968
s_add_u32 s18, s99, 106496
buffer_load_dwordx4 v1, s[36:39], s18 offen lds
v_mfma_f32_16x16x32_bf16 v[196:199], a[240:243], v[60:63], v[196:199]
ds_read_b128 a[240:243], v13 offset:4096
s_waitcnt lgkmcnt(3)
v_mfma_f32_16x16x32_bf16 v[200:203], a[244:247], v[56:59], v[200:203]
s_add_u32 s81, s81, s77
s_lshl_b32 s77, s74, 3
s_add_u32 s81, s81, s77
s_lshl_b32 s80, s80, 15
v_mfma_f32_16x16x32_bf16 v[204:207], a[244:247], v[60:63], v[204:207]
ds_read_b128 a[244:247], v13 offset:5120
s_waitcnt lgkmcnt(3)
v_mfma_f32_16x16x32_bf16 v[208:211], a[248:251], v[56:59], v[208:211]
buffer_load_dwordx4 v1, s[36:39], s18 offen offset:1024 lds
s_lshl_b32 s77, s72, 7
s_lshl_b32 s78, s74, 6
v_mfma_f32_16x16x32_bf16 v[212:215], a[248:251], v[60:63], v[212:215]
ds_read_b128 a[248:251], v13 offset:6144
s_waitcnt lgkmcnt(3)
v_mfma_f32_16x16x32_bf16 v[216:219], a[252:255], v[56:59], v[216:219]
s_add_u32 s77, s77, s78
s_add_u32 s79, s80, s77
s_lshl_b32 s77, s77, 5
s_add_u32 s80, s80, s77
v_mfma_f32_16x16x32_bf16 v[220:223], a[252:255], v[60:63], v[220:223]
ds_read_b128 a[252:255], v13 offset:7168
s_waitcnt vmcnt(14) lgkmcnt(3)
v_mfma_f32_16x16x32_bf16 v[144:147], a[240:243], v[64:67], v[144:147]
s_add_u32 s89, s89, 4096
buffer_load_dwordx4 v[96:99], v14, s[36:39], s89 offen sc1
v_and_b32 v7, 31, v0
v_mfma_f32_16x16x32_bf16 v[148:151], a[240:243], v[68:71], v[148:151]
s_barrier
ds_read_b128 a[240:243], v13 offset:8192
s_waitcnt lgkmcnt(3)
v_mfma_f32_16x16x32_bf16 v[152:155], a[244:247], v[64:67], v[152:155]
v_lshrrev_b32 v11, 5, v0
v_lshlrev_b32 v7, 4, v7
v_mfma_f32_16x16x32_bf16 v[156:159], a[244:247], v[68:71], v[156:159]
ds_read_b128 a[244:247], v13 offset:9216
s_waitcnt lgkmcnt(3)
v_mfma_f32_16x16x32_bf16 v[160:163], a[248:251], v[64:67], v[160:163]
buffer_load_dwordx4 v[100:103], v14, s[36:39], s89 offen offset:256 sc1
v_lshl_add_u32 v5, v11, 2, v7
v_mfma_f32_16x16x32_bf16 v[164:167], a[248:251], v[68:71], v[164:167]
ds_read_b128 a[248:251], v13 offset:10240
s_waitcnt lgkmcnt(3)
v_mfma_f32_16x16x32_bf16 v[168:171], a[252:255], v[64:67], v[168:171]
s_lshl_b32 s77, s69, 8
s_lshl_b32 s78, s73, 7
s_add_u32 s77, s77, s78
s_lshl_b32 s78, s68, 4
v_mfma_f32_16x16x32_bf16 v[172:175], a[252:255], v[68:71], v[172:175]
ds_read_b128 a[252:255], v13 offset:11264
s_waitcnt lgkmcnt(3)
v_mfma_f32_16x16x32_bf16 v[176:179], a[240:243], v[64:67], v[176:179]
buffer_load_dwordx4 v[104:107], v14, s[36:39], s89 offen offset:2048 sc1
s_add_u32 s77, s77, s78
v_and_b32_e64 v7, 3, v0
v_mfma_f32_16x16x32_bf16 v[180:183], a[240:243], v[68:71], v[180:183]
ds_read_b128 a[240:243], v13 offset:12288
s_waitcnt lgkmcnt(3)
v_mfma_f32_16x16x32_bf16 v[184:187], a[244:247], v[64:67], v[184:187]
v_bfe_u32 v11, v0, 2, 1
v_lshlrev_b32 v11, 6, v11
v_mfma_f32_16x16x32_bf16 v[188:191], a[244:247], v[68:71], v[188:191]
ds_read_b128 a[244:247], v13 offset:13312
s_waitcnt lgkmcnt(3)
v_mfma_f32_16x16x32_bf16 v[192:195], a[248:251], v[64:67], v[192:195]
s_add_u32 m0, s100, 100352
s_add_u32 s18, s99, 114688
buffer_load_dwordx4 v1, s[36:39], s18 offen lds
v_mfma_f32_16x16x32_bf16 v[196:199], a[248:251], v[68:71], v[196:199]
ds_read_b128 a[248:251], v13 offset:14336
s_waitcnt lgkmcnt(3)
v_mfma_f32_16x16x32_bf16 v[200:203], a[252:255], v[64:67], v[200:203]
v_lshl_add_u32 v11, v7, 2, v11
v_add_u32_e64 v11, s77, v11
v_mfma_f32_16x16x32_bf16 v[204:207], a[252:255], v[68:71], v[204:207]
ds_read_b128 a[252:255], v13 offset:15360
s_waitcnt lgkmcnt(3)
v_mfma_f32_16x16x32_bf16 v[208:211], a[240:243], v[64:67], v[208:211]
buffer_load_dwordx4 v1, s[36:39], s18 offen offset:1024 lds
s_lshl_b32 s77, s69, 2
s_lshl_b32 s78, s73, 1
v_mfma_f32_16x16x32_bf16 v[212:215], a[240:243], v[68:71], v[212:215]
ds_read_b128 a[240:243], v13 offset:16384
s_waitcnt lgkmcnt(3)
v_mfma_f32_16x16x32_bf16 v[216:219], a[244:247], v[64:67], v[216:219]
s_add_u32 s77, s77, s78
s_mul_i32 s92, s77, 114688
s_mul_i32 s78, s68, 28672
s_add_u32 s92, s92, s78
v_mfma_f32_16x16x32_bf16 v[220:223], a[244:247], v[68:71], v[220:223]
ds_read_b128 a[244:247], v13 offset:17408
s_waitcnt vmcnt(17) lgkmcnt(3)
v_mfma_f32_16x16x32_bf16 v[144:147], a[248:251], v[72:75], v[144:147]
s_add_u32 m0, s100, 108544
s_add_u32 s18, s99, 122880
buffer_load_dwordx4 v1, s[36:39], s18 offen lds
v_mfma_f32_16x16x32_bf16 v[148:151], a[248:251], v[76:79], v[148:151]
ds_read_b128 a[248:251], v13 offset:18432
s_waitcnt lgkmcnt(3)
v_mfma_f32_16x16x32_bf16 v[152:155], a[252:255], v[72:75], v[152:155]
s_add_u32 s92, s92, 10485760
s_add_u32 s93, s92, 114688
v_mfma_f32_16x16x32_bf16 v[156:159], a[252:255], v[76:79], v[156:159]
ds_read_b128 a[252:255], v13 offset:19456
s_waitcnt lgkmcnt(3)
v_mfma_f32_16x16x32_bf16 v[160:163], a[240:243], v[72:75], v[160:163]
buffer_load_dwordx4 v1, s[36:39], s18 offen offset:1024 lds
v_mfma_f32_16x16x32_bf16 v[164:167], a[240:243], v[76:79], v[164:167]
ds_read_b128 a[240:243], v13 offset:20480
s_waitcnt lgkmcnt(3)
v_mfma_f32_16x16x32_bf16 v[168:171], a[244:247], v[72:75], v[168:171]
v_mfma_f32_16x16x32_bf16 v[172:175], a[244:247], v[76:79], v[172:175]
ds_read_b128 a[244:247], v13 offset:21504
s_waitcnt lgkmcnt(3)
v_mfma_f32_16x16x32_bf16 v[176:179], a[248:251], v[72:75], v[176:179]
buffer_load_dwordx4 v[108:111], v14, s[36:39], s89 offen offset:2304 sc1
v_mfma_f32_16x16x32_bf16 v[180:183], a[248:251], v[76:79], v[180:183]
ds_read_b128 a[248:251], v13 offset:22528
s_waitcnt lgkmcnt(3)
v_mfma_f32_16x16x32_bf16 v[184:187], a[252:255], v[72:75], v[184:187]
v_mfma_f32_16x16x32_bf16 v[188:191], a[252:255], v[76:79], v[188:191]
ds_read_b128 a[252:255], v13 offset:23552
s_waitcnt lgkmcnt(3)
v_mfma_f32_16x16x32_bf16 v[192:195], a[240:243], v[72:75], v[192:195]
s_add_u32 s89, s89, 4096
buffer_load_dwordx4 v[112:115], v14, s[36:39], s89 offen sc1
v_mfma_f32_16x16x32_bf16 v[196:199], a[240:243], v[76:79], v[196:199]
s_waitcnt vmcnt(16)
s_barrier
ds_read_b128 a[240:243], v12 offset:24576
s_waitcnt lgkmcnt(3)
v_mfma_f32_16x16x32_bf16 v[200:203], a[244:247], v[72:75], v[200:203]
v_mfma_f32_16x16x32_bf16 v[204:207], a[244:247], v[76:79], v[204:207]
ds_read_b128 a[244:247], v12 offset:25600
s_waitcnt lgkmcnt(3)
v_mfma_f32_16x16x32_bf16 v[208:211], a[248:251], v[72:75], v[208:211]
buffer_load_dwordx4 v[116:119], v14, s[36:39], s89 offen offset:256 sc1
v_mfma_f32_16x16x32_bf16 v[212:215], a[248:251], v[76:79], v[212:215]
ds_read_b128 a[248:251], v12 offset:26624
s_waitcnt lgkmcnt(3)
v_mfma_f32_16x16x32_bf16 v[216:219], a[252:255], v[72:75], v[216:219]
v_mfma_f32_16x16x32_bf16 v[220:223], a[252:255], v[76:79], v[220:223]
ds_read_b128 a[252:255], v12 offset:27648
s_waitcnt vmcnt(16) lgkmcnt(3)
v_mfma_f32_16x16x32_bf16 v[144:147], a[240:243], v[80:83], v[144:147]
s_add_u32 m0, s100, 116736
s_add_u32 s18, s99, 131072
buffer_load_dwordx4 v1, s[36:39], s18 offen lds
v_mfma_f32_16x16x32_bf16 v[148:151], a[240:243], v[84:87], v[148:151]
ds_read_b128 a[240:243], v12 offset:28672
s_waitcnt lgkmcnt(3)
v_mfma_f32_16x16x32_bf16 v[152:155], a[244:247], v[80:83], v[152:155]
v_mfma_f32_16x16x32_bf16 v[156:159], a[244:247], v[84:87], v[156:159]
ds_read_b128 a[244:247], v12 offset:29696
s_waitcnt lgkmcnt(3)
v_mfma_f32_16x16x32_bf16 v[160:163], a[248:251], v[80:83], v[160:163]
buffer_load_dwordx4 v1, s[36:39], s18 offen offset:1024 lds
v_mfma_f32_16x16x32_bf16 v[164:167], a[248:251], v[84:87], v[164:167]
ds_read_b128 a[248:251], v12 offset:30720
s_waitcnt lgkmcnt(3)
v_mfma_f32_16x16x32_bf16 v[168:171], a[252:255], v[80:83], v[168:171]
v_mfma_f32_16x16x32_bf16 v[172:175], a[252:255], v[84:87], v[172:175]
ds_read_b128 a[252:255], v12 offset:31744
s_waitcnt lgkmcnt(3)
v_mfma_f32_16x16x32_bf16 v[176:179], a[240:243], v[80:83], v[176:179]
s_add_u32 m0, s100, 124928
s_add_u32 s18, s99, 139264
buffer_load_dwordx4 v1, s[36:39], s18 offen lds
v_mfma_f32_16x16x32_bf16 v[180:183], a[240:243], v[84:87], v[180:183]
ds_read_b128 a[240:243], v12 offset:0
s_waitcnt lgkmcnt(3)
v_mfma_f32_16x16x32_bf16 v[184:187], a[244:247], v[80:83], v[184:187]
v_mfma_f32_16x16x32_bf16 v[188:191], a[244:247], v[84:87], v[188:191]
ds_read_b128 a[244:247], v12 offset:1024
s_waitcnt lgkmcnt(3)
v_mfma_f32_16x16x32_bf16 v[192:195], a[248:251], v[80:83], v[192:195]
buffer_load_dwordx4 v1, s[36:39], s18 offen offset:1024 lds
v_mfma_f32_16x16x32_bf16 v[196:199], a[248:251], v[84:87], v[196:199]
ds_read_b128 a[248:251], v12 offset:2048
s_waitcnt lgkmcnt(3)
v_mfma_f32_16x16x32_bf16 v[200:203], a[252:255], v[80:83], v[200:203]
v_mfma_f32_16x16x32_bf16 v[204:207], a[252:255], v[84:87], v[204:207]
ds_read_b128 a[252:255], v12 offset:3072
s_waitcnt lgkmcnt(3)
v_mfma_f32_16x16x32_bf16 v[208:211], a[240:243], v[80:83], v[208:211]
buffer_load_dwordx4 v[120:123], v14, s[36:39], s89 offen offset:2048 sc1
v_mfma_f32_16x16x32_bf16 v[212:215], a[240:243], v[84:87], v[212:215]
ds_read_b128 a[240:243], v12 offset:4096
s_waitcnt lgkmcnt(3)
v_mfma_f32_16x16x32_bf16 v[216:219], a[244:247], v[80:83], v[216:219]
v_mfma_f32_16x16x32_bf16 v[220:223], a[244:247], v[84:87], v[220:223]
ds_read_b128 a[244:247], v12 offset:5120
s_waitcnt vmcnt(19) lgkmcnt(3)
v_mfma_f32_16x16x32_bf16 v[144:147], a[248:251], v[88:91], v[144:147]
buffer_load_dwordx4 v[124:127], v14, s[36:39], s89 offen offset:2304 sc1
ds_read_b128 v[244:247], v240 offset:640
ds_read_b128 v[248:251], v240 offset:704
v_mfma_f32_16x16x32_bf16 v[148:151], a[248:251], v[92:95], v[148:151]
ds_read_b128 a[248:251], v12 offset:6144
s_waitcnt lgkmcnt(5)
v_mfma_f32_16x16x32_bf16 v[152:155], a[252:255], v[88:91], v[152:155]
v_mfma_f32_16x16x32_bf16 v[156:159], a[252:255], v[92:95], v[156:159]
ds_read_b128 a[252:255], v12 offset:7168
s_waitcnt lgkmcnt(5)
v_mfma_f32_16x16x32_bf16 v[160:163], a[240:243], v[88:91], v[160:163]
s_add_u32 s89, s89, 4096
buffer_load_dwordx4 v[128:131], v14, s[36:39], s89 offen sc1
s_waitcnt lgkmcnt(2)
v_mul_f32_e64 v224, v8, v244
v_mfma_f32_16x16x32_bf16 v[164:167], a[240:243], v[92:95], v[164:167]
s_waitcnt vmcnt(17)
s_barrier
ds_read_b128 a[240:243], v12 offset:8192
v_mfma_f32_16x16x32_bf16 v[168:171], a[244:247], v[88:91], v[168:171]
v_mul_f32 v225, v8, v245
v_mul_f32 v226, v8, v246
v_mfma_f32_16x16x32_bf16 v[172:175], a[244:247], v[92:95], v[172:175]
ds_read_b128 a[244:247], v12 offset:9216
s_waitcnt lgkmcnt(3)
v_mfma_f32_16x16x32_bf16 v[176:179], a[248:251], v[88:91], v[176:179]
s_add_u32 m0, s100, 133120
s_add_u32 s18, s99, 147456
buffer_load_dwordx4 v1, s[36:39], s18 offen lds
v_mul_f32 v227, v8, v247
v_mfma_f32_16x16x32_bf16 v[180:183], a[248:251], v[92:95], v[180:183]
ds_read_b128 a[248:251], v12 offset:10240
s_waitcnt lgkmcnt(3)
v_mfma_f32_16x16x32_bf16 v[184:187], a[252:255], v[88:91], v[184:187]
v_mul_f32 v228, v242, v244
v_mul_f32_e64 v229, v242, v245
v_mfma_f32_16x16x32_bf16 v[188:191], a[252:255], v[92:95], v[188:191]
ds_read_b128 a[252:255], v12 offset:11264
s_waitcnt lgkmcnt(3)
v_mfma_f32_16x16x32_bf16 v[192:195], a[240:243], v[88:91], v[192:195]
buffer_load_dwordx4 v1, s[36:39], s18 offen offset:1024 lds
v_mul_f32 v230, v242, v246
v_mul_f32_e64 v231, v242, v247
v_mfma_f32_16x16x32_bf16 v[196:199], a[240:243], v[92:95], v[196:199]
ds_read_b128 a[240:243], v12 offset:12288
s_waitcnt lgkmcnt(3)
v_mfma_f32_16x16x32_bf16 v[200:203], a[244:247], v[88:91], v[200:203]
v_mul_f32 v232, v8, v248
v_mul_f32_e64 v233, v8, v249
v_mfma_f32_16x16x32_bf16 v[204:207], a[244:247], v[92:95], v[204:207]
ds_read_b128 a[244:247], v12 offset:13312
s_waitcnt lgkmcnt(3)
v_mfma_f32_16x16x32_bf16 v[208:211], a[248:251], v[88:91], v[208:211]
s_add_u32 m0, s100, 141312
s_add_u32 s18, s99, 155648
buffer_load_dwordx4 v1, s[36:39], s18 offen lds
v_mul_f32 v234, v8, v250
v_mfma_f32_16x16x32_bf16 v[212:215], a[248:251], v[92:95], v[212:215]
ds_read_b128 a[248:251], v12 offset:14336
s_waitcnt lgkmcnt(3)
v_mfma_f32_16x16x32_bf16 v[216:219], a[252:255], v[88:91], v[216:219]
v_mul_f32 v235, v8, v251
v_mul_f32_e64 v236, v242, v248
v_mfma_f32_16x16x32_bf16 v[220:223], a[252:255], v[92:95], v[220:223]
ds_read_b128 a[252:255], v12 offset:15360
s_waitcnt vmcnt(18) lgkmcnt(3)
v_mfma_f32_16x16x32_bf16 v[144:147], a[240:243], v[96:99], v[144:147]
buffer_load_dwordx4 v1, s[36:39], s18 offen offset:1024 lds
v_mul_f32 v237, v242, v249
v_mul_f32_e64 v238, v242, v250
v_mfma_f32_16x16x32_bf16 v[148:151], a[240:243], v[100:103], v[148:151]
ds_read_b128 a[240:243], v12 offset:16384
s_waitcnt lgkmcnt(3)
v_mfma_f32_16x16x32_bf16 v[152:155], a[244:247], v[96:99], v[152:155]
v_mul_f32 v239, v242, v251
ds_read_b128 v[244:247], v240 offset:0
ds_read_b128 v[248:251], v240 offset:64
v_mfma_f32_16x16x32_bf16 v[156:159], a[244:247], v[100:103], v[156:159]
ds_read_b128 a[244:247], v12 offset:17408
s_waitcnt lgkmcnt(5)
v_mfma_f32_16x16x32_bf16 v[160:163], a[248:251], v[96:99], v[160:163]
buffer_load_dwordx4 v[132:135], v14, s[36:39], s89 offen offset:256 sc1
s_waitcnt lgkmcnt(1)
v_fmac_f32 v144, v8, v244
v_fmac_f32 v145, v8, v245
v_mfma_f32_16x16x32_bf16 v[164:167], a[248:251], v[100:103], v[164:167]
ds_read_b128 a[248:251], v12 offset:18432
v_mfma_f32_16x16x32_bf16 v[168:171], a[252:255], v[96:99], v[168:171]
v_fmac_f32 v146, v8, v246
v_fmac_f32 v147, v8, v247
v_mfma_f32_16x16x32_bf16 v[172:175], a[252:255], v[100:103], v[172:175]
ds_read_b128 a[252:255], v12 offset:19456
v_mfma_f32_16x16x32_bf16 v[176:179], a[240:243], v[96:99], v[176:179]
buffer_load_dwordx4 v[136:139], v14, s[36:39], s89 offen offset:2048 sc1
v_fmac_f32 v148, v242, v244
v_fmac_f32 v149, v242, v245
v_mfma_f32_16x16x32_bf16 v[180:183], a[240:243], v[100:103], v[180:183]
ds_read_b128 a[240:243], v12 offset:20480
s_waitcnt lgkmcnt(3)
v_mfma_f32_16x16x32_bf16 v[184:187], a[244:247], v[96:99], v[184:187]
v_fmac_f32 v150, v242, v246
v_fmac_f32_e64 v151, v242, v247
v_mfma_f32_16x16x32_bf16 v[188:191], a[244:247], v[100:103], v[188:191]
ds_read_b128 a[244:247], v12 offset:21504
s_waitcnt lgkmcnt(3)
v_mfma_f32_16x16x32_bf16 v[192:195], a[248:251], v[96:99], v[192:195]
buffer_load_dwordx4 v[140:143], v14, s[36:39], s89 offen offset:2304 sc1
v_fmac_f32 v152, v8, v248
v_fmac_f32_e64 v153, v8, v249
v_mfma_f32_16x16x32_bf16 v[196:199], a[248:251], v[100:103], v[196:199]
ds_read_b128 a[248:251], v12 offset:22528
s_waitcnt lgkmcnt(3)
v_mfma_f32_16x16x32_bf16 v[200:203], a[252:255], v[96:99], v[200:203]
v_fmac_f32 v154, v8, v250
v_fmac_f32_e64 v155, v8, v251
v_mfma_f32_16x16x32_bf16 v[204:207], a[252:255], v[100:103], v[204:207]
ds_read_b128 a[252:255], v12 offset:23552
s_waitcnt lgkmcnt(3)
v_mfma_f32_16x16x32_bf16 v[208:211], a[240:243], v[96:99], v[208:211]
s_add_u32 m0, s100, 149504
s_add_u32 s18, s99, 163840
buffer_load_dwordx4 v1, s[36:39], s18 offen lds
v_fmac_f32 v156, v242, v248
v_mfma_f32_16x16x32_bf16 v[212:215], a[240:243], v[100:103], v[212:215]
s_waitcnt vmcnt(18)
s_barrier
ds_read_b128 a[240:243], v12 offset:32768
s_waitcnt lgkmcnt(3)
v_mfma_f32_16x16x32_bf16 v[216:219], a[244:247], v[96:99], v[216:219]
v_fmac_f32 v157, v242, v249
v_fmac_f32_e64 v158, v242, v250
v_mfma_f32_16x16x32_bf16 v[220:223], a[244:247], v[100:103], v[220:223]
ds_read_b128 a[244:247], v12 offset:33792
s_waitcnt vmcnt(17) lgkmcnt(3)
v_mfma_f32_16x16x32_bf16 v[144:147], a[248:251], v[104:107], v[144:147]
buffer_load_dwordx4 v1, s[36:39], s18 offen offset:1024 lds
v_fmac_f32 v159, v242, v251
ds_read_b128 v[244:247], v240 offset:128
ds_read_b128 v[248:251], v240 offset:192
v_mfma_f32_16x16x32_bf16 v[148:151], a[248:251], v[108:111], v[148:151]
ds_read_b128 a[248:251], v12 offset:34816
s_waitcnt lgkmcnt(5)
v_mfma_f32_16x16x32_bf16 v[152:155], a[252:255], v[104:107], v[152:155]
v_mfma_f32_16x16x32_bf16 v[156:159], a[252:255], v[108:111], v[156:159]
ds_read_b128 a[252:255], v12 offset:35840
s_waitcnt lgkmcnt(5)
v_mfma_f32_16x16x32_bf16 v[160:163], a[240:243], v[104:107], v[160:163]
s_add_u32 m0, s100, 92160
s_add_u32 s18, s99, 172032
buffer_load_dwordx4 v1, s[36:39], s18 offen lds
v_mfma_f32_16x16x32_bf16 v[164:167], a[240:243], v[108:111], v[164:167]
ds_read_b128 a[240:243], v12 offset:36864
s_waitcnt lgkmcnt(5)
v_mfma_f32_16x16x32_bf16 v[168:171], a[244:247], v[104:107], v[168:171]
v_mfma_f32_16x16x32_bf16 v[172:175], a[244:247], v[108:111], v[172:175]
ds_read_b128 a[244:247], v12 offset:37888
s_waitcnt lgkmcnt(3)
v_mfma_f32_16x16x32_bf16 v[176:179], a[248:251], v[104:107], v[176:179]
buffer_load_dwordx4 v1, s[36:39], s18 offen offset:1024 lds
v_fmac_f32 v160, v8, v244
v_fmac_f32 v161, v8, v245
v_mfma_f32_16x16x32_bf16 v[180:183], a[248:251], v[108:111], v[180:183]
ds_read_b128 a[248:251], v12 offset:38912
s_waitcnt lgkmcnt(3)
v_mfma_f32_16x16x32_bf16 v[184:187], a[252:255], v[104:107], v[184:187]
v_fmac_f32 v162, v8, v246
v_fmac_f32_e64 v163, v8, v247
v_mfma_f32_16x16x32_bf16 v[188:191], a[252:255], v[108:111], v[188:191]
ds_read_b128 a[252:255], v12 offset:39936
s_waitcnt lgkmcnt(3)
v_mfma_f32_16x16x32_bf16 v[192:195], a[240:243], v[104:107], v[192:195]
s_add_u32 m0, s100, 67584
s_add_u32 s18, s99, 180224
buffer_load_dwordx4 v1, s[36:39], s18 offen lds
v_fmac_f32 v164, v242, v244
v_mfma_f32_16x16x32_bf16 v[196:199], a[240:243], v[108:111], v[196:199]
ds_read_b128 a[240:243], v12 offset:40960
s_waitcnt lgkmcnt(3)
v_mfma_f32_16x16x32_bf16 v[200:203], a[244:247], v[104:107], v[200:203]
v_fmac_f32 v165, v242, v245
v_fmac_f32_e64 v166, v242, v246
v_mfma_f32_16x16x32_bf16 v[204:207], a[244:247], v[108:111], v[204:207]
ds_read_b128 a[244:247], v12 offset:41984
s_waitcnt lgkmcnt(3)
v_mfma_f32_16x16x32_bf16 v[208:211], a[248:251], v[104:107], v[208:211]
buffer_load_dwordx4 v1, s[36:39], s18 offen offset:1024 lds
v_fmac_f32 v167, v242, v247
v_fmac_f32_e64 v168, v8, v248
v_mfma_f32_16x16x32_bf16 v[212:215], a[248:251], v[108:111], v[212:215]
ds_read_b128 a[248:251], v12 offset:43008
s_waitcnt lgkmcnt(3)
v_mfma_f32_16x16x32_bf16 v[216:219], a[252:255], v[104:107], v[216:219]
v_fmac_f32 v169, v8, v249
v_fmac_f32_e64 v170, v8, v250
v_mfma_f32_16x16x32_bf16 v[220:223], a[252:255], v[108:111], v[220:223]
ds_read_b128 a[252:255], v12 offset:44032
s_waitcnt vmcnt(20) lgkmcnt(3)
v_mfma_f32_16x16x32_bf16 v[144:147], a[240:243], v[112:115], v[144:147]
s_add_u32 m0, s100, 75776
s_add_u32 s18, s99, 188416
buffer_load_dwordx4 v1, s[36:39], s18 offen lds
v_fmac_f32 v171, v8, v251
v_mfma_f32_16x16x32_bf16 v[148:151], a[240:243], v[116:119], v[148:151]
ds_read_b128 a[240:243], v12 offset:45056
s_waitcnt lgkmcnt(3)
v_mfma_f32_16x16x32_bf16 v[152:155], a[244:247], v[112:115], v[152:155]
v_fmac_f32 v172, v242, v248
v_fmac_f32_e64 v173, v242, v249
v_mfma_f32_16x16x32_bf16 v[156:159], a[244:247], v[116:119], v[156:159]
ds_read_b128 a[244:247], v12 offset:46080
s_waitcnt lgkmcnt(3)
v_mfma_f32_16x16x32_bf16 v[160:163], a[248:251], v[112:115], v[160:163]
buffer_load_dwordx4 v1, s[36:39], s18 offen offset:1024 lds
v_fmac_f32 v174, v242, v250
v_fmac_f32_e64 v175, v242, v251
v_mfma_f32_16x16x32_bf16 v[164:167], a[248:251], v[116:119], v[164:167]
ds_read_b128 a[248:251], v12 offset:47104
s_waitcnt lgkmcnt(3)
v_mfma_f32_16x16x32_bf16 v[168:171], a[252:255], v[112:115], v[168:171]
ds_read_b128 v[244:247], v240 offset:256
ds_read_b128 v[248:251], v240 offset:320
v_mfma_f32_16x16x32_bf16 v[172:175], a[252:255], v[116:119], v[172:175]
ds_read_b128 a[252:255], v12 offset:48128
s_waitcnt lgkmcnt(5)
v_mfma_f32_16x16x32_bf16 v[176:179], a[240:243], v[112:115], v[176:179]
v_mfma_f32_16x16x32_bf16 v[180:183], a[240:243], v[116:119], v[180:183]
s_waitcnt vmcnt(18)
s_barrier
ds_read_b128 a[240:243], v12 offset:49152
s_waitcnt lgkmcnt(5)
v_mfma_f32_16x16x32_bf16 v[184:187], a[244:247], v[112:115], v[184:187]
v_mfma_f32_16x16x32_bf16 v[188:191], a[244:247], v[116:119], v[188:191]
ds_read_b128 a[244:247], v12 offset:50176
s_waitcnt lgkmcnt(5)
v_mfma_f32_16x16x32_bf16 v[192:195], a[248:251], v[112:115], v[192:195]
s_add_u32 m0, s100, 83968
s_add_u32 s18, s99, 196608
buffer_load_dwordx4 v1, s[36:39], s18 offen lds
s_waitcnt lgkmcnt(3)
v_fmac_f32 v176, v8, v244
v_mfma_f32_16x16x32_bf16 v[196:199], a[248:251], v[116:119], v[196:199]
ds_read_b128 a[248:251], v12 offset:51200
s_waitcnt lgkmcnt(3)
v_mfma_f32_16x16x32_bf16 v[200:203], a[252:255], v[112:115], v[200:203]
v_fmac_f32 v177, v8, v245
v_fmac_f32_e64 v178, v8, v246
v_mfma_f32_16x16x32_bf16 v[204:207], a[252:255], v[116:119], v[204:207]
ds_read_b128 a[252:255], v12 offset:52224
s_waitcnt lgkmcnt(3)
v_mfma_f32_16x16x32_bf16 v[208:211], a[240:243], v[112:115], v[208:211]
buffer_load_dwordx4 v1, s[36:39], s18 offen offset:1024 lds
v_fmac_f32 v179, v8, v247
v_fmac_f32_e64 v180, v242, v244
v_mfma_f32_16x16x32_bf16 v[212:215], a[240:243], v[116:119], v[212:215]
ds_read_b128 a[240:243], v12 offset:53248
s_waitcnt lgkmcnt(3)
v_mfma_f32_16x16x32_bf16 v[216:219], a[244:247], v[112:115], v[216:219]
v_fmac_f32 v181, v242, v245
v_fmac_f32_e64 v182, v242, v246
v_mfma_f32_16x16x32_bf16 v[220:223], a[244:247], v[116:119], v[220:223]
ds_read_b128 a[244:247], v12 offset:54272
s_waitcnt vmcnt(18) lgkmcnt(3)
v_mfma_f32_16x16x32_bf16 v[144:147], a[248:251], v[120:123], v[144:147]
s_add_u32 m0, s100, 100352
s_add_u32 s18, s99, 204800
buffer_load_dwordx4 v1, s[36:39], s18 offen lds
v_fmac_f32 v183, v242, v247
v_mfma_f32_16x16x32_bf16 v[148:151], a[248:251], v[124:127], v[148:151]
ds_read_b128 a[248:251], v12 offset:55296
s_waitcnt lgkmcnt(3)
v_mfma_f32_16x16x32_bf16 v[152:155], a[252:255], v[120:123], v[152:155]
v_fmac_f32 v184, v8, v248
v_fmac_f32_e64 v185, v8, v249
v_mfma_f32_16x16x32_bf16 v[156:159], a[252:255], v[124:127], v[156:159]
ds_read_b128 a[252:255], v12 offset:56320
s_waitcnt lgkmcnt(3)
v_mfma_f32_16x16x32_bf16 v[160:163], a[240:243], v[120:123], v[160:163]
buffer_load_dwordx4 v1, s[36:39], s18 offen offset:1024 lds
v_fmac_f32 v186, v8, v250
v_fmac_f32_e64 v187, v8, v251
v_mfma_f32_16x16x32_bf16 v[164:167], a[240:243], v[124:127], v[164:167]
ds_read_b128 a[240:243], v12 offset:57344
s_waitcnt lgkmcnt(3)
v_mfma_f32_16x16x32_bf16 v[168:171], a[244:247], v[120:123], v[168:171]
v_fmac_f32 v188, v242, v248
v_fmac_f32_e64 v189, v242, v249
v_mfma_f32_16x16x32_bf16 v[172:175], a[244:247], v[124:127], v[172:175]
ds_read_b128 a[244:247], v12 offset:58368
s_waitcnt lgkmcnt(3)
v_mfma_f32_16x16x32_bf16 v[176:179], a[248:251], v[120:123], v[176:179]
v_fmac_f32 v190, v242, v250
v_fmac_f32_e64 v191, v242, v251
v_mfma_f32_16x16x32_bf16 v[180:183], a[248:251], v[124:127], v[180:183]
ds_read_b128 a[248:251], v12 offset:59392
s_waitcnt lgkmcnt(3)
v_mfma_f32_16x16x32_bf16 v[184:187], a[252:255], v[120:123], v[184:187]
ds_read_b128 v[244:247], v240 offset:384
ds_read_b128 v[248:251], v240 offset:448
v_mfma_f32_16x16x32_bf16 v[188:191], a[252:255], v[124:127], v[188:191]
ds_read_b128 a[252:255], v12 offset:60416
s_waitcnt lgkmcnt(5)
v_mfma_f32_16x16x32_bf16 v[192:195], a[240:243], v[120:123], v[192:195]
v_mfma_f32_16x16x32_bf16 v[196:199], a[240:243], v[124:127], v[196:199]
ds_read_b128 a[240:243], v12 offset:61440
s_waitcnt lgkmcnt(5)
v_mfma_f32_16x16x32_bf16 v[200:203], a[244:247], v[120:123], v[200:203]
v_mfma_f32_16x16x32_bf16 v[204:207], a[244:247], v[124:127], v[204:207]
ds_read_b128 a[244:247], v12 offset:62464
s_waitcnt lgkmcnt(5)
v_mfma_f32_16x16x32_bf16 v[208:211], a[248:251], v[120:123], v[208:211]
s_waitcnt lgkmcnt(3)
v_fmac_f32 v192, v8, v244
v_fmac_f32_e64 v193, v8, v245
v_mfma_f32_16x16x32_bf16 v[212:215], a[248:251], v[124:127], v[212:215]
ds_read_b128 a[248:251], v12 offset:63488
s_waitcnt lgkmcnt(3)
v_mfma_f32_16x16x32_bf16 v[216:219], a[252:255], v[120:123], v[216:219]
v_fmac_f32 v194, v8, v246
v_fmac_f32_e64 v195, v8, v247
v_mfma_f32_16x16x32_bf16 v[220:223], a[252:255], v[124:127], v[220:223]
ds_read_b128 a[252:255], v12 offset:64512
s_waitcnt vmcnt(14) lgkmcnt(3)
v_mfma_f32_16x16x32_bf16 v[144:147], a[240:243], v[128:131], v[144:147]
v_fmac_f32 v196, v242, v244
v_fmac_f32_e64 v197, v242, v245
v_mfma_f32_16x16x32_bf16 v[148:151], a[240:243], v[132:135], v[148:151]
s_barrier
ds_read_b128 a[240:243], v13 offset:0
s_waitcnt lgkmcnt(3)
v_mfma_f32_16x16x32_bf16 v[152:155], a[244:247], v[128:131], v[152:155]
v_fmac_f32 v198, v242, v246
v_fmac_f32 v199, v242, v247
v_mfma_f32_16x16x32_bf16 v[156:159], a[244:247], v[132:135], v[156:159]
ds_read_b128 a[244:247], v13 offset:1024
s_waitcnt lgkmcnt(3)
v_mfma_f32_16x16x32_bf16 v[160:163], a[248:251], v[128:131], v[160:163]
s_add_u32 m0, s100, 108544
s_add_u32 s18, s99, 212992
buffer_load_dwordx4 v1, s[36:39], s18 offen lds
v_fmac_f32 v200, v8, v248
v_mfma_f32_16x16x32_bf16 v[164:167], a[248:251], v[132:135], v[164:167]
ds_read_b128 a[248:251], v13 offset:2048
s_waitcnt lgkmcnt(3)
v_mfma_f32_16x16x32_bf16 v[168:171], a[252:255], v[128:131], v[168:171]
v_fmac_f32 v201, v8, v249
v_fmac_f32_e64 v202, v8, v250
v_mfma_f32_16x16x32_bf16 v[172:175], a[252:255], v[132:135], v[172:175]
ds_read_b128 a[252:255], v13 offset:3072
s_waitcnt lgkmcnt(3)
v_mfma_f32_16x16x32_bf16 v[176:179], a[240:243], v[128:131], v[176:179]
buffer_load_dwordx4 v1, s[36:39], s18 offen offset:1024 lds
v_fmac_f32 v203, v8, v251
v_fmac_f32_e64 v204, v242, v248
v_mfma_f32_16x16x32_bf16 v[180:183], a[240:243], v[132:135], v[180:183]
ds_read_b128 a[240:243], v13 offset:4096
s_waitcnt lgkmcnt(3)
v_mfma_f32_16x16x32_bf16 v[184:187], a[244:247], v[128:131], v[184:187]
v_fmac_f32 v205, v242, v249
v_fmac_f32_e64 v206, v242, v250
v_mfma_f32_16x16x32_bf16 v[188:191], a[244:247], v[132:135], v[188:191]
ds_read_b128 a[244:247], v13 offset:5120
s_waitcnt lgkmcnt(3)
v_mfma_f32_16x16x32_bf16 v[192:195], a[248:251], v[128:131], v[192:195]
s_add_u32 m0, s100, 116736
s_add_u32 s18, s99, 221184
buffer_load_dwordx4 v1, s[36:39], s18 offen lds
v_fmac_f32 v207, v242, v251
v_mfma_f32_16x16x32_bf16 v[196:199], a[248:251], v[132:135], v[196:199]
ds_read_b128 a[248:251], v13 offset:6144
s_waitcnt lgkmcnt(3)
v_mfma_f32_16x16x32_bf16 v[200:203], a[252:255], v[128:131], v[200:203]
ds_read_b128 v[244:247], v240 offset:512
ds_read_b128 v[248:251], v240 offset:576
v_mfma_f32_16x16x32_bf16 v[204:207], a[252:255], v[132:135], v[204:207]
ds_read_b128 a[252:255], v13 offset:7168
s_waitcnt lgkmcnt(5)
v_mfma_f32_16x16x32_bf16 v[208:211], a[240:243], v[128:131], v[208:211]
buffer_load_dwordx4 v1, s[36:39], s18 offen offset:1024 lds
v_mfma_f32_16x16x32_bf16 v[212:215], a[240:243], v[132:135], v[212:215]
ds_read_b128 a[240:243], v13 offset:8192
s_waitcnt lgkmcnt(5)
v_mfma_f32_16x16x32_bf16 v[216:219], a[244:247], v[128:131], v[216:219]
v_mfma_f32_16x16x32_bf16 v[220:223], a[244:247], v[132:135], v[220:223]
ds_read_b128 a[244:247], v13 offset:9216
s_waitcnt vmcnt(16) lgkmcnt(5)
v_mfma_f32_16x16x32_bf16 v[144:147], a[248:251], v[136:139], v[144:147]
s_waitcnt lgkmcnt(3)
v_fmac_f32 v208, v8, v244
v_fmac_f32_e64 v209, v8, v245
v_mfma_f32_16x16x32_bf16 v[148:151], a[248:251], v[140:143], v[148:151]
ds_read_b128 a[248:251], v13 offset:10240
s_waitcnt lgkmcnt(3)
v_mfma_f32_16x16x32_bf16 v[152:155], a[252:255], v[136:139], v[152:155]
v_fmac_f32 v210, v8, v246
v_fmac_f32_e64 v211, v8, v247
v_mfma_f32_16x16x32_bf16 v[156:159], a[252:255], v[140:143], v[156:159]
ds_read_b128 a[252:255], v13 offset:11264
s_waitcnt lgkmcnt(3)
v_mfma_f32_16x16x32_bf16 v[160:163], a[240:243], v[136:139], v[160:163]
v_fmac_f32 v212, v242, v244
v_fmac_f32_e64 v213, v242, v245
v_mfma_f32_16x16x32_bf16 v[164:167], a[240:243], v[140:143], v[164:167]
ds_read_b128 a[240:243], v13 offset:12288
s_waitcnt lgkmcnt(3)
v_mfma_f32_16x16x32_bf16 v[168:171], a[244:247], v[136:139], v[168:171]
v_fmac_f32 v214, v242, v246
v_fmac_f32_e64 v215, v242, v247
v_mfma_f32_16x16x32_bf16 v[172:175], a[244:247], v[140:143], v[172:175]
ds_read_b128 a[244:247], v13 offset:13312
s_waitcnt lgkmcnt(3)
v_mfma_f32_16x16x32_bf16 v[176:179], a[248:251], v[136:139], v[176:179]
v_fmac_f32 v216, v8, v248
v_fmac_f32_e64 v217, v8, v249
v_mfma_f32_16x16x32_bf16 v[180:183], a[248:251], v[140:143], v[180:183]
ds_read_b128 a[248:251], v13 offset:14336
s_waitcnt lgkmcnt(3)
v_mfma_f32_16x16x32_bf16 v[184:187], a[252:255], v[136:139], v[184:187]
v_fmac_f32 v218, v8, v250
v_fmac_f32_e64 v219, v8, v251
v_mfma_f32_16x16x32_bf16 v[188:191], a[252:255], v[140:143], v[188:191]
ds_read_b128 a[252:255], v13 offset:15360
s_waitcnt lgkmcnt(3)
v_mfma_f32_16x16x32_bf16 v[192:195], a[240:243], v[136:139], v[192:195]
v_fmac_f32 v220, v242, v248
v_fmac_f32_e64 v221, v242, v249
v_mfma_f32_16x16x32_bf16 v[196:199], a[240:243], v[140:143], v[196:199]
s_waitcnt vmcnt(12)
s_barrier
ds_read_b128 a[240:243], v13 offset:16384
s_waitcnt lgkmcnt(3)
v_mfma_f32_16x16x32_bf16 v[200:203], a[244:247], v[136:139], v[200:203]
v_fmac_f32 v222, v242, v250
v_fmac_f32_e64 v223, v242, v251
v_mfma_f32_16x16x32_bf16 v[204:207], a[244:247], v[140:143], v[204:207]
ds_read_b128 a[244:247], v13 offset:17408
s_waitcnt lgkmcnt(3)
v_mfma_f32_16x16x32_bf16 v[208:211], a[248:251], v[136:139], v[208:211]
ds_read_b128 v[244:247], v240 offset:768
ds_read_b128 v[248:251], v240 offset:832
v_mfma_f32_16x16x32_bf16 v[212:215], a[248:251], v[140:143], v[212:215]
ds_read_b128 a[248:251], v13 offset:18432
s_waitcnt lgkmcnt(5)
v_mfma_f32_16x16x32_bf16 v[216:219], a[252:255], v[136:139], v[216:219]
v_mfma_f32_16x16x32_bf16 v[220:223], a[252:255], v[140:143], v[220:223]
ds_read_b128 a[252:255], v13 offset:19456
s_waitcnt lgkmcnt(5)
v_mfma_f32_16x16x32_bf16 v[224:227], a[240:243], v[16:19], v[224:227]
v_mfma_f32_16x16x32_bf16 v[228:231], a[240:243], v[20:23], v[228:231]
ds_read_b128 a[240:243], v13 offset:20480
s_waitcnt lgkmcnt(5)
v_mfma_f32_16x16x32_bf16 v[232:235], a[244:247], v[16:19], v[232:235]
v_mul_f32 v144, v144, v152
v_mul_f32 v145, v145, v153
v_mfma_f32_16x16x32_bf16 v[236:239], a[244:247], v[20:23], v[236:239]
ds_read_b128 a[244:247], v13 offset:21504
s_waitcnt lgkmcnt(3)
v_mfma_f32_16x16x32_bf16 v[224:227], a[248:251], v[24:27], v[224:227]
v_mul_f32 v146, v146, v154
v_mul_f32_e64 v147, v147, v155
v_mfma_f32_16x16x32_bf16 v[228:231], a[248:251], v[28:31], v[228:231]
ds_read_b128 a[248:251], v13 offset:22528
s_waitcnt lgkmcnt(3)
v_mfma_f32_16x16x32_bf16 v[232:235], a[252:255], v[24:27], v[232:235]
v_mul_f32 v148, v148, v156
v_mul_f32_e64 v149, v149, v157
v_mfma_f32_16x16x32_bf16 v[236:239], a[252:255], v[28:31], v[236:239]
ds_read_b128 a[252:255], v13 offset:23552
s_waitcnt lgkmcnt(3)
v_mfma_f32_16x16x32_bf16 v[224:227], a[240:243], v[32:35], v[224:227]
v_mul_f32 v150, v150, v158
v_mul_f32_e64 v151, v151, v159
v_mfma_f32_16x16x32_bf16 v[228:231], a[240:243], v[36:39], v[228:231]
ds_read_b128 a[240:243], v12 offset:24576
s_waitcnt lgkmcnt(3)
v_mfma_f32_16x16x32_bf16 v[232:235], a[244:247], v[32:35], v[232:235]
v_cvt_pk_bf16_f32 v152, v144, v145
v_cvt_pk_bf16_f32 v154, v148, v149
v_mfma_f32_16x16x32_bf16 v[236:239], a[244:247], v[36:39], v[236:239]
ds_read_b128 a[244:247], v12 offset:25600
s_waitcnt lgkmcnt(3)
v_mfma_f32_16x16x32_bf16 v[224:227], a[248:251], v[40:43], v[224:227]
v_cvt_pk_bf16_f32 v153, v146, v147
v_cvt_pk_bf16_f32 v155, v150, v151
v_mfma_f32_16x16x32_bf16 v[228:231], a[248:251], v[44:47], v[228:231]
ds_read_b128 a[248:251], v12 offset:26624
s_waitcnt lgkmcnt(3)
v_mfma_f32_16x16x32_bf16 v[232:235], a[252:255], v[40:43], v[232:235]
v_permlane16_swap_b32 v152, v154
v_permlane16_swap_b32_e64 v153, v155
v_mfma_f32_16x16x32_bf16 v[236:239], a[252:255], v[44:47], v[236:239]
ds_read_b128 a[252:255], v12 offset:27648
s_waitcnt lgkmcnt(3)
v_mfma_f32_16x16x32_bf16 v[224:227], a[240:243], v[48:51], v[224:227]
buffer_store_dwordx4 v[152:155], v1, s[36:39], s90 offen sc1
v_mul_f32 v160, v160, v168
v_mfma_f32_16x16x32_bf16 v[228:231], a[240:243], v[52:55], v[228:231]
ds_read_b128 a[240:243], v12 offset:28672
s_waitcnt lgkmcnt(3)
v_mfma_f32_16x16x32_bf16 v[232:235], a[244:247], v[48:51], v[232:235]
v_mul_f32 v161, v161, v169
v_mul_f32_e64 v162, v162, v170
v_mfma_f32_16x16x32_bf16 v[236:239], a[244:247], v[52:55], v[236:239]
ds_read_b128 a[244:247], v12 offset:29696
s_waitcnt lgkmcnt(3)
v_mfma_f32_16x16x32_bf16 v[224:227], a[248:251], v[56:59], v[224:227]
v_mul_f32 v163, v163, v171
v_mul_f32_e64 v164, v164, v172
v_mfma_f32_16x16x32_bf16 v[228:231], a[248:251], v[60:63], v[228:231]
ds_read_b128 a[248:251], v12 offset:30720
s_waitcnt lgkmcnt(3)
v_mfma_f32_16x16x32_bf16 v[232:235], a[252:255], v[56:59], v[232:235]
v_mul_f32 v165, v165, v173
v_mul_f32_e64 v166, v166, v174
v_mfma_f32_16x16x32_bf16 v[236:239], a[252:255], v[60:63], v[236:239]
ds_read_b128 a[252:255], v12 offset:31744
s_waitcnt lgkmcnt(3)
v_mfma_f32_16x16x32_bf16 v[224:227], a[240:243], v[64:67], v[224:227]
v_mul_f32 v167, v167, v175
v_cvt_pk_bf16_f32 v168, v160, v161
v_mfma_f32_16x16x32_bf16 v[228:231], a[240:243], v[68:71], v[228:231]
s_waitcnt vmcnt(9)
s_barrier
ds_read_b128 a[240:243], v12 offset:0
s_waitcnt lgkmcnt(3)
v_mfma_f32_16x16x32_bf16 v[232:235], a[244:247], v[64:67], v[232:235]
v_cvt_pk_bf16_f32 v170, v164, v165
v_cvt_pk_bf16_f32 v169, v162, v163
v_mfma_f32_16x16x32_bf16 v[236:239], a[244:247], v[68:71], v[236:239]
ds_read_b128 a[244:247], v12 offset:1024
s_waitcnt lgkmcnt(3)
v_mfma_f32_16x16x32_bf16 v[224:227], a[248:251], v[72:75], v[224:227]
v_cvt_pk_bf16_f32 v171, v166, v167
v_permlane16_swap_b32_e64 v168, v170
v_mfma_f32_16x16x32_bf16 v[228:231], a[248:251], v[76:79], v[228:231]
ds_read_b128 a[248:251], v12 offset:2048
s_waitcnt lgkmcnt(3)
v_mfma_f32_16x16x32_bf16 v[232:235], a[252:255], v[72:75], v[232:235]
v_permlane16_swap_b32 v169, v171
buffer_store_dwordx4 v[168:171], v1, s[36:39], s90 offen offset:1024 sc1
v_mfma_f32_16x16x32_bf16 v[236:239], a[252:255], v[76:79], v[236:239]
ds_read_b128 a[252:255], v12 offset:3072
s_waitcnt lgkmcnt(3)
v_mfma_f32_16x16x32_bf16 v[224:227], a[240:243], v[80:83], v[224:227]
v_mul_f32 v176, v176, v184
v_mul_f32_e64 v177, v177, v185
v_mfma_f32_16x16x32_bf16 v[228:231], a[240:243], v[84:87], v[228:231]
ds_read_b128 a[240:243], v12 offset:4096
s_waitcnt lgkmcnt(3)
v_mfma_f32_16x16x32_bf16 v[232:235], a[244:247], v[80:83], v[232:235]
v_mul_f32 v178, v178, v186
v_mul_f32_e64 v179, v179, v187
v_mfma_f32_16x16x32_bf16 v[236:239], a[244:247], v[84:87], v[236:239]
ds_read_b128 a[244:247], v12 offset:5120
s_waitcnt lgkmcnt(3)
v_mfma_f32_16x16x32_bf16 v[224:227], a[248:251], v[88:91], v[224:227]
v_mul_f32 v180, v180, v188
v_mul_f32_e64 v181, v181, v189
v_mfma_f32_16x16x32_bf16 v[228:231], a[248:251], v[92:95], v[228:231]
ds_read_b128 a[248:251], v12 offset:6144
s_waitcnt lgkmcnt(3)
v_mfma_f32_16x16x32_bf16 v[232:235], a[252:255], v[88:91], v[232:235]
v_mul_f32 v182, v182, v190
v_mul_f32_e64 v183, v183, v191
v_mfma_f32_16x16x32_bf16 v[236:239], a[252:255], v[92:95], v[236:239]
ds_read_b128 a[252:255], v12 offset:7168
s_waitcnt lgkmcnt(3)
v_mfma_f32_16x16x32_bf16 v[224:227], a[240:243], v[96:99], v[224:227]
v_cvt_pk_bf16_f32 v184, v176, v177
v_cvt_pk_bf16_f32 v186, v180, v181
v_mfma_f32_16x16x32_bf16 v[228:231], a[240:243], v[100:103], v[228:231]
ds_read_b128 a[240:243], v12 offset:8192
s_waitcnt lgkmcnt(3)
v_mfma_f32_16x16x32_bf16 v[232:235], a[244:247], v[96:99], v[232:235]
v_cvt_pk_bf16_f32 v185, v178, v179
v_cvt_pk_bf16_f32 v187, v182, v183
v_mfma_f32_16x16x32_bf16 v[236:239], a[244:247], v[100:103], v[236:239]
ds_read_b128 a[244:247], v12 offset:9216
s_waitcnt lgkmcnt(3)
v_mfma_f32_16x16x32_bf16 v[224:227], a[248:251], v[104:107], v[224:227]
v_permlane16_swap_b32 v184, v186
v_permlane16_swap_b32_e64 v185, v187
v_mfma_f32_16x16x32_bf16 v[228:231], a[248:251], v[108:111], v[228:231]
ds_read_b128 a[248:251], v12 offset:10240
s_waitcnt lgkmcnt(3)
v_mfma_f32_16x16x32_bf16 v[232:235], a[252:255], v[104:107], v[232:235]
buffer_store_dwordx4 v[184:187], v1, s[36:39], s90 offen offset:2048 sc1
v_mul_f32 v192, v192, v200
v_mfma_f32_16x16x32_bf16 v[236:239], a[252:255], v[108:111], v[236:239]
ds_read_b128 a[252:255], v12 offset:11264
s_waitcnt lgkmcnt(3)
v_mfma_f32_16x16x32_bf16 v[224:227], a[240:243], v[112:115], v[224:227]
v_mul_f32 v193, v193, v201
v_mul_f32_e64 v194, v194, v202
v_mfma_f32_16x16x32_bf16 v[228:231], a[240:243], v[116:119], v[228:231]
ds_read_b128 a[240:243], v12 offset:12288
s_waitcnt lgkmcnt(3)
v_mfma_f32_16x16x32_bf16 v[232:235], a[244:247], v[112:115], v[232:235]
v_mul_f32 v195, v195, v203
v_mul_f32_e64 v196, v196, v204
v_mfma_f32_16x16x32_bf16 v[236:239], a[244:247], v[116:119], v[236:239]
ds_read_b128 a[244:247], v12 offset:13312
s_waitcnt lgkmcnt(3)
v_mfma_f32_16x16x32_bf16 v[224:227], a[248:251], v[120:123], v[224:227]
v_mul_f32 v197, v197, v205
v_mul_f32_e64 v198, v198, v206
v_mfma_f32_16x16x32_bf16 v[228:231], a[248:251], v[124:127], v[228:231]
ds_read_b128 a[248:251], v12 offset:14336
s_waitcnt lgkmcnt(3)
v_mfma_f32_16x16x32_bf16 v[232:235], a[252:255], v[120:123], v[232:235]
v_mul_f32 v199, v199, v207
v_cvt_pk_bf16_f32 v200, v192, v193
v_mfma_f32_16x16x32_bf16 v[236:239], a[252:255], v[124:127], v[236:239]
ds_read_b128 a[252:255], v12 offset:15360
s_waitcnt lgkmcnt(3)
v_mfma_f32_16x16x32_bf16 v[224:227], a[240:243], v[128:131], v[224:227]
v_cvt_pk_bf16_f32 v202, v196, v197
v_cvt_pk_bf16_f32 v201, v194, v195
v_mfma_f32_16x16x32_bf16 v[228:231], a[240:243], v[132:135], v[228:231]
s_waitcnt vmcnt(7)
s_barrier
ds_read_b128 a[240:243], v12 offset:16384
s_waitcnt lgkmcnt(3)
v_mfma_f32_16x16x32_bf16 v[232:235], a[244:247], v[128:131], v[232:235]
v_cvt_pk_bf16_f32 v203, v198, v199
v_permlane16_swap_b32_e64 v200, v202
v_mfma_f32_16x16x32_bf16 v[236:239], a[244:247], v[132:135], v[236:239]
ds_read_b128 a[244:247], v12 offset:17408
s_waitcnt lgkmcnt(3)
v_mfma_f32_16x16x32_bf16 v[224:227], a[248:251], v[136:139], v[224:227]
v_permlane16_swap_b32 v201, v203
buffer_store_dwordx4 v[200:203], v1, s[36:39], s90 offen offset:3072 sc1
v_mfma_f32_16x16x32_bf16 v[228:231], a[248:251], v[140:143], v[228:231]
ds_read_b128 a[248:251], v12 offset:18432
s_waitcnt lgkmcnt(3)
v_mfma_f32_16x16x32_bf16 v[232:235], a[252:255], v[136:139], v[232:235]
v_mul_f32 v208, v208, v216
v_mul_f32_e64 v209, v209, v217
v_mfma_f32_16x16x32_bf16 v[236:239], a[252:255], v[140:143], v[236:239]
ds_read_b128 a[252:255], v12 offset:19456
s_waitcnt lgkmcnt(3)
v_mfma_f32_16x16x32_bf16 v[144:147], a[240:243], v[16:19], 0
v_mul_f32 v210, v210, v218
v_mul_f32_e64 v211, v211, v219
v_mfma_f32_16x16x32_bf16 v[148:151], a[240:243], v[20:23], 0
ds_read_b128 a[240:243], v12 offset:20480
s_waitcnt lgkmcnt(3)
v_mfma_f32_16x16x32_bf16 v[152:155], a[244:247], v[16:19], 0
v_mul_f32 v212, v212, v220
v_mul_f32_e64 v213, v213, v221
v_mfma_f32_16x16x32_bf16 v[156:159], a[244:247], v[20:23], 0
ds_read_b128 a[244:247], v12 offset:21504
s_waitcnt lgkmcnt(3)
v_mfma_f32_16x16x32_bf16 v[144:147], a[248:251], v[24:27], v[144:147]
v_mul_f32 v214, v214, v222
v_mul_f32_e64 v215, v215, v223
v_mfma_f32_16x16x32_bf16 v[148:151], a[248:251], v[28:31], v[148:151]
ds_read_b128 a[248:251], v12 offset:22528
s_waitcnt lgkmcnt(3)
v_mfma_f32_16x16x32_bf16 v[152:155], a[252:255], v[24:27], v[152:155]
v_cvt_pk_bf16_f32 v216, v208, v209
v_cvt_pk_bf16_f32 v218, v212, v213
v_mfma_f32_16x16x32_bf16 v[156:159], a[252:255], v[28:31], v[156:159]
ds_read_b128 a[252:255], v12 offset:23552
s_waitcnt lgkmcnt(3)
v_mfma_f32_16x16x32_bf16 v[144:147], a[240:243], v[32:35], v[144:147]
v_cvt_pk_bf16_f32 v217, v210, v211
v_cvt_pk_bf16_f32 v219, v214, v215
v_mfma_f32_16x16x32_bf16 v[148:151], a[240:243], v[36:39], v[148:151]
ds_read_b128 a[240:243], v12 offset:32768
s_waitcnt lgkmcnt(3)
v_mfma_f32_16x16x32_bf16 v[152:155], a[244:247], v[32:35], v[152:155]
v_permlane16_swap_b32 v216, v218
v_permlane16_swap_b32_e64 v217, v219
v_mfma_f32_16x16x32_bf16 v[156:159], a[244:247], v[36:39], v[156:159]
ds_read_b128 a[244:247], v12 offset:33792
s_waitcnt lgkmcnt(3)
v_mfma_f32_16x16x32_bf16 v[144:147], a[248:251], v[40:43], v[144:147]
s_add_u32 s90, s90, 4096
buffer_store_dwordx4 v[216:219], v1, s[36:39], s90 offen sc1
v_mul_f32 v224, v224, v232
v_mfma_f32_16x16x32_bf16 v[148:151], a[248:251], v[44:47], v[148:151]
ds_read_b128 a[248:251], v12 offset:34816
s_waitcnt lgkmcnt(3)
v_mfma_f32_16x16x32_bf16 v[152:155], a[252:255], v[40:43], v[152:155]
v_mul_f32 v225, v225, v233
v_mul_f32_e64 v226, v226, v234
v_mfma_f32_16x16x32_bf16 v[156:159], a[252:255], v[44:47], v[156:159]
ds_read_b128 a[252:255], v12 offset:35840
s_waitcnt lgkmcnt(3)
v_mfma_f32_16x16x32_bf16 v[144:147], a[240:243], v[48:51], v[144:147]
v_mul_f32 v227, v227, v235
v_mul_f32_e64 v228, v228, v236
v_mfma_f32_16x16x32_bf16 v[148:151], a[240:243], v[52:55], v[148:151]
ds_read_b128 a[240:243], v12 offset:36864
s_waitcnt lgkmcnt(3)
v_mfma_f32_16x16x32_bf16 v[152:155], a[244:247], v[48:51], v[152:155]
v_mul_f32 v229, v229, v237
v_mul_f32_e64 v230, v230, v238
v_mfma_f32_16x16x32_bf16 v[156:159], a[244:247], v[52:55], v[156:159]
ds_read_b128 a[244:247], v12 offset:37888
s_waitcnt lgkmcnt(3)
v_mfma_f32_16x16x32_bf16 v[144:147], a[248:251], v[56:59], v[144:147]
v_mul_f32 v231, v231, v239
v_cvt_pk_bf16_f32 v232, v224, v225
v_mfma_f32_16x16x32_bf16 v[148:151], a[248:251], v[60:63], v[148:151]
ds_read_b128 a[248:251], v12 offset:38912
s_waitcnt lgkmcnt(3)
v_mfma_f32_16x16x32_bf16 v[152:155], a[252:255], v[56:59], v[152:155]
v_cvt_pk_bf16_f32 v234, v228, v229
v_cvt_pk_bf16_f32 v233, v226, v227
v_mfma_f32_16x16x32_bf16 v[156:159], a[252:255], v[60:63], v[156:159]
ds_read_b128 a[252:255], v12 offset:39936
s_waitcnt lgkmcnt(3)
v_mfma_f32_16x16x32_bf16 v[144:147], a[240:243], v[64:67], v[144:147]
v_mov_b32 v243, 8
v_mov_b32 v6, s83
s_waitcnt vmcnt(1)
s_mov_b64 exec, 1
buffer_store_dword v243, v6, s[36:39], 0 offen
s_mov_b64 exec, -1
v_mfma_f32_16x16x32_bf16 v[148:151], a[240:243], v[68:71], v[148:151]
s_barrier
ds_read_b128 a[240:243], v12 offset:40960
s_waitcnt lgkmcnt(3)
v_mfma_f32_16x16x32_bf16 v[152:155], a[244:247], v[64:67], v[152:155]
v_cvt_pk_bf16_f32 v235, v230, v231
v_permlane16_swap_b32 v232, v234
v_mfma_f32_16x16x32_bf16 v[156:159], a[244:247], v[68:71], v[156:159]
ds_read_b128 a[244:247], v12 offset:41984
s_waitcnt lgkmcnt(3)
v_mfma_f32_16x16x32_bf16 v[144:147], a[248:251], v[72:75], v[144:147]
v_permlane16_swap_b32 v233, v235
buffer_store_dwordx4 v[232:235], v1, s[36:39], s90 offen offset:1024 sc1
v_mfma_f32_16x16x32_bf16 v[148:151], a[248:251], v[76:79], v[148:151]
ds_read_b128 a[248:251], v12 offset:43008
s_waitcnt lgkmcnt(3)
v_mfma_f32_16x16x32_bf16 v[152:155], a[252:255], v[72:75], v[152:155]
v_mfma_f32_16x16x32_bf16 v[156:159], a[252:255], v[76:79], v[156:159]
ds_read_b128 a[252:255], v12 offset:44032
s_waitcnt lgkmcnt(3)
v_mfma_f32_16x16x32_bf16 v[144:147], a[240:243], v[80:83], v[144:147]
v_mfma_f32_16x16x32_bf16 v[148:151], a[240:243], v[84:87], v[148:151]
ds_read_b128 a[240:243], v12 offset:45056
s_waitcnt lgkmcnt(3)
v_mfma_f32_16x16x32_bf16 v[152:155], a[244:247], v[80:83], v[152:155]
v_mfma_f32_16x16x32_bf16 v[156:159], a[244:247], v[84:87], v[156:159]
ds_read_b128 a[244:247], v12 offset:46080
s_waitcnt lgkmcnt(3)
v_mfma_f32_16x16x32_bf16 v[144:147], a[248:251], v[88:91], v[144:147]
v_mfma_f32_16x16x32_bf16 v[148:151], a[248:251], v[92:95], v[148:151]
ds_read_b128 a[248:251], v12 offset:47104
s_waitcnt lgkmcnt(3)
v_mfma_f32_16x16x32_bf16 v[152:155], a[252:255], v[88:91], v[152:155]
v_mfma_f32_16x16x32_bf16 v[156:159], a[252:255], v[92:95], v[156:159]
ds_read_b128 a[252:255], v12 offset:48128
s_waitcnt lgkmcnt(3)
v_mfma_f32_16x16x32_bf16 v[144:147], a[240:243], v[96:99], v[144:147]
v_mfma_f32_16x16x32_bf16 v[148:151], a[240:243], v[100:103], v[148:151]
ds_read_b128 a[240:243], v12 offset:49152
s_waitcnt lgkmcnt(3)
v_mfma_f32_16x16x32_bf16 v[152:155], a[244:247], v[96:99], v[152:155]
v_mfma_f32_16x16x32_bf16 v[156:159], a[244:247], v[100:103], v[156:159]
ds_read_b128 a[244:247], v12 offset:50176
s_waitcnt lgkmcnt(3)
v_mfma_f32_16x16x32_bf16 v[144:147], a[248:251], v[104:107], v[144:147]
v_mfma_f32_16x16x32_bf16 v[148:151], a[248:251], v[108:111], v[148:151]
ds_read_b128 a[248:251], v12 offset:51200
s_waitcnt lgkmcnt(3)
v_mfma_f32_16x16x32_bf16 v[152:155], a[252:255], v[104:107], v[152:155]
v_mfma_f32_16x16x32_bf16 v[156:159], a[252:255], v[108:111], v[156:159]
ds_read_b128 a[252:255], v12 offset:52224
s_waitcnt lgkmcnt(3)
v_mfma_f32_16x16x32_bf16 v[144:147], a[240:243], v[112:115], v[144:147]
v_mfma_f32_16x16x32_bf16 v[148:151], a[240:243], v[116:119], v[148:151]
ds_read_b128 a[240:243], v12 offset:53248
s_waitcnt lgkmcnt(3)
v_mfma_f32_16x16x32_bf16 v[152:155], a[244:247], v[112:115], v[152:155]
v_mfma_f32_16x16x32_bf16 v[156:159], a[244:247], v[116:119], v[156:159]
ds_read_b128 a[244:247], v12 offset:54272
s_waitcnt lgkmcnt(3)
v_mfma_f32_16x16x32_bf16 v[144:147], a[248:251], v[120:123], v[144:147]
v_mfma_f32_16x16x32_bf16 v[148:151], a[248:251], v[124:127], v[148:151]
ds_read_b128 a[248:251], v12 offset:55296
s_waitcnt lgkmcnt(3)
v_mfma_f32_16x16x32_bf16 v[152:155], a[252:255], v[120:123], v[152:155]
v_mfma_f32_16x16x32_bf16 v[156:159], a[252:255], v[124:127], v[156:159]
ds_read_b128 a[252:255], v12 offset:56320
buffer_load_dword v6, v11, s[36:39], 0 offen sc1
s_waitcnt lgkmcnt(3)
v_mfma_f32_16x16x32_bf16 v[144:147], a[240:243], v[128:131], v[144:147]
v_mfma_f32_16x16x32_bf16 v[148:151], a[240:243], v[132:135], v[148:151]
s_waitcnt lgkmcnt(2)
v_mfma_f32_16x16x32_bf16 v[152:155], a[244:247], v[128:131], v[152:155]
v_mfma_f32_16x16x32_bf16 v[156:159], a[244:247], v[132:135], v[156:159]
s_waitcnt lgkmcnt(1)
v_mfma_f32_16x16x32_bf16 v[144:147], a[248:251], v[136:139], v[144:147]
v_mfma_f32_16x16x32_bf16 v[148:151], a[248:251], v[140:143], v[148:151]
s_waitcnt lgkmcnt(0)
v_mfma_f32_16x16x32_bf16 v[152:155], a[252:255], v[136:139], v[152:155]
v_mfma_f32_16x16x32_bf16 v[156:159], a[252:255], v[140:143], v[156:159]
s_barrier
s_nop 2
v_fmac_f32 v144, v8, v244
v_fmac_f32 v145, v8, v245
v_fmac_f32 v146, v8, v246
v_fmac_f32 v147, v8, v247
v_fmac_f32 v148, v242, v244
v_fmac_f32 v149, v242, v245
v_fmac_f32 v150, v242, v246
v_fmac_f32 v151, v242, v247
v_fmac_f32 v152, v8, v248
v_fmac_f32 v153, v8, v249
v_fmac_f32 v154, v8, v250
v_fmac_f32 v155, v8, v251
v_fmac_f32 v156, v242, v248
v_fmac_f32 v157, v242, v249
v_fmac_f32 v158, v242, v250
v_fmac_f32 v159, v242, v251
v_mul_f32 v144, v144, v152
v_mul_f32 v145, v145, v153
v_mul_f32 v146, v146, v154
v_mul_f32 v147, v147, v155
v_mul_f32 v148, v148, v156
v_mul_f32 v149, v149, v157
v_mul_f32 v150, v150, v158
v_mul_f32_e64 v151, v151, v159
v_cvt_pk_bf16_f32 v152, v144, v145
v_cvt_pk_bf16_f32 v154, v148, v149
v_cvt_pk_bf16_f32 v153, v146, v147
v_cvt_pk_bf16_f32 v155, v150, v151
v_permlane16_swap_b32 v152, v154
s_nop 0
v_permlane16_swap_b32_e64 v153, v155
buffer_store_dwordx4 v[152:155], v1, s[36:39], s90 offen offset:2048
s_waitcnt vmcnt(1)
v_cmp_gt_u32 vcc, 8, v6
s_nop 0
s_cbranch_vccz Lgo_52
Lpoll_51:
buffer_load_dword v6, v11, s[36:39], 0 offen sc1
s_waitcnt vmcnt(0)
v_cmp_gt_u32 vcc, 8, v6
s_nop 0
s_cbranch_vccz Lgo_52
s_add_u32 s91, s91, 1
s_bitcmp0_b32 s91, 16
s_cbranch_scc1 Lpoll_51
Lgo_52:
s_add_u32 s77, s92, 0
buffer_load_dwordx4 v[80:83], v14, s[36:39], s77 offen sc1
buffer_load_dwordx4 v[84:87], v14, s[36:39], s77 offen offset:256 sc1
s_add_u32 s77, s93, 0
buffer_load_dwordx4 v[88:91], v14, s[36:39], s77 offen sc1
buffer_load_dwordx4 v[92:95], v14, s[36:39], s77 offen offset:256 sc1
v_mov_b32 v7, 9
v_mov_b32_e64 v6, s83
s_waitcnt vmcnt(4)
s_mov_b64 exec, 1
buffer_store_dword v7, v6, s[36:39], 0 offen
s_mov_b64 exec, -1
s_add_u32 s77, s92, 7168
buffer_load_dwordx4 v[96:99], v14, s[36:39], s77 offen sc1
buffer_load_dwordx4 v[100:103], v14, s[36:39], s77 offen offset:256 sc1
s_add_u32 s77, s93, 7168
buffer_load_dwordx4 v[104:107], v14, s[36:39], s77 offen sc1
buffer_load_dwordx4 v[108:111], v14, s[36:39], s77 offen offset:256 sc1
s_add_u32 s77, s92, 14336
buffer_load_dwordx4 v[112:115], v14, s[36:39], s77 offen sc1
buffer_load_dwordx4 v[116:119], v14, s[36:39], s77 offen offset:256 sc1
s_add_u32 s77, s93, 14336
buffer_load_dwordx4 v[120:123], v14, s[36:39], s77 offen sc1
buffer_load_dwordx4 v[124:127], v14, s[36:39], s77 offen offset:256 sc1
s_waitcnt vmcnt(12)
v_mfma_f32_16x16x32_bf16 v[16:19], a[0:3], v[80:83], 0
s_add_u32 s77, s92, 21504
buffer_load_dwordx4 v[128:131], v14, s[36:39], s77 offen sc1
v_mfma_f32_16x16x32_bf16 v[24:27], a[4:7], v[80:83], 0
v_lshrrev_b32_e64 v7, 5, v0
v_mul_u32_u24 v7, 6144, v7
v_mfma_f32_16x16x32_bf16 v[48:51], a[8:11], v[80:83], 0
v_mfma_f32_16x16x32_bf16 v[56:59], a[12:15], v[80:83], 0
s_waitcnt vmcnt(12)
v_mfma_f32_16x16x32_bf16 v[20:23], a[0:3], v[84:87], 0
buffer_load_dwordx4 v[132:135], v14, s[36:39], s77 offen offset:256 sc1
v_mfma_f32_16x16x32_bf16 v[28:31], a[4:7], v[84:87], 0
v_add_u32_e64 v250, v7, v14
s_sub_u32 s78, s68, 1
v_mfma_f32_16x16x32_bf16 v[52:55], a[8:11], v[84:87], 0
v_mfma_f32_16x16x32_bf16 v[60:63], a[12:15], v[84:87], 0
s_waitcnt vmcnt(12)
v_mfma_f32_16x16x32_bf16 v[32:35], a[0:3], v[88:91], 0
s_add_u32 s77, s93, 21504
buffer_load_dwordx4 v[136:139], v14, s[36:39], s77 offen sc1
v_mfma_f32_16x16x32_bf16 v[40:43], a[4:7], v[88:91], 0
s_and_b32 s78, s78, 3
s_lshl_b32 s78, s78, 12
v_mfma_f32_16x16x32_bf16 v[64:67], a[8:11], v[88:91], 0
v_mfma_f32_16x16x32_bf16 v[72:75], a[12:15], v[88:91], 0
s_waitcnt vmcnt(12)
v_mfma_f32_16x16x32_bf16 v[36:39], a[0:3], v[92:95], 0
buffer_load_dwordx4 v[140:143], v14, s[36:39], s77 offen offset:256 sc1
v_mfma_f32_16x16x32_bf16 v[44:47], a[4:7], v[92:95], 0
s_add_u32 s78, s78, 67584
v_add_u32_e64 v12, s78, v1
v_mfma_f32_16x16x32_bf16 v[68:71], a[8:11], v[92:95], 0
v_mfma_f32_16x16x32_bf16 v[76:79], a[12:15], v[92:95], 0
s_waitcnt vmcnt(11)
v_mfma_f32_16x16x32_bf16 v[16:19], a[16:19], v[96:99], v[16:19]
s_add_u32 s77, s92, 2048
buffer_load_dwordx4 v[160:163], v14, s[36:39], s77 offen sc1
v_mfma_f32_16x16x32_bf16 v[24:27], a[20:23], v[96:99], v[24:27]
s_sub_u32 s78, s68, 3
s_and_b32 s78, s78, 3
v_mfma_f32_16x16x32_bf16 v[48:51], a[24:27], v[96:99], v[48:51]
v_mfma_f32_16x16x32_bf16 v[56:59], a[28:31], v[96:99], v[56:59]
s_waitcnt vmcnt(11)
v_mfma_f32_16x16x32_bf16 v[20:23], a[16:19], v[100:103], v[20:23]
buffer_load_dwordx4 v[164:167], v14, s[36:39], s77 offen offset:256 sc1
v_mfma_f32_16x16x32_bf16 v[28:31], a[20:23], v[100:103], v[28:31]
s_lshl_b32 s78, s78, 12
s_add_u32 s78, s78, 100352
v_mfma_f32_16x16x32_bf16 v[52:55], a[24:27], v[100:103], v[52:55]
v_mfma_f32_16x16x32_bf16 v[60:63], a[28:31], v[100:103], v[60:63]
s_waitcnt vmcnt(11)
v_mfma_f32_16x16x32_bf16 v[32:35], a[16:19], v[104:107], v[32:35]
s_add_u32 s77, s93, 2048
buffer_load_dwordx4 v[168:171], v14, s[36:39], s77 offen sc1
v_mfma_f32_16x16x32_bf16 v[40:43], a[20:23], v[104:107], v[40:43]
v_add_u32 v13, s78, v1
s_lshl_b32 s78, s68, 14
v_mfma_f32_16x16x32_bf16 v[64:67], a[24:27], v[104:107], v[64:67]
v_mfma_f32_16x16x32_bf16 v[72:75], a[28:31], v[104:107], v[72:75]
s_waitcnt vmcnt(11)
v_mfma_f32_16x16x32_bf16 v[36:39], a[16:19], v[108:111], v[36:39]
buffer_load_dwordx4 v[172:175], v14, s[36:39], s77 offen offset:256 sc1
v_mfma_f32_16x16x32_bf16 v[44:47], a[20:23], v[108:111], v[44:47]
s_add_u32 s78, s78, 67584
v_add_u32 v248, s78, v1
v_mfma_f32_16x16x32_bf16 v[68:71], a[24:27], v[108:111], v[68:71]
v_mfma_f32_16x16x32_bf16 v[76:79], a[28:31], v[108:111], v[76:79]
s_waitcnt vmcnt(11)
v_mfma_f32_16x16x32_bf16 v[16:19], a[32:35], v[112:115], v[16:19]
buffer_load_dword v6, v11, s[36:39], 0 offen sc1
s_add_u32 s77, s92, 9216
buffer_load_dwordx4 v[176:179], v14, s[36:39], s77 offen sc1
v_mfma_f32_16x16x32_bf16 v[24:27], a[36:39], v[112:115], v[24:27]
s_lshl_b32 s78, s73, 1
s_add_u32 s78, s78, s75
v_mfma_f32_16x16x32_bf16 v[48:51], a[40:43], v[112:115], v[48:51]
v_mfma_f32_16x16x32_bf16 v[56:59], a[44:47], v[112:115], v[56:59]
s_waitcnt vmcnt(12)
v_mfma_f32_16x16x32_bf16 v[20:23], a[32:35], v[116:119], v[20:23]
buffer_load_dwordx4 v[180:183], v14, s[36:39], s77 offen offset:256 sc1
v_mfma_f32_16x16x32_bf16 v[28:31], a[36:39], v[116:119], v[28:31]
s_lshl_b32 s78, s78, 7
s_add_u32 s78, s78, 66944
v_mfma_f32_16x16x32_bf16 v[52:55], a[40:43], v[116:119], v[52:55]
v_mfma_f32_16x16x32_bf16 v[60:63], a[44:47], v[116:119], v[60:63]
s_waitcnt vmcnt(12)
v_mfma_f32_16x16x32_bf16 v[32:35], a[32:35], v[120:123], v[32:35]
s_add_u32 s77, s93, 9216
buffer_load_dwordx4 v[184:187], v14, s[36:39], s77 offen sc1
v_mfma_f32_16x16x32_bf16 v[40:43], a[36:39], v[120:123], v[40:43]
v_and_b32_e64 v7, 15, v0
v_lshl_add_u32 v249, v7, 2, s78
v_mfma_f32_16x16x32_bf16 v[64:67], a[40:43], v[120:123], v[64:67]
v_mfma_f32_16x16x32_bf16 v[72:75], a[44:47], v[120:123], v[72:75]
s_waitcnt vmcnt(12)
v_mfma_f32_16x16x32_bf16 v[36:39], a[32:35], v[124:127], v[36:39]
buffer_load_dwordx4 v[188:191], v14, s[36:39], s77 offen offset:256 sc1
v_mfma_f32_16x16x32_bf16 v[44:47], a[36:39], v[124:127], v[44:47]
v_mfma_f32_16x16x32_bf16 v[68:71], a[40:43], v[124:127], v[68:71]
v_mfma_f32_16x16x32_bf16 v[76:79], a[44:47], v[124:127], v[76:79]
s_waitcnt vmcnt(12)
v_mfma_f32_16x16x32_bf16 v[16:19], a[48:51], v[128:131], v[16:19]
s_add_u32 s77, s92, 16384
buffer_load_dwordx4 v[192:195], v14, s[36:39], s77 offen sc1
v_mfma_f32_16x16x32_bf16 v[24:27], a[52:55], v[128:131], v[24:27]
v_mfma_f32_16x16x32_bf16 v[48:51], a[56:59], v[128:131], v[48:51]
v_mfma_f32_16x16x32_bf16 v[56:59], a[60:63], v[128:131], v[56:59]
s_waitcnt vmcnt(12)
v_mfma_f32_16x16x32_bf16 v[20:23], a[48:51], v[132:135], v[20:23]
buffer_load_dwordx4 v[196:199], v14, s[36:39], s77 offen offset:256 sc1
v_mfma_f32_16x16x32_bf16 v[28:31], a[52:55], v[132:135], v[28:31]
v_mfma_f32_16x16x32_bf16 v[52:55], a[56:59], v[132:135], v[52:55]
v_mfma_f32_16x16x32_bf16 v[60:63], a[60:63], v[132:135], v[60:63]
s_waitcnt vmcnt(12)
v_mfma_f32_16x16x32_bf16 v[32:35], a[48:51], v[136:139], v[32:35]
s_add_u32 s77, s93, 16384
buffer_load_dwordx4 v[200:203], v14, s[36:39], s77 offen sc1
v_mfma_f32_16x16x32_bf16 v[40:43], a[52:55], v[136:139], v[40:43]
v_mfma_f32_16x16x32_bf16 v[64:67], a[56:59], v[136:139], v[64:67]
v_mfma_f32_16x16x32_bf16 v[72:75], a[60:63], v[136:139], v[72:75]
s_waitcnt vmcnt(12)
v_mfma_f32_16x16x32_bf16 v[36:39], a[48:51], v[140:143], v[36:39]
buffer_load_dwordx4 v[204:207], v14, s[36:39], s77 offen offset:256 sc1
v_mfma_f32_16x16x32_bf16 v[44:47], a[52:55], v[140:143], v[44:47]
v_mfma_f32_16x16x32_bf16 v[68:71], a[56:59], v[140:143], v[68:71]
v_mfma_f32_16x16x32_bf16 v[76:79], a[60:63], v[140:143], v[76:79]
s_waitcnt vmcnt(12)
v_mfma_f32_16x16x32_bf16 v[16:19], a[64:67], v[160:163], v[16:19]
s_add_u32 s77, s92, 23552
buffer_load_dwordx4 v[208:211], v14, s[36:39], s77 offen sc1
v_mfma_f32_16x16x32_bf16 v[24:27], a[68:71], v[160:163], v[24:27]
v_mfma_f32_16x16x32_bf16 v[48:51], a[72:75], v[160:163], v[48:51]
v_mfma_f32_16x16x32_bf16 v[56:59], a[76:79], v[160:163], v[56:59]
s_waitcnt vmcnt(12)
v_mfma_f32_16x16x32_bf16 v[20:23], a[64:67], v[164:167], v[20:23]
buffer_load_dwordx4 v[212:215], v14, s[36:39], s77 offen offset:256 sc1
v_mfma_f32_16x16x32_bf16 v[28:31], a[68:71], v[164:167], v[28:31]
v_mfma_f32_16x16x32_bf16 v[52:55], a[72:75], v[164:167], v[52:55]
v_mfma_f32_16x16x32_bf16 v[60:63], a[76:79], v[164:167], v[60:63]
s_waitcnt vmcnt(12)
v_mfma_f32_16x16x32_bf16 v[32:35], a[64:67], v[168:171], v[32:35]
s_add_u32 s77, s93, 23552
buffer_load_dwordx4 v[216:219], v14, s[36:39], s77 offen sc1
v_mfma_f32_16x16x32_bf16 v[40:43], a[68:71], v[168:171], v[40:43]
v_mfma_f32_16x16x32_bf16 v[64:67], a[72:75], v[168:171], v[64:67]
v_mfma_f32_16x16x32_bf16 v[72:75], a[76:79], v[168:171], v[72:75]
s_waitcnt vmcnt(12)
v_mfma_f32_16x16x32_bf16 v[36:39], a[64:67], v[172:175], v[36:39]
buffer_load_dwordx4 v[220:223], v14, s[36:39], s77 offen offset:256 sc1
v_mfma_f32_16x16x32_bf16 v[44:47], a[68:71], v[172:175], v[44:47]
v_mfma_f32_16x16x32_bf16 v[68:71], a[72:75], v[172:175], v[68:71]
v_mfma_f32_16x16x32_bf16 v[76:79], a[76:79], v[172:175], v[76:79]
s_waitcnt vmcnt(11)
v_mfma_f32_16x16x32_bf16 v[16:19], a[80:83], v[176:179], v[16:19]
v_cmp_gt_u32 vcc, 9, v6
s_nop 0
s_cbranch_vccz Lgo_54
Lpoll_53:
buffer_load_dword v6, v11, s[36:39], 0 offen sc1
s_waitcnt vmcnt(0)
v_cmp_gt_u32 vcc, 9, v6
s_nop 0
s_cbranch_vccz Lgo_54
s_add_u32 s91, s91, 1
s_bitcmp0_b32 s91, 16
s_cbranch_scc1 Lpoll_53
Lgo_54:
s_add_u32 s77, s92, 4096
buffer_load_dwordx4 v[224:227], v14, s[36:39], s77 offen sc1
v_mfma_f32_16x16x32_bf16 v[24:27], a[84:87], v[176:179], v[24:27]
v_mfma_f32_16x16x32_bf16 v[48:51], a[88:91], v[176:179], v[48:51]
v_mfma_f32_16x16x32_bf16 v[56:59], a[92:95], v[176:179], v[56:59]
s_waitcnt vmcnt(11)
v_mfma_f32_16x16x32_bf16 v[20:23], a[80:83], v[180:183], v[20:23]
buffer_load_dwordx4 v[228:231], v14, s[36:39], s77 offen offset:256 sc1
v_mfma_f32_16x16x32_bf16 v[28:31], a[84:87], v[180:183], v[28:31]
v_mfma_f32_16x16x32_bf16 v[52:55], a[88:91], v[180:183], v[52:55]
v_mfma_f32_16x16x32_bf16 v[60:63], a[92:95], v[180:183], v[60:63]
s_waitcnt vmcnt(11)
v_mfma_f32_16x16x32_bf16 v[32:35], a[80:83], v[184:187], v[32:35]
s_add_u32 s77, s92, 11264
buffer_load_dwordx4 v[232:235], v14, s[36:39], s77 offen sc1
v_mfma_f32_16x16x32_bf16 v[40:43], a[84:87], v[184:187], v[40:43]
v_mfma_f32_16x16x32_bf16 v[64:67], a[88:91], v[184:187], v[64:67]
v_mfma_f32_16x16x32_bf16 v[72:75], a[92:95], v[184:187], v[72:75]
s_waitcnt vmcnt(11)
v_mfma_f32_16x16x32_bf16 v[36:39], a[80:83], v[188:191], v[36:39]
buffer_load_dwordx4 v[236:239], v14, s[36:39], s77 offen offset:256 sc1
v_mfma_f32_16x16x32_bf16 v[44:47], a[84:87], v[188:191], v[44:47]
v_mfma_f32_16x16x32_bf16 v[68:71], a[88:91], v[188:191], v[68:71]
v_mfma_f32_16x16x32_bf16 v[76:79], a[92:95], v[188:191], v[76:79]
s_waitcnt vmcnt(11)
v_mfma_f32_16x16x32_bf16 v[16:19], a[96:99], v[192:195], v[16:19]
s_add_u32 s77, s92, 18432
buffer_load_dwordx4 v[80:83], v14, s[36:39], s77 offen sc1
v_mfma_f32_16x16x32_bf16 v[24:27], a[100:103], v[192:195], v[24:27]
v_mfma_f32_16x16x32_bf16 v[48:51], a[104:107], v[192:195], v[48:51]
v_mfma_f32_16x16x32_bf16 v[56:59], a[108:111], v[192:195], v[56:59]
s_waitcnt vmcnt(11)
v_mfma_f32_16x16x32_bf16 v[20:23], a[96:99], v[196:199], v[20:23]
buffer_load_dwordx4 v[84:87], v14, s[36:39], s77 offen offset:256 sc1
v_mfma_f32_16x16x32_bf16 v[28:31], a[100:103], v[196:199], v[28:31]
v_mfma_f32_16x16x32_bf16 v[52:55], a[104:107], v[196:199], v[52:55]
v_mfma_f32_16x16x32_bf16 v[60:63], a[108:111], v[196:199], v[60:63]
s_waitcnt vmcnt(11)
v_mfma_f32_16x16x32_bf16 v[32:35], a[96:99], v[200:203], v[32:35]
s_add_u32 s77, s92, 25600
buffer_load_dwordx4 v[88:91], v14, s[36:39], s77 offen sc1
v_mfma_f32_16x16x32_bf16 v[40:43], a[100:103], v[200:203], v[40:43]
v_mfma_f32_16x16x32_bf16 v[64:67], a[104:107], v[200:203], v[64:67]
v_mfma_f32_16x16x32_bf16 v[72:75], a[108:111], v[200:203], v[72:75]
s_waitcnt vmcnt(11)
v_mfma_f32_16x16x32_bf16 v[36:39], a[96:99], v[204:207], v[36:39]
buffer_load_dwordx4 v[92:95], v14, s[36:39], s77 offen offset:256 sc1
v_mfma_f32_16x16x32_bf16 v[44:47], a[100:103], v[204:207], v[44:47]
v_mfma_f32_16x16x32_bf16 v[68:71], a[104:107], v[204:207], v[68:71]
v_mfma_f32_16x16x32_bf16 v[76:79], a[108:111], v[204:207], v[76:79]
s_waitcnt vmcnt(11)
v_mfma_f32_16x16x32_bf16 v[16:19], a[112:115], v[208:211], v[16:19]
s_add_u32 s77, s92, 6144
buffer_load_dwordx4 v[96:99], v250, s[36:39], s77 offen sc1
v_mfma_f32_16x16x32_bf16 v[24:27], a[116:119], v[208:211], v[24:27]
v_mfma_f32_16x16x32_bf16 v[48:51], a[120:123], v[208:211], v[48:51]
v_mfma_f32_16x16x32_bf16 v[56:59], a[124:127], v[208:211], v[56:59]
s_waitcnt vmcnt(11)
v_mfma_f32_16x16x32_bf16 v[20:23], a[112:115], v[212:215], v[20:23]
buffer_load_dwordx4 v[100:103], v250, s[36:39], s77 offen offset:256 sc1
v_mfma_f32_16x16x32_bf16 v[28:31], a[116:119], v[212:215], v[28:31]
v_mfma_f32_16x16x32_bf16 v[52:55], a[120:123], v[212:215], v[52:55]
v_mfma_f32_16x16x32_bf16 v[60:63], a[124:127], v[212:215], v[60:63]
s_waitcnt vmcnt(11)
v_mfma_f32_16x16x32_bf16 v[32:35], a[112:115], v[216:219], v[32:35]
s_add_u32 s77, s92, 20480
buffer_load_dwordx4 v[104:107], v250, s[36:39], s77 offen sc1
v_mfma_f32_16x16x32_bf16 v[40:43], a[116:119], v[216:219], v[40:43]
v_mfma_f32_16x16x32_bf16 v[64:67], a[120:123], v[216:219], v[64:67]
v_mfma_f32_16x16x32_bf16 v[72:75], a[124:127], v[216:219], v[72:75]
s_waitcnt vmcnt(11)
v_mfma_f32_16x16x32_bf16 v[36:39], a[112:115], v[220:223], v[36:39]
buffer_load_dwordx4 v[108:111], v250, s[36:39], s77 offen offset:256 sc1
v_mfma_f32_16x16x32_bf16 v[44:47], a[116:119], v[220:223], v[44:47]
v_mfma_f32_16x16x32_bf16 v[68:71], a[120:123], v[220:223], v[68:71]
v_mfma_f32_16x16x32_bf16 v[76:79], a[124:127], v[220:223], v[76:79]
s_waitcnt vmcnt(11)
v_mfma_f32_16x16x32_bf16 v[16:19], a[128:131], v[224:227], v[16:19]
s_add_u32 s77, s93, 4096
buffer_load_dwordx4 v[112:115], v14, s[36:39], s77 offen sc1
v_mfma_f32_16x16x32_bf16 v[24:27], a[132:135], v[224:227], v[24:27]
v_mfma_f32_16x16x32_bf16 v[48:51], a[136:139], v[224:227], v[48:51]
v_mfma_f32_16x16x32_bf16 v[56:59], a[140:143], v[224:227], v[56:59]
s_waitcnt vmcnt(11)
v_mfma_f32_16x16x32_bf16 v[20:23], a[128:131], v[228:231], v[20:23]
buffer_load_dwordx4 v[116:119], v14, s[36:39], s77 offen offset:256 sc1
v_mfma_f32_16x16x32_bf16 v[28:31], a[132:135], v[228:231], v[28:31]
v_mfma_f32_16x16x32_bf16 v[52:55], a[136:139], v[228:231], v[52:55]
v_mfma_f32_16x16x32_bf16 v[60:63], a[140:143], v[228:231], v[60:63]
s_waitcnt vmcnt(11)
v_mfma_f32_16x16x32_bf16 v[16:19], a[144:147], v[232:235], v[16:19]
s_add_u32 s77, s93, 11264
buffer_load_dwordx4 v[120:123], v14, s[36:39], s77 offen sc1
v_mfma_f32_16x16x32_bf16 v[24:27], a[148:151], v[232:235], v[24:27]
v_mfma_f32_16x16x32_bf16 v[48:51], a[152:155], v[232:235], v[48:51]
v_mfma_f32_16x16x32_bf16 v[56:59], a[156:159], v[232:235], v[56:59]
s_waitcnt vmcnt(11)
v_mfma_f32_16x16x32_bf16 v[20:23], a[144:147], v[236:239], v[20:23]
buffer_load_dwordx4 v[124:127], v14, s[36:39], s77 offen offset:256 sc1
v_mfma_f32_16x16x32_bf16 v[28:31], a[148:151], v[236:239], v[28:31]
v_mfma_f32_16x16x32_bf16 v[52:55], a[152:155], v[236:239], v[52:55]
v_mfma_f32_16x16x32_bf16 v[60:63], a[156:159], v[236:239], v[60:63]
s_waitcnt vmcnt(11)
v_mfma_f32_16x16x32_bf16 v[16:19], a[160:163], v[80:83], v[16:19]
s_add_u32 s77, s93, 18432
buffer_load_dwordx4 v[128:131], v14, s[36:39], s77 offen sc1
v_mfma_f32_16x16x32_bf16 v[24:27], a[164:167], v[80:83], v[24:27]
v_mfma_f32_16x16x32_bf16 v[48:51], a[168:171], v[80:83], v[48:51]
v_mfma_f32_16x16x32_bf16 v[56:59], a[172:175], v[80:83], v[56:59]
s_waitcnt vmcnt(11)
v_mfma_f32_16x16x32_bf16 v[20:23], a[160:163], v[84:87], v[20:23]
buffer_load_dwordx4 v[132:135], v14, s[36:39], s77 offen offset:256 sc1
v_mfma_f32_16x16x32_bf16 v[28:31], a[164:167], v[84:87], v[28:31]
v_mfma_f32_16x16x32_bf16 v[52:55], a[168:171], v[84:87], v[52:55]
v_mfma_f32_16x16x32_bf16 v[60:63], a[172:175], v[84:87], v[60:63]
s_waitcnt vmcnt(11)
v_mfma_f32_16x16x32_bf16 v[16:19], a[176:179], v[88:91], v[16:19]
s_add_u32 s77, s93, 25600
buffer_load_dwordx4 v[136:139], v14, s[36:39], s77 offen sc1
v_mfma_f32_16x16x32_bf16 v[24:27], a[180:183], v[88:91], v[24:27]
v_mfma_f32_16x16x32_bf16 v[48:51], a[184:187], v[88:91], v[48:51]
v_mfma_f32_16x16x32_bf16 v[56:59], a[188:191], v[88:91], v[56:59]
s_waitcnt vmcnt(11)
v_mfma_f32_16x16x32_bf16 v[20:23], a[176:179], v[92:95], v[20:23]
buffer_load_dwordx4 v[140:143], v14, s[36:39], s77 offen offset:256 sc1
v_mfma_f32_16x16x32_bf16 v[28:31], a[180:183], v[92:95], v[28:31]
v_mfma_f32_16x16x32_bf16 v[52:55], a[184:187], v[92:95], v[52:55]
v_mfma_f32_16x16x32_bf16 v[60:63], a[188:191], v[92:95], v[60:63]
s_waitcnt vmcnt(11)
v_mfma_f32_16x16x32_bf16 v[16:19], a[192:195], v[96:99], v[16:19]
s_add_u32 s77, s93, 6144
buffer_load_dwordx4 v[160:163], v250, s[36:39], s77 offen sc1
v_mfma_f32_16x16x32_bf16 v[24:27], a[196:199], v[96:99], v[24:27]
v_mfma_f32_16x16x32_bf16 v[48:51], a[200:203], v[96:99], v[48:51]
v_mfma_f32_16x16x32_bf16 v[56:59], a[204:207], v[96:99], v[56:59]
s_waitcnt vmcnt(11)
v_mfma_f32_16x16x32_bf16 v[20:23], a[192:195], v[100:103], v[20:23]
buffer_load_dwordx4 v[164:167], v250, s[36:39], s77 offen offset:256 sc1
v_mfma_f32_16x16x32_bf16 v[28:31], a[196:199], v[100:103], v[28:31]
v_mfma_f32_16x16x32_bf16 v[52:55], a[200:203], v[100:103], v[52:55]
v_mfma_f32_16x16x32_bf16 v[60:63], a[204:207], v[100:103], v[60:63]
s_waitcnt vmcnt(11)
v_mfma_f32_16x16x32_bf16 v[16:19], a[208:211], v[104:107], v[16:19]
s_add_u32 s77, s93, 20480
buffer_load_dwordx4 v[168:171], v250, s[36:39], s77 offen sc1
v_mfma_f32_16x16x32_bf16 v[24:27], a[212:215], v[104:107], v[24:27]
v_mfma_f32_16x16x32_bf16 v[48:51], a[216:219], v[104:107], v[48:51]
v_mfma_f32_16x16x32_bf16 v[56:59], a[220:223], v[104:107], v[56:59]
s_waitcnt vmcnt(11)
v_mfma_f32_16x16x32_bf16 v[20:23], a[208:211], v[108:111], v[20:23]
buffer_load_dwordx4 v[172:175], v250, s[36:39], s77 offen offset:256 sc1
v_mfma_f32_16x16x32_bf16 v[28:31], a[212:215], v[108:111], v[28:31]
v_mfma_f32_16x16x32_bf16 v[52:55], a[216:219], v[108:111], v[52:55]
v_mfma_f32_16x16x32_bf16 v[60:63], a[220:223], v[108:111], v[60:63]
s_waitcnt vmcnt(11)
v_mfma_f32_16x16x32_bf16 v[32:35], a[128:131], v[112:115], v[32:35]
s_add_u32 s94, s80, 4194304
buffer_load_dwordx4 v[240:243], v1, s[36:39], s94 offen sc1
buffer_load_dwordx4 v[244:247], v1, s[36:39], s94 offen offset:1024 sc1
v_mfma_f32_16x16x32_bf16 v[40:43], a[132:135], v[112:115], v[40:43]
v_and_b32_e64 v7, 15, v0
v_mfma_f32_16x16x32_bf16 v[64:67], a[136:139], v[112:115], v[64:67]
v_mfma_f32_16x16x32_bf16 v[72:75], a[140:143], v[112:115], v[72:75]
s_waitcnt vmcnt(12)
v_mfma_f32_16x16x32_bf16 v[36:39], a[128:131], v[116:119], v[36:39]
v_mfma_f32_16x16x32_bf16 v[44:47], a[132:135], v[116:119], v[44:47]
v_and_b32 v14, 16, v0
v_mfma_f32_16x16x32_bf16 v[68:71], a[136:139], v[116:119], v[68:71]
v_mfma_f32_16x16x32_bf16 v[76:79], a[140:143], v[116:119], v[76:79]
s_waitcnt vmcnt(11)
v_mfma_f32_16x16x32_bf16 v[32:35], a[144:147], v[120:123], v[32:35]
v_mfma_f32_16x16x32_bf16 v[40:43], a[148:151], v[120:123], v[40:43]
v_lshlrev_b32 v14, 1, v14
v_mfma_f32_16x16x32_bf16 v[64:67], a[152:155], v[120:123], v[64:67]
v_mfma_f32_16x16x32_bf16 v[72:75], a[156:159], v[120:123], v[72:75]
ds_read2_b32 v[8:9], v249 offset0:0 offset1:16
s_waitcnt vmcnt(10)
v_mfma_f32_16x16x32_bf16 v[36:39], a[144:147], v[124:127], v[36:39]
v_mfma_f32_16x16x32_bf16 v[44:47], a[148:151], v[124:127], v[44:47]
v_lshl_add_u32 v14, v7, 10, v14
v_mfma_f32_16x16x32_bf16 v[68:71], a[152:155], v[124:127], v[68:71]
v_mfma_f32_16x16x32_bf16 v[76:79], a[156:159], v[124:127], v[76:79]
ds_write_b128 v12, v[16:19] offset:0
s_waitcnt vmcnt(9)
v_mfma_f32_16x16x32_bf16 v[32:35], a[160:163], v[128:131], v[32:35]
v_mfma_f32_16x16x32_bf16 v[40:43], a[164:167], v[128:131], v[40:43]
v_lshrrev_b32_e64 v7, 5, v0
v_mfma_f32_16x16x32_bf16 v[64:67], a[168:171], v[128:131], v[64:67]
v_mfma_f32_16x16x32_bf16 v[72:75], a[172:175], v[128:131], v[72:75]
ds_write_b128 v12, v[20:23] offset:1024
s_waitcnt vmcnt(8)
v_mfma_f32_16x16x32_bf16 v[36:39], a[160:163], v[132:135], v[36:39]
v_mfma_f32_16x16x32_bf16 v[44:47], a[164:167], v[132:135], v[44:47]
v_lshl_add_u32 v14, v7, 4, v14
v_mfma_f32_16x16x32_bf16 v[68:71], a[168:171], v[132:135], v[68:71]
v_mfma_f32_16x16x32_bf16 v[76:79], a[172:175], v[132:135], v[76:79]
ds_write_b128 v12, v[24:27] offset:2048
s_waitcnt vmcnt(7)
v_mfma_f32_16x16x32_bf16 v[32:35], a[176:179], v[136:139], v[32:35]
v_mfma_f32_16x16x32_bf16 v[40:43], a[180:183], v[136:139], v[40:43]
v_mfma_f32_16x16x32_bf16 v[64:67], a[184:187], v[136:139], v[64:67]
v_mfma_f32_16x16x32_bf16 v[72:75], a[188:191], v[136:139], v[72:75]
ds_write_b128 v12, v[28:31] offset:3072
s_waitcnt vmcnt(6)
v_mfma_f32_16x16x32_bf16 v[36:39], a[176:179], v[140:143], v[36:39]
v_mfma_f32_16x16x32_bf16 v[44:47], a[180:183], v[140:143], v[44:47]
v_mfma_f32_16x16x32_bf16 v[68:71], a[184:187], v[140:143], v[68:71]
v_mfma_f32_16x16x32_bf16 v[76:79], a[188:191], v[140:143], v[76:79]
ds_write_b128 v13, v[48:51] offset:0
s_waitcnt vmcnt(5)
v_mfma_f32_16x16x32_bf16 v[32:35], a[192:195], v[160:163], v[32:35]
v_mfma_f32_16x16x32_bf16 v[40:43], a[196:199], v[160:163], v[40:43]
v_mfma_f32_16x16x32_bf16 v[64:67], a[200:203], v[160:163], v[64:67]
v_mfma_f32_16x16x32_bf16 v[72:75], a[204:207], v[160:163], v[72:75]
ds_write_b128 v13, v[52:55] offset:1024
s_waitcnt vmcnt(4)
v_mfma_f32_16x16x32_bf16 v[36:39], a[192:195], v[164:167], v[36:39]
v_mfma_f32_16x16x32_bf16 v[44:47], a[196:199], v[164:167], v[44:47]
v_mfma_f32_16x16x32_bf16 v[68:71], a[200:203], v[164:167], v[68:71]
v_mfma_f32_16x16x32_bf16 v[76:79], a[204:207], v[164:167], v[76:79]
ds_write_b128 v13, v[56:59] offset:2048
s_waitcnt vmcnt(3)
v_mfma_f32_16x16x32_bf16 v[32:35], a[208:211], v[168:171], v[32:35]
v_mfma_f32_16x16x32_bf16 v[40:43], a[212:215], v[168:171], v[40:43]
v_mfma_f32_16x16x32_bf16 v[64:67], a[216:219], v[168:171], v[64:67]
v_mfma_f32_16x16x32_bf16 v[72:75], a[220:223], v[168:171], v[72:75]
ds_write_b128 v13, v[60:63] offset:3072
s_waitcnt vmcnt(2)
v_mfma_f32_16x16x32_bf16 v[36:39], a[208:211], v[172:175], v[36:39]
v_mfma_f32_16x16x32_bf16 v[44:47], a[212:215], v[172:175], v[44:47]
v_mfma_f32_16x16x32_bf16 v[68:71], a[216:219], v[172:175], v[68:71]
v_mfma_f32_16x16x32_bf16 v[76:79], a[220:223], v[172:175], v[76:79]
v_add_u32 v11, 67584, v1
s_cmp_ge_u32 s68, 2
s_cbranch_scc1 Lsc_57
Lsc_55:
s_cmp_eq_u32 s68, 1
s_cbranch_scc1 Lsc_56
ds_write_b128 v11, v[32:35] offset:24576
ds_write_b128 v11, v[36:39] offset:25600
ds_write_b128 v11, v[40:43] offset:26624
ds_write_b128 v11, v[44:47] offset:27648
ds_write_b128 v11, v[64:67] offset:49152
ds_write_b128 v11, v[68:71] offset:50176
ds_write_b128 v11, v[72:75] offset:51200
ds_write_b128 v11, v[76:79] offset:52224
v_pk_add_f32 v[144:145], v[16:17], 0
v_pk_add_f32 v[146:147], v[18:19], 0
v_pk_add_f32 v[148:149], v[20:21], 0
v_pk_add_f32 v[150:151], v[22:23], 0
v_pk_add_f32 v[152:153], v[24:25], 0
v_pk_add_f32 v[154:155], v[26:27], 0
v_pk_add_f32 v[156:157], v[28:29], 0
v_pk_add_f32 v[158:159], v[30:31], 0
s_branch Lscd_59
Lsc_56:
ds_write_b128 v11, v[64:67] offset:53248
s_nop 0
ds_write_b128 v11, v[68:71] offset:54272
ds_write_b128 v11, v[72:75] offset:55296
ds_write_b128 v11, v[76:79] offset:56320
v_pk_add_f32 v[144:145], v[32:33], 0
v_pk_add_f32 v[146:147], v[34:35], 0
v_pk_add_f32 v[148:149], v[36:37], 0
v_pk_add_f32 v[150:151], v[38:39], 0
v_pk_add_f32 v[152:153], v[40:41], 0
v_pk_add_f32 v[154:155], v[42:43], 0
v_pk_add_f32 v[156:157], v[44:45], 0
v_pk_add_f32 v[158:159], v[46:47], 0
s_branch Lscd_59
Lsc_57:
s_cmp_eq_u32 s68, 3
s_cbranch_scc1 Lsc_58
ds_write_b128 v11, v[32:35] offset:16384
ds_write_b128 v11, v[36:39] offset:17408
ds_write_b128 v11, v[40:43] offset:18432
ds_write_b128 v11, v[44:47] offset:19456
ds_write_b128 v11, v[64:67] offset:57344
ds_write_b128 v11, v[68:71] offset:58368
ds_write_b128 v11, v[72:75] offset:59392
ds_write_b128 v11, v[76:79] offset:60416
v_pk_add_f32 v[144:145], v[48:49], 0
v_pk_add_f32 v[146:147], v[50:51], 0
v_pk_add_f32 v[148:149], v[52:53], 0
v_pk_add_f32 v[150:151], v[54:55], 0
v_pk_add_f32 v[152:153], v[56:57], 0
v_pk_add_f32 v[154:155], v[58:59], 0
v_pk_add_f32 v[156:157], v[60:61], 0
v_pk_add_f32 v[158:159], v[62:63], 0
s_branch Lscd_59
Lsc_58:
ds_write_b128 v11, v[32:35] offset:20480
ds_write_b128 v11, v[36:39] offset:21504
ds_write_b128 v11, v[40:43] offset:22528
ds_write_b128 v11, v[44:47] offset:23552
v_pk_add_f32 v[144:145], v[64:65], 0
v_pk_add_f32 v[146:147], v[66:67], 0
v_pk_add_f32 v[148:149], v[68:69], 0
v_pk_add_f32 v[150:151], v[70:71], 0
v_pk_add_f32 v[152:153], v[72:73], 0
v_pk_add_f32 v[154:155], v[74:75], 0
v_pk_add_f32 v[156:157], v[76:77], 0
v_pk_add_f32 v[158:159], v[78:79], 0
Lscd_59:
s_waitcnt lgkmcnt(0)
s_barrier
ds_read_b128 v[16:19], v248 offset:0
ds_read_b128 v[20:23], v248 offset:1024
ds_read_b128 v[24:27], v248 offset:2048
ds_read_b128 v[28:31], v248 offset:3072
ds_read_b128 v[32:35], v248 offset:4096
ds_read_b128 v[36:39], v248 offset:5120
ds_read_b128 v[40:43], v248 offset:6144
ds_read_b128 v[44:47], v248 offset:7168
ds_read_b128 v[48:51], v248 offset:8192
ds_read_b128 v[52:55], v248 offset:9216
ds_read_b128 v[56:59], v248 offset:10240
ds_read_b128 v[60:63], v248 offset:11264
s_waitcnt vmcnt(0)
v_permlane16_swap_b32 v240, v242
v_permlane16_swap_b32 v241, v243
v_permlane16_swap_b32 v244, v246
v_permlane16_swap_b32_e64 v245, v247
s_waitcnt lgkmcnt(8)
v_pk_add_f32 v[144:145], v[144:145], v[16:17]
v_pk_add_f32 v[146:147], v[146:147], v[18:19]
v_pk_add_f32 v[148:149], v[148:149], v[20:21]
v_pk_add_f32 v[150:151], v[150:151], v[22:23]
v_pk_add_f32 v[152:153], v[152:153], v[24:25]
v_pk_add_f32 v[154:155], v[154:155], v[26:27]
v_pk_add_f32 v[156:157], v[156:157], v[28:29]
v_pk_add_f32 v[158:159], v[158:159], v[30:31]
s_waitcnt lgkmcnt(4)
v_pk_add_f32 v[144:145], v[144:145], v[32:33]
v_pk_add_f32 v[146:147], v[146:147], v[34:35]
v_pk_add_f32 v[148:149], v[148:149], v[36:37]
v_pk_add_f32 v[150:151], v[150:151], v[38:39]
v_pk_add_f32 v[152:153], v[152:153], v[40:41]
v_pk_add_f32 v[154:155], v[154:155], v[42:43]
v_pk_add_f32 v[156:157], v[156:157], v[44:45]
v_pk_add_f32 v[158:159], v[158:159], v[46:47]
s_waitcnt lgkmcnt(0)
v_pk_add_f32 v[144:145], v[144:145], v[48:49]
v_pk_add_f32 v[146:147], v[146:147], v[50:51]
v_pk_add_f32 v[148:149], v[148:149], v[52:53]
v_pk_add_f32 v[150:151], v[150:151], v[54:55]
v_pk_add_f32 v[152:153], v[152:153], v[56:57]
v_pk_add_f32 v[154:155], v[154:155], v[58:59]
v_pk_add_f32 v[156:157], v[156:157], v[60:61]
v_pk_add_f32 v[158:159], v[158:159], v[62:63]
v_pk_mul_f32 v[144:145], v[144:145], v[8:9] op_sel_hi:[1,0]
v_pk_mul_f32 v[146:147], v[146:147], v[8:9] op_sel_hi:[1,0]
v_pk_mul_f32 v[148:149], v[148:149], v[8:9] op_sel:[0,1] op_sel_hi:[1,1]
v_pk_mul_f32 v[150:151], v[150:151], v[8:9] op_sel:[0,1] op_sel_hi:[1,1]
v_pk_mul_f32 v[152:153], v[152:153], v[8:9] op_sel_hi:[1,0]
v_pk_mul_f32 v[154:155], v[154:155], v[8:9] op_sel_hi:[1,0]
v_pk_mul_f32 v[156:157], v[156:157], v[8:9] op_sel:[0,1] op_sel_hi:[1,1]
v_pk_mul_f32 v[158:159], v[158:159], v[8:9] op_sel:[0,1] op_sel_hi:[1,1]
v_dot2c_f32_bf16 v144, s87, v240
v_dot2c_f32_bf16 v145, s88, v240
v_dot2c_f32_bf16 v146, s87, v241
v_dot2c_f32_bf16 v147, s88, v241
v_dot2c_f32_bf16 v148, s87, v242
v_dot2c_f32_bf16 v149, s88, v242
v_dot2c_f32_bf16 v150, s87, v243
v_dot2c_f32_bf16 v151, s88, v243
v_dot2c_f32_bf16 v152, s87, v244
v_dot2c_f32_bf16 v153, s88, v244
v_dot2c_f32_bf16 v154, s87, v245
v_dot2c_f32_bf16 v155, s88, v245
v_dot2c_f32_bf16 v156, s87, v246
v_dot2c_f32_bf16 v157, s88, v246
v_dot2c_f32_bf16 v158, s87, v247
v_dot2c_f32_bf16 v159, s88, v247
s_add_u32 s77, s79, 16384
v_cvt_pk_bf16_f32 v160, v144, v145
v_cvt_pk_bf16_f32 v161, v146, v147
v_cvt_pk_bf16_f32 v162, v152, v153
v_cvt_pk_bf16_f32 v163, v154, v155
s_nop 0
v_permlane16_swap_b32 v160, v162
v_permlane16_swap_b32_e64 v161, v163
buffer_store_dwordx4 v[160:163], v14, s[64:67], s79 offen
v_cvt_pk_bf16_f32 v164, v148, v149
v_cvt_pk_bf16_f32 v165, v150, v151
v_cvt_pk_bf16_f32 v166, v156, v157
v_cvt_pk_bf16_f32 v167, v158, v159
s_nop 0
v_permlane16_swap_b32 v164, v166
v_permlane16_swap_b32_e64 v165, v167
buffer_store_dwordx4 v[164:167], v14, s[64:67], s77 offen
L_end:
s_endpgm
L_slow:
s_waitcnt vmcnt(0) lgkmcnt(0)
s_barrier
s_lshr_b32 s69, s2, 4
s_and_b32 s70, s2, 15
s_lshl_b32 s71, s69, 2
s_add_u32 s71, s71, s68
s_and_b32 s72, s70, 7
s_lshr_b32 s73, s70, 3
s_lshr_b32 s74, s68, 1
s_and_b32 s75, s68, 1
v_lshrrev_b32 v7, 3, v0
v_lshrrev_b32 v11, 4, v0
v_xor_b32 v11, v11, v0
v_and_b32 v11, 7, v11
v_lshlrev_b32 v11, 4, v11
v_lshl_add_u32 v144, v7, 10, v11
v_xor_b32_e64 v145, 64, v144
s_lshl_b32 s89, s71, 15
s_lshl_b32 s90, s68, 14
s_add_u32 s90, s90, 67584
v_lshrrev_b32_e64 v7, 3, v0
v_mul_u32_u24 v7, 3072, v7
v_and_b32_e64 v154, 3, v0
v_lshl_add_u32 v7, v154, 4, v7
v_lshrrev_b32 v154, 2, v0
v_lshrrev_b32 v11, 4, v0
v_xor_b32 v154, v154, v11
v_and_b32 v154, 1, v154
v_mul_u32_u24 v154, 1024, v154
v_add_u32 v7, 1024, v7
v_add_u32_e64 v154, v154, v7
s_mul_i32 s97, s68, 98304
s_lshl_b32 s78, s70, 6
s_add_u32 s97, s97, s78
s_lshl_b32 s98, s68, 12
s_add_u32 m0, s90, 0
s_add_u32 s94, s89, 0
buffer_load_dwordx4 v144, s[28:31], s94 offen lds
s_add_u32 m0, s90, 1024
s_add_u32 s94, s89, 8192
buffer_load_dwordx4 v145, s[28:31], s94 offen lds
s_add_u32 m0, s90, 2048
s_add_u32 s94, s89, 16384
buffer_load_dwordx4 v144, s[28:31], s94 offen lds
s_add_u32 m0, s90, 3072
s_add_u32 s94, s89, 24576
buffer_load_dwordx4 v145, s[28:31], s94 offen lds
s_add_u32 m0, s90, 4096
s_add_u32 s94, s89, 128
buffer_load_dwordx4 v144, s[28:31], s94 offen lds
s_add_u32 m0, s90, 5120
s_add_u32 s94, s89, 8320
buffer_load_dwordx4 v145, s[28:31], s94 offen lds
s_mov_b32 m0, 157696
s_lshl_b32 s77, s70, 10
buffer_load_dwordx4 v1, s[44:47], s77 offen lds
v_bfe_u32 v7, v0, 2, 2
v_lshrrev_b32_e64 v11, 5, v0
v_lshl_add_u32 v12, v11, 3, v7
v_and_b32 v13, 1, v0
v_lshlrev_b32 v13, 4, v13
v_bfe_u32 v6, v0, 1, 1
v_lshl_add_u32 v13, v6, 3, v13
v_bfe_u32 v6, v0, 4, 1
v_lshl_add_u32 v13, v6, 5, v13
v_lshl_add_u32 v4, v12, 6, v13
v_add_u32 v4, 67584, v4
v_lshl_add_u32 v2, v12, 7, v13
v_lshrrev_b32_e64 v7, 1, v7
v_lshl_add_u32 v2, v7, 6, v2
v_xor_b32_e64 v3, 64, v2
s_add_u32 m0, s90, 6144
s_add_u32 s94, s89, 16512
buffer_load_dwordx4 v144, s[28:31], s94 offen lds
v_lshlrev_b32_e64 v10, 5, v11
v_add_u32 v10, 65536, v10
s_lshl_b32 s77, s71, 6
s_lshl_b32 s78, s70, 2
s_add_u32 s83, s77, s78
s_add_u32 s83, s83, 16384
s_mov_b32 s84, 0x3fb8aa3b
s_mov_b32 s85, 0x3fb8aa3b
s_mov_b32 s86, 0x3f803f80
s_mov_b32 s87, 0x3f80
s_mov_b32 s88, 0x3f800000
v_bfe_u32 v7, v0, 2, 1
v_cmp_eq_u32 vcc, v7, v11
v_and_b32 v7, 1, v0
v_lshlrev_b32_e64 v7, 4, v7
v_mov_b32 v12, 0x3f80
v_lshlrev_b32 v12, v7, v12
v_cndmask_b32 v12, 0, v12, vcc
v_bfe_u32 v7, v0, 1, 1
v_bfe_u32 v13, v0, 3, 2
v_lshl_add_u32 v7, v13, 1, v7
v_cmp_eq_u32 vcc, 0, v7
s_nop 1
v_cndmask_b32 v13, 0, v12, vcc
v_accvgpr_write_b32 a224, v13
s_add_u32 m0, s90, 7168
s_add_u32 s94, s89, 24704
buffer_load_dwordx4 v145, s[28:31], s94 offen lds
v_cmp_eq_u32 vcc, 1, v7
s_nop 1
v_cndmask_b32 v13, 0, v12, vcc
v_accvgpr_write_b32 a225, v13
v_cmp_eq_u32 vcc, 2, v7
s_nop 1
v_cndmask_b32 v13, 0, v12, vcc
v_accvgpr_write_b32 a226, v13
v_cmp_eq_u32 vcc, 3, v7
s_nop 1
v_cndmask_b32 v13, 0, v12, vcc
v_accvgpr_write_b32 a227, v13
v_cmp_eq_u32 vcc, 4, v7
s_nop 1
v_cndmask_b32 v13, 0, v12, vcc
v_accvgpr_write_b32 a228, v13
v_cmp_eq_u32 vcc, 5, v7
s_nop 1
v_cndmask_b32 v13, 0, v12, vcc
v_accvgpr_write_b32 a229, v13
s_add_u32 m0, s98, 0
s_add_u32 s94, s97, 0
buffer_load_dwordx4 v154, s[32:35], s94 offen lds
v_cmp_eq_u32 vcc, 6, v7
s_nop 1
v_cndmask_b32 v13, 0, v12, vcc
v_accvgpr_write_b32 a230, v13
v_cmp_eq_u32 vcc, 7, v7
s_nop 1
v_cndmask_b32 v13, 0, v12, vcc
v_accvgpr_write_b32 a231, v13
v_bfe_u32 v7, v0, 2, 2
v_lshrrev_b32_e64 v11, 5, v0
v_lshl_add_u32 v7, v11, 3, v7
v_and_b32 v11, 3, v0
v_lshlrev_b32 v11, 3, v11
v_lshl_add_u32 v7, v7, 5, v11
v_add_u32 v222, 157696, v7
v_bfe_u32 v11, v0, 4, 1
v_mul_u32_u24 v11, 0x8000, v11
s_add_u32 m0, s98, 1024
s_add_u32 s94, s97, 24576
buffer_load_dwordx4 v154, s[32:35], s94 offen lds
v_lshl_or_b32 v223, v11, 16, v11
v_and_b32_e64 v7, 31, v0
v_bfe_u32 v11, v0, 1, 3
v_lshrrev_b32 v6, 5, v0
v_xor_b32 v11, v11, v6
v_lshlrev_b32_e64 v11, 4, v11
v_lshl_add_u32 v11, v7, 7, v11
v_xor_b32 v146, 0, v11
v_add_u32 v146, s90, v146
v_xor_b32 v147, 32, v11
v_add_u32 v147, s90, v147
v_xor_b32 v148, 64, v11
v_add_u32 v148, s90, v148
v_xor_b32 v149, 96, v11
v_add_u32_e64 v149, s90, v149
s_add_u32 m0, s98, 2048
s_add_u32 s94, s97, 49152
buffer_load_dwordx4 v154, s[32:35], s94 offen lds
v_mov_b32 v150, 0
v_mov_b32 v151, 0
v_mov_b32 v152, 0
v_mov_b32 v153, 0
v_mov_b32 v156, 0
v_mov_b32 v157, 0
v_mov_b32 v158, 0
v_mov_b32 v159, 0
v_add_u32 v220, s98, v2
v_add_u32 v221, s98, v3
s_add_u32 m0, s98, 3072
s_add_u32 s94, s97, 73728
buffer_load_dwordx4 v154, s[32:35], s94 offen lds
s_add_u32 m0, s90, 8192
s_add_u32 s94, s89, 256
buffer_load_dwordx4 v144, s[28:31], s94 offen lds
s_add_u32 m0, s90, 9216
s_add_u32 s94, s89, 8448
buffer_load_dwordx4 v145, s[28:31], s94 offen lds
s_add_u32 m0, s90, 10240
s_add_u32 s94, s89, 16640
buffer_load_dwordx4 v144, s[28:31], s94 offen lds
s_add_u32 m0, s90, 11264
s_add_u32 s94, s89, 24832
buffer_load_dwordx4 v145, s[28:31], s94 offen lds
s_add_u32 m0, s90, 12288
s_add_u32 s94, s89, 384
buffer_load_dwordx4 v144, s[28:31], s94 offen lds
s_add_u32 m0, s90, 13312
s_add_u32 s94, s89, 8576
buffer_load_dwordx4 v145, s[28:31], s94 offen lds
s_add_u32 m0, s90, 14336
s_add_u32 s94, s89, 16768
buffer_load_dwordx4 v144, s[28:31], s94 offen lds
s_add_u32 m0, s90, 15360
s_add_u32 s94, s89, 24960
buffer_load_dwordx4 v145, s[28:31], s94 offen lds
s_waitcnt vmcnt(12)
ds_read_b128 v[16:19], v146 offset:0
ds_read_b128 v[20:23], v147 offset:0
ds_read_b128 v[24:27], v148 offset:0
ds_read_b128 v[28:31], v149 offset:0
ds_read_b128 v[32:35], v146 offset:4096
ds_read_b128 v[36:39], v147 offset:4096
ds_read_b128 v[40:43], v148 offset:4096
ds_read_b128 v[44:47], v149 offset:4096
s_waitcnt vmcnt(8)
ds_read_b64_tr_b16 v[224:225], v220 offset:0
ds_read_b64_tr_b16 v[226:227], v220 offset:512
ds_read_b64_tr_b16 v[228:229], v221 offset:0
ds_read_b64_tr_b16 v[230:231], v221 offset:512
ds_read_b64_tr_b16 v[232:233], v220 offset:2048
ds_read_b64_tr_b16 v[234:235], v220 offset:2560
ds_read_b64_tr_b16 v[236:237], v221 offset:2048
ds_read_b64_tr_b16 v[238:239], v221 offset:2560
s_barrier
s_waitcnt lgkmcnt(8)
ds_read_b64_tr_b16 v[192:193], v2 offset:0
ds_read_b64_tr_b16 v[194:195], v2 offset:512
ds_read_b64_tr_b16 v[196:197], v3 offset:0
ds_read_b64_tr_b16 v[198:199], v3 offset:512
ds_read_b64_tr_b16 v[200:201], v2 offset:2048
ds_read_b64_tr_b16 v[202:203], v2 offset:2560
ds_read_b64_tr_b16 v[204:205], v3 offset:2048
ds_read_b64_tr_b16 v[206:207], v3 offset:2560
v_dot2c_f32_bf16 v150, s86, v16
v_dot2c_f32_bf16 v152, v16, v16
v_dot2c_f32_bf16 v151, s86, v17
v_dot2c_f32_bf16 v153, v17, v17
v_dot2c_f32_bf16 v150, s86, v18
v_dot2c_f32_bf16 v152, v18, v18
v_dot2c_f32_bf16 v151, s86, v19
v_dot2c_f32_bf16 v153, v19, v19
v_dot2c_f32_bf16 v150, s86, v20
v_dot2c_f32_bf16 v152, v20, v20
v_dot2c_f32_bf16 v151, s86, v21
v_dot2c_f32_bf16 v153, v21, v21
v_dot2c_f32_bf16 v150, s86, v22
v_dot2c_f32_bf16 v152, v22, v22
v_dot2c_f32_bf16 v151, s86, v23
s_add_u32 m0, s98, 16384
s_add_u32 s94, s97, 393216
buffer_load_dwordx4 v154, s[32:35], s94 offen lds
v_dot2c_f32_bf16 v153, v23, v23
v_dot2c_f32_bf16 v150, s86, v24
v_dot2c_f32_bf16 v152, v24, v24
v_dot2c_f32_bf16 v151, s86, v25
v_dot2c_f32_bf16 v153, v25, v25
v_dot2c_f32_bf16 v150, s86, v26
v_dot2c_f32_bf16 v152, v26, v26
v_dot2c_f32_bf16 v151, s86, v27
v_dot2c_f32_bf16 v153, v27, v27
v_dot2c_f32_bf16 v150, s86, v28
v_dot2c_f32_bf16 v152, v28, v28
v_dot2c_f32_bf16 v151, s86, v29
v_dot2c_f32_bf16 v153, v29, v29
v_dot2c_f32_bf16 v150, s86, v30
v_dot2c_f32_bf16 v152, v30, v30
s_add_u32 m0, s98, 17408
s_add_u32 s94, s97, 417792
buffer_load_dwordx4 v154, s[32:35], s94 offen lds
v_dot2c_f32_bf16 v151, s86, v31
v_dot2c_f32_bf16 v153, v31, v31
v_dot2c_f32_bf16 v150, s86, v32
v_dot2c_f32_bf16 v152, v32, v32
v_dot2c_f32_bf16 v151, s86, v33
v_dot2c_f32_bf16 v153, v33, v33
v_dot2c_f32_bf16 v150, s86, v34
v_dot2c_f32_bf16 v152, v34, v34
v_dot2c_f32_bf16 v151, s86, v35
v_dot2c_f32_bf16 v153, v35, v35
v_dot2c_f32_bf16 v150, s86, v36
v_dot2c_f32_bf16 v152, v36, v36
v_dot2c_f32_bf16 v151, s86, v37
v_dot2c_f32_bf16 v153, v37, v37
v_dot2c_f32_bf16 v150, s86, v38
s_add_u32 m0, s98, 18432
s_add_u32 s94, s97, 442368
buffer_load_dwordx4 v154, s[32:35], s94 offen lds
v_dot2c_f32_bf16 v152, v38, v38
v_dot2c_f32_bf16 v151, s86, v39
v_dot2c_f32_bf16 v153, v39, v39
v_dot2c_f32_bf16 v150, s86, v40
v_dot2c_f32_bf16 v152, v40, v40
v_dot2c_f32_bf16 v151, s86, v41
v_dot2c_f32_bf16 v153, v41, v41
v_dot2c_f32_bf16 v150, s86, v42
v_dot2c_f32_bf16 v152, v42, v42
v_dot2c_f32_bf16 v151, s86, v43
v_dot2c_f32_bf16 v153, v43, v43
v_dot2c_f32_bf16 v150, s86, v44
v_dot2c_f32_bf16 v152, v44, v44
v_dot2c_f32_bf16 v151, s86, v45
v_dot2c_f32_bf16 v153, v45, v45
s_add_u32 m0, s98, 19456
s_add_u32 s94, s97, 466944
buffer_load_dwordx4 v154, s[32:35], s94 offen lds
v_dot2c_f32_bf16 v150, s86, v46
v_dot2c_f32_bf16 v152, v46, v46
v_dot2c_f32_bf16 v151, s86, v47
v_dot2c_f32_bf16 v153, v47, v47
s_waitcnt lgkmcnt(8)
v_dot2c_f32_bf16 v156, s86, v224
v_dot2c_f32_bf16 v157, s86, v225
v_dot2c_f32_bf16 v156, s86, v226
v_dot2c_f32_bf16 v157, s86, v227
v_dot2c_f32_bf16 v158, s86, v228
v_dot2c_f32_bf16 v159, s86, v229
v_dot2c_f32_bf16 v158, s86, v230
v_dot2c_f32_bf16 v159, s86, v231
v_dot2c_f32_bf16 v156, s86, v232
v_dot2c_f32_bf16 v157, s86, v233
v_dot2c_f32_bf16 v156, s86, v234
s_add_u32 m0, s90, 0
s_add_u32 s94, s89, 512
buffer_load_dwordx4 v144, s[28:31], s94 offen lds
v_dot2c_f32_bf16 v157, s86, v235
v_dot2c_f32_bf16 v158, s86, v236
v_dot2c_f32_bf16 v159, s86, v237
v_dot2c_f32_bf16 v158, s86, v238
v_dot2c_f32_bf16 v159, s86, v239
ds_read_b64_tr_b16 v[240:241], v222 offset:0
ds_read_b64_tr_b16 v[242:243], v222 offset:128
ds_read_b64_tr_b16 v[244:245], v222 offset:512
ds_read_b64_tr_b16 v[246:247], v222 offset:640
s_waitcnt lgkmcnt(8)
v_mfma_f32_32x32x16_bf16 v[160:175], v[192:195], v[16:19], 0
ds_read_b64_tr_b16 v[208:209], v2 offset:4096
ds_read_b64_tr_b16 v[210:211], v2 offset:4608
v_mfma_f32_32x32x16_bf16 v[176:191], v[196:199], v[16:19], 0
s_add_u32 m0, s90, 1024
s_add_u32 s94, s89, 8704
buffer_load_dwordx4 v145, s[28:31], s94 offen lds
ds_read_b64_tr_b16 v[212:213], v3 offset:4096
ds_read_b64_tr_b16 v[214:215], v3 offset:4608
s_waitcnt lgkmcnt(8)
v_mfma_f32_32x32x16_bf16 v[160:175], v[200:203], v[20:23], v[160:175]
ds_read_b64_tr_b16 v[192:193], v2 offset:6144
ds_read_b64_tr_b16 v[194:195], v2 offset:6656
v_mfma_f32_32x32x16_bf16 v[176:191], v[204:207], v[20:23], v[176:191]
s_add_u32 m0, s90, 2048
s_add_u32 s94, s89, 16896
buffer_load_dwordx4 v144, s[28:31], s94 offen lds
ds_read_b64_tr_b16 v[196:197], v3 offset:6144
ds_read_b64_tr_b16 v[198:199], v3 offset:6656
s_waitcnt lgkmcnt(4)
v_mfma_f32_32x32x16_bf16 v[160:175], v[208:211], v[24:27], v[160:175]
ds_read_b64_tr_b16 v[200:201], v2 offset:8192
ds_read_b64_tr_b16 v[202:203], v2 offset:8704
v_mfma_f32_32x32x16_bf16 v[176:191], v[212:215], v[24:27], v[176:191]
s_add_u32 m0, s90, 3072
s_add_u32 s94, s89, 25088
buffer_load_dwordx4 v145, s[28:31], s94 offen lds
ds_read_b64_tr_b16 v[204:205], v3 offset:8192
ds_read_b64_tr_b16 v[206:207], v3 offset:8704
s_waitcnt lgkmcnt(4)
v_mfma_f32_32x32x16_bf16 v[160:175], v[192:195], v[28:31], v[160:175]
ds_read_b64_tr_b16 v[208:209], v2 offset:10240
ds_read_b64_tr_b16 v[210:211], v2 offset:10752
v_xor_b32_e64 v240, v223, v240
v_accvgpr_write_b32 a232, v240
v_xor_b32_e64 v241, v223, v241
v_mfma_f32_32x32x16_bf16 v[176:191], v[196:199], v[28:31], v[176:191]
s_add_u32 m0, s90, 4096
s_add_u32 s94, s89, 640
buffer_load_dwordx4 v144, s[28:31], s94 offen lds
ds_read_b64_tr_b16 v[212:213], v3 offset:10240
ds_read_b64_tr_b16 v[214:215], v3 offset:10752
v_accvgpr_write_b32 a233, v241
v_xor_b32_e64 v242, v223, v242
v_accvgpr_write_b32 a234, v242
s_waitcnt lgkmcnt(4)
v_mfma_f32_32x32x16_bf16 v[160:175], v[200:203], v[32:35], v[160:175]
ds_read_b64_tr_b16 v[192:193], v2 offset:12288
ds_read_b64_tr_b16 v[194:195], v2 offset:12800
v_xor_b32 v243, v223, v243
v_accvgpr_write_b32 a235, v243
v_xor_b32_e64 v244, v223, v244
v_mfma_f32_32x32x16_bf16 v[176:191], v[204:207], v[32:35], v[176:191]
s_add_u32 m0, s90, 5120
s_add_u32 s94, s89, 8832
buffer_load_dwordx4 v145, s[28:31], s94 offen lds
ds_read_b64_tr_b16 v[196:197], v3 offset:12288
ds_read_b64_tr_b16 v[198:199], v3 offset:12800
v_accvgpr_write_b32 a236, v244
v_xor_b32_e64 v245, v223, v245
v_accvgpr_write_b32 a237, v245
s_waitcnt lgkmcnt(4)
v_mfma_f32_32x32x16_bf16 v[160:175], v[208:211], v[36:39], v[160:175]
ds_read_b64_tr_b16 v[200:201], v2 offset:14336
ds_read_b64_tr_b16 v[202:203], v2 offset:14848
v_xor_b32 v246, v223, v246
v_accvgpr_write_b32 a238, v246
v_xor_b32_e64 v247, v223, v247
v_mfma_f32_32x32x16_bf16 v[176:191], v[212:215], v[36:39], v[176:191]
s_add_u32 m0, s90, 6144
s_add_u32 s94, s89, 17024
buffer_load_dwordx4 v144, s[28:31], s94 offen lds
ds_read_b64_tr_b16 v[204:205], v3 offset:14336
ds_read_b64_tr_b16 v[206:207], v3 offset:14848
s_waitcnt vmcnt(11)
v_accvgpr_write_b32 a239, v247
s_waitcnt lgkmcnt(4)
v_mfma_f32_32x32x16_bf16 v[160:175], v[192:195], v[40:43], v[160:175]
ds_read_b128 v[48:51], v146 offset:8192
ds_read_b128 v[52:55], v147 offset:8192
v_mfma_f32_32x32x16_bf16 v[176:191], v[196:199], v[40:43], v[176:191]
s_add_u32 m0, s90, 7168
s_add_u32 s94, s89, 25216
buffer_load_dwordx4 v145, s[28:31], s94 offen lds
ds_read_b128 v[56:59], v148 offset:8192
ds_read_b128 v[60:63], v149 offset:8192
s_waitcnt lgkmcnt(4)
v_mfma_f32_32x32x16_bf16 v[160:175], v[200:203], v[44:47], v[160:175]
ds_read_b128 v[64:67], v146 offset:12288
ds_read_b128 v[68:71], v147 offset:12288
v_mfma_f32_32x32x16_bf16 v[176:191], v[204:207], v[44:47], v[176:191]
s_add_u32 m0, s98, 32768
s_add_u32 s94, s97, 786432
buffer_load_dwordx4 v154, s[32:35], s94 offen lds
ds_read_b128 v[72:75], v148 offset:12288
ds_read_b128 v[76:79], v149 offset:12288
s_waitcnt vmcnt(9)
ds_read_b64_tr_b16 v[224:225], v220 offset:16384
ds_read_b64_tr_b16 v[226:227], v220 offset:16896
ds_read_b64_tr_b16 v[228:229], v221 offset:16384
ds_read_b64_tr_b16 v[230:231], v221 offset:16896
ds_read_b64_tr_b16 v[232:233], v220 offset:18432
ds_read_b64_tr_b16 v[234:235], v220 offset:18944
ds_read_b64_tr_b16 v[236:237], v221 offset:18432
ds_read_b64_tr_b16 v[238:239], v221 offset:18944
s_barrier
s_waitcnt lgkmcnt(8)
ds_read_b64_tr_b16 v[208:209], v2 offset:16384
ds_read_b64_tr_b16 v[210:211], v2 offset:16896
ds_read_b64_tr_b16 v[212:213], v3 offset:16384
ds_read_b64_tr_b16 v[214:215], v3 offset:16896
ds_read_b64_tr_b16 v[192:193], v2 offset:18432
ds_read_b64_tr_b16 v[194:195], v2 offset:18944
ds_read_b64_tr_b16 v[196:197], v3 offset:18432
ds_read_b64_tr_b16 v[198:199], v3 offset:18944
v_dot2c_f32_bf16 v150, s86, v48
v_dot2c_f32_bf16 v152, v48, v48
v_dot2c_f32_bf16 v151, s86, v49
v_dot2c_f32_bf16 v153, v49, v49
v_dot2c_f32_bf16 v150, s86, v50
v_dot2c_f32_bf16 v152, v50, v50
v_dot2c_f32_bf16 v151, s86, v51
v_dot2c_f32_bf16 v153, v51, v51
v_dot2c_f32_bf16 v150, s86, v52
v_dot2c_f32_bf16 v152, v52, v52
v_dot2c_f32_bf16 v151, s86, v53
v_dot2c_f32_bf16 v153, v53, v53
v_dot2c_f32_bf16 v150, s86, v54
v_dot2c_f32_bf16 v152, v54, v54
v_dot2c_f32_bf16 v151, s86, v55
s_add_u32 m0, s98, 33792
s_add_u32 s94, s97, 811008
buffer_load_dwordx4 v154, s[32:35], s94 offen lds
v_dot2c_f32_bf16 v153, v55, v55
v_dot2c_f32_bf16 v150, s86, v56
v_dot2c_f32_bf16 v152, v56, v56
v_dot2c_f32_bf16 v151, s86, v57
v_dot2c_f32_bf16 v153, v57, v57
v_dot2c_f32_bf16 v150, s86, v58
v_dot2c_f32_bf16 v152, v58, v58
v_dot2c_f32_bf16 v151, s86, v59
v_dot2c_f32_bf16 v153, v59, v59
v_dot2c_f32_bf16 v150, s86, v60
v_dot2c_f32_bf16 v152, v60, v60
v_dot2c_f32_bf16 v151, s86, v61
v_dot2c_f32_bf16 v153, v61, v61
v_dot2c_f32_bf16 v150, s86, v62
v_dot2c_f32_bf16 v152, v62, v62
s_add_u32 m0, s98, 34816
s_add_u32 s94, s97, 835584
buffer_load_dwordx4 v154, s[32:35], s94 offen lds
v_dot2c_f32_bf16 v151, s86, v63
v_dot2c_f32_bf16 v153, v63, v63
v_dot2c_f32_bf16 v150, s86, v64
v_dot2c_f32_bf16 v152, v64, v64
v_dot2c_f32_bf16 v151, s86, v65
v_dot2c_f32_bf16 v153, v65, v65
v_dot2c_f32_bf16 v150, s86, v66
v_dot2c_f32_bf16 v152, v66, v66
v_dot2c_f32_bf16 v151, s86, v67
v_dot2c_f32_bf16 v153, v67, v67
v_dot2c_f32_bf16 v150, s86, v68
v_dot2c_f32_bf16 v152, v68, v68
v_dot2c_f32_bf16 v151, s86, v69
v_dot2c_f32_bf16 v153, v69, v69
v_dot2c_f32_bf16 v150, s86, v70
s_add_u32 m0, s98, 35840
s_add_u32 s94, s97, 860160
buffer_load_dwordx4 v154, s[32:35], s94 offen lds
v_dot2c_f32_bf16 v152, v70, v70
v_dot2c_f32_bf16 v151, s86, v71
v_dot2c_f32_bf16 v153, v71, v71
v_dot2c_f32_bf16 v150, s86, v72
v_dot2c_f32_bf16 v152, v72, v72
v_dot2c_f32_bf16 v151, s86, v73
v_dot2c_f32_bf16 v153, v73, v73
v_dot2c_f32_bf16 v150, s86, v74
v_dot2c_f32_bf16 v152, v74, v74
v_dot2c_f32_bf16 v151, s86, v75
v_dot2c_f32_bf16 v153, v75, v75
v_dot2c_f32_bf16 v150, s86, v76
v_dot2c_f32_bf16 v152, v76, v76
v_dot2c_f32_bf16 v151, s86, v77
v_dot2c_f32_bf16 v153, v77, v77
s_add_u32 m0, s90, 8192
s_add_u32 s94, s89, 768
buffer_load_dwordx4 v144, s[28:31], s94 offen lds
v_dot2c_f32_bf16 v150, s86, v78
v_dot2c_f32_bf16 v152, v78, v78
v_dot2c_f32_bf16 v151, s86, v79
v_dot2c_f32_bf16 v153, v79, v79
s_waitcnt lgkmcnt(8)
v_dot2c_f32_bf16 v156, s86, v224
v_dot2c_f32_bf16 v157, s86, v225
v_dot2c_f32_bf16 v156, s86, v226
v_dot2c_f32_bf16 v157, s86, v227
v_dot2c_f32_bf16 v158, s86, v228
v_dot2c_f32_bf16 v159, s86, v229
v_dot2c_f32_bf16 v158, s86, v230
v_dot2c_f32_bf16 v159, s86, v231
v_dot2c_f32_bf16 v156, s86, v232
v_dot2c_f32_bf16 v157, s86, v233
v_dot2c_f32_bf16 v156, s86, v234
s_add_u32 m0, s90, 9216
s_add_u32 s94, s89, 8960
buffer_load_dwordx4 v145, s[28:31], s94 offen lds
v_dot2c_f32_bf16 v157, s86, v235
v_dot2c_f32_bf16 v158, s86, v236
v_dot2c_f32_bf16 v159, s86, v237
v_dot2c_f32_bf16 v158, s86, v238
v_dot2c_f32_bf16 v159, s86, v239
s_waitcnt lgkmcnt(4)
v_mfma_f32_32x32x16_bf16 v[160:175], v[208:211], v[48:51], v[160:175]
ds_read_b64_tr_b16 v[200:201], v2 offset:20480
ds_read_b64_tr_b16 v[202:203], v2 offset:20992
v_mfma_f32_32x32x16_bf16 v[176:191], v[212:215], v[48:51], v[176:191]
s_add_u32 m0, s90, 10240
s_add_u32 s94, s89, 17152
buffer_load_dwordx4 v144, s[28:31], s94 offen lds
ds_read_b64_tr_b16 v[204:205], v3 offset:20480
ds_read_b64_tr_b16 v[206:207], v3 offset:20992
s_waitcnt lgkmcnt(4)
v_mfma_f32_32x32x16_bf16 v[160:175], v[192:195], v[52:55], v[160:175]
ds_read_b64_tr_b16 v[208:209], v2 offset:22528
ds_read_b64_tr_b16 v[210:211], v2 offset:23040
v_mfma_f32_32x32x16_bf16 v[176:191], v[196:199], v[52:55], v[176:191]
s_add_u32 m0, s90, 11264
s_add_u32 s94, s89, 25344
buffer_load_dwordx4 v145, s[28:31], s94 offen lds
ds_read_b64_tr_b16 v[212:213], v3 offset:22528
ds_read_b64_tr_b16 v[214:215], v3 offset:23040
s_waitcnt lgkmcnt(4)
v_mfma_f32_32x32x16_bf16 v[160:175], v[200:203], v[56:59], v[160:175]
ds_read_b64_tr_b16 v[192:193], v2 offset:24576
ds_read_b64_tr_b16 v[194:195], v2 offset:25088
v_mfma_f32_32x32x16_bf16 v[176:191], v[204:207], v[56:59], v[176:191]
s_add_u32 m0, s90, 12288
s_add_u32 s94, s89, 896
buffer_load_dwordx4 v144, s[28:31], s94 offen lds
ds_read_b64_tr_b16 v[196:197], v3 offset:24576
ds_read_b64_tr_b16 v[198:199], v3 offset:25088
s_waitcnt lgkmcnt(4)
v_mfma_f32_32x32x16_bf16 v[160:175], v[208:211], v[60:63], v[160:175]
ds_read_b64_tr_b16 v[200:201], v2 offset:26624
ds_read_b64_tr_b16 v[202:203], v2 offset:27136
v_mfma_f32_32x32x16_bf16 v[176:191], v[212:215], v[60:63], v[176:191]
s_add_u32 m0, s90, 13312
s_add_u32 s94, s89, 9088
buffer_load_dwordx4 v145, s[28:31], s94 offen lds
ds_read_b64_tr_b16 v[204:205], v3 offset:26624
ds_read_b64_tr_b16 v[206:207], v3 offset:27136
s_waitcnt lgkmcnt(4)
v_mfma_f32_32x32x16_bf16 v[160:175], v[192:195], v[64:67], v[160:175]
ds_read_b64_tr_b16 v[208:209], v2 offset:28672
ds_read_b64_tr_b16 v[210:211], v2 offset:29184
v_mfma_f32_32x32x16_bf16 v[176:191], v[196:199], v[64:67], v[176:191]
s_add_u32 m0, s90, 14336
s_add_u32 s94, s89, 17280
buffer_load_dwordx4 v144, s[28:31], s94 offen lds
ds_read_b64_tr_b16 v[212:213], v3 offset:28672
ds_read_b64_tr_b16 v[214:215], v3 offset:29184
s_waitcnt lgkmcnt(4)
v_mfma_f32_32x32x16_bf16 v[160:175], v[200:203], v[68:71], v[160:175]
ds_read_b64_tr_b16 v[192:193], v2 offset:30720
ds_read_b64_tr_b16 v[194:195], v2 offset:31232
v_mfma_f32_32x32x16_bf16 v[176:191], v[204:207], v[68:71], v[176:191]
s_add_u32 m0, s90, 15360
s_add_u32 s94, s89, 25472
buffer_load_dwordx4 v145, s[28:31], s94 offen lds
ds_read_b64_tr_b16 v[196:197], v3 offset:30720
ds_read_b64_tr_b16 v[198:199], v3 offset:31232
s_waitcnt vmcnt(12)
s_waitcnt lgkmcnt(4)
v_mfma_f32_32x32x16_bf16 v[160:175], v[208:211], v[72:75], v[160:175]
ds_read_b128 v[80:83], v146 offset:0
ds_read_b128 v[84:87], v147 offset:0
v_mfma_f32_32x32x16_bf16 v[176:191], v[212:215], v[72:75], v[176:191]
s_add_u32 m0, s98, 49152
s_add_u32 s94, s97, 1179648
buffer_load_dwordx4 v154, s[32:35], s94 offen lds
ds_read_b128 v[88:91], v148 offset:0
ds_read_b128 v[92:95], v149 offset:0
s_waitcnt lgkmcnt(4)
v_mfma_f32_32x32x16_bf16 v[160:175], v[192:195], v[76:79], v[160:175]
ds_read_b128 v[96:99], v146 offset:4096
ds_read_b128 v[100:103], v147 offset:4096
v_mfma_f32_32x32x16_bf16 v[176:191], v[196:199], v[76:79], v[176:191]
s_add_u32 m0, s98, 50176
s_add_u32 s94, s97, 1204224
buffer_load_dwordx4 v154, s[32:35], s94 offen lds
ds_read_b128 v[104:107], v148 offset:4096
ds_read_b128 v[108:111], v149 offset:4096
s_waitcnt vmcnt(10)
ds_read_b64_tr_b16 v[224:225], v220 offset:32768
ds_read_b64_tr_b16 v[226:227], v220 offset:33280
ds_read_b64_tr_b16 v[228:229], v221 offset:32768
ds_read_b64_tr_b16 v[230:231], v221 offset:33280
ds_read_b64_tr_b16 v[232:233], v220 offset:34816
ds_read_b64_tr_b16 v[234:235], v220 offset:35328
ds_read_b64_tr_b16 v[236:237], v221 offset:34816
ds_read_b64_tr_b16 v[238:239], v221 offset:35328
s_barrier
s_waitcnt lgkmcnt(8)
ds_read_b64_tr_b16 v[200:201], v2 offset:32768
ds_read_b64_tr_b16 v[202:203], v2 offset:33280
ds_read_b64_tr_b16 v[204:205], v3 offset:32768
ds_read_b64_tr_b16 v[206:207], v3 offset:33280
ds_read_b64_tr_b16 v[208:209], v2 offset:34816
ds_read_b64_tr_b16 v[210:211], v2 offset:35328
ds_read_b64_tr_b16 v[212:213], v3 offset:34816
ds_read_b64_tr_b16 v[214:215], v3 offset:35328
v_dot2c_f32_bf16 v150, s86, v80
v_dot2c_f32_bf16 v152, v80, v80
v_dot2c_f32_bf16 v151, s86, v81
v_dot2c_f32_bf16 v153, v81, v81
v_dot2c_f32_bf16 v150, s86, v82
v_dot2c_f32_bf16 v152, v82, v82
v_dot2c_f32_bf16 v151, s86, v83
v_dot2c_f32_bf16 v153, v83, v83
v_dot2c_f32_bf16 v150, s86, v84
v_dot2c_f32_bf16 v152, v84, v84
v_dot2c_f32_bf16 v151, s86, v85
v_dot2c_f32_bf16 v153, v85, v85
v_dot2c_f32_bf16 v150, s86, v86
v_dot2c_f32_bf16 v152, v86, v86
v_dot2c_f32_bf16 v151, s86, v87
s_add_u32 m0, s98, 51200
s_add_u32 s94, s97, 1228800
buffer_load_dwordx4 v154, s[32:35], s94 offen lds
v_dot2c_f32_bf16 v153, v87, v87
v_dot2c_f32_bf16 v150, s86, v88
v_dot2c_f32_bf16 v152, v88, v88
v_dot2c_f32_bf16 v151, s86, v89
v_dot2c_f32_bf16 v153, v89, v89
v_dot2c_f32_bf16 v150, s86, v90
v_dot2c_f32_bf16 v152, v90, v90
v_dot2c_f32_bf16 v151, s86, v91
v_dot2c_f32_bf16 v153, v91, v91
v_dot2c_f32_bf16 v150, s86, v92
v_dot2c_f32_bf16 v152, v92, v92
v_dot2c_f32_bf16 v151, s86, v93
v_dot2c_f32_bf16 v153, v93, v93
v_dot2c_f32_bf16 v150, s86, v94
v_dot2c_f32_bf16 v152, v94, v94
s_add_u32 m0, s98, 52224
s_add_u32 s94, s97, 1253376
buffer_load_dwordx4 v154, s[32:35], s94 offen lds
v_dot2c_f32_bf16 v151, s86, v95
v_dot2c_f32_bf16 v153, v95, v95
v_dot2c_f32_bf16 v150, s86, v96
v_dot2c_f32_bf16 v152, v96, v96
v_dot2c_f32_bf16 v151, s86, v97
v_dot2c_f32_bf16 v153, v97, v97
v_dot2c_f32_bf16 v150, s86, v98
v_dot2c_f32_bf16 v152, v98, v98
v_dot2c_f32_bf16 v151, s86, v99
v_dot2c_f32_bf16 v153, v99, v99
v_dot2c_f32_bf16 v150, s86, v100
v_dot2c_f32_bf16 v152, v100, v100
v_dot2c_f32_bf16 v151, s86, v101
v_dot2c_f32_bf16 v153, v101, v101
v_dot2c_f32_bf16 v150, s86, v102
v_dot2c_f32_bf16 v152, v102, v102
v_dot2c_f32_bf16 v151, s86, v103
v_dot2c_f32_bf16 v153, v103, v103
v_dot2c_f32_bf16 v150, s86, v104
v_dot2c_f32_bf16 v152, v104, v104
v_dot2c_f32_bf16 v151, s86, v105
v_dot2c_f32_bf16 v153, v105, v105
v_dot2c_f32_bf16 v150, s86, v106
v_dot2c_f32_bf16 v152, v106, v106
v_dot2c_f32_bf16 v151, s86, v107
v_dot2c_f32_bf16 v153, v107, v107
v_dot2c_f32_bf16 v150, s86, v108
v_dot2c_f32_bf16 v152, v108, v108
v_dot2c_f32_bf16 v151, s86, v109
v_dot2c_f32_bf16 v153, v109, v109
v_dot2c_f32_bf16 v150, s86, v110
v_dot2c_f32_bf16 v152, v110, v110
v_dot2c_f32_bf16 v151, s86, v111
v_dot2c_f32_bf16 v153, v111, v111
s_waitcnt lgkmcnt(8)
v_dot2c_f32_bf16 v156, s86, v224
v_dot2c_f32_bf16 v157, s86, v225
v_dot2c_f32_bf16 v156, s86, v226
v_dot2c_f32_bf16 v157, s86, v227
v_dot2c_f32_bf16 v158, s86, v228
v_dot2c_f32_bf16 v159, s86, v229
v_dot2c_f32_bf16 v158, s86, v230
v_dot2c_f32_bf16 v159, s86, v231
v_dot2c_f32_bf16 v156, s86, v232
v_dot2c_f32_bf16 v157, s86, v233
v_dot2c_f32_bf16 v156, s86, v234
v_dot2c_f32_bf16 v157, s86, v235
v_dot2c_f32_bf16 v158, s86, v236
v_dot2c_f32_bf16 v159, s86, v237
v_dot2c_f32_bf16 v158, s86, v238
v_dot2c_f32_bf16 v159, s86, v239
s_waitcnt lgkmcnt(4)
v_mfma_f32_32x32x16_bf16 v[160:175], v[200:203], v[80:83], v[160:175]
ds_read_b64_tr_b16 v[192:193], v2 offset:36864
ds_read_b64_tr_b16 v[194:195], v2 offset:37376
v_mfma_f32_32x32x16_bf16 v[176:191], v[204:207], v[80:83], v[176:191]
ds_read_b64_tr_b16 v[196:197], v3 offset:36864
ds_read_b64_tr_b16 v[198:199], v3 offset:37376
s_waitcnt lgkmcnt(4)
v_mfma_f32_32x32x16_bf16 v[160:175], v[208:211], v[84:87], v[160:175]
ds_read_b64_tr_b16 v[200:201], v2 offset:38912
ds_read_b64_tr_b16 v[202:203], v2 offset:39424
v_mfma_f32_32x32x16_bf16 v[176:191], v[212:215], v[84:87], v[176:191]
ds_read_b64_tr_b16 v[204:205], v3 offset:38912
ds_read_b64_tr_b16 v[206:207], v3 offset:39424
s_waitcnt lgkmcnt(4)
v_mfma_f32_32x32x16_bf16 v[160:175], v[192:195], v[88:91], v[160:175]
ds_read_b64_tr_b16 v[208:209], v2 offset:40960
ds_read_b64_tr_b16 v[210:211], v2 offset:41472
v_mfma_f32_32x32x16_bf16 v[176:191], v[196:199], v[88:91], v[176:191]
ds_read_b64_tr_b16 v[212:213], v3 offset:40960
ds_read_b64_tr_b16 v[214:215], v3 offset:41472
s_waitcnt lgkmcnt(4)
v_mfma_f32_32x32x16_bf16 v[160:175], v[200:203], v[92:95], v[160:175]
ds_read_b64_tr_b16 v[192:193], v2 offset:43008
ds_read_b64_tr_b16 v[194:195], v2 offset:43520
v_mfma_f32_32x32x16_bf16 v[176:191], v[204:207], v[92:95], v[176:191]
ds_read_b64_tr_b16 v[196:197], v3 offset:43008
ds_read_b64_tr_b16 v[198:199], v3 offset:43520
s_waitcnt lgkmcnt(4)
v_mfma_f32_32x32x16_bf16 v[160:175], v[208:211], v[96:99], v[160:175]
ds_read_b64_tr_b16 v[200:201], v2 offset:45056
ds_read_b64_tr_b16 v[202:203], v2 offset:45568
v_mfma_f32_32x32x16_bf16 v[176:191], v[212:215], v[96:99], v[176:191]
ds_read_b64_tr_b16 v[204:205], v3 offset:45056
ds_read_b64_tr_b16 v[206:207], v3 offset:45568
s_waitcnt lgkmcnt(4)
v_mfma_f32_32x32x16_bf16 v[160:175], v[192:195], v[100:103], v[160:175]
ds_read_b64_tr_b16 v[208:209], v2 offset:47104
ds_read_b64_tr_b16 v[210:211], v2 offset:47616
v_mfma_f32_32x32x16_bf16 v[176:191], v[196:199], v[100:103], v[176:191]
ds_read_b64_tr_b16 v[212:213], v3 offset:47104
ds_read_b64_tr_b16 v[214:215], v3 offset:47616
s_waitcnt vmcnt(4)
s_waitcnt lgkmcnt(4)
v_mfma_f32_32x32x16_bf16 v[160:175], v[200:203], v[104:107], v[160:175]
ds_read_b128 v[112:115], v146 offset:8192
ds_read_b128 v[116:119], v147 offset:8192
v_mfma_f32_32x32x16_bf16 v[176:191], v[204:207], v[104:107], v[176:191]
ds_read_b128 v[120:123], v148 offset:8192
ds_read_b128 v[124:127], v149 offset:8192
s_waitcnt lgkmcnt(4)
v_mfma_f32_32x32x16_bf16 v[160:175], v[208:211], v[108:111], v[160:175]
ds_read_b128 v[128:131], v146 offset:12288
ds_read_b128 v[132:135], v147 offset:12288
v_mfma_f32_32x32x16_bf16 v[176:191], v[212:215], v[108:111], v[176:191]
ds_read_b128 v[136:139], v148 offset:12288
ds_read_b128 v[140:143], v149 offset:12288
s_waitcnt vmcnt(0)
ds_read_b64_tr_b16 v[224:225], v220 offset:49152
ds_read_b64_tr_b16 v[226:227], v220 offset:49664
ds_read_b64_tr_b16 v[228:229], v221 offset:49152
ds_read_b64_tr_b16 v[230:231], v221 offset:49664
ds_read_b64_tr_b16 v[232:233], v220 offset:51200
ds_read_b64_tr_b16 v[234:235], v220 offset:51712
ds_read_b64_tr_b16 v[236:237], v221 offset:51200
ds_read_b64_tr_b16 v[238:239], v221 offset:51712
s_barrier
s_waitcnt lgkmcnt(8)
ds_read_b64_tr_b16 v[192:193], v2 offset:49152
ds_read_b64_tr_b16 v[194:195], v2 offset:49664
ds_read_b64_tr_b16 v[196:197], v3 offset:49152
ds_read_b64_tr_b16 v[198:199], v3 offset:49664
ds_read_b64_tr_b16 v[200:201], v2 offset:51200
ds_read_b64_tr_b16 v[202:203], v2 offset:51712
ds_read_b64_tr_b16 v[204:205], v3 offset:51200
ds_read_b64_tr_b16 v[206:207], v3 offset:51712
v_dot2c_f32_bf16 v150, s86, v112
v_dot2c_f32_bf16 v152, v112, v112
v_dot2c_f32_bf16 v151, s86, v113
v_dot2c_f32_bf16 v153, v113, v113
v_dot2c_f32_bf16 v150, s86, v114
v_dot2c_f32_bf16 v152, v114, v114
v_dot2c_f32_bf16 v151, s86, v115
v_dot2c_f32_bf16 v153, v115, v115
v_dot2c_f32_bf16 v150, s86, v116
v_dot2c_f32_bf16 v152, v116, v116
v_dot2c_f32_bf16 v151, s86, v117
v_dot2c_f32_bf16 v153, v117, v117
v_dot2c_f32_bf16 v150, s86, v118
v_dot2c_f32_bf16 v152, v118, v118
v_dot2c_f32_bf16 v151, s86, v119
v_dot2c_f32_bf16 v153, v119, v119
v_dot2c_f32_bf16 v150, s86, v120
v_dot2c_f32_bf16 v152, v120, v120
v_dot2c_f32_bf16 v151, s86, v121
v_dot2c_f32_bf16 v153, v121, v121
v_dot2c_f32_bf16 v150, s86, v122
v_dot2c_f32_bf16 v152, v122, v122
v_dot2c_f32_bf16 v151, s86, v123
v_dot2c_f32_bf16 v153, v123, v123
v_dot2c_f32_bf16 v150, s86, v124
v_dot2c_f32_bf16 v152, v124, v124
v_dot2c_f32_bf16 v151, s86, v125
v_dot2c_f32_bf16 v153, v125, v125
v_dot2c_f32_bf16 v150, s86, v126
v_dot2c_f32_bf16 v152, v126, v126
v_dot2c_f32_bf16 v151, s86, v127
v_dot2c_f32_bf16 v153, v127, v127
v_dot2c_f32_bf16 v150, s86, v128
v_dot2c_f32_bf16 v152, v128, v128
v_dot2c_f32_bf16 v151, s86, v129
v_dot2c_f32_bf16 v153, v129, v129
v_dot2c_f32_bf16 v150, s86, v130
v_dot2c_f32_bf16 v152, v130, v130
v_dot2c_f32_bf16 v151, s86, v131
v_dot2c_f32_bf16 v153, v131, v131
v_dot2c_f32_bf16 v150, s86, v132
v_dot2c_f32_bf16 v152, v132, v132
v_dot2c_f32_bf16 v151, s86, v133
v_dot2c_f32_bf16 v153, v133, v133
v_dot2c_f32_bf16 v150, s86, v134
v_dot2c_f32_bf16 v152, v134, v134
v_dot2c_f32_bf16 v151, s86, v135
v_dot2c_f32_bf16 v153, v135, v135
v_dot2c_f32_bf16 v150, s86, v136
v_dot2c_f32_bf16 v152, v136, v136
v_dot2c_f32_bf16 v151, s86, v137
v_dot2c_f32_bf16 v153, v137, v137
v_dot2c_f32_bf16 v150, s86, v138
v_dot2c_f32_bf16 v152, v138, v138
v_dot2c_f32_bf16 v151, s86, v139
v_dot2c_f32_bf16 v153, v139, v139
v_dot2c_f32_bf16 v150, s86, v140
v_dot2c_f32_bf16 v152, v140, v140
v_dot2c_f32_bf16 v151, s86, v141
v_dot2c_f32_bf16 v153, v141, v141
v_dot2c_f32_bf16 v150, s86, v142
v_dot2c_f32_bf16 v152, v142, v142
v_dot2c_f32_bf16 v151, s86, v143
v_dot2c_f32_bf16 v153, v143, v143
s_waitcnt lgkmcnt(8)
v_dot2c_f32_bf16 v156, s86, v224
v_dot2c_f32_bf16 v157, s86, v225
v_dot2c_f32_bf16 v156, s86, v226
v_dot2c_f32_bf16 v157, s86, v227
v_dot2c_f32_bf16 v158, s86, v228
v_dot2c_f32_bf16 v159, s86, v229
v_dot2c_f32_bf16 v158, s86, v230
v_dot2c_f32_bf16 v159, s86, v231
v_dot2c_f32_bf16 v156, s86, v232
v_dot2c_f32_bf16 v157, s86, v233
v_dot2c_f32_bf16 v156, s86, v234
v_dot2c_f32_bf16 v157, s86, v235
v_dot2c_f32_bf16 v158, s86, v236
v_dot2c_f32_bf16 v159, s86, v237
v_dot2c_f32_bf16 v158, s86, v238
v_dot2c_f32_bf16 v159, s86, v239
s_waitcnt lgkmcnt(4)
v_mfma_f32_32x32x16_bf16 v[160:175], v[192:195], v[112:115], v[160:175]
ds_read_b64_tr_b16 v[208:209], v2 offset:53248
ds_read_b64_tr_b16 v[210:211], v2 offset:53760
v_add_f32 v150, v150, v151
v_add_f32 v152, v152, v153
s_nop 1
v_permlane32_swap_b32 v150, v152
v_mfma_f32_32x32x16_bf16 v[176:191], v[196:199], v[112:115], v[176:191]
ds_read_b64_tr_b16 v[212:213], v3 offset:53248
ds_read_b64_tr_b16 v[214:215], v3 offset:53760
v_add_f32 v150, v150, v152
v_mov_b32 v152, v150
s_nop 1
v_permlane32_swap_b32_e64 v150, v152
s_waitcnt lgkmcnt(4)
v_mfma_f32_32x32x16_bf16 v[160:175], v[200:203], v[116:119], v[160:175]
ds_read_b64_tr_b16 v[192:193], v2 offset:55296
ds_read_b64_tr_b16 v[194:195], v2 offset:55808
v_mul_f32 v8, -0.001953125, v150
v_mul_f32 v152, 0.001953125, v152
v_fma_f32 v152, -v8, v8, v152
v_mfma_f32_32x32x16_bf16 v[176:191], v[204:207], v[116:119], v[176:191]
ds_read_b64_tr_b16 v[196:197], v3 offset:55296
ds_read_b64_tr_b16 v[198:199], v3 offset:55808
v_max_f32_e64 v152, 0, v152
v_add_f32 v152, 0x3727c5ac, v152
v_rsq_f32 v9, v152
s_waitcnt lgkmcnt(4)
v_mfma_f32_32x32x16_bf16 v[160:175], v[208:211], v[120:123], v[160:175]
ds_read_b64_tr_b16 v[200:201], v2 offset:57344
ds_read_b64_tr_b16 v[202:203], v2 offset:57856
v_and_b32_e64 v7, 19, v0
v_bfe_u32 v11, v0, 2, 1
v_lshl_add_u32 v7, v11, 3, v7
v_mfma_f32_32x32x16_bf16 v[176:191], v[212:215], v[120:123], v[176:191]
ds_read_b64_tr_b16 v[204:205], v3 offset:57344
ds_read_b64_tr_b16 v[206:207], v3 offset:57856
v_bfe_u32 v11, v0, 3, 1
v_lshl_add_u32 v7, v11, 2, v7
v_lshlrev_b32 v11, 2, v7
s_waitcnt lgkmcnt(4)
v_mfma_f32_32x32x16_bf16 v[160:175], v[192:195], v[124:127], v[160:175]
ds_read_b64_tr_b16 v[208:209], v2 offset:59392
ds_read_b64_tr_b16 v[210:211], v2 offset:59904
s_mul_i32 s77, s68, 256
s_add_u32 s77, s77, 158720
v_add_u32_e64 v11, s77, v11
v_mfma_f32_32x32x16_bf16 v[176:191], v[196:199], v[124:127], v[176:191]
ds_read_b64_tr_b16 v[212:213], v3 offset:59392
ds_read_b64_tr_b16 v[214:215], v3 offset:59904
v_add_f32 v156, v156, v157
v_mov_b32 v157, v156
s_nop 1
v_permlane32_swap_b32_e64 v156, v157
s_waitcnt lgkmcnt(4)
v_mfma_f32_32x32x16_bf16 v[160:175], v[200:203], v[128:131], v[160:175]
ds_read_b64_tr_b16 v[192:193], v2 offset:61440
ds_read_b64_tr_b16 v[194:195], v2 offset:61952
v_add_f32 v156, v156, v157
v_add_f32 v158, v158, v159
v_mov_b32_e64 v159, v158
v_mfma_f32_32x32x16_bf16 v[176:191], v[204:207], v[128:131], v[176:191]
ds_read_b64_tr_b16 v[196:197], v3 offset:61440
ds_read_b64_tr_b16 v[198:199], v3 offset:61952
v_permlane32_swap_b32 v158, v159
v_add_f32 v158, v158, v159
s_lshl_b32 s77, s70, 4
s_waitcnt lgkmcnt(4)
v_mfma_f32_32x32x16_bf16 v[160:175], v[208:211], v[132:135], v[160:175]
ds_read_b64_tr_b16 v[200:201], v2 offset:63488
ds_read_b64_tr_b16 v[202:203], v2 offset:64000
s_add_u32 s77, s77, s69
s_mul_i32 s77, s77, 2304
s_add_u32 s20, s77, 2359296
v_mfma_f32_32x32x16_bf16 v[176:191], v[212:215], v[132:135], v[176:191]
ds_read_b64_tr_b16 v[204:205], v3 offset:63488
ds_read_b64_tr_b16 v[206:207], v3 offset:64000
s_lshl_b32 s78, s68, 9
s_add_u32 s21, s78, s20
s_lshl_b32 s77, s70, 8
s_waitcnt lgkmcnt(4)
v_mfma_f32_32x32x16_bf16 v[160:175], v[192:195], v[136:139], v[160:175]
s_lshl_b32 s78, s68, 6
s_add_u32 s77, s77, s78
s_add_u32 s23, s77, 20480
v_mfma_f32_32x32x16_bf16 v[176:191], v[196:199], v[136:139], v[176:191]
s_lshl_b32 s78, s69, 2
s_add_u32 s22, s23, s78
s_lshl_b32 s24, s68, 8
s_waitcnt lgkmcnt(0)
v_mfma_f32_32x32x16_bf16 v[160:175], v[200:203], v[140:143], v[160:175]
s_add_u32 s24, s24, 112640
s_mul_i32 s25, s68, 3072
s_add_u32 s25, s25, 100352
v_mfma_f32_32x32x16_bf16 v[176:191], v[204:207], v[140:143], v[176:191]
ds_write_b32 v11, v156 offset:0
ds_write_b32 v11, v158 offset:128
v_lshrrev_b32 v7, 2, v0
v_mul_u32_u24 v7, 3072, v7
v_and_b32_e64 v5, 3, v0
v_lshl_add_u32 v5, v5, 4, v7
s_mul_i32 s95, s68, 393216
s_lshl_b32 s78, s70, 6
s_add_u32 s95, s95, s78
s_lshl_b32 s96, s68, 13
s_waitcnt lgkmcnt(0)
s_barrier
v_lshlrev_b32 v7, 2, v0
v_add_u32 v11, 158720, v7
ds_read_b32 v224, v11 offset:0
ds_read_b32 v225, v11 offset:256
ds_read_b32 v226, v11 offset:512
ds_read_b32 v227, v11 offset:768
v_add_u32 v11, 65536, v7
s_waitcnt lgkmcnt(0)
v_add_f32 v224, v224, v225
v_add_f32 v226, v226, v227
v_add_f32 v224, v224, v226
ds_write_b32 v11, v224
ds_read_b128 v[192:195], v10 offset:0
ds_read_b128 v[196:199], v10 offset:16
ds_read_b128 v[200:203], v10 offset:64
ds_read_b128 v[204:207], v10 offset:80
ds_read_b128 v[208:211], v10 offset:128
ds_read_b128 v[212:215], v10 offset:144
ds_read_b128 v[216:219], v10 offset:192
ds_read_b128 v[220:223], v10 offset:208
s_waitcnt lgkmcnt(4)
v_pk_fma_f32 v[160:161], v[192:193], v[8:9], v[160:161] op_sel_hi:[1,0,1]
s_add_u32 m0, s96, 67584
s_add_u32 s94, s95, 0
buffer_load_dwordx4 v5, s[32:35], s94 offen lds
v_pk_fma_f32 v[162:163], v[194:195], v[8:9], v[162:163] op_sel_hi:[1,0,1]
v_pk_fma_f32 v[164:165], v[196:197], v[8:9], v[164:165] op_sel_hi:[1,0,1]
v_pk_fma_f32 v[166:167], v[198:199], v[8:9], v[166:167] op_sel_hi:[1,0,1]
v_pk_fma_f32 v[168:169], v[200:201], v[8:9], v[168:169] op_sel_hi:[1,0,1]
v_pk_fma_f32 v[170:171], v[202:203], v[8:9], v[170:171] op_sel_hi:[1,0,1]
v_pk_fma_f32 v[172:173], v[204:205], v[8:9], v[172:173] op_sel_hi:[1,0,1]
v_pk_fma_f32 v[174:175], v[206:207], v[8:9], v[174:175] op_sel_hi:[1,0,1]
v_pk_mul_f32 v[160:161], v[160:161], v[8:9] op_sel:[0,1] op_sel_hi:[1,1]
v_pk_mul_f32 v[162:163], v[162:163], v[8:9] op_sel:[0,1] op_sel_hi:[1,1]
v_pk_mul_f32 v[164:165], v[164:165], v[8:9] op_sel:[0,1] op_sel_hi:[1,1]
v_pk_mul_f32 v[166:167], v[166:167], v[8:9] op_sel:[0,1] op_sel_hi:[1,1]
v_pk_mul_f32 v[168:169], v[168:169], v[8:9] op_sel:[0,1] op_sel_hi:[1,1]
v_pk_mul_f32 v[170:171], v[170:171], v[8:9] op_sel:[0,1] op_sel_hi:[1,1]
v_pk_mul_f32 v[172:173], v[172:173], v[8:9] op_sel:[0,1] op_sel_hi:[1,1]
v_pk_mul_f32 v[174:175], v[174:175], v[8:9] op_sel:[0,1] op_sel_hi:[1,1]
s_waitcnt lgkmcnt(0)
v_pk_fma_f32 v[176:177], v[208:209], v[8:9], v[176:177] op_sel_hi:[1,0,1]
v_pk_fma_f32 v[178:179], v[210:211], v[8:9], v[178:179] op_sel_hi:[1,0,1]
v_pk_fma_f32 v[180:181], v[212:213], v[8:9], v[180:181] op_sel_hi:[1,0,1]
v_pk_fma_f32 v[182:183], v[214:215], v[8:9], v[182:183] op_sel_hi:[1,0,1]
v_pk_fma_f32 v[184:185], v[216:217], v[8:9], v[184:185] op_sel_hi:[1,0,1]
v_pk_fma_f32 v[186:187], v[218:219], v[8:9], v[186:187] op_sel_hi:[1,0,1]
v_pk_fma_f32 v[188:189], v[220:221], v[8:9], v[188:189] op_sel_hi:[1,0,1]
v_pk_fma_f32 v[190:191], v[222:223], v[8:9], v[190:191] op_sel_hi:[1,0,1]
v_pk_mul_f32 v[176:177], v[176:177], v[8:9] op_sel:[0,1] op_sel_hi:[1,1]
v_pk_mul_f32 v[178:179], v[178:179], v[8:9] op_sel:[0,1] op_sel_hi:[1,1]
s_add_u32 m0, s96, 68608
s_add_u32 s94, s95, 49152
buffer_load_dwordx4 v5, s[32:35], s94 offen lds
v_pk_mul_f32 v[180:181], v[180:181], v[8:9] op_sel:[0,1] op_sel_hi:[1,1]
v_pk_mul_f32 v[182:183], v[182:183], v[8:9] op_sel:[0,1] op_sel_hi:[1,1]
v_pk_mul_f32 v[184:185], v[184:185], v[8:9] op_sel:[0,1] op_sel_hi:[1,1]
v_pk_mul_f32 v[186:187], v[186:187], v[8:9] op_sel:[0,1] op_sel_hi:[1,1]
v_pk_mul_f32 v[188:189], v[188:189], v[8:9] op_sel:[0,1] op_sel_hi:[1,1]
v_pk_mul_f32 v[190:191], v[190:191], v[8:9] op_sel:[0,1] op_sel_hi:[1,1]
v_cvt_pk_bf16_f32 v224, v160, v161
v_cvt_pk_bf16_f32 v225, v162, v163
v_cvt_pk_bf16_f32 v226, v164, v165
v_cvt_pk_bf16_f32 v227, v166, v167
v_cvt_pk_bf16_f32 v228, v168, v169
v_cvt_pk_bf16_f32 v229, v170, v171
v_cvt_pk_bf16_f32 v230, v172, v173
v_cvt_pk_bf16_f32 v231, v174, v175
v_mfma_f32_32x32x16_bf16 v[160:175], a[232:235], v[224:227], 0
s_nop 0
v_mfma_f32_32x32x16_bf16 v[240:255], a[236:239], v[228:231], 0
s_add_u32 m0, s96, 69632
s_add_u32 s94, s95, 98304
buffer_load_dwordx4 v5, s[32:35], s94 offen lds
v_cvt_pk_bf16_f32 v232, v176, v177
v_cvt_pk_bf16_f32 v233, v178, v179
v_cvt_pk_bf16_f32 v234, v180, v181
v_cvt_pk_bf16_f32 v235, v182, v183
v_cvt_pk_bf16_f32 v236, v184, v185
v_cvt_pk_bf16_f32 v237, v186, v187
v_cvt_pk_bf16_f32 v238, v188, v189
v_cvt_pk_bf16_f32 v239, v190, v191
v_mfma_f32_32x32x16_bf16 v[176:191], v[232:235], a[224:227], 0
s_nop 0
v_mfma_f32_32x32x16_bf16 v[144:159], v[236:239], a[228:231], 0
v_max3_f32 v192, v160, v161, v162
s_add_u32 m0, s96, 70656
s_add_u32 s94, s95, 147456
buffer_load_dwordx4 v5, s[32:35], s94 offen lds
v_max3_f32 v193, v163, v164, v165
v_max3_f32 v192, v166, v167, v192
v_max_f32 v192, v192, v193
v_max3_f32 v194, v168, v169, v170
v_max3_f32 v195, v171, v172, v173
v_max3_f32 v194, v174, v175, v194
v_max_f32_e64 v194, v194, v195
v_max3_f32 v196, v240, v241, v242
v_max3_f32 v197, v243, v244, v245
v_max3_f32 v196, v246, v247, v196
v_max_f32_e64 v196, v196, v197
v_max3_f32 v198, v248, v249, v250
v_max3_f32 v199, v251, v252, v253
v_max3_f32 v198, v254, v255, v198
v_max_f32 v198, v198, v199
v_permlane32_swap_b32 v192, v194
s_nop 0
v_permlane32_swap_b32 v196, v198
v_max_f32 v192, v192, v194
v_max_f32 v196, v196, v198
v_mov_b32 v194, v192
v_mov_b32 v198, v196
s_nop 0
v_permlane32_swap_b32 v192, v194
s_add_u32 m0, s96, 71680
s_add_u32 s94, s95, 196608
buffer_load_dwordx4 v5, s[32:35], s94 offen lds
v_permlane32_swap_b32_e64 v196, v198
v_mul_f32 v192, 0xbfb8aa3b, v192
v_mul_f32 v194, 0xbfb8aa3b, v194
v_mul_f32 v196, 0xbfb8aa3b, v196
v_mul_f32 v198, 0xbfb8aa3b, v198
v_pk_fma_f32 v[160:161], v[160:161], s[84:85], v[192:193] op_sel_hi:[1,1,0]
v_pk_fma_f32 v[162:163], v[162:163], s[84:85], v[192:193] op_sel_hi:[1,1,0]
v_pk_fma_f32 v[164:165], v[164:165], s[84:85], v[192:193] op_sel_hi:[1,1,0]
v_pk_fma_f32 v[166:167], v[166:167], s[84:85], v[192:193] op_sel_hi:[1,1,0]
v_pk_fma_f32 v[168:169], v[168:169], s[84:85], v[194:195] op_sel_hi:[1,1,0]
v_pk_fma_f32 v[170:171], v[170:171], s[84:85], v[194:195] op_sel_hi:[1,1,0]
v_pk_fma_f32 v[172:173], v[172:173], s[84:85], v[194:195] op_sel_hi:[1,1,0]
v_pk_fma_f32 v[174:175], v[174:175], s[84:85], v[194:195] op_sel_hi:[1,1,0]
v_pk_fma_f32 v[240:241], v[240:241], s[84:85], v[196:197] op_sel_hi:[1,1,0]
v_pk_fma_f32 v[242:243], v[242:243], s[84:85], v[196:197] op_sel_hi:[1,1,0]
v_pk_fma_f32 v[244:245], v[244:245], s[84:85], v[196:197] op_sel_hi:[1,1,0]
v_pk_fma_f32 v[246:247], v[246:247], s[84:85], v[196:197] op_sel_hi:[1,1,0]
v_pk_fma_f32 v[248:249], v[248:249], s[84:85], v[198:199] op_sel_hi:[1,1,0]
v_pk_fma_f32 v[250:251], v[250:251], s[84:85], v[198:199] op_sel_hi:[1,1,0]
v_pk_fma_f32 v[252:253], v[252:253], s[84:85], v[198:199] op_sel_hi:[1,1,0]
v_pk_fma_f32 v[254:255], v[254:255], s[84:85], v[198:199] op_sel_hi:[1,1,0]
v_exp_f32 v160, v160
v_exp_f32 v161, v161
s_add_u32 m0, s96, 72704
s_add_u32 s94, s95, 245760
buffer_load_dwordx4 v5, s[32:35], s94 offen lds
v_exp_f32 v162, v162
v_exp_f32 v163, v163
v_exp_f32 v164, v164
v_exp_f32 v165, v165
v_exp_f32 v166, v166
v_exp_f32 v167, v167
v_exp_f32 v168, v168
v_exp_f32 v169, v169
v_exp_f32 v170, v170
v_exp_f32 v171, v171
v_exp_f32 v172, v172
v_exp_f32 v173, v173
v_exp_f32_e64 v174, v174
s_add_u32 m0, s96, 73728
s_add_u32 s94, s95, 294912
buffer_load_dwordx4 v5, s[32:35], s94 offen lds
v_exp_f32 v175, v175
v_exp_f32 v240, v240
v_exp_f32 v241, v241
v_exp_f32 v242, v242
v_exp_f32 v243, v243
v_exp_f32 v244, v244
v_exp_f32 v245, v245
v_exp_f32 v246, v246
v_exp_f32 v247, v247
v_exp_f32 v248, v248
v_exp_f32 v249, v249
v_exp_f32 v250, v250
v_exp_f32_e64 v251, v251
s_add_u32 m0, s96, 74752
s_add_u32 s94, s95, 344064
buffer_load_dwordx4 v5, s[32:35], s94 offen lds
v_exp_f32 v252, v252
v_exp_f32 v253, v253
v_exp_f32 v254, v254
v_exp_f32 v255, v255
v_pk_add_f32 v[192:193], v[160:161], v[162:163]
v_pk_add_f32 v[200:201], v[164:165], v[166:167]
v_pk_add_f32 v[192:193], v[192:193], v[200:201]
v_add_f32_e64 v192, v192, v193
v_pk_add_f32 v[194:195], v[168:169], v[170:171]
v_pk_add_f32 v[200:201], v[172:173], v[174:175]
v_pk_add_f32 v[194:195], v[194:195], v[200:201]
v_add_f32_e64 v194, v194, v195
v_pk_add_f32 v[196:197], v[240:241], v[242:243]
v_pk_add_f32 v[200:201], v[244:245], v[246:247]
v_pk_add_f32 v[196:197], v[196:197], v[200:201]
v_add_f32_e64 v196, v196, v197
v_pk_add_f32 v[198:199], v[248:249], v[250:251]
v_pk_add_f32 v[200:201], v[252:253], v[254:255]
v_pk_add_f32 v[198:199], v[198:199], v[200:201]
v_add_f32 v198, v198, v199
v_permlane32_swap_b32 v192, v194
s_nop 0
v_permlane32_swap_b32 v196, v198
v_add_f32 v192, v192, v194
v_add_f32 v196, v196, v198
v_mov_b32 v194, v192
v_mov_b32 v198, v196
s_nop 0
v_permlane32_swap_b32 v192, v194
v_permlane32_swap_b32 v196, v198
v_rcp_f32 v192, v192
v_rcp_f32 v194, v194
v_rcp_f32 v196, v196
v_rcp_f32_e64 v198, v198
v_pk_mul_f32 v[160:161], v[160:161], v[192:193] op_sel_hi:[1,0]
v_pk_mul_f32 v[162:163], v[162:163], v[192:193] op_sel_hi:[1,0]
v_pk_mul_f32 v[164:165], v[164:165], v[192:193] op_sel_hi:[1,0]
v_pk_mul_f32 v[166:167], v[166:167], v[192:193] op_sel_hi:[1,0]
v_pk_mul_f32 v[168:169], v[168:169], v[194:195] op_sel_hi:[1,0]
v_pk_mul_f32 v[170:171], v[170:171], v[194:195] op_sel_hi:[1,0]
v_pk_mul_f32 v[172:173], v[172:173], v[194:195] op_sel_hi:[1,0]
v_pk_mul_f32 v[174:175], v[174:175], v[194:195] op_sel_hi:[1,0]
v_pk_mul_f32 v[240:241], v[240:241], v[196:197] op_sel_hi:[1,0]
v_pk_mul_f32 v[242:243], v[242:243], v[196:197] op_sel_hi:[1,0]
v_pk_mul_f32 v[244:245], v[244:245], v[196:197] op_sel_hi:[1,0]
v_pk_mul_f32 v[246:247], v[246:247], v[196:197] op_sel_hi:[1,0]
v_pk_mul_f32 v[248:249], v[248:249], v[198:199] op_sel_hi:[1,0]
v_pk_mul_f32 v[250:251], v[250:251], v[198:199] op_sel_hi:[1,0]
v_pk_mul_f32 v[252:253], v[252:253], v[198:199] op_sel_hi:[1,0]
v_pk_mul_f32 v[254:255], v[254:255], v[198:199] op_sel_hi:[1,0]
v_cvt_pk_bf16_f32 v204, v160, v161
v_cvt_pk_bf16_f32 v205, v162, v163
v_cvt_pk_bf16_f32 v206, v164, v165
v_cvt_pk_bf16_f32 v207, v166, v167
v_cvt_pk_bf16_f32 v208, v168, v169
v_cvt_pk_bf16_f32 v209, v170, v171
v_cvt_pk_bf16_f32 v210, v172, v173
v_cvt_pk_bf16_f32 v211, v174, v175
v_cvt_pk_bf16_f32 v212, v240, v241
v_cvt_pk_bf16_f32 v213, v242, v243
v_cvt_pk_bf16_f32 v214, v244, v245
v_cvt_pk_bf16_f32 v215, v246, v247
v_cvt_pk_bf16_f32 v216, v248, v249
v_cvt_pk_bf16_f32 v217, v250, v251
v_cvt_pk_bf16_f32 v218, v252, v253
v_cvt_pk_bf16_f32 v219, v254, v255
v_mfma_f32_32x32x16_bf16 v[160:175], v[204:207], a[224:227], 0
v_mfma_f32_32x32x16_bf16 v[160:175], v[208:211], a[228:231], v[160:175]
v_mfma_f32_32x32x16_bf16 v[240:255], v[212:215], a[224:227], 0
v_mfma_f32_32x32x16_bf16 v[240:255], v[216:219], a[228:231], v[240:255]
v_cvt_pk_bf16_f32 v224, v176, v177
v_cvt_pk_bf16_f32 v225, v178, v179
v_cvt_pk_bf16_f32 v226, v180, v181
v_cvt_pk_bf16_f32 v227, v182, v183
v_cvt_pk_bf16_f32 v228, v184, v185
v_cvt_pk_bf16_f32 v229, v186, v187
v_cvt_pk_bf16_f32 v230, v188, v189
v_cvt_pk_bf16_f32 v231, v190, v191
v_cvt_pk_bf16_f32 v232, v144, v145
v_cvt_pk_bf16_f32 v233, v146, v147
v_cvt_pk_bf16_f32 v234, v148, v149
v_cvt_pk_bf16_f32 v235, v150, v151
v_cvt_pk_bf16_f32 v236, v152, v153
v_cvt_pk_bf16_f32 v237, v154, v155
v_cvt_pk_bf16_f32 v238, v156, v157
v_cvt_pk_bf16_f32 v239, v158, v159
v_cvt_pk_bf16_f32 v204, v160, v161
v_cvt_pk_bf16_f32 v205, v162, v163
v_cvt_pk_bf16_f32 v206, v164, v165
v_cvt_pk_bf16_f32 v207, v166, v167
v_cvt_pk_bf16_f32 v208, v168, v169
v_cvt_pk_bf16_f32 v209, v170, v171
v_cvt_pk_bf16_f32 v210, v172, v173
v_cvt_pk_bf16_f32 v211, v174, v175
v_mfma_f32_32x32x16_bf16 v[176:191], v[204:207], v[224:227], 0
s_nop 0
v_mfma_f32_32x32x16_bf16 v[176:191], v[208:211], v[228:231], v[176:191]
v_cvt_pk_bf16_f32 v212, v240, v241
v_cvt_pk_bf16_f32 v213, v242, v243
v_cvt_pk_bf16_f32 v214, v244, v245
v_cvt_pk_bf16_f32 v215, v246, v247
v_cvt_pk_bf16_f32 v216, v248, v249
v_cvt_pk_bf16_f32 v217, v250, v251
v_cvt_pk_bf16_f32 v218, v252, v253
v_cvt_pk_bf16_f32 v219, v254, v255
v_mfma_f32_32x32x16_bf16 v[176:191], v[212:215], v[232:235], v[176:191]
s_nop 0
v_mfma_f32_32x32x16_bf16 v[176:191], v[216:219], v[236:239], v[176:191]
v_add_f32 v160, v160, v168
v_add_f32 v161, v161, v169
v_add_f32 v162, v162, v170
v_add_f32 v163, v163, v171
v_add_f32 v164, v164, v172
v_add_f32 v165, v165, v173
v_add_f32 v166, v166, v174
v_add_f32 v167, v167, v175
v_add_f32 v240, v240, v248
v_add_f32 v241, v241, v249
v_add_f32 v242, v242, v250
v_add_f32 v243, v243, v251
v_add_f32 v244, v244, v252
v_add_f32 v245, v245, v253
v_add_f32 v246, v246, v254
v_add_f32 v247, v247, v255
v_add_f32 v160, v160, v164
v_add_f32 v161, v161, v165
v_add_f32 v162, v162, v166
v_add_f32 v163, v163, v167
v_add_f32 v240, v240, v244
v_add_f32 v241, v241, v245
v_add_f32 v242, v242, v246
v_add_f32 v243, v243, v247
v_add_f32 v160, v160, v162
v_add_f32 v161, v161, v163
v_add_f32 v240, v240, v242
v_add_f32 v241, v241, v243
v_add_f32 v160, v160, v161
v_add_f32 v240, v240, v241
v_lshl_add_u32 v11, v0, 2, s24
v_lshlrev_b32 v7, 2, v0
v_permlane32_swap_b32 v160, v240
v_add_u32 v12, 112640, v7
v_add_u32 v13, s25, v1
v_add_f32 v160, v160, v240
ds_write_b32 v11, v160
v_add_u32 v11, 100352, v1
s_cmp_ge_u32 s68, 2
s_cbranch_scc1 Lsc_62
Lsc_60:
s_cmp_eq_u32 s68, 1
s_cbranch_scc1 Lsc_61
ds_write_b128 v11, v[180:183] offset:5120
ds_write_b128 v11, v[184:187] offset:7168
ds_write_b128 v11, v[188:191] offset:9216
v_pk_add_f32 v[192:193], v[176:177], 0
v_pk_add_f32 v[194:195], v[178:179], 0
s_branch Lscd_64
Lsc_61:
ds_write_b128 v11, v[176:179] offset:0
ds_write_b128 v11, v[184:187] offset:8192
ds_write_b128 v11, v[188:191] offset:10240
v_pk_add_f32 v[192:193], v[180:181], 0
v_pk_add_f32 v[194:195], v[182:183], 0
s_branch Lscd_64
Lsc_62:
s_cmp_eq_u32 s68, 3
s_cbranch_scc1 Lsc_63
ds_write_b128 v11, v[176:179] offset:1024
ds_write_b128 v11, v[180:183] offset:3072
ds_write_b128 v11, v[188:191] offset:11264
v_pk_add_f32 v[192:193], v[184:185], 0
v_pk_add_f32 v[194:195], v[186:187], 0
s_branch Lscd_64
Lsc_63:
ds_write_b128 v11, v[176:179] offset:2048
ds_write_b128 v11, v[180:183] offset:4096
ds_write_b128 v11, v[184:187] offset:6144
v_pk_add_f32 v[192:193], v[188:189], 0
v_pk_add_f32 v[194:195], v[190:191], 0
Lscd_64:
v_lshlrev_b32 v11, 3, v0
s_waitcnt lgkmcnt(0)
s_barrier
ds_read_b128 v[196:199], v13 offset:0
ds_read_b128 v[200:203], v13 offset:1024
ds_read_b128 v[204:207], v13 offset:2048
ds_read_b32 v208, v12 offset:0
ds_read_b32 v209, v12 offset:256
ds_read_b32 v210, v12 offset:512
ds_read_b32 v211, v12 offset:768
s_waitcnt lgkmcnt(4)
v_pk_add_f32 v[192:193], v[192:193], v[196:197]
v_pk_add_f32 v[200:201], v[200:201], v[204:205]
v_pk_add_f32 v[194:195], v[194:195], v[198:199]
v_pk_add_f32 v[202:203], v[202:203], v[206:207]
v_pk_add_f32 v[192:193], v[192:193], v[200:201]
v_pk_add_f32 v[194:195], v[194:195], v[202:203]
v_cvt_pk_bf16_f32 v192, v192, v193
v_cvt_pk_bf16_f32 v193, v194, v195
s_waitcnt vmcnt(0)
buffer_store_dwordx2 v[192:193], v11, s[36:39], s21 offen sc1
s_waitcnt lgkmcnt(0)
s_cmp_lg_u32 s68, 0
s_cbranch_scc1 Lnoz_65
v_pk_add_f32 v[208:209], v[208:209], v[210:211]
v_add_f32 v208, v208, v209
buffer_store_dword v208, v7, s[36:39], s20 offen offset:2048 sc1
Lnoz_65:
s_lshl_b32 s77, s68, 13
v_add_u32 v12, s77, v4
v_mov_b32 v248, 0
v_mov_b32 v249, 0
ds_read_b64_tr_b16 v[144:145], v12 offset:0
ds_read_b64_tr_b16 v[146:147], v12 offset:256
ds_read_b64_tr_b16 v[148:149], v12 offset:1024
ds_read_b64_tr_b16 v[150:151], v12 offset:1280
ds_read_b64_tr_b16 v[152:153], v12 offset:2048
ds_read_b64_tr_b16 v[154:155], v12 offset:2304
ds_read_b64_tr_b16 v[156:157], v12 offset:3072
ds_read_b64_tr_b16 v[158:159], v12 offset:3328
ds_read_b64_tr_b16 v[160:161], v12 offset:4096
ds_read_b64_tr_b16 v[162:163], v12 offset:4352
ds_read_b64_tr_b16 v[164:165], v12 offset:5120
ds_read_b64_tr_b16 v[166:167], v12 offset:5376
ds_read_b64_tr_b16 v[168:169], v12 offset:6144
ds_read_b64_tr_b16 v[170:171], v12 offset:6400
ds_read_b64_tr_b16 v[172:173], v12 offset:7168
ds_read_b64_tr_b16 v[174:175], v12 offset:7424
v_lshrrev_b32_e64 v7, 3, v0
v_mul_u32_u24 v7, 1024, v7
v_and_b32_e64 v14, 3, v0
v_lshl_add_u32 v7, v14, 4, v7
v_lshrrev_b32 v14, 2, v0
v_lshrrev_b32 v11, 4, v0
v_xor_b32 v14, v14, v11
v_and_b32 v14, 1, v14
v_mul_u32_u24 v14, 64, v14
v_add_u32 v14, v14, v7
s_lshl_b32 s93, s68, 14
s_lshl_b32 s77, s68, 17
s_lshl_b32 s78, s72, 7
s_add_u32 s92, s77, s78
s_sub_u32 s77, s92, 16384
s_and_b32 s97, s77, 0x7ffff
s_waitcnt lgkmcnt(0)
v_dot2c_f32_bf16 v248, s86, v144
v_dot2c_f32_bf16 v249, s86, v145
v_dot2c_f32_bf16 v248, s86, v146
v_dot2c_f32_bf16 v249, s86, v147
v_dot2c_f32_bf16 v248, s86, v148
v_dot2c_f32_bf16 v249, s86, v149
v_dot2c_f32_bf16 v248, s86, v150
v_dot2c_f32_bf16 v249, s86, v151
v_dot2c_f32_bf16 v248, s86, v152
v_dot2c_f32_bf16 v249, s86, v153
v_dot2c_f32_bf16 v248, s86, v154
v_dot2c_f32_bf16 v249, s86, v155
v_dot2c_f32_bf16 v248, s86, v156
v_dot2c_f32_bf16 v249, s86, v157
v_dot2c_f32_bf16 v248, s86, v158
v_dot2c_f32_bf16 v249, s86, v159
v_dot2c_f32_bf16 v248, s86, v160
v_dot2c_f32_bf16 v249, s86, v161
v_dot2c_f32_bf16 v248, s86, v162
v_dot2c_f32_bf16 v249, s86, v163
v_dot2c_f32_bf16 v248, s86, v164
v_dot2c_f32_bf16 v249, s86, v165
v_dot2c_f32_bf16 v248, s86, v166
v_dot2c_f32_bf16 v249, s86, v167
v_dot2c_f32_bf16 v248, s86, v168
v_dot2c_f32_bf16 v249, s86, v169
v_dot2c_f32_bf16 v248, s86, v170
v_dot2c_f32_bf16 v249, s86, v171
v_dot2c_f32_bf16 v248, s86, v172
v_dot2c_f32_bf16 v249, s86, v173
v_dot2c_f32_bf16 v248, s86, v174
v_dot2c_f32_bf16 v249, s86, v175
v_mov_b32 v7, 1
v_mov_b32_e64 v6, s22
s_waitcnt vmcnt(0)
s_mov_b64 exec, 1
buffer_store_dword v7, v6, s[36:39], 0 offen sc1
s_mov_b64 exec, -1
v_and_b32 v7, 19, v0
v_bfe_u32 v11, v0, 2, 1
v_lshl_add_u32 v7, v11, 3, v7
v_bfe_u32 v11, v0, 3, 1
v_lshl_add_u32 v7, v11, 2, v7
v_lshlrev_b32_e64 v11, 2, v7
s_mul_i32 s77, s68, 128
s_add_u32 s77, s77, 66944
v_add_u32 v11, s77, v11
v_add_f32 v248, v248, v249
v_mov_b32 v249, v248
s_nop 1
v_permlane32_swap_b32 v248, v249
v_add_f32 v248, v248, v249
ds_write_b32 v11, v248 offset:0
s_barrier
s_add_u32 m0, s93, 100352
s_add_u32 s94, s92, 0
buffer_load_dwordx4 v14, s[48:51], s94 offen lds
s_add_u32 m0, s93, 101376
s_add_u32 s94, s92, 8192
buffer_load_dwordx4 v14, s[48:51], s94 offen lds
ds_read_b64_tr_b16 v[160:161], v4 offset:0
ds_read_b64_tr_b16 v[162:163], v4 offset:256
ds_read_b64_tr_b16 v[164:165], v4 offset:1024
ds_read_b64_tr_b16 v[166:167], v4 offset:1280
ds_read_b64_tr_b16 v[168:169], v4 offset:2048
ds_read_b64_tr_b16 v[170:171], v4 offset:2304
ds_read_b64_tr_b16 v[172:173], v4 offset:3072
ds_read_b64_tr_b16 v[174:175], v4 offset:3328
s_waitcnt lgkmcnt(6)
v_mfma_f32_32x32x16_bf16 v[144:159], v[160:163], v[16:19], 0
v_and_b32 v11, 15, v0
v_lshl_add_u32 v5, v11, 2, s23
ds_read_b64_tr_b16 v[160:161], v4 offset:4096
ds_read_b64_tr_b16 v[162:163], v4 offset:4352
s_waitcnt lgkmcnt(6)
v_mfma_f32_32x32x16_bf16 v[144:159], v[164:167], v[20:23], v[144:159]
s_add_u32 m0, s93, 102400
s_add_u32 s94, s92, 16384
buffer_load_dwordx4 v14, s[48:51], s94 offen lds
v_lshrrev_b32 v7, 4, v0
v_mul_u32_u24 v7, 2304, v7
ds_read_b64_tr_b16 v[164:165], v4 offset:5120
ds_read_b64_tr_b16 v[166:167], v4 offset:5376
s_waitcnt lgkmcnt(6)
v_mfma_f32_32x32x16_bf16 v[144:159], v[168:171], v[24:27], v[144:159]
v_lshl_add_u32 v13, v11, 4, v7
v_lshrrev_b32 v7, 5, v0
ds_read_b64_tr_b16 v[168:169], v4 offset:6144
ds_read_b64_tr_b16 v[170:171], v4 offset:6400
s_waitcnt lgkmcnt(6)
v_mfma_f32_32x32x16_bf16 v[144:159], v[172:175], v[28:31], v[144:159]
s_add_u32 m0, s93, 103424
s_add_u32 s94, s92, 24576
buffer_load_dwordx4 v14, s[48:51], s94 offen lds
v_mul_u32_u24 v7, 2304, v7
v_and_b32 v12, 31, v0
ds_read_b64_tr_b16 v[172:173], v4 offset:7168
ds_read_b64_tr_b16 v[174:175], v4 offset:7424
s_waitcnt lgkmcnt(6)
v_mfma_f32_32x32x16_bf16 v[144:159], v[160:163], v[32:35], v[144:159]
v_lshl_add_u32 v12, v12, 4, v7
s_mul_i32 s79, s70, 36864
ds_read_b64_tr_b16 v[160:161], v4 offset:8192
ds_read_b64_tr_b16 v[162:163], v4 offset:8448
s_waitcnt lgkmcnt(6)
v_mfma_f32_32x32x16_bf16 v[144:159], v[164:167], v[36:39], v[144:159]
s_add_u32 m0, s93, 104448
s_add_u32 s94, s92, 32768
buffer_load_dwordx4 v14, s[48:51], s94 offen lds
s_add_u32 s79, s79, 2359296
s_lshl_b32 s80, s68, 9
ds_read_b64_tr_b16 v[164:165], v4 offset:9216
ds_read_b64_tr_b16 v[166:167], v4 offset:9472
s_waitcnt lgkmcnt(6)
v_mfma_f32_32x32x16_bf16 v[144:159], v[168:171], v[40:43], v[144:159]
s_add_u32 s80, s80, s79
s_lshl_b32 s100, s68, 11
ds_read_b64_tr_b16 v[168:169], v4 offset:10240
ds_read_b64_tr_b16 v[170:171], v4 offset:10496
s_waitcnt lgkmcnt(6)
v_mfma_f32_32x32x16_bf16 v[144:159], v[172:175], v[44:47], v[144:159]
s_add_u32 m0, s93, 105472
s_add_u32 s94, s92, 40960
buffer_load_dwordx4 v14, s[48:51], s94 offen lds
s_mul_i32 s99, s70, 229376
s_add_u32 s99, s99, s100
ds_read_b64_tr_b16 v[172:173], v4 offset:11264
ds_read_b64_tr_b16 v[174:175], v4 offset:11520
s_waitcnt lgkmcnt(6)
v_mfma_f32_32x32x16_bf16 v[144:159], v[160:163], v[48:51], v[144:159]
s_add_u32 s99, s99, 18874368
s_mul_i32 s101, s72, 229376
ds_read_b64_tr_b16 v[160:161], v4 offset:12288
ds_read_b64_tr_b16 v[162:163], v4 offset:12544
s_waitcnt lgkmcnt(6)
v_mfma_f32_32x32x16_bf16 v[144:159], v[164:167], v[52:55], v[144:159]
s_add_u32 m0, s93, 106496
s_add_u32 s94, s92, 49152
buffer_load_dwordx4 v14, s[48:51], s94 offen lds
s_mul_i32 s78, s68, 57344
s_add_u32 s101, s101, s78
ds_read_b64_tr_b16 v[164:165], v4 offset:13312
ds_read_b64_tr_b16 v[166:167], v4 offset:13568
s_waitcnt lgkmcnt(6)
v_mfma_f32_32x32x16_bf16 v[144:159], v[168:171], v[56:59], v[144:159]
s_add_u32 s101, s101, 23068672
v_mov_b32_e64 v188, 0
ds_read_b64_tr_b16 v[168:169], v4 offset:14336
ds_read_b64_tr_b16 v[170:171], v4 offset:14592
s_waitcnt lgkmcnt(6)
v_mfma_f32_32x32x16_bf16 v[144:159], v[172:175], v[60:63], v[144:159]
s_add_u32 m0, s93, 107520
s_add_u32 s94, s92, 57344
buffer_load_dwordx4 v14, s[48:51], s94 offen lds
v_mov_b32 v189, 0
v_mov_b32_e64 v190, 0
ds_read_b64_tr_b16 v[172:173], v4 offset:15360
ds_read_b64_tr_b16 v[174:175], v4 offset:15616
s_waitcnt lgkmcnt(6)
v_mfma_f32_32x32x16_bf16 v[144:159], v[160:163], v[64:67], v[144:159]
v_mov_b32 v191, 0
v_mov_b32_e64 v192, 0
ds_read_b64_tr_b16 v[160:161], v4 offset:16384
ds_read_b64_tr_b16 v[162:163], v4 offset:16640
s_waitcnt lgkmcnt(6)
v_mfma_f32_32x32x16_bf16 v[144:159], v[164:167], v[68:71], v[144:159]
s_add_u32 m0, s93, 108544
s_add_u32 s94, s92, 65536
buffer_load_dwordx4 v14, s[48:51], s94 offen lds
v_mov_b32 v193, 0
v_mov_b32_e64 v194, 0
ds_read_b64_tr_b16 v[164:165], v4 offset:17408
ds_read_b64_tr_b16 v[166:167], v4 offset:17664
s_waitcnt lgkmcnt(6)
v_mfma_f32_32x32x16_bf16 v[144:159], v[168:171], v[72:75], v[144:159]
v_mov_b32 v195, 0
v_lshlrev_b32_e64 v11, 1, v0
ds_read_b64_tr_b16 v[168:169], v4 offset:18432
ds_read_b64_tr_b16 v[170:171], v4 offset:18688
s_waitcnt lgkmcnt(6)
v_mfma_f32_32x32x16_bf16 v[144:159], v[172:175], v[76:79], v[144:159]
s_add_u32 m0, s93, 109568
s_add_u32 s94, s92, 73728
buffer_load_dwordx4 v14, s[48:51], s94 offen lds
v_lshrrev_b32 v7, 5, v0
v_and_or_b32 v11, v11, 62, v7
ds_read_b64_tr_b16 v[172:173], v4 offset:19456
ds_read_b64_tr_b16 v[174:175], v4 offset:19712
s_waitcnt lgkmcnt(6)
v_mfma_f32_32x32x16_bf16 v[144:159], v[160:163], v[80:83], v[144:159]
v_bfe_u32 v7, v11, 4, 1
v_lshlrev_b32 v7, 11, v7
ds_read_b64_tr_b16 v[160:161], v4 offset:20480
ds_read_b64_tr_b16 v[162:163], v4 offset:20736
s_waitcnt lgkmcnt(6)
v_mfma_f32_32x32x16_bf16 v[144:159], v[164:167], v[84:87], v[144:159]
s_add_u32 m0, s93, 110592
s_add_u32 s94, s92, 81920
buffer_load_dwordx4 v14, s[48:51], s94 offen lds
v_and_b32 v11, 47, v11
v_lshl_add_u32 v7, v11, 4, v7
ds_read_b64_tr_b16 v[164:165], v4 offset:21504
ds_read_b64_tr_b16 v[166:167], v4 offset:21760
s_waitcnt lgkmcnt(6)
v_mfma_f32_32x32x16_bf16 v[144:159], v[168:171], v[88:91], v[144:159]
s_lshl_b32 s77, s74, 10
s_lshl_b32 s78, s75, 3
ds_read_b64_tr_b16 v[168:169], v4 offset:22528
ds_read_b64_tr_b16 v[170:171], v4 offset:22784
s_waitcnt lgkmcnt(6)
v_mfma_f32_32x32x16_bf16 v[144:159], v[172:175], v[92:95], v[144:159]
s_add_u32 m0, s93, 111616
s_add_u32 s94, s92, 90112
buffer_load_dwordx4 v14, s[48:51], s94 offen lds
s_add_u32 s77, s77, s78
s_add_u32 s77, s77, 92160
ds_read_b64_tr_b16 v[172:173], v4 offset:23552
ds_read_b64_tr_b16 v[174:175], v4 offset:23808
s_waitcnt lgkmcnt(6)
v_mfma_f32_32x32x16_bf16 v[144:159], v[160:163], v[96:99], v[144:159]
v_add_u32 v196, s77, v7
v_and_b32 v7, 31, v0
ds_read_b64_tr_b16 v[160:161], v4 offset:24576
ds_read_b64_tr_b16 v[162:163], v4 offset:24832
s_waitcnt lgkmcnt(6)
v_mfma_f32_32x32x16_bf16 v[144:159], v[164:167], v[100:103], v[144:159]
s_add_u32 m0, s93, 112640
s_add_u32 s94, s92, 98304
buffer_load_dwordx4 v14, s[48:51], s94 offen lds
v_min_u32 v7, 16, v7
v_and_b32_e64 v11, 32, v0
ds_read_b64_tr_b16 v[164:165], v4 offset:25600
ds_read_b64_tr_b16 v[166:167], v4 offset:25856
s_waitcnt lgkmcnt(6)
v_mfma_f32_32x32x16_bf16 v[144:159], v[168:171], v[104:107], v[144:159]
v_add_u32 v7, v7, v11
v_lshlrev_b32_e64 v7, 4, v7
ds_read_b64_tr_b16 v[168:169], v4 offset:26624
ds_read_b64_tr_b16 v[170:171], v4 offset:26880
s_waitcnt lgkmcnt(6)
v_mfma_f32_32x32x16_bf16 v[144:159], v[172:175], v[108:111], v[144:159]
s_add_u32 m0, s93, 113664
s_add_u32 s94, s92, 106496
buffer_load_dwordx4 v14, s[48:51], s94 offen lds
v_add_u32 v197, 92160, v7
s_lshl_b32 s77, s71, 15
ds_read_b64_tr_b16 v[172:173], v4 offset:27648
ds_read_b64_tr_b16 v[174:175], v4 offset:27904
s_waitcnt lgkmcnt(6)
v_mfma_f32_32x32x16_bf16 v[144:159], v[160:163], v[112:115], v[144:159]
s_lshl_b32 s78, s70, 11
s_add_u32 s77, s77, s78
ds_read_b64_tr_b16 v[160:161], v4 offset:28672
ds_read_b64_tr_b16 v[162:163], v4 offset:28928
s_waitcnt lgkmcnt(6)
v_mfma_f32_32x32x16_bf16 v[144:159], v[164:167], v[116:119], v[144:159]
buffer_load_dword v6, v5, s[36:39], 0 offen sc1
s_add_u32 s82, s77, 4194304
v_bfe_u32 v7, v0, 2, 2
ds_read_b64_tr_b16 v[164:165], v4 offset:29696
ds_read_b64_tr_b16 v[166:167], v4 offset:29952
s_waitcnt lgkmcnt(6)
v_mfma_f32_32x32x16_bf16 v[144:159], v[168:171], v[120:123], v[144:159]
v_lshlrev_b32 v7, 10, v7
v_and_b32_e64 v11, 1, v0
ds_read_b64_tr_b16 v[168:169], v4 offset:30720
ds_read_b64_tr_b16 v[170:171], v4 offset:30976
s_waitcnt lgkmcnt(6)
v_mfma_f32_32x32x16_bf16 v[144:159], v[172:175], v[124:127], v[144:159]
v_lshl_add_u32 v7, v11, 9, v7
v_bfe_u32 v11, v0, 1, 1
ds_read_b64_tr_b16 v[172:173], v4 offset:31744
ds_read_b64_tr_b16 v[174:175], v4 offset:32000
s_waitcnt lgkmcnt(6)
v_mfma_f32_32x32x16_bf16 v[144:159], v[160:163], v[128:131], v[144:159]
v_lshl_add_u32 v7, v11, 3, v7
v_add_u32 v198, 92416, v7
s_waitcnt lgkmcnt(4)
v_mfma_f32_32x32x16_bf16 v[144:159], v[164:167], v[132:135], v[144:159]
s_waitcnt lgkmcnt(2)
v_mfma_f32_32x32x16_bf16 v[144:159], v[168:171], v[136:139], v[144:159]
s_waitcnt lgkmcnt(0)
v_mfma_f32_32x32x16_bf16 v[144:159], v[172:175], v[140:143], v[144:159]
s_waitcnt lgkmcnt(0)
s_barrier
s_cmp_lg_u32 s68, 3
s_cbranch_scc1 Lpd_66
s_lshl_b32 s77, s2, 2
s_add_u32 s77, s77, 12288
v_mov_b32 v7, 1
v_mov_b32_e64 v11, s77
s_mov_b64 exec, 1
buffer_store_dword v7, v11, s[36:39], 0 offen sc1
s_mov_b64 exec, -1
Lpd_66:
v_lshlrev_b32 v7, 2, v0
v_and_b32 v7, 127, v7
v_add_u32 v11, 66944, v7
ds_read_b32 v208, v11 offset:0
ds_read_b32 v209, v11 offset:128
ds_read_b32 v210, v11 offset:256
ds_read_b32 v211, v11 offset:384
v_add_u32 v11, 65792, v7
s_waitcnt lgkmcnt(0)
v_add_f32 v208, v208, v209
v_add_f32 v210, v210, v211
v_add_f32 v208, v208, v210
ds_write_b32 v11, v208
ds_read_b128 v[160:163], v10 offset:256
ds_read_b128 v[164:167], v10 offset:272
ds_read_b128 v[168:171], v10 offset:320
ds_read_b128 v[172:175], v10 offset:336
s_waitcnt lgkmcnt(0)
v_pk_fma_f32 v[144:145], v[160:161], v[8:9], v[144:145] op_sel_hi:[1,0,1]
v_pk_fma_f32 v[146:147], v[162:163], v[8:9], v[146:147] op_sel_hi:[1,0,1]
v_pk_fma_f32 v[148:149], v[164:165], v[8:9], v[148:149] op_sel_hi:[1,0,1]
v_pk_fma_f32 v[150:151], v[166:167], v[8:9], v[150:151] op_sel_hi:[1,0,1]
v_pk_fma_f32 v[152:153], v[168:169], v[8:9], v[152:153] op_sel_hi:[1,0,1]
v_pk_fma_f32 v[154:155], v[170:171], v[8:9], v[154:155] op_sel_hi:[1,0,1]
v_pk_fma_f32 v[156:157], v[172:173], v[8:9], v[156:157] op_sel_hi:[1,0,1]
v_pk_fma_f32 v[158:159], v[174:175], v[8:9], v[158:159] op_sel_hi:[1,0,1]
v_pk_mul_f32 v[144:145], v[144:145], v[8:9] op_sel:[0,1] op_sel_hi:[1,1]
v_pk_mul_f32 v[146:147], v[146:147], v[8:9] op_sel:[0,1] op_sel_hi:[1,1]
v_pk_mul_f32 v[148:149], v[148:149], v[8:9] op_sel:[0,1] op_sel_hi:[1,1]
v_pk_mul_f32 v[150:151], v[150:151], v[8:9] op_sel:[0,1] op_sel_hi:[1,1]
v_pk_mul_f32 v[152:153], v[152:153], v[8:9] op_sel:[0,1] op_sel_hi:[1,1]
v_pk_mul_f32 v[154:155], v[154:155], v[8:9] op_sel:[0,1] op_sel_hi:[1,1]
v_pk_mul_f32 v[156:157], v[156:157], v[8:9] op_sel:[0,1] op_sel_hi:[1,1]
v_pk_mul_f32 v[158:159], v[158:159], v[8:9] op_sel:[0,1] op_sel_hi:[1,1]
v_cvt_pk_bf16_f32 v176, v144, v145
v_cvt_pk_bf16_f32 v177, v146, v147
v_cvt_pk_bf16_f32 v178, v148, v149
v_cvt_pk_bf16_f32 v179, v150, v151
v_cvt_pk_bf16_f32 v180, v152, v153
v_cvt_pk_bf16_f32 v181, v154, v155
v_cvt_pk_bf16_f32 v182, v156, v157
v_cvt_pk_bf16_f32 v183, v158, v159
v_mfma_f32_32x32x16_bf16 v[144:159], a[232:235], v[176:179], 0
s_nop 0
v_mfma_f32_32x32x16_bf16 v[200:215], a[236:239], v[180:183], 0
s_waitcnt vmcnt(0)
v_cmp_gt_u32 vcc, 1, v6
s_nop 0
s_cbranch_vccz Lgo_68
Lpoll_67:
s_sleep 1
buffer_load_dword v6, v5, s[36:39], 0 offen sc1
s_waitcnt vmcnt(0)
v_cmp_gt_u32 vcc, 1, v6
s_nop 0
s_cbranch_vccz Lgo_68
s_add_u32 s91, s91, 1
s_bitcmp0_b32 s91, 16
s_cbranch_scc1 Lpoll_67
Lgo_68:
s_cmp_lg_u32 s68, 0
s_cbranch_scc1 Lzld_69
buffer_load_dwordx4 v[16:19], v13, s[36:39], s79 offen offset:2048 sc1
s_add_u32 s79, s79, 9216
buffer_load_dwordx4 v[20:23], v13, s[36:39], s79 offen offset:2048 sc1
s_add_u32 s79, s79, 9216
buffer_load_dwordx4 v[24:27], v13, s[36:39], s79 offen offset:2048 sc1
s_add_u32 s79, s79, 9216
buffer_load_dwordx4 v[28:31], v13, s[36:39], s79 offen offset:2048 sc1
Lzld_69:
buffer_load_dwordx4 v[220:223], v12, s[36:39], s80 offen sc1
s_add_u32 s80, s80, 4608
buffer_load_dwordx4 v[224:227], v12, s[36:39], s80 offen sc1
s_add_u32 s80, s80, 4608
buffer_load_dwordx4 v[228:231], v12, s[36:39], s80 offen sc1
s_add_u32 s80, s80, 4608
buffer_load_dwordx4 v[232:235], v12, s[36:39], s80 offen sc1
v_max3_f32 v176, v144, v145, v146
v_max3_f32 v177, v147, v148, v149
v_max3_f32 v176, v150, v151, v176
v_max_f32_e64 v176, v176, v177
v_max3_f32 v178, v152, v153, v154
v_max3_f32 v179, v155, v156, v157
v_max3_f32 v178, v158, v159, v178
v_max_f32_e64 v178, v178, v179
v_max3_f32 v180, v200, v201, v202
v_max3_f32 v181, v203, v204, v205
s_add_u32 s80, s80, 4608
buffer_load_dwordx4 v[236:239], v12, s[36:39], s80 offen sc1
v_max3_f32 v180, v206, v207, v180
v_max_f32_e64 v180, v180, v181
v_max3_f32 v182, v208, v209, v210
v_max3_f32 v183, v211, v212, v213
v_max3_f32 v182, v214, v215, v182
v_max_f32 v182, v182, v183
v_permlane32_swap_b32 v176, v178
s_nop 0
v_permlane32_swap_b32 v180, v182
s_add_u32 s80, s80, 4608
buffer_load_dwordx4 v[240:243], v12, s[36:39], s80 offen sc1
v_max_f32 v176, v176, v178
v_max_f32 v180, v180, v182
v_mov_b32 v178, v176
v_mov_b32 v182, v180
s_nop 0
v_permlane32_swap_b32 v176, v178
v_permlane32_swap_b32_e64 v180, v182
v_mul_f32 v176, 0xbfb8aa3b, v176
v_mul_f32 v178, 0xbfb8aa3b, v178
s_add_u32 s80, s80, 4608
buffer_load_dwordx4 v[244:247], v12, s[36:39], s80 offen sc1
v_mul_f32 v180, 0xbfb8aa3b, v180
v_mul_f32 v182, 0xbfb8aa3b, v182
v_pk_fma_f32 v[144:145], v[144:145], s[84:85], v[176:177] op_sel_hi:[1,1,0]
v_pk_fma_f32 v[146:147], v[146:147], s[84:85], v[176:177] op_sel_hi:[1,1,0]
v_pk_fma_f32 v[148:149], v[148:149], s[84:85], v[176:177] op_sel_hi:[1,1,0]
v_pk_fma_f32 v[150:151], v[150:151], s[84:85], v[176:177] op_sel_hi:[1,1,0]
v_pk_fma_f32 v[152:153], v[152:153], s[84:85], v[178:179] op_sel_hi:[1,1,0]
v_pk_fma_f32 v[154:155], v[154:155], s[84:85], v[178:179] op_sel_hi:[1,1,0]
v_pk_fma_f32 v[156:157], v[156:157], s[84:85], v[178:179] op_sel_hi:[1,1,0]
v_pk_fma_f32 v[158:159], v[158:159], s[84:85], v[178:179] op_sel_hi:[1,1,0]
s_add_u32 s80, s80, 4608
buffer_load_dwordx4 v[248:251], v12, s[36:39], s80 offen sc1
v_pk_fma_f32 v[200:201], v[200:201], s[84:85], v[180:181] op_sel_hi:[1,1,0]
v_pk_fma_f32 v[202:203], v[202:203], s[84:85], v[180:181] op_sel_hi:[1,1,0]
v_pk_fma_f32 v[204:205], v[204:205], s[84:85], v[180:181] op_sel_hi:[1,1,0]
v_pk_fma_f32 v[206:207], v[206:207], s[84:85], v[180:181] op_sel_hi:[1,1,0]
v_pk_fma_f32 v[208:209], v[208:209], s[84:85], v[182:183] op_sel_hi:[1,1,0]
v_pk_fma_f32 v[210:211], v[210:211], s[84:85], v[182:183] op_sel_hi:[1,1,0]
v_pk_fma_f32 v[212:213], v[212:213], s[84:85], v[182:183] op_sel_hi:[1,1,0]
v_pk_fma_f32 v[214:215], v[214:215], s[84:85], v[182:183] op_sel_hi:[1,1,0]
v_exp_f32 v144, v144
v_exp_f32 v145, v145
v_exp_f32 v146, v146
v_exp_f32 v147, v147
v_exp_f32_e64 v148, v148
s_add_u32 m0, s93, 98304
s_add_u32 s94, s97, 0
buffer_load_dwordx4 v14, s[48:51], s94 offen lds
v_exp_f32 v149, v149
v_exp_f32 v150, v150
v_exp_f32 v151, v151
v_exp_f32 v152, v152
v_exp_f32 v153, v153
v_exp_f32 v154, v154
v_exp_f32 v155, v155
v_exp_f32 v156, v156
v_exp_f32 v157, v157
s_add_u32 m0, s93, 99328
s_add_u32 s94, s97, 8192
buffer_load_dwordx4 v14, s[48:51], s94 offen lds
v_exp_f32 v158, v158
v_exp_f32 v159, v159
v_exp_f32 v200, v200
v_exp_f32 v201, v201
v_exp_f32 v202, v202
v_exp_f32 v203, v203
v_exp_f32 v204, v204
v_exp_f32 v205, v205
v_exp_f32 v206, v206
v_exp_f32 v207, v207
v_exp_f32 v208, v208
v_exp_f32 v209, v209
v_exp_f32 v210, v210
v_exp_f32 v211, v211
v_exp_f32 v212, v212
v_exp_f32 v213, v213
v_exp_f32 v214, v214
v_exp_f32 v215, v215
v_pk_add_f32 v[176:177], v[144:145], v[146:147]
v_pk_add_f32 v[184:185], v[148:149], v[150:151]
v_pk_add_f32 v[176:177], v[176:177], v[184:185]
v_add_f32_e64 v176, v176, v177
v_pk_add_f32 v[178:179], v[152:153], v[154:155]
v_pk_add_f32 v[184:185], v[156:157], v[158:159]
v_pk_add_f32 v[178:179], v[178:179], v[184:185]
v_add_f32_e64 v178, v178, v179
v_pk_add_f32 v[180:181], v[200:201], v[202:203]
v_pk_add_f32 v[184:185], v[204:205], v[206:207]
v_pk_add_f32 v[180:181], v[180:181], v[184:185]
v_add_f32_e64 v180, v180, v181
v_pk_add_f32 v[182:183], v[208:209], v[210:211]
v_pk_add_f32 v[184:185], v[212:213], v[214:215]
v_pk_add_f32 v[182:183], v[182:183], v[184:185]
v_add_f32 v182, v182, v183
v_permlane32_swap_b32 v176, v178
s_nop 0
v_permlane32_swap_b32 v180, v182
v_add_f32 v176, v176, v178
v_add_f32 v180, v180, v182
v_mov_b32 v178, v176
v_mov_b32 v182, v180
s_nop 0
v_permlane32_swap_b32 v176, v178
v_permlane32_swap_b32 v180, v182
v_rcp_f32 v176, v176
v_rcp_f32 v178, v178
v_rcp_f32 v180, v180
v_rcp_f32_e64 v182, v182
v_pk_mul_f32 v[144:145], v[144:145], v[176:177] op_sel_hi:[1,0]
v_pk_mul_f32 v[146:147], v[146:147], v[176:177] op_sel_hi:[1,0]
v_pk_mul_f32 v[148:149], v[148:149], v[176:177] op_sel_hi:[1,0]
v_pk_mul_f32 v[150:151], v[150:151], v[176:177] op_sel_hi:[1,0]
v_pk_mul_f32 v[152:153], v[152:153], v[178:179] op_sel_hi:[1,0]
v_pk_mul_f32 v[154:155], v[154:155], v[178:179] op_sel_hi:[1,0]
v_pk_mul_f32 v[156:157], v[156:157], v[178:179] op_sel_hi:[1,0]
v_pk_mul_f32 v[158:159], v[158:159], v[178:179] op_sel_hi:[1,0]
v_pk_mul_f32 v[200:201], v[200:201], v[180:181] op_sel_hi:[1,0]
v_pk_mul_f32 v[202:203], v[202:203], v[180:181] op_sel_hi:[1,0]
v_pk_mul_f32 v[204:205], v[204:205], v[180:181] op_sel_hi:[1,0]
v_pk_mul_f32 v[206:207], v[206:207], v[180:181] op_sel_hi:[1,0]
v_pk_mul_f32 v[208:209], v[208:209], v[182:183] op_sel_hi:[1,0]
v_pk_mul_f32 v[210:211], v[210:211], v[182:183] op_sel_hi:[1,0]
v_pk_mul_f32 v[212:213], v[212:213], v[182:183] op_sel_hi:[1,0]
v_pk_mul_f32 v[214:215], v[214:215], v[182:183] op_sel_hi:[1,0]
v_cvt_pk_bf16_f32 v160, v144, v145
v_cvt_pk_bf16_f32 v161, v146, v147
v_cvt_pk_bf16_f32 v162, v148, v149
v_cvt_pk_bf16_f32 v163, v150, v151
v_cvt_pk_bf16_f32 v164, v152, v153
v_cvt_pk_bf16_f32 v165, v154, v155
v_cvt_pk_bf16_f32 v166, v156, v157
v_cvt_pk_bf16_f32 v167, v158, v159
v_cvt_pk_bf16_f32 v168, v200, v201
v_cvt_pk_bf16_f32 v169, v202, v203
v_cvt_pk_bf16_f32 v170, v204, v205
v_cvt_pk_bf16_f32 v171, v206, v207
v_cvt_pk_bf16_f32 v172, v208, v209
v_cvt_pk_bf16_f32 v173, v210, v211
v_cvt_pk_bf16_f32 v174, v212, v213
v_cvt_pk_bf16_f32 v175, v214, v215
s_cmp_lg_u32 s68, 0
s_cbranch_scc1 Lzsum_70
s_waitcnt vmcnt(10)
v_pk_add_f32 v[16:17], v[16:17], v[20:21]
v_pk_add_f32 v[24:25], v[24:25], v[28:29]
v_pk_add_f32 v[18:19], v[18:19], v[22:23]
v_pk_add_f32 v[26:27], v[26:27], v[30:31]
v_pk_add_f32 v[16:17], v[16:17], v[24:25]
v_pk_add_f32 v[18:19], v[18:19], v[26:27]
v_mov_b32 v20, v16
v_mov_b32 v21, v17
v_mov_b32 v22, v18
v_mov_b32 v23, v19
v_permlane16_swap_b32 v16, v20
v_permlane16_swap_b32 v17, v21
v_permlane16_swap_b32 v18, v22
v_permlane16_swap_b32 v19, v23
v_add_f32 v16, v16, v20
v_add_f32 v17, v17, v21
v_add_f32 v18, v18, v22
v_add_f32 v19, v19, v23
v_mov_b32 v20, v16
v_mov_b32 v21, v17
v_mov_b32 v22, v18
v_mov_b32 v23, v19
v_permlane32_swap_b32 v16, v20
v_permlane32_swap_b32 v17, v21
v_permlane32_swap_b32 v18, v22
v_permlane32_swap_b32 v19, v23
v_add_f32 v16, v16, v20
v_add_f32 v17, v17, v21
v_add_f32 v18, v18, v22
v_add_f32_e64 v19, v19, v23
v_cvt_pk_bf16_f32 v16, v16, v17
v_cvt_pk_bf16_f32 v17, v18, v19
ds_write_b64 v198, v[16:17]
Lzsum_70:
s_waitcnt vmcnt(9)
v_dot2c_f32_bf16 v188, s87, v220
v_dot2c_f32_bf16 v189, s88, v220
v_dot2c_f32_bf16 v190, s87, v221
v_dot2c_f32_bf16 v191, s88, v221
v_dot2c_f32_bf16 v192, s87, v222
v_dot2c_f32_bf16 v193, s88, v222
v_dot2c_f32_bf16 v194, s87, v223
v_dot2c_f32_bf16 v195, s88, v223
s_waitcnt vmcnt(8)
v_dot2c_f32_bf16 v188, s87, v224
v_dot2c_f32_bf16 v189, s88, v224
v_dot2c_f32_bf16 v190, s87, v225
v_dot2c_f32_bf16 v191, s88, v225
v_dot2c_f32_bf16 v192, s87, v226
v_dot2c_f32_bf16 v193, s88, v226
v_dot2c_f32_bf16 v194, s87, v227
v_dot2c_f32_bf16 v195, s88, v227
s_waitcnt vmcnt(7)
v_dot2c_f32_bf16 v188, s87, v228
v_dot2c_f32_bf16 v189, s88, v228
v_dot2c_f32_bf16 v190, s87, v229
v_dot2c_f32_bf16 v191, s88, v229
v_dot2c_f32_bf16 v192, s87, v230
v_dot2c_f32_bf16 v193, s88, v230
v_dot2c_f32_bf16 v194, s87, v231
v_dot2c_f32_bf16 v195, s88, v231
s_waitcnt vmcnt(6)
v_dot2c_f32_bf16 v188, s87, v232
v_dot2c_f32_bf16 v189, s88, v232
v_dot2c_f32_bf16 v190, s87, v233
v_dot2c_f32_bf16 v191, s88, v233
v_dot2c_f32_bf16 v192, s87, v234
v_dot2c_f32_bf16 v193, s88, v234
v_dot2c_f32_bf16 v194, s87, v235
v_dot2c_f32_bf16 v195, s88, v235
s_waitcnt vmcnt(5)
v_dot2c_f32_bf16 v188, s87, v236
v_dot2c_f32_bf16 v189, s88, v236
v_dot2c_f32_bf16 v190, s87, v237
v_dot2c_f32_bf16 v191, s88, v237
v_dot2c_f32_bf16 v192, s87, v238
v_dot2c_f32_bf16 v193, s88, v238
v_dot2c_f32_bf16 v194, s87, v239
v_dot2c_f32_bf16 v195, s88, v239
s_waitcnt vmcnt(4)
v_dot2c_f32_bf16 v188, s87, v240
v_dot2c_f32_bf16 v189, s88, v240
v_dot2c_f32_bf16 v190, s87, v241
v_dot2c_f32_bf16 v191, s88, v241
v_dot2c_f32_bf16 v192, s87, v242
v_dot2c_f32_bf16 v193, s88, v242
v_dot2c_f32_bf16 v194, s87, v243
v_dot2c_f32_bf16 v195, s88, v243
s_waitcnt vmcnt(3)
v_dot2c_f32_bf16 v188, s87, v244
v_dot2c_f32_bf16 v189, s88, v244
v_dot2c_f32_bf16 v190, s87, v245
v_dot2c_f32_bf16 v191, s88, v245
v_dot2c_f32_bf16 v192, s87, v246
v_dot2c_f32_bf16 v193, s88, v246
v_dot2c_f32_bf16 v194, s87, v247
v_dot2c_f32_bf16 v195, s88, v247
s_waitcnt vmcnt(2)
v_dot2c_f32_bf16 v188, s87, v248
v_dot2c_f32_bf16 v189, s88, v248
v_dot2c_f32_bf16 v190, s87, v249
v_dot2c_f32_bf16 v191, s88, v249
v_dot2c_f32_bf16 v192, s87, v250
v_dot2c_f32_bf16 v193, s88, v250
v_dot2c_f32_bf16 v194, s87, v251
v_dot2c_f32_bf16 v195, s88, v251
v_permlane32_swap_b32 v188, v192
v_permlane32_swap_b32 v189, v193
v_permlane32_swap_b32 v190, v194
v_permlane32_swap_b32 v191, v195
v_pk_add_f32 v[188:189], v[188:189], v[192:193]
v_pk_add_f32 v[190:191], v[190:191], v[194:195]
v_cvt_pk_bf16_f32 v188, v188, v189
v_cvt_pk_bf16_f32 v189, v190, v191
ds_write_b64 v196, v[188:189]
s_waitcnt vmcnt(0)
s_waitcnt lgkmcnt(0)
s_barrier
ds_read_b128 v[176:179], v197 offset:0
ds_read_b128 v[180:183], v197 offset:1024
ds_read_b128 v[184:187], v197 offset:2048
ds_read_b128 v[188:191], v197 offset:3072
s_waitcnt lgkmcnt(0)
v_mfma_f32_32x32x16_bf16 v[200:215], v[176:179], v[160:163], 0
v_mfma_f32_32x32x16_bf16 v[200:215], v[180:183], v[164:167], v[200:215]
v_mfma_f32_32x32x16_bf16 v[216:231], v[184:187], v[168:171], 0
v_mfma_f32_32x32x16_bf16 v[216:231], v[188:191], v[172:175], v[216:231]
s_nop 9
v_add_f32 v208, 0x358637bd, v208
v_rcp_f32_e64 v208, v208
s_nop 0
v_pk_mul_f32 v[200:201], v[200:201], v[208:209] op_sel_hi:[1,0]
v_pk_mul_f32 v[202:203], v[202:203], v[208:209] op_sel_hi:[1,0]
v_pk_mul_f32 v[204:205], v[204:205], v[208:209] op_sel_hi:[1,0]
v_pk_mul_f32 v[206:207], v[206:207], v[208:209] op_sel_hi:[1,0]
v_cvt_pk_bf16_f32 v212, v200, v201
v_cvt_pk_bf16_f32 v213, v202, v203
v_cvt_pk_bf16_f32 v214, v204, v205
v_cvt_pk_bf16_f32 v215, v206, v207
buffer_store_dwordx4 v[212:215], v1, s[36:39], s82 offen sc1
v_add_f32 v224, 0x358637bd, v224
v_rcp_f32 v224, v224
s_nop 0
v_pk_mul_f32 v[216:217], v[216:217], v[224:225] op_sel_hi:[1,0]
v_pk_mul_f32 v[218:219], v[218:219], v[224:225] op_sel_hi:[1,0]
v_pk_mul_f32 v[220:221], v[220:221], v[224:225] op_sel_hi:[1,0]
v_pk_mul_f32 v[222:223], v[222:223], v[224:225] op_sel_hi:[1,0]
v_cvt_pk_bf16_f32 v228, v216, v217
v_cvt_pk_bf16_f32 v229, v218, v219
v_cvt_pk_bf16_f32 v230, v220, v221
v_cvt_pk_bf16_f32 v231, v222, v223
buffer_store_dwordx4 v[228:231], v1, s[36:39], s82 offen offset:1024 sc1
s_lshl_b32 s77, s74, 15
s_add_u32 s77, s77, 100352
s_mul_i32 s78, s74, 4294934528
s_add_u32 s78, s78, 131072
v_add_u32 v7, s77, v2
v_add_u32_e64 v11, s77, v3
ds_read_b64_tr_b16 v[16:17], v7 offset:0
ds_read_b64_tr_b16 v[18:19], v7 offset:512
ds_read_b64_tr_b16 v[20:21], v11 offset:0
ds_read_b64_tr_b16 v[22:23], v11 offset:512
ds_read_b64_tr_b16 v[24:25], v7 offset:2048
ds_read_b64_tr_b16 v[26:27], v7 offset:2560
ds_read_b64_tr_b16 v[28:29], v11 offset:2048
ds_read_b64_tr_b16 v[30:31], v11 offset:2560
ds_read_b64_tr_b16 v[32:33], v7 offset:4096
ds_read_b64_tr_b16 v[34:35], v7 offset:4608
ds_read_b64_tr_b16 v[36:37], v11 offset:4096
ds_read_b64_tr_b16 v[38:39], v11 offset:4608
s_lshl_b32 s80, s69, 2
s_lshl_b32 s77, s73, 1
s_add_u32 s80, s80, s77
s_add_u32 s80, s80, s75
s_lshl_b32 s81, s80, 12
s_lshl_b32 s77, s72, 9
s_add_u32 s81, s81, s77
s_lshl_b32 s77, s74, 3
s_add_u32 s81, s81, s77
s_lshl_b32 s80, s80, 15
s_lshl_b32 s77, s72, 7
s_lshl_b32 s78, s74, 6
s_add_u32 s77, s77, s78
s_add_u32 s79, s80, s77
s_lshl_b32 s77, s77, 5
s_add_u32 s80, s80, s77
v_and_b32 v7, 31, v0
v_lshrrev_b32 v11, 5, v0
v_lshlrev_b32_e64 v14, 10, v7
v_lshl_add_u32 v14, v11, 4, v14
v_lshlrev_b32_e64 v7, 4, v7
v_lshl_add_u32 v5, v11, 2, v7
s_lshl_b32 s77, s73, 1
s_add_u32 s77, s77, s75
s_lshl_b32 s82, s69, 2
s_add_u32 s82, s82, s77
s_lshl_b32 s77, s82, 6
s_lshl_b32 s78, s74, 5
s_add_u32 s77, s77, s78
s_add_u32 s77, s77, 16384
v_and_b32 v252, 7, v0
v_lshl_add_u32 v252, v252, 2, s77
s_lshl_b32 s82, s82, 15
s_lshl_b32 s78, s74, 14
s_add_u32 s82, s82, s78
s_add_u32 s89, s82, 4194304
s_xor_b32 s77, s68, 2
s_lshl_b32 s77, s77, 12
s_add_u32 s77, s77, 141312
v_add_u32_e64 v12, s77, v1
s_lshl_b32 s77, s68, 12
s_add_u32 s77, s77, 141312
v_add_u32 v13, s77, v1
v_mov_b32 v7, 1
v_mov_b32_e64 v6, s83
s_waitcnt vmcnt(0)
s_mov_b64 exec, 1
buffer_store_dword v7, v6, s[36:39], 0 offen sc1
s_mov_b64 exec, -1
buffer_load_dwordx4 v[240:243], v14, s[28:31], s79 offen
buffer_load_dwordx4 v[244:247], v14, s[28:31], s79 offen offset:32
s_lshl_b32 s77, s74, 15
s_add_u32 s77, s77, 100352
s_mul_i32 s78, s74, 4294934528
s_add_u32 s78, s78, 131072
v_add_u32 v7, s77, v2
v_add_u32 v11, s77, v3
ds_read_b64_tr_b16 v[40:41], v7 offset:6144
ds_read_b64_tr_b16 v[42:43], v7 offset:6656
ds_read_b64_tr_b16 v[44:45], v11 offset:6144
ds_read_b64_tr_b16 v[46:47], v11 offset:6656
ds_read_b64_tr_b16 v[48:49], v7 offset:8192
ds_read_b64_tr_b16 v[50:51], v7 offset:8704
ds_read_b64_tr_b16 v[52:53], v11 offset:8192
ds_read_b64_tr_b16 v[54:55], v11 offset:8704
ds_read_b64_tr_b16 v[56:57], v7 offset:10240
ds_read_b64_tr_b16 v[58:59], v7 offset:10752
ds_read_b64_tr_b16 v[60:61], v11 offset:10240
ds_read_b64_tr_b16 v[62:63], v11 offset:10752
ds_read_b64_tr_b16 v[64:65], v7 offset:12288
ds_read_b64_tr_b16 v[66:67], v7 offset:12800
ds_read_b64_tr_b16 v[68:69], v11 offset:12288
ds_read_b64_tr_b16 v[70:71], v11 offset:12800
ds_read_b64_tr_b16 v[72:73], v7 offset:14336
ds_read_b64_tr_b16 v[74:75], v7 offset:14848
ds_read_b64_tr_b16 v[76:77], v11 offset:14336
ds_read_b64_tr_b16 v[78:79], v11 offset:14848
ds_read_b64_tr_b16 v[80:81], v7 offset:16384
ds_read_b64_tr_b16 v[82:83], v7 offset:16896
ds_read_b64_tr_b16 v[84:85], v11 offset:16384
ds_read_b64_tr_b16 v[86:87], v11 offset:16896
buffer_load_dword v6, v252, s[36:39], 0 offen sc1
s_lshl_b32 s77, s74, 15
s_add_u32 s77, s77, 100352
s_mul_i32 s78, s74, 4294934528
s_add_u32 s78, s78, 131072
v_add_u32 v7, s77, v2
v_add_u32_e64 v11, s77, v3
ds_read_b64_tr_b16 v[88:89], v7 offset:18432
ds_read_b64_tr_b16 v[90:91], v7 offset:18944
ds_read_b64_tr_b16 v[92:93], v11 offset:18432
ds_read_b64_tr_b16 v[94:95], v11 offset:18944
ds_read_b64_tr_b16 v[96:97], v7 offset:20480
ds_read_b64_tr_b16 v[98:99], v7 offset:20992
ds_read_b64_tr_b16 v[100:101], v11 offset:20480
ds_read_b64_tr_b16 v[102:103], v11 offset:20992
ds_read_b64_tr_b16 v[104:105], v7 offset:22528
ds_read_b64_tr_b16 v[106:107], v7 offset:23040
ds_read_b64_tr_b16 v[108:109], v11 offset:22528
ds_read_b64_tr_b16 v[110:111], v11 offset:23040
ds_read_b64_tr_b16 v[112:113], v7 offset:24576
ds_read_b64_tr_b16 v[114:115], v7 offset:25088
ds_read_b64_tr_b16 v[116:117], v11 offset:24576
ds_read_b64_tr_b16 v[118:119], v11 offset:25088
ds_read_b64_tr_b16 v[120:121], v7 offset:26624
ds_read_b64_tr_b16 v[122:123], v7 offset:27136
ds_read_b64_tr_b16 v[124:125], v11 offset:26624
ds_read_b64_tr_b16 v[126:127], v11 offset:27136
ds_read_b64_tr_b16 v[128:129], v7 offset:28672
ds_read_b64_tr_b16 v[130:131], v7 offset:29184
ds_read_b64_tr_b16 v[132:133], v11 offset:28672
ds_read_b64_tr_b16 v[134:135], v11 offset:29184
v_add_u32 v7, s78, v2
v_add_u32 v11, s78, v3
ds_read_b64_tr_b16 v[136:137], v7 offset:0
ds_read_b64_tr_b16 v[138:139], v7 offset:512
ds_read_b64_tr_b16 v[140:141], v11 offset:0
ds_read_b64_tr_b16 v[142:143], v11 offset:512
s_waitcnt vmcnt(0)
v_cmp_gt_u32 vcc, 1, v6
s_nop 0
s_cbranch_vccz Lgo_72
Lpoll_71:
buffer_load_dword v6, v252, s[36:39], 0 offen sc1
s_waitcnt vmcnt(0)
v_cmp_gt_u32 vcc, 1, v6
s_nop 0
s_cbranch_vccz Lgo_72
s_add_u32 s91, s91, 1
s_bitcmp0_b32 s91, 16
s_cbranch_scc1 Lpoll_71
Lgo_72:
s_mov_b32 s94, 12288
buffer_load_dwordx4 v[248:251], v1, s[36:39], s94 offen sc1
buffer_load_dwordx4 v[144:147], v1, s[36:39], s89 offen sc1
buffer_load_dwordx4 v[148:151], v1, s[36:39], s89 offen offset:1024 sc1
buffer_load_dwordx4 v[152:155], v1, s[36:39], s89 offen offset:2048 sc1
buffer_load_dwordx4 v[156:159], v1, s[36:39], s89 offen offset:3072 sc1
s_add_u32 s89, s89, 4096
buffer_load_dwordx4 v[160:163], v1, s[36:39], s89 offen sc1
buffer_load_dwordx4 v[164:167], v1, s[36:39], s89 offen offset:1024 sc1
buffer_load_dwordx4 v[168:171], v1, s[36:39], s89 offen offset:2048 sc1
buffer_load_dwordx4 v[172:175], v1, s[36:39], s89 offen offset:3072 sc1
s_add_u32 s89, s89, 4096
buffer_load_dwordx4 v[176:179], v1, s[36:39], s89 offen sc1
buffer_load_dwordx4 v[180:183], v1, s[36:39], s89 offen offset:1024 sc1
buffer_load_dwordx4 v[184:187], v1, s[36:39], s89 offen offset:2048 sc1
buffer_load_dwordx4 v[188:191], v1, s[36:39], s89 offen offset:3072 sc1
s_waitcnt lgkmcnt(0)
s_barrier
s_waitcnt vmcnt(11)
v_mfma_f32_32x32x16_bf16 v[208:223], v[16:19], v[144:147], 0
v_mfma_f32_32x32x16_bf16 v[224:239], v[20:23], v[144:147], 0
s_add_u32 s89, s89, 4096
buffer_load_dwordx4 v[192:195], v1, s[36:39], s89 offen sc1
s_waitcnt vmcnt(11)
v_mfma_f32_32x32x16_bf16 v[208:223], v[24:27], v[148:151], v[208:223]
v_mfma_f32_32x32x16_bf16 v[224:239], v[28:31], v[148:151], v[224:239]
buffer_load_dwordx4 v[196:199], v1, s[36:39], s89 offen offset:1024 sc1
s_waitcnt vmcnt(11)
v_mfma_f32_32x32x16_bf16 v[208:223], v[32:35], v[152:155], v[208:223]
v_mfma_f32_32x32x16_bf16 v[224:239], v[36:39], v[152:155], v[224:239]
buffer_load_dwordx4 v[200:203], v1, s[36:39], s89 offen offset:2048 sc1
s_waitcnt vmcnt(11)
v_mfma_f32_32x32x16_bf16 v[208:223], v[40:43], v[156:159], v[208:223]
v_mfma_f32_32x32x16_bf16 v[224:239], v[44:47], v[156:159], v[224:239]
buffer_load_dwordx4 v[204:207], v1, s[36:39], s89 offen offset:3072 sc1
s_waitcnt vmcnt(11)
v_mfma_f32_32x32x16_bf16 v[208:223], v[48:51], v[160:163], v[208:223]
v_min_u32_e64 v248, v248, v249
v_min3_u32 v248, v248, v250, v251
v_cmp_eq_u32 vcc, 0, v248
s_nop 0
s_cbranch_vccz Lpwok_74
Lpw_73:
s_mov_b32 s94, 12288
buffer_load_dwordx4 v[248:251], v1, s[36:39], s94 offen sc1
s_waitcnt vmcnt(0)
v_min_u32_e64 v248, v248, v249
v_min3_u32 v248, v248, v250, v251
v_cmp_eq_u32 vcc, 0, v248
s_nop 0
s_cbranch_vccz Lpwok_74
s_add_u32 s91, s91, 1
s_bitcmp0_b32 s91, 16
s_cbranch_scc1 Lpw_73
Lpwok_74:
v_mfma_f32_32x32x16_bf16 v[224:239], v[52:55], v[160:163], v[224:239]
s_waitcnt vmcnt(10)
v_mfma_f32_32x32x16_bf16 v[208:223], v[56:59], v[164:167], v[208:223]
s_add_u32 m0, s100, 67584
s_add_u32 s18, s99, 0
buffer_load_dwordx4 v1, s[36:39], s18 offen lds
v_mfma_f32_32x32x16_bf16 v[224:239], v[60:63], v[164:167], v[224:239]
s_waitcnt vmcnt(10)
v_mfma_f32_32x32x16_bf16 v[208:223], v[64:67], v[168:171], v[208:223]
s_add_u32 m0, s100, 67584
s_add_u32 s18, s99, 0
buffer_load_dwordx4 v1, s[36:39], s18 offen offset:1024 lds
v_mfma_f32_32x32x16_bf16 v[224:239], v[68:71], v[168:171], v[224:239]
s_waitcnt vmcnt(10)
v_mfma_f32_32x32x16_bf16 v[208:223], v[72:75], v[172:175], v[208:223]
s_add_u32 m0, s100, 75776
s_add_u32 s18, s99, 8192
buffer_load_dwordx4 v1, s[36:39], s18 offen lds
v_mfma_f32_32x32x16_bf16 v[224:239], v[76:79], v[172:175], v[224:239]
s_waitcnt vmcnt(10)
v_mfma_f32_32x32x16_bf16 v[208:223], v[80:83], v[176:179], v[208:223]
s_add_u32 m0, s100, 75776
s_add_u32 s18, s99, 8192
buffer_load_dwordx4 v1, s[36:39], s18 offen offset:1024 lds
v_mfma_f32_32x32x16_bf16 v[224:239], v[84:87], v[176:179], v[224:239]
s_waitcnt vmcnt(10)
v_mfma_f32_32x32x16_bf16 v[208:223], v[88:91], v[180:183], v[208:223]
s_add_u32 m0, s100, 83968
s_add_u32 s18, s99, 16384
buffer_load_dwordx4 v1, s[36:39], s18 offen lds
v_mfma_f32_32x32x16_bf16 v[224:239], v[92:95], v[180:183], v[224:239]
s_waitcnt vmcnt(10)
v_mfma_f32_32x32x16_bf16 v[208:223], v[96:99], v[184:187], v[208:223]
s_add_u32 m0, s100, 83968
s_add_u32 s18, s99, 16384
buffer_load_dwordx4 v1, s[36:39], s18 offen offset:1024 lds
v_mfma_f32_32x32x16_bf16 v[224:239], v[100:103], v[184:187], v[224:239]
s_waitcnt vmcnt(10)
v_mfma_f32_32x32x16_bf16 v[208:223], v[104:107], v[188:191], v[208:223]
s_add_u32 m0, s100, 100352
s_add_u32 s18, s99, 24576
buffer_load_dwordx4 v1, s[36:39], s18 offen lds
v_mfma_f32_32x32x16_bf16 v[224:239], v[108:111], v[188:191], v[224:239]
s_waitcnt vmcnt(10)
v_mfma_f32_32x32x16_bf16 v[208:223], v[112:115], v[192:195], v[208:223]
s_add_u32 m0, s100, 100352
s_add_u32 s18, s99, 24576
buffer_load_dwordx4 v1, s[36:39], s18 offen offset:1024 lds
v_mfma_f32_32x32x16_bf16 v[224:239], v[116:119], v[192:195], v[224:239]
s_waitcnt vmcnt(10)
v_mfma_f32_32x32x16_bf16 v[208:223], v[120:123], v[196:199], v[208:223]
s_add_u32 m0, s100, 108544
s_add_u32 s18, s99, 32768
buffer_load_dwordx4 v1, s[36:39], s18 offen lds
v_mfma_f32_32x32x16_bf16 v[224:239], v[124:127], v[196:199], v[224:239]
s_waitcnt vmcnt(10)
v_mfma_f32_32x32x16_bf16 v[208:223], v[128:131], v[200:203], v[208:223]
s_add_u32 m0, s100, 108544
s_add_u32 s18, s99, 32768
buffer_load_dwordx4 v1, s[36:39], s18 offen offset:1024 lds
v_mfma_f32_32x32x16_bf16 v[224:239], v[132:135], v[200:203], v[224:239]
s_waitcnt vmcnt(10)
v_mfma_f32_32x32x16_bf16 v[208:223], v[136:139], v[204:207], v[208:223]
s_add_u32 m0, s100, 116736
s_add_u32 s18, s99, 40960
buffer_load_dwordx4 v1, s[36:39], s18 offen lds
v_mfma_f32_32x32x16_bf16 v[224:239], v[140:143], v[204:207], v[224:239]
s_add_u32 m0, s100, 116736
s_add_u32 s18, s99, 40960
buffer_load_dwordx4 v1, s[36:39], s18 offen offset:1024 lds
s_add_u32 m0, s100, 124928
s_add_u32 s18, s99, 49152
buffer_load_dwordx4 v1, s[36:39], s18 offen lds
s_add_u32 m0, s100, 124928
s_add_u32 s18, s99, 49152
buffer_load_dwordx4 v1, s[36:39], s18 offen offset:1024 lds
s_add_u32 m0, s100, 133120
s_add_u32 s18, s99, 57344
buffer_load_dwordx4 v1, s[36:39], s18 offen lds
s_add_u32 m0, s100, 133120
s_add_u32 s18, s99, 57344
buffer_load_dwordx4 v1, s[36:39], s18 offen offset:1024 lds
s_cmp_lg_u32 s74, 0
s_cbranch_scc1 Lkhi_75
ds_write_b128 v12, v[224:227] offset:0
ds_write_b128 v12, v[228:231] offset:1024
ds_write_b128 v12, v[232:235] offset:2048
ds_write_b128 v12, v[236:239] offset:3072
s_branch Lkd_76
Lkhi_75:
ds_write_b128 v12, v[208:211] offset:0
ds_write_b128 v12, v[212:215] offset:1024
ds_write_b128 v12, v[216:219] offset:2048
ds_write_b128 v12, v[220:223] offset:3072
v_pk_add_f32 v[208:209], v[224:225], 0
v_pk_add_f32 v[210:211], v[226:227], 0
v_pk_add_f32 v[212:213], v[228:229], 0
v_pk_add_f32 v[214:215], v[230:231], 0
v_pk_add_f32 v[216:217], v[232:233], 0
v_pk_add_f32 v[218:219], v[234:235], 0
v_pk_add_f32 v[220:221], v[236:237], 0
v_pk_add_f32 v[222:223], v[238:239], 0
Lkd_76:
v_dot2c_f32_bf16 v208, s87, v240
v_dot2c_f32_bf16 v209, s88, v240
v_dot2c_f32_bf16 v210, s87, v241
v_dot2c_f32_bf16 v211, s88, v241
v_dot2c_f32_bf16 v212, s87, v242
v_dot2c_f32_bf16 v213, s88, v242
v_dot2c_f32_bf16 v214, s87, v243
v_dot2c_f32_bf16 v215, s88, v243
v_dot2c_f32_bf16 v216, s87, v244
v_dot2c_f32_bf16 v217, s88, v244
v_dot2c_f32_bf16 v218, s87, v245
v_dot2c_f32_bf16 v219, s88, v245
v_dot2c_f32_bf16 v220, s87, v246
v_dot2c_f32_bf16 v221, s88, v246
v_dot2c_f32_bf16 v222, s87, v247
v_dot2c_f32_bf16 v223, s88, v247
s_waitcnt lgkmcnt(0)
s_barrier
ds_read_b128 v[224:227], v13 offset:0
ds_read_b128 v[228:231], v13 offset:1024
ds_read_b128 v[232:235], v13 offset:2048
ds_read_b128 v[236:239], v13 offset:3072
s_waitcnt lgkmcnt(0)
v_pk_add_f32 v[208:209], v[208:209], v[224:225]
v_pk_add_f32 v[210:211], v[210:211], v[226:227]
v_pk_add_f32 v[212:213], v[212:213], v[228:229]
v_pk_add_f32 v[214:215], v[214:215], v[230:231]
v_pk_add_f32 v[216:217], v[216:217], v[232:233]
v_pk_add_f32 v[218:219], v[218:219], v[234:235]
v_pk_add_f32 v[220:221], v[220:221], v[236:237]
v_pk_add_f32 v[222:223], v[222:223], v[238:239]
v_cvt_pk_bf16_f32 v240, v208, v209
v_cvt_pk_bf16_f32 v241, v210, v211
v_cvt_pk_bf16_f32 v242, v212, v213
v_cvt_pk_bf16_f32 v243, v214, v215
v_cvt_pk_bf16_f32 v244, v216, v217
v_cvt_pk_bf16_f32 v245, v218, v219
v_cvt_pk_bf16_f32 v246, v220, v221
v_cvt_pk_bf16_f32 v247, v222, v223
s_add_u32 s77, s80, 6291456
buffer_store_dwordx4 v[240:243], v1, s[36:39], s77 offen sc1
buffer_store_dwordx4 v[244:247], v1, s[36:39], s77 offen offset:1024 sc1
v_mov_b32 v208, 0
v_mov_b32_e64 v209, 0
v_dot2c_f32_bf16 v208, s86, v240
v_dot2c_f32_bf16 v209, v240, v240
v_dot2c_f32_bf16 v208, s86, v241
v_dot2c_f32_bf16 v209, v241, v241
v_dot2c_f32_bf16 v208, s86, v242
v_dot2c_f32_bf16 v209, v242, v242
v_dot2c_f32_bf16 v208, s86, v243
v_dot2c_f32_bf16 v209, v243, v243
v_dot2c_f32_bf16 v208, s86, v244
v_dot2c_f32_bf16 v209, v244, v244
v_dot2c_f32_bf16 v208, s86, v245
v_dot2c_f32_bf16 v209, v245, v245
v_dot2c_f32_bf16 v208, s86, v246
v_dot2c_f32_bf16 v209, v246, v246
v_dot2c_f32_bf16 v208, s86, v247
v_dot2c_f32_bf16 v209, v247, v247
s_add_u32 s77, s81, 262144
s_nop 1
v_permlane32_swap_b32 v208, v209
v_add_f32_e64 v208, v208, v209
buffer_store_dword v208, v5, s[36:39], s77 offen sc1
s_lshl_b32 s97, s71, 12
s_add_u32 s97, s97, 262144
v_and_b32 v7, 31, v0
v_lshlrev_b32 v7, 4, v7
v_lshrrev_b32 v5, 5, v0
v_lshl_add_u32 v5, v5, 11, v7
s_lshl_b32 s89, s71, 15
s_add_u32 s89, s89, 6291456
v_lshrrev_b32 v7, 4, v0
v_and_b32 v14, 15, v0
v_lshlrev_b32 v14, 4, v14
v_lshl_add_u32 v14, v7, 9, v14
v_add_u32 v12, 67584, v1
v_add_u32 v13, 133120, v1
s_mul_i32 s90, s71, 114688
s_mul_i32 s77, s70, 7168
s_add_u32 s90, s90, s77
s_add_u32 s90, s90, 10485760
s_lshl_b32 s77, s69, 8
s_lshl_b32 s78, s75, 6
s_add_u32 s77, s77, s78
s_lshl_b32 s78, s74, 5
s_add_u32 s77, s77, s78
s_add_u32 s77, s77, 16384
v_and_b32_e64 v7, 7, v0
v_bfe_u32 v11, v0, 3, 1
v_lshlrev_b32_e64 v11, 7, v11
v_lshl_add_u32 v11, v7, 2, v11
v_add_u32 v11, s77, v11
v_mov_b32 v7, 2
v_mov_b32_e64 v6, s83
s_waitcnt vmcnt(0)
s_mov_b64 exec, 1
buffer_store_dword v7, v6, s[36:39], 0 offen sc1
s_mov_b64 exec, -1
s_barrier
ds_read_b128 a[240:243], v12 offset:0
ds_read_b128 a[244:247], v12 offset:1024
ds_read_b128 a[248:251], v12 offset:2048
ds_read_b128 a[252:255], v12 offset:3072
Lpoll_77:
buffer_load_dword v6, v11, s[36:39], 0 offen sc1
s_waitcnt vmcnt(0)
v_cmp_gt_u32 vcc, 2, v6
s_nop 0
s_cbranch_vccz Lgo_78
s_add_u32 s91, s91, 1
s_bitcmp0_b32 s91, 16
s_cbranch_scc1 Lpoll_77
Lgo_78:
buffer_load_dwordx4 v[16:19], v14, s[36:39], s89 offen sc1
buffer_load_dwordx4 v[20:23], v14, s[36:39], s89 offen offset:256 sc1
buffer_load_dwordx4 v[24:27], v14, s[36:39], s89 offen offset:2048 sc1
buffer_load_dwordx4 v[28:31], v14, s[36:39], s89 offen offset:2304 sc1
s_mul_i32 s77, s70, 896
s_mul_i32 s78, s68, 28672
s_add_u32 s77, s77, s78
s_add_u32 s16, s77, 131072
s_add_u32 s17, s16, 14336
s_waitcnt vmcnt(2) lgkmcnt(3)
v_mfma_f32_16x16x32_bf16 v[144:147], a[240:243], v[16:19], 0
s_add_u32 s89, s89, 4096
buffer_load_dwordx4 v[32:35], v14, s[36:39], s89 offen sc1
v_mfma_f32_16x16x32_bf16 v[148:151], a[240:243], v[20:23], 0
ds_read_b128 a[240:243], v12 offset:4096
s_waitcnt lgkmcnt(3)
v_mfma_f32_16x16x32_bf16 v[152:155], a[244:247], v[16:19], 0
buffer_load_dwordx4 v[36:39], v14, s[36:39], s89 offen offset:256 sc1
v_mfma_f32_16x16x32_bf16 v[156:159], a[244:247], v[20:23], 0
ds_read_b128 a[244:247], v12 offset:5120
s_waitcnt lgkmcnt(3)
v_mfma_f32_16x16x32_bf16 v[160:163], a[248:251], v[16:19], 0
buffer_load_dwordx4 v[40:43], v14, s[36:39], s89 offen offset:2048 sc1
v_mfma_f32_16x16x32_bf16 v[164:167], a[248:251], v[20:23], 0
ds_read_b128 a[248:251], v12 offset:6144
s_waitcnt lgkmcnt(3)
v_mfma_f32_16x16x32_bf16 v[168:171], a[252:255], v[16:19], 0
buffer_load_dwordx4 v[44:47], v14, s[36:39], s89 offen offset:2304 sc1
v_mfma_f32_16x16x32_bf16 v[172:175], a[252:255], v[20:23], 0
ds_read_b128 a[252:255], v12 offset:7168
s_waitcnt lgkmcnt(3)
v_mfma_f32_16x16x32_bf16 v[176:179], a[240:243], v[16:19], 0
s_add_u32 s89, s89, 4096
buffer_load_dwordx4 v[48:51], v14, s[36:39], s89 offen sc1
v_mfma_f32_16x16x32_bf16 v[180:183], a[240:243], v[20:23], 0
ds_read_b128 a[240:243], v12 offset:8192
s_waitcnt lgkmcnt(3)
v_mfma_f32_16x16x32_bf16 v[184:187], a[244:247], v[16:19], 0
buffer_load_dwordx4 v[52:55], v14, s[36:39], s89 offen offset:256 sc1
v_mfma_f32_16x16x32_bf16 v[188:191], a[244:247], v[20:23], 0
ds_read_b128 a[244:247], v12 offset:9216
s_waitcnt lgkmcnt(3)
v_mfma_f32_16x16x32_bf16 v[192:195], a[248:251], v[16:19], 0
buffer_load_dwordx4 v[240:243], v5, s[36:39], s97 offen sc1
v_mfma_f32_16x16x32_bf16 v[196:199], a[248:251], v[20:23], 0
ds_read_b128 a[248:251], v12 offset:10240
s_waitcnt lgkmcnt(3)
v_mfma_f32_16x16x32_bf16 v[200:203], a[252:255], v[16:19], 0
v_mfma_f32_16x16x32_bf16 v[204:207], a[252:255], v[20:23], 0
ds_read_b128 a[252:255], v12 offset:11264
s_waitcnt lgkmcnt(3)
v_mfma_f32_16x16x32_bf16 v[208:211], a[240:243], v[16:19], 0
buffer_load_dwordx4 v[244:247], v5, s[36:39], s97 offen offset:512 sc1
v_mfma_f32_16x16x32_bf16 v[212:215], a[240:243], v[20:23], 0
ds_read_b128 a[240:243], v12 offset:12288
s_waitcnt lgkmcnt(3)
v_mfma_f32_16x16x32_bf16 v[216:219], a[244:247], v[16:19], 0
v_mfma_f32_16x16x32_bf16 v[220:223], a[244:247], v[20:23], 0
ds_read_b128 a[244:247], v12 offset:13312
s_waitcnt vmcnt(8) lgkmcnt(3)
v_mfma_f32_16x16x32_bf16 v[144:147], a[248:251], v[24:27], v[144:147]
buffer_load_dwordx4 v[248:251], v5, s[36:39], s97 offen offset:1024 sc1
v_mfma_f32_16x16x32_bf16 v[148:151], a[248:251], v[28:31], v[148:151]
ds_read_b128 a[248:251], v12 offset:14336
s_waitcnt lgkmcnt(3)
v_mfma_f32_16x16x32_bf16 v[152:155], a[252:255], v[24:27], v[152:155]
v_mfma_f32_16x16x32_bf16 v[156:159], a[252:255], v[28:31], v[156:159]
ds_read_b128 a[252:255], v12 offset:15360
s_waitcnt lgkmcnt(3)
v_mfma_f32_16x16x32_bf16 v[160:163], a[240:243], v[24:27], v[160:163]
buffer_load_dwordx4 v[252:255], v5, s[36:39], s97 offen offset:1536 sc1
v_mfma_f32_16x16x32_bf16 v[164:167], a[240:243], v[28:31], v[164:167]
s_barrier
ds_read_b128 a[240:243], v12 offset:16384
s_waitcnt lgkmcnt(3)
v_mfma_f32_16x16x32_bf16 v[168:171], a[244:247], v[24:27], v[168:171]
v_mfma_f32_16x16x32_bf16 v[172:175], a[244:247], v[28:31], v[172:175]
ds_read_b128 a[244:247], v12 offset:17408
s_waitcnt lgkmcnt(3)
v_mfma_f32_16x16x32_bf16 v[176:179], a[248:251], v[24:27], v[176:179]
buffer_load_dwordx4 v[224:227], v1, s[36:39], s16 offen sc1
v_mfma_f32_16x16x32_bf16 v[180:183], a[248:251], v[28:31], v[180:183]
ds_read_b128 a[248:251], v12 offset:18432
s_waitcnt lgkmcnt(3)
v_mfma_f32_16x16x32_bf16 v[184:187], a[252:255], v[24:27], v[184:187]
v_mfma_f32_16x16x32_bf16 v[188:191], a[252:255], v[28:31], v[188:191]
ds_read_b128 a[252:255], v12 offset:19456
s_waitcnt lgkmcnt(3)
v_mfma_f32_16x16x32_bf16 v[192:195], a[240:243], v[24:27], v[192:195]
buffer_load_dwordx4 v[228:231], v1, s[36:39], s17 offen sc1
v_mfma_f32_16x16x32_bf16 v[196:199], a[240:243], v[28:31], v[196:199]
ds_read_b128 a[240:243], v12 offset:20480
s_waitcnt lgkmcnt(3)
v_mfma_f32_16x16x32_bf16 v[200:203], a[244:247], v[24:27], v[200:203]
v_mfma_f32_16x16x32_bf16 v[204:207], a[244:247], v[28:31], v[204:207]
ds_read_b128 a[244:247], v12 offset:21504
s_waitcnt lgkmcnt(3)
v_mfma_f32_16x16x32_bf16 v[208:211], a[248:251], v[24:27], v[208:211]
buffer_load_dwordx4 v[56:59], v14, s[36:39], s89 offen offset:2048 sc1
v_mfma_f32_16x16x32_bf16 v[212:215], a[248:251], v[28:31], v[212:215]
ds_read_b128 a[248:251], v12 offset:22528
s_waitcnt lgkmcnt(3)
v_mfma_f32_16x16x32_bf16 v[216:219], a[252:255], v[24:27], v[216:219]
v_mfma_f32_16x16x32_bf16 v[220:223], a[252:255], v[28:31], v[220:223]
ds_read_b128 a[252:255], v12 offset:23552
s_waitcnt vmcnt(11) lgkmcnt(3)
v_mfma_f32_16x16x32_bf16 v[144:147], a[240:243], v[32:35], v[144:147]
buffer_load_dwordx4 v[60:63], v14, s[36:39], s89 offen offset:2304 sc1
v_mfma_f32_16x16x32_bf16 v[148:151], a[240:243], v[36:39], v[148:151]
ds_read_b128 a[240:243], v12 offset:32768
s_waitcnt lgkmcnt(3)
v_mfma_f32_16x16x32_bf16 v[152:155], a[244:247], v[32:35], v[152:155]
v_mfma_f32_16x16x32_bf16 v[156:159], a[244:247], v[36:39], v[156:159]
ds_read_b128 a[244:247], v12 offset:33792
s_waitcnt lgkmcnt(3)
v_mfma_f32_16x16x32_bf16 v[160:163], a[248:251], v[32:35], v[160:163]
s_add_u32 s89, s89, 4096
buffer_load_dwordx4 v[64:67], v14, s[36:39], s89 offen sc1
v_mfma_f32_16x16x32_bf16 v[164:167], a[248:251], v[36:39], v[164:167]
ds_read_b128 a[248:251], v12 offset:34816
s_waitcnt lgkmcnt(3)
v_mfma_f32_16x16x32_bf16 v[168:171], a[252:255], v[32:35], v[168:171]
v_mfma_f32_16x16x32_bf16 v[172:175], a[252:255], v[36:39], v[172:175]
ds_read_b128 a[252:255], v12 offset:35840
s_waitcnt lgkmcnt(3)
v_mfma_f32_16x16x32_bf16 v[176:179], a[240:243], v[32:35], v[176:179]
s_add_u32 m0, s100, 141312
s_add_u32 s18, s99, 65536
buffer_load_dwordx4 v1, s[36:39], s18 offen lds
v_mfma_f32_16x16x32_bf16 v[180:183], a[240:243], v[36:39], v[180:183]
ds_read_b128 a[240:243], v12 offset:36864
s_waitcnt lgkmcnt(3)
v_mfma_f32_16x16x32_bf16 v[184:187], a[244:247], v[32:35], v[184:187]
v_mfma_f32_16x16x32_bf16 v[188:191], a[244:247], v[36:39], v[188:191]
ds_read_b128 a[244:247], v12 offset:37888
s_waitcnt lgkmcnt(3)
v_mfma_f32_16x16x32_bf16 v[192:195], a[248:251], v[32:35], v[192:195]
buffer_load_dwordx4 v1, s[36:39], s18 offen offset:1024 lds
v_mfma_f32_16x16x32_bf16 v[196:199], a[248:251], v[36:39], v[196:199]
ds_read_b128 a[248:251], v12 offset:38912
s_waitcnt lgkmcnt(3)
v_mfma_f32_16x16x32_bf16 v[200:203], a[252:255], v[32:35], v[200:203]
v_mfma_f32_16x16x32_bf16 v[204:207], a[252:255], v[36:39], v[204:207]
ds_read_b128 a[252:255], v12 offset:39936
s_waitcnt lgkmcnt(3)
v_mfma_f32_16x16x32_bf16 v[208:211], a[240:243], v[32:35], v[208:211]
s_add_u32 m0, s100, 149504
s_add_u32 s18, s99, 73728
buffer_load_dwordx4 v1, s[36:39], s18 offen lds
v_mfma_f32_16x16x32_bf16 v[212:215], a[240:243], v[36:39], v[212:215]
s_barrier
ds_read_b128 a[240:243], v12 offset:40960
s_waitcnt lgkmcnt(3)
v_mfma_f32_16x16x32_bf16 v[216:219], a[244:247], v[32:35], v[216:219]
v_mfma_f32_16x16x32_bf16 v[220:223], a[244:247], v[36:39], v[220:223]
ds_read_b128 a[244:247], v12 offset:41984
s_waitcnt vmcnt(14) lgkmcnt(3)
v_mfma_f32_16x16x32_bf16 v[144:147], a[248:251], v[40:43], v[144:147]
buffer_load_dwordx4 v1, s[36:39], s18 offen offset:1024 lds
s_waitcnt vmcnt(9)
v_add_f32_e64 v240, v240, v248
v_mfma_f32_16x16x32_bf16 v[148:151], a[248:251], v[44:47], v[148:151]
ds_read_b128 a[248:251], v12 offset:43008
v_add_f32 v241, v241, v249
s_waitcnt lgkmcnt(3)
v_mfma_f32_16x16x32_bf16 v[152:155], a[252:255], v[40:43], v[152:155]
v_add_f32 v242, v242, v250
v_add_f32 v243, v243, v251
v_mfma_f32_16x16x32_bf16 v[156:159], a[252:255], v[44:47], v[156:159]
ds_read_b128 a[252:255], v12 offset:44032
s_waitcnt lgkmcnt(3)
v_mfma_f32_16x16x32_bf16 v[160:163], a[240:243], v[40:43], v[160:163]
buffer_load_dwordx4 v[68:71], v14, s[36:39], s89 offen offset:256 sc1
v_add_f32 v244, v244, v252
v_mfma_f32_16x16x32_bf16 v[164:167], a[240:243], v[44:47], v[164:167]
ds_read_b128 a[240:243], v12 offset:45056
v_add_f32 v245, v245, v253
s_waitcnt lgkmcnt(3)
v_mfma_f32_16x16x32_bf16 v[168:171], a[244:247], v[40:43], v[168:171]
v_add_f32 v246, v246, v254
v_add_f32 v247, v247, v255
v_mfma_f32_16x16x32_bf16 v[172:175], a[244:247], v[44:47], v[172:175]
ds_read_b128 a[244:247], v12 offset:46080
s_waitcnt lgkmcnt(3)
v_mfma_f32_16x16x32_bf16 v[176:179], a[248:251], v[40:43], v[176:179]
buffer_load_dwordx4 v[72:75], v14, s[36:39], s89 offen offset:2048 sc1
v_add_f32 v240, v240, v244
v_mfma_f32_16x16x32_bf16 v[180:183], a[248:251], v[44:47], v[180:183]
ds_read_b128 a[248:251], v12 offset:47104
v_add_f32 v241, v241, v245
s_waitcnt lgkmcnt(3)
v_mfma_f32_16x16x32_bf16 v[184:187], a[252:255], v[40:43], v[184:187]
v_add_f32 v242, v242, v246
v_add_f32 v243, v243, v247
v_mfma_f32_16x16x32_bf16 v[188:191], a[252:255], v[44:47], v[188:191]
ds_read_b128 a[252:255], v12 offset:48128
s_waitcnt lgkmcnt(3)
v_mfma_f32_16x16x32_bf16 v[192:195], a[240:243], v[40:43], v[192:195]
buffer_load_dwordx4 v[76:79], v14, s[36:39], s89 offen offset:2304 sc1
v_add_f32 v240, v240, v242
v_mfma_f32_16x16x32_bf16 v[196:199], a[240:243], v[44:47], v[196:199]
ds_read_b128 a[240:243], v12 offset:49152
v_add_f32 v241, v241, v243
s_waitcnt lgkmcnt(3)
v_mfma_f32_16x16x32_bf16 v[200:203], a[244:247], v[40:43], v[200:203]
v_permlane32_swap_b32 v240, v241
v_add_f32 v240, v240, v241
v_mfma_f32_16x16x32_bf16 v[204:207], a[244:247], v[44:47], v[204:207]
ds_read_b128 a[244:247], v12 offset:50176
s_waitcnt lgkmcnt(3)
v_mfma_f32_16x16x32_bf16 v[208:211], a[248:251], v[40:43], v[208:211]
s_add_u32 s89, s89, 4096
buffer_load_dwordx4 v[80:83], v14, s[36:39], s89 offen sc1
v_mov_b32 v241, v240
v_mfma_f32_16x16x32_bf16 v[212:215], a[248:251], v[44:47], v[212:215]
ds_read_b128 a[248:251], v12 offset:51200
v_permlane32_swap_b32 v240, v241
s_waitcnt lgkmcnt(3)
v_mfma_f32_16x16x32_bf16 v[216:219], a[252:255], v[40:43], v[216:219]
v_mul_f32 v8, -0.001953125, v240
v_mul_f32 v241, 0.001953125, v241
v_mfma_f32_16x16x32_bf16 v[220:223], a[252:255], v[44:47], v[220:223]
ds_read_b128 a[252:255], v12 offset:52224
s_waitcnt lgkmcnt(3)
v_mfma_f32_16x16x32_bf16 v[144:147], a[240:243], v[48:51], v[144:147]
s_add_u32 m0, s100, 92160
s_add_u32 s18, s99, 81920
buffer_load_dwordx4 v1, s[36:39], s18 offen lds
v_mfma_f32_16x16x32_bf16 v[148:151], a[240:243], v[52:55], v[148:151]
ds_read_b128 a[240:243], v12 offset:53248
v_fma_f32 v241, -v8, v8, v241
s_waitcnt lgkmcnt(3)
v_mfma_f32_16x16x32_bf16 v[152:155], a[244:247], v[48:51], v[152:155]
v_max_f32_e64 v241, 0, v241
v_add_f32 v241, 0x3727c5ac, v241
v_mfma_f32_16x16x32_bf16 v[156:159], a[244:247], v[52:55], v[156:159]
ds_read_b128 a[244:247], v12 offset:54272
s_waitcnt lgkmcnt(3)
v_mfma_f32_16x16x32_bf16 v[160:163], a[248:251], v[48:51], v[160:163]
buffer_load_dwordx4 v1, s[36:39], s18 offen offset:1024 lds
v_rsq_f32 v9, v241
v_mfma_f32_16x16x32_bf16 v[164:167], a[248:251], v[52:55], v[164:167]
ds_read_b128 a[248:251], v12 offset:55296
v_mul_f32 v9, v9, v9
s_waitcnt lgkmcnt(3)
v_mfma_f32_16x16x32_bf16 v[168:171], a[252:255], v[48:51], v[168:171]
v_mov_b32 v242, v8
v_and_b32 v241, 31, v0
v_mfma_f32_16x16x32_bf16 v[172:175], a[252:255], v[52:55], v[172:175]
ds_read_b128 a[252:255], v12 offset:56320
s_waitcnt lgkmcnt(3)
v_mfma_f32_16x16x32_bf16 v[176:179], a[240:243], v[48:51], v[176:179]
s_add_u32 m0, s100, 67584
s_add_u32 s18, s99, 90112
buffer_load_dwordx4 v1, s[36:39], s18 offen lds
v_mfma_f32_16x16x32_bf16 v[180:183], a[240:243], v[52:55], v[180:183]
s_barrier
ds_read_b128 a[240:243], v12 offset:57344
s_lshl_b32 s77, s68, 7
s_waitcnt lgkmcnt(3)
v_mfma_f32_16x16x32_bf16 v[184:187], a[244:247], v[48:51], v[184:187]
s_add_u32 s77, s77, 66944
v_lshl_add_u32 v241, v241, 2, s77
v_permlane16_swap_b32_e64 v8, v242
v_mfma_f32_16x16x32_bf16 v[188:191], a[244:247], v[52:55], v[188:191]
ds_read_b128 a[244:247], v12 offset:58368
s_waitcnt lgkmcnt(3)
v_mfma_f32_16x16x32_bf16 v[192:195], a[248:251], v[48:51], v[192:195]
buffer_load_dwordx4 v1, s[36:39], s18 offen offset:1024 lds
v_and_b32 v240, 48, v0
v_mfma_f32_16x16x32_bf16 v[196:199], a[248:251], v[52:55], v[196:199]
ds_read_b128 a[248:251], v12 offset:59392
v_add_u32 v240, 66048, v240
s_waitcnt lgkmcnt(3)
v_mfma_f32_16x16x32_bf16 v[200:203], a[252:255], v[48:51], v[200:203]
ds_write_b32 v241, v9
s_waitcnt vmcnt(15)
v_add_f32_e64 v224, v224, v228
v_mfma_f32_16x16x32_bf16 v[204:207], a[252:255], v[52:55], v[204:207]
ds_read_b128 a[252:255], v12 offset:60416
s_waitcnt lgkmcnt(4)
v_mfma_f32_16x16x32_bf16 v[208:211], a[240:243], v[48:51], v[208:211]
buffer_load_dwordx4 v[84:87], v14, s[36:39], s89 offen offset:256 sc1
v_add_f32 v225, v225, v229
v_mfma_f32_16x16x32_bf16 v[212:215], a[240:243], v[52:55], v[212:215]
ds_read_b128 a[240:243], v12 offset:61440
v_add_f32 v226, v226, v230
s_waitcnt lgkmcnt(4)
v_mfma_f32_16x16x32_bf16 v[216:219], a[244:247], v[48:51], v[216:219]
v_add_f32 v227, v227, v231
s_lshl_b32 s77, s68, 10
s_add_u32 s77, s77, 157696
v_mfma_f32_16x16x32_bf16 v[220:223], a[244:247], v[52:55], v[220:223]
ds_read_b128 a[244:247], v12 offset:62464
s_waitcnt vmcnt(14) lgkmcnt(4)
v_mfma_f32_16x16x32_bf16 v[144:147], a[248:251], v[56:59], v[144:147]
buffer_load_dwordx4 v[88:91], v14, s[36:39], s89 offen offset:2048 sc1
v_add_u32 v228, s77, v1
v_mfma_f32_16x16x32_bf16 v[148:151], a[248:251], v[60:63], v[148:151]
ds_read_b128 a[248:251], v12 offset:63488
v_add_u32 v229, 157696, v1
s_waitcnt lgkmcnt(3)
v_mfma_f32_16x16x32_bf16 v[152:155], a[252:255], v[56:59], v[152:155]
ds_write_b128 v228, v[224:227]
v_mfma_f32_16x16x32_bf16 v[156:159], a[252:255], v[60:63], v[156:159]
ds_read_b128 a[252:255], v12 offset:64512
s_waitcnt lgkmcnt(4)
v_mfma_f32_16x16x32_bf16 v[160:163], a[240:243], v[56:59], v[160:163]
buffer_load_dwordx4 v[92:95], v14, s[36:39], s89 offen offset:2304 sc1
v_mfma_f32_16x16x32_bf16 v[164:167], a[240:243], v[60:63], v[164:167]
ds_read_b128 a[240:243], v13 offset:0
s_waitcnt lgkmcnt(4)
v_mfma_f32_16x16x32_bf16 v[168:171], a[244:247], v[56:59], v[168:171]
v_mfma_f32_16x16x32_bf16 v[172:175], a[244:247], v[60:63], v[172:175]
ds_read_b128 a[244:247], v13 offset:1024
s_waitcnt lgkmcnt(4)
v_mfma_f32_16x16x32_bf16 v[176:179], a[248:251], v[56:59], v[176:179]
s_add_u32 m0, s100, 75776
s_add_u32 s18, s99, 98304
buffer_load_dwordx4 v1, s[36:39], s18 offen lds
v_mfma_f32_16x16x32_bf16 v[180:183], a[248:251], v[60:63], v[180:183]
ds_read_b128 a[248:251], v13 offset:2048
s_waitcnt lgkmcnt(3)
v_mfma_f32_16x16x32_bf16 v[184:187], a[252:255], v[56:59], v[184:187]
v_mfma_f32_16x16x32_bf16 v[188:191], a[252:255], v[60:63], v[188:191]
ds_read_b128 a[252:255], v13 offset:3072
s_waitcnt lgkmcnt(3)
v_mfma_f32_16x16x32_bf16 v[192:195], a[240:243], v[56:59], v[192:195]
buffer_load_dwordx4 v1, s[36:39], s18 offen offset:1024 lds
v_mfma_f32_16x16x32_bf16 v[196:199], a[240:243], v[60:63], v[196:199]
ds_read_b128 a[240:243], v13 offset:4096
s_waitcnt lgkmcnt(3)
v_mfma_f32_16x16x32_bf16 v[200:203], a[244:247], v[56:59], v[200:203]
v_mfma_f32_16x16x32_bf16 v[204:207], a[244:247], v[60:63], v[204:207]
ds_read_b128 a[244:247], v13 offset:5120
s_waitcnt lgkmcnt(3)
v_mfma_f32_16x16x32_bf16 v[208:211], a[248:251], v[56:59], v[208:211]
s_add_u32 m0, s100, 83968
s_add_u32 s18, s99, 106496
buffer_load_dwordx4 v1, s[36:39], s18 offen lds
v_mfma_f32_16x16x32_bf16 v[212:215], a[248:251], v[60:63], v[212:215]
ds_read_b128 a[248:251], v13 offset:6144
s_waitcnt lgkmcnt(3)
v_mfma_f32_16x16x32_bf16 v[216:219], a[252:255], v[56:59], v[216:219]
v_mfma_f32_16x16x32_bf16 v[220:223], a[252:255], v[60:63], v[220:223]
ds_read_b128 a[252:255], v13 offset:7168
s_waitcnt vmcnt(13) lgkmcnt(3)
v_mfma_f32_16x16x32_bf16 v[144:147], a[240:243], v[64:67], v[144:147]
buffer_load_dwordx4 v1, s[36:39], s18 offen offset:1024 lds
v_mfma_f32_16x16x32_bf16 v[148:151], a[240:243], v[68:71], v[148:151]
s_barrier
ds_read_b128 a[240:243], v13 offset:8192
s_waitcnt lgkmcnt(3)
v_mfma_f32_16x16x32_bf16 v[152:155], a[244:247], v[64:67], v[152:155]
v_mfma_f32_16x16x32_bf16 v[156:159], a[244:247], v[68:71], v[156:159]
ds_read_b128 a[244:247], v13 offset:9216
s_waitcnt lgkmcnt(3)
v_mfma_f32_16x16x32_bf16 v[160:163], a[248:251], v[64:67], v[160:163]
s_add_u32 s89, s89, 4096
buffer_load_dwordx4 v[96:99], v14, s[36:39], s89 offen sc1
v_mfma_f32_16x16x32_bf16 v[164:167], a[248:251], v[68:71], v[164:167]
ds_read_b128 a[248:251], v13 offset:10240
s_waitcnt lgkmcnt(3)
v_mfma_f32_16x16x32_bf16 v[168:171], a[252:255], v[64:67], v[168:171]
v_mfma_f32_16x16x32_bf16 v[172:175], a[252:255], v[68:71], v[172:175]
ds_read_b128 a[252:255], v13 offset:11264
s_waitcnt lgkmcnt(3)
v_mfma_f32_16x16x32_bf16 v[176:179], a[240:243], v[64:67], v[176:179]
buffer_load_dwordx4 v[100:103], v14, s[36:39], s89 offen offset:256 sc1
v_mfma_f32_16x16x32_bf16 v[180:183], a[240:243], v[68:71], v[180:183]
ds_read_b128 a[240:243], v13 offset:12288
s_waitcnt lgkmcnt(3)
v_mfma_f32_16x16x32_bf16 v[184:187], a[244:247], v[64:67], v[184:187]
v_mfma_f32_16x16x32_bf16 v[188:191], a[244:247], v[68:71], v[188:191]
ds_read_b128 a[244:247], v13 offset:13312
s_waitcnt lgkmcnt(3)
v_mfma_f32_16x16x32_bf16 v[192:195], a[248:251], v[64:67], v[192:195]
buffer_load_dwordx4 v[104:107], v14, s[36:39], s89 offen offset:2048 sc1
v_mfma_f32_16x16x32_bf16 v[196:199], a[248:251], v[68:71], v[196:199]
ds_read_b128 a[248:251], v13 offset:14336
s_waitcnt lgkmcnt(3)
v_mfma_f32_16x16x32_bf16 v[200:203], a[252:255], v[64:67], v[200:203]
v_mfma_f32_16x16x32_bf16 v[204:207], a[252:255], v[68:71], v[204:207]
ds_read_b128 a[252:255], v13 offset:15360
s_waitcnt lgkmcnt(3)
v_mfma_f32_16x16x32_bf16 v[208:211], a[240:243], v[64:67], v[208:211]
s_add_u32 m0, s100, 100352
s_add_u32 s18, s99, 114688
buffer_load_dwordx4 v1, s[36:39], s18 offen lds
v_mfma_f32_16x16x32_bf16 v[212:215], a[240:243], v[68:71], v[212:215]
ds_read_b128 a[240:243], v13 offset:16384
s_waitcnt lgkmcnt(3)
v_mfma_f32_16x16x32_bf16 v[216:219], a[244:247], v[64:67], v[216:219]
v_mfma_f32_16x16x32_bf16 v[220:223], a[244:247], v[68:71], v[220:223]
ds_read_b128 a[244:247], v13 offset:17408
s_waitcnt vmcnt(16) lgkmcnt(3)
v_mfma_f32_16x16x32_bf16 v[144:147], a[248:251], v[72:75], v[144:147]
buffer_load_dwordx4 v1, s[36:39], s18 offen offset:1024 lds
v_mfma_f32_16x16x32_bf16 v[148:151], a[248:251], v[76:79], v[148:151]
ds_read_b128 a[248:251], v13 offset:18432
s_waitcnt lgkmcnt(3)
v_mfma_f32_16x16x32_bf16 v[152:155], a[252:255], v[72:75], v[152:155]
v_mfma_f32_16x16x32_bf16 v[156:159], a[252:255], v[76:79], v[156:159]
ds_read_b128 a[252:255], v13 offset:19456
s_waitcnt lgkmcnt(3)
v_mfma_f32_16x16x32_bf16 v[160:163], a[240:243], v[72:75], v[160:163]
s_add_u32 m0, s100, 108544
s_add_u32 s18, s99, 122880
buffer_load_dwordx4 v1, s[36:39], s18 offen lds
v_mfma_f32_16x16x32_bf16 v[164:167], a[240:243], v[76:79], v[164:167]
ds_read_b128 a[240:243], v13 offset:20480
s_waitcnt lgkmcnt(3)
v_mfma_f32_16x16x32_bf16 v[168:171], a[244:247], v[72:75], v[168:171]
v_mfma_f32_16x16x32_bf16 v[172:175], a[244:247], v[76:79], v[172:175]
ds_read_b128 a[244:247], v13 offset:21504
s_waitcnt lgkmcnt(3)
v_mfma_f32_16x16x32_bf16 v[176:179], a[248:251], v[72:75], v[176:179]
buffer_load_dwordx4 v1, s[36:39], s18 offen offset:1024 lds
v_mfma_f32_16x16x32_bf16 v[180:183], a[248:251], v[76:79], v[180:183]
ds_read_b128 a[248:251], v13 offset:22528
s_waitcnt lgkmcnt(3)
v_mfma_f32_16x16x32_bf16 v[184:187], a[252:255], v[72:75], v[184:187]
v_mfma_f32_16x16x32_bf16 v[188:191], a[252:255], v[76:79], v[188:191]
ds_read_b128 a[252:255], v13 offset:23552
s_waitcnt lgkmcnt(3)
v_mfma_f32_16x16x32_bf16 v[192:195], a[240:243], v[72:75], v[192:195]
buffer_load_dwordx4 v[108:111], v14, s[36:39], s89 offen offset:2304 sc1
v_mfma_f32_16x16x32_bf16 v[196:199], a[240:243], v[76:79], v[196:199]
s_waitcnt vmcnt(15)
s_barrier
ds_read_b128 a[240:243], v12 offset:24576
s_waitcnt lgkmcnt(3)
v_mfma_f32_16x16x32_bf16 v[200:203], a[244:247], v[72:75], v[200:203]
ds_read_b128 v[236:239], v229 offset:3072
ds_read_b128 v[232:235], v229 offset:2048
ds_read_b128 v[224:227], v229 offset:0
ds_read_b128 v[228:231], v229 offset:1024
v_mfma_f32_16x16x32_bf16 v[204:207], a[244:247], v[76:79], v[204:207]
ds_read_b128 a[244:247], v12 offset:25600
s_waitcnt lgkmcnt(7)
v_mfma_f32_16x16x32_bf16 v[208:211], a[248:251], v[72:75], v[208:211]
s_add_u32 s89, s89, 4096
buffer_load_dwordx4 v[112:115], v14, s[36:39], s89 offen sc1
v_mfma_f32_16x16x32_bf16 v[212:215], a[248:251], v[76:79], v[212:215]
ds_read_b128 a[248:251], v12 offset:26624
s_waitcnt lgkmcnt(7)
v_mfma_f32_16x16x32_bf16 v[216:219], a[252:255], v[72:75], v[216:219]
s_waitcnt lgkmcnt(2)
v_add_f32 v224, v224, v232
v_add_f32_e64 v228, v228, v236
v_mfma_f32_16x16x32_bf16 v[220:223], a[252:255], v[76:79], v[220:223]
ds_read_b128 a[252:255], v12 offset:27648
s_waitcnt vmcnt(15)
v_mfma_f32_16x16x32_bf16 v[144:147], a[240:243], v[80:83], v[144:147]
buffer_load_dwordx4 v[116:119], v14, s[36:39], s89 offen offset:256 sc1
v_add_f32 v225, v225, v233
v_mfma_f32_16x16x32_bf16 v[148:151], a[240:243], v[84:87], v[148:151]
ds_read_b128 a[240:243], v12 offset:28672
v_add_f32 v229, v229, v237
s_waitcnt lgkmcnt(3)
v_mfma_f32_16x16x32_bf16 v[152:155], a[244:247], v[80:83], v[152:155]
v_add_f32 v226, v226, v234
v_add_f32 v230, v230, v238
v_mfma_f32_16x16x32_bf16 v[156:159], a[244:247], v[84:87], v[156:159]
ds_read_b128 a[244:247], v12 offset:29696
s_waitcnt lgkmcnt(3)
v_mfma_f32_16x16x32_bf16 v[160:163], a[248:251], v[80:83], v[160:163]
s_add_u32 m0, s100, 116736
s_add_u32 s18, s99, 131072
buffer_load_dwordx4 v1, s[36:39], s18 offen lds
v_mfma_f32_16x16x32_bf16 v[164:167], a[248:251], v[84:87], v[164:167]
ds_read_b128 a[248:251], v12 offset:30720
v_add_f32_e64 v227, v227, v235
s_waitcnt lgkmcnt(3)
v_mfma_f32_16x16x32_bf16 v[168:171], a[252:255], v[80:83], v[168:171]
v_add_f32 v231, v231, v239
v_add_f32 v224, v224, v228
v_mfma_f32_16x16x32_bf16 v[172:175], a[252:255], v[84:87], v[172:175]
ds_read_b128 a[252:255], v12 offset:31744
s_waitcnt lgkmcnt(3)
v_mfma_f32_16x16x32_bf16 v[176:179], a[240:243], v[80:83], v[176:179]
buffer_load_dwordx4 v1, s[36:39], s18 offen offset:1024 lds
v_add_f32 v225, v225, v229
v_mfma_f32_16x16x32_bf16 v[180:183], a[240:243], v[84:87], v[180:183]
ds_read_b128 a[240:243], v12 offset:0
v_add_f32 v226, v226, v230
s_waitcnt lgkmcnt(3)
v_mfma_f32_16x16x32_bf16 v[184:187], a[244:247], v[80:83], v[184:187]
v_add_f32_e64 v227, v227, v231
v_add_u32 v228, 66048, v1
v_mfma_f32_16x16x32_bf16 v[188:191], a[244:247], v[84:87], v[188:191]
ds_read_b128 a[244:247], v12 offset:1024
s_waitcnt lgkmcnt(3)
v_mfma_f32_16x16x32_bf16 v[192:195], a[248:251], v[80:83], v[192:195]
s_add_u32 m0, s100, 124928
s_add_u32 s18, s99, 139264
buffer_load_dwordx4 v1, s[36:39], s18 offen lds
v_mfma_f32_16x16x32_bf16 v[196:199], a[248:251], v[84:87], v[196:199]
ds_read_b128 a[248:251], v12 offset:2048
s_mov_b32 exec_hi, 0x00ffffff
ds_write_b128 v228, v[224:227]
s_mov_b64 exec, -1
s_waitcnt lgkmcnt(4)
v_mfma_f32_16x16x32_bf16 v[200:203], a[252:255], v[80:83], v[200:203]
v_mfma_f32_16x16x32_bf16 v[204:207], a[252:255], v[84:87], v[204:207]
ds_read_b128 a[252:255], v12 offset:3072
s_waitcnt lgkmcnt(4)
v_mfma_f32_16x16x32_bf16 v[208:211], a[240:243], v[80:83], v[208:211]
buffer_load_dwordx4 v1, s[36:39], s18 offen offset:1024 lds
v_mfma_f32_16x16x32_bf16 v[212:215], a[240:243], v[84:87], v[212:215]
ds_read_b128 a[240:243], v12 offset:4096
s_waitcnt lgkmcnt(4)
v_mfma_f32_16x16x32_bf16 v[216:219], a[244:247], v[80:83], v[216:219]
v_mfma_f32_16x16x32_bf16 v[220:223], a[244:247], v[84:87], v[220:223]
ds_read_b128 a[244:247], v12 offset:5120
s_waitcnt vmcnt(18) lgkmcnt(4)
v_mfma_f32_16x16x32_bf16 v[144:147], a[248:251], v[88:91], v[144:147]
buffer_load_dwordx4 v[120:123], v14, s[36:39], s89 offen offset:2048 sc1
ds_read_b128 v[244:247], v240 offset:640
ds_read_b128 v[248:251], v240 offset:704
v_mfma_f32_16x16x32_bf16 v[148:151], a[248:251], v[92:95], v[148:151]
ds_read_b128 a[248:251], v12 offset:6144
s_waitcnt lgkmcnt(5)
v_mfma_f32_16x16x32_bf16 v[152:155], a[252:255], v[88:91], v[152:155]
v_mfma_f32_16x16x32_bf16 v[156:159], a[252:255], v[92:95], v[156:159]
ds_read_b128 a[252:255], v12 offset:7168
s_waitcnt lgkmcnt(5)
v_mfma_f32_16x16x32_bf16 v[160:163], a[240:243], v[88:91], v[160:163]
buffer_load_dwordx4 v[124:127], v14, s[36:39], s89 offen offset:2304 sc1
s_waitcnt lgkmcnt(2)
v_mul_f32 v224, v8, v244
v_mul_f32_e64 v225, v8, v245
v_mfma_f32_16x16x32_bf16 v[164:167], a[240:243], v[92:95], v[164:167]
s_waitcnt vmcnt(16)
s_barrier
ds_read_b128 a[240:243], v12 offset:8192
v_mul_f32_e64 v226, v8, v246
v_mfma_f32_16x16x32_bf16 v[168:171], a[244:247], v[88:91], v[168:171]
v_mul_f32 v227, v8, v247
v_mul_f32 v228, v242, v244
v_mfma_f32_16x16x32_bf16 v[172:175], a[244:247], v[92:95], v[172:175]
ds_read_b128 a[244:247], v12 offset:9216
s_waitcnt lgkmcnt(3)
v_mfma_f32_16x16x32_bf16 v[176:179], a[248:251], v[88:91], v[176:179]
s_add_u32 s89, s89, 4096
buffer_load_dwordx4 v[128:131], v14, s[36:39], s89 offen sc1
v_mul_f32 v229, v242, v245
v_mul_f32_e64 v230, v242, v246
v_mfma_f32_16x16x32_bf16 v[180:183], a[248:251], v[92:95], v[180:183]
ds_read_b128 a[248:251], v12 offset:10240
v_mul_f32 v231, v242, v247
s_waitcnt lgkmcnt(3)
v_mfma_f32_16x16x32_bf16 v[184:187], a[252:255], v[88:91], v[184:187]
v_mul_f32 v232, v8, v248
v_mul_f32 v233, v8, v249
v_mfma_f32_16x16x32_bf16 v[188:191], a[252:255], v[92:95], v[188:191]
ds_read_b128 a[252:255], v12 offset:11264
s_waitcnt lgkmcnt(3)
v_mfma_f32_16x16x32_bf16 v[192:195], a[240:243], v[88:91], v[192:195]
s_add_u32 m0, s100, 133120
s_add_u32 s18, s99, 147456
buffer_load_dwordx4 v1, s[36:39], s18 offen lds
v_mul_f32 v234, v8, v250
v_mfma_f32_16x16x32_bf16 v[196:199], a[240:243], v[92:95], v[196:199]
ds_read_b128 a[240:243], v12 offset:12288
v_mul_f32 v235, v8, v251
s_waitcnt lgkmcnt(3)
v_mfma_f32_16x16x32_bf16 v[200:203], a[244:247], v[88:91], v[200:203]
v_mul_f32 v236, v242, v248
v_mul_f32 v237, v242, v249
v_mfma_f32_16x16x32_bf16 v[204:207], a[244:247], v[92:95], v[204:207]
ds_read_b128 a[244:247], v12 offset:13312
s_waitcnt lgkmcnt(3)
v_mfma_f32_16x16x32_bf16 v[208:211], a[248:251], v[88:91], v[208:211]
buffer_load_dwordx4 v1, s[36:39], s18 offen offset:1024 lds
v_mul_f32 v238, v242, v250
v_mul_f32_e64 v239, v242, v251
v_mfma_f32_16x16x32_bf16 v[212:215], a[248:251], v[92:95], v[212:215]
ds_read_b128 a[248:251], v12 offset:14336
ds_read_b128 v[244:247], v240 offset:0
ds_read_b128 v[248:251], v240 offset:64
s_waitcnt lgkmcnt(5)
v_mfma_f32_16x16x32_bf16 v[216:219], a[252:255], v[88:91], v[216:219]
v_mfma_f32_16x16x32_bf16 v[220:223], a[252:255], v[92:95], v[220:223]
ds_read_b128 a[252:255], v12 offset:15360
s_waitcnt vmcnt(17) lgkmcnt(5)
v_mfma_f32_16x16x32_bf16 v[144:147], a[240:243], v[96:99], v[144:147]
s_add_u32 m0, s100, 141312
s_add_u32 s18, s99, 155648
buffer_load_dwordx4 v1, s[36:39], s18 offen lds
v_mfma_f32_16x16x32_bf16 v[148:151], a[240:243], v[100:103], v[148:151]
ds_read_b128 a[240:243], v12 offset:16384
s_waitcnt lgkmcnt(5)
v_mfma_f32_16x16x32_bf16 v[152:155], a[244:247], v[96:99], v[152:155]
v_mfma_f32_16x16x32_bf16 v[156:159], a[244:247], v[100:103], v[156:159]
ds_read_b128 a[244:247], v12 offset:17408
s_waitcnt lgkmcnt(5)
v_mfma_f32_16x16x32_bf16 v[160:163], a[248:251], v[96:99], v[160:163]
buffer_load_dwordx4 v1, s[36:39], s18 offen offset:1024 lds
s_waitcnt lgkmcnt(3)
v_fmac_f32 v144, v8, v244
v_fmac_f32_e64 v145, v8, v245
v_mfma_f32_16x16x32_bf16 v[164:167], a[248:251], v[100:103], v[164:167]
ds_read_b128 a[248:251], v12 offset:18432
v_fmac_f32 v146, v8, v246
s_waitcnt lgkmcnt(3)
v_mfma_f32_16x16x32_bf16 v[168:171], a[252:255], v[96:99], v[168:171]
v_fmac_f32 v147, v8, v247
v_fmac_f32 v148, v242, v244
v_mfma_f32_16x16x32_bf16 v[172:175], a[252:255], v[100:103], v[172:175]
ds_read_b128 a[252:255], v12 offset:19456
s_waitcnt lgkmcnt(3)
v_mfma_f32_16x16x32_bf16 v[176:179], a[240:243], v[96:99], v[176:179]
buffer_load_dwordx4 v[132:135], v14, s[36:39], s89 offen offset:256 sc1
v_fmac_f32 v149, v242, v245
v_fmac_f32_e64 v150, v242, v246
v_mfma_f32_16x16x32_bf16 v[180:183], a[240:243], v[100:103], v[180:183]
ds_read_b128 a[240:243], v12 offset:20480
v_fmac_f32 v151, v242, v247
s_waitcnt lgkmcnt(3)
v_mfma_f32_16x16x32_bf16 v[184:187], a[244:247], v[96:99], v[184:187]
v_fmac_f32 v152, v8, v248
v_fmac_f32 v153, v8, v249
v_mfma_f32_16x16x32_bf16 v[188:191], a[244:247], v[100:103], v[188:191]
ds_read_b128 a[244:247], v12 offset:21504
s_waitcnt lgkmcnt(3)
v_mfma_f32_16x16x32_bf16 v[192:195], a[248:251], v[96:99], v[192:195]
buffer_load_dwordx4 v[136:139], v14, s[36:39], s89 offen offset:2048 sc1
v_fmac_f32 v154, v8, v250
v_fmac_f32_e64 v155, v8, v251
v_mfma_f32_16x16x32_bf16 v[196:199], a[248:251], v[100:103], v[196:199]
ds_read_b128 a[248:251], v12 offset:22528
v_fmac_f32 v156, v242, v248
s_waitcnt lgkmcnt(3)
v_mfma_f32_16x16x32_bf16 v[200:203], a[252:255], v[96:99], v[200:203]
v_fmac_f32 v157, v242, v249
v_fmac_f32 v158, v242, v250
v_mfma_f32_16x16x32_bf16 v[204:207], a[252:255], v[100:103], v[204:207]
ds_read_b128 a[252:255], v12 offset:23552
s_waitcnt lgkmcnt(3)
v_mfma_f32_16x16x32_bf16 v[208:211], a[240:243], v[96:99], v[208:211]
buffer_load_dwordx4 v[140:143], v14, s[36:39], s89 offen offset:2304 sc1
v_fmac_f32 v159, v242, v251
ds_read_b128 v[244:247], v240 offset:128
ds_read_b128 v[248:251], v240 offset:192
v_mfma_f32_16x16x32_bf16 v[212:215], a[240:243], v[100:103], v[212:215]
s_waitcnt vmcnt(17)
s_barrier
ds_read_b128 a[240:243], v12 offset:32768
s_waitcnt lgkmcnt(5)
v_mfma_f32_16x16x32_bf16 v[216:219], a[244:247], v[96:99], v[216:219]
v_mfma_f32_16x16x32_bf16 v[220:223], a[244:247], v[100:103], v[220:223]
ds_read_b128 a[244:247], v12 offset:33792
s_waitcnt vmcnt(16) lgkmcnt(5)
v_mfma_f32_16x16x32_bf16 v[144:147], a[248:251], v[104:107], v[144:147]
s_add_u32 m0, s100, 149504
s_add_u32 s18, s99, 163840
buffer_load_dwordx4 v1, s[36:39], s18 offen lds
v_mfma_f32_16x16x32_bf16 v[148:151], a[248:251], v[108:111], v[148:151]
ds_read_b128 a[248:251], v12 offset:34816
s_waitcnt lgkmcnt(5)
v_mfma_f32_16x16x32_bf16 v[152:155], a[252:255], v[104:107], v[152:155]
v_mfma_f32_16x16x32_bf16 v[156:159], a[252:255], v[108:111], v[156:159]
ds_read_b128 a[252:255], v12 offset:35840
s_waitcnt lgkmcnt(3)
v_mfma_f32_16x16x32_bf16 v[160:163], a[240:243], v[104:107], v[160:163]
buffer_load_dwordx4 v1, s[36:39], s18 offen offset:1024 lds
v_mfma_f32_16x16x32_bf16 v[164:167], a[240:243], v[108:111], v[164:167]
ds_read_b128 a[240:243], v12 offset:36864
s_waitcnt lgkmcnt(3)
v_mfma_f32_16x16x32_bf16 v[168:171], a[244:247], v[104:107], v[168:171]
v_mfma_f32_16x16x32_bf16 v[172:175], a[244:247], v[108:111], v[172:175]
ds_read_b128 a[244:247], v12 offset:37888
s_waitcnt lgkmcnt(3)
v_mfma_f32_16x16x32_bf16 v[176:179], a[248:251], v[104:107], v[176:179]
s_add_u32 m0, s100, 92160
s_add_u32 s18, s99, 172032
buffer_load_dwordx4 v1, s[36:39], s18 offen lds
v_fmac_f32_e64 v160, v8, v244
v_mfma_f32_16x16x32_bf16 v[180:183], a[248:251], v[108:111], v[180:183]
ds_read_b128 a[248:251], v12 offset:38912
v_fmac_f32 v161, v8, v245
s_waitcnt lgkmcnt(3)
v_mfma_f32_16x16x32_bf16 v[184:187], a[252:255], v[104:107], v[184:187]
v_fmac_f32 v162, v8, v246
v_fmac_f32 v163, v8, v247
v_mfma_f32_16x16x32_bf16 v[188:191], a[252:255], v[108:111], v[188:191]
ds_read_b128 a[252:255], v12 offset:39936
s_waitcnt lgkmcnt(3)
v_mfma_f32_16x16x32_bf16 v[192:195], a[240:243], v[104:107], v[192:195]
buffer_load_dwordx4 v1, s[36:39], s18 offen offset:1024 lds
v_fmac_f32 v164, v242, v244
v_fmac_f32_e64 v165, v242, v245
v_mfma_f32_16x16x32_bf16 v[196:199], a[240:243], v[108:111], v[196:199]
ds_read_b128 a[240:243], v12 offset:40960
v_fmac_f32 v166, v242, v246
s_waitcnt lgkmcnt(3)
v_mfma_f32_16x16x32_bf16 v[200:203], a[244:247], v[104:107], v[200:203]
v_fmac_f32 v167, v242, v247
v_fmac_f32 v168, v8, v248
v_mfma_f32_16x16x32_bf16 v[204:207], a[244:247], v[108:111], v[204:207]
ds_read_b128 a[244:247], v12 offset:41984
s_waitcnt lgkmcnt(3)
v_mfma_f32_16x16x32_bf16 v[208:211], a[248:251], v[104:107], v[208:211]
s_add_u32 m0, s100, 67584
s_add_u32 s18, s99, 180224
buffer_load_dwordx4 v1, s[36:39], s18 offen lds
v_fmac_f32 v169, v8, v249
v_mfma_f32_16x16x32_bf16 v[212:215], a[248:251], v[108:111], v[212:215]
ds_read_b128 a[248:251], v12 offset:43008
v_fmac_f32 v170, v8, v250
s_waitcnt lgkmcnt(3)
v_mfma_f32_16x16x32_bf16 v[216:219], a[252:255], v[104:107], v[216:219]
v_fmac_f32 v171, v8, v251
v_fmac_f32 v172, v242, v248
v_mfma_f32_16x16x32_bf16 v[220:223], a[252:255], v[108:111], v[220:223]
ds_read_b128 a[252:255], v12 offset:44032
s_waitcnt vmcnt(19) lgkmcnt(3)
v_mfma_f32_16x16x32_bf16 v[144:147], a[240:243], v[112:115], v[144:147]
buffer_load_dwordx4 v1, s[36:39], s18 offen offset:1024 lds
v_fmac_f32 v173, v242, v249
v_fmac_f32_e64 v174, v242, v250
v_mfma_f32_16x16x32_bf16 v[148:151], a[240:243], v[116:119], v[148:151]
ds_read_b128 a[240:243], v12 offset:45056
v_fmac_f32 v175, v242, v251
s_waitcnt lgkmcnt(3)
v_mfma_f32_16x16x32_bf16 v[152:155], a[244:247], v[112:115], v[152:155]
ds_read_b128 v[244:247], v240 offset:256
ds_read_b128 v[248:251], v240 offset:320
v_mfma_f32_16x16x32_bf16 v[156:159], a[244:247], v[116:119], v[156:159]
ds_read_b128 a[244:247], v12 offset:46080
s_waitcnt lgkmcnt(5)
v_mfma_f32_16x16x32_bf16 v[160:163], a[248:251], v[112:115], v[160:163]
s_add_u32 m0, s100, 75776
s_add_u32 s18, s99, 188416
buffer_load_dwordx4 v1, s[36:39], s18 offen lds
v_mfma_f32_16x16x32_bf16 v[164:167], a[248:251], v[116:119], v[164:167]
ds_read_b128 a[248:251], v12 offset:47104
s_waitcnt lgkmcnt(5)
v_mfma_f32_16x16x32_bf16 v[168:171], a[252:255], v[112:115], v[168:171]
v_mfma_f32_16x16x32_bf16 v[172:175], a[252:255], v[116:119], v[172:175]
ds_read_b128 a[252:255], v12 offset:48128
s_waitcnt lgkmcnt(5)
v_mfma_f32_16x16x32_bf16 v[176:179], a[240:243], v[112:115], v[176:179]
buffer_load_dwordx4 v1, s[36:39], s18 offen offset:1024 lds
v_mfma_f32_16x16x32_bf16 v[180:183], a[240:243], v[116:119], v[180:183]
s_waitcnt vmcnt(18)
s_barrier
ds_read_b128 a[240:243], v12 offset:49152
s_waitcnt lgkmcnt(3)
v_mfma_f32_16x16x32_bf16 v[184:187], a[244:247], v[112:115], v[184:187]
v_mfma_f32_16x16x32_bf16 v[188:191], a[244:247], v[116:119], v[188:191]
ds_read_b128 a[244:247], v12 offset:50176
s_waitcnt lgkmcnt(3)
v_mfma_f32_16x16x32_bf16 v[192:195], a[248:251], v[112:115], v[192:195]
s_add_u32 m0, s100, 83968
s_add_u32 s18, s99, 196608
buffer_load_dwordx4 v1, s[36:39], s18 offen lds
v_fmac_f32 v176, v8, v244
v_mfma_f32_16x16x32_bf16 v[196:199], a[248:251], v[116:119], v[196:199]
ds_read_b128 a[248:251], v12 offset:51200
v_fmac_f32 v177, v8, v245
s_waitcnt lgkmcnt(3)
v_mfma_f32_16x16x32_bf16 v[200:203], a[252:255], v[112:115], v[200:203]
v_fmac_f32 v178, v8, v246
v_fmac_f32 v179, v8, v247
v_mfma_f32_16x16x32_bf16 v[204:207], a[252:255], v[116:119], v[204:207]
ds_read_b128 a[252:255], v12 offset:52224
s_waitcnt lgkmcnt(3)
v_mfma_f32_16x16x32_bf16 v[208:211], a[240:243], v[112:115], v[208:211]
buffer_load_dwordx4 v1, s[36:39], s18 offen offset:1024 lds
v_fmac_f32 v180, v242, v244
v_fmac_f32_e64 v181, v242, v245
v_mfma_f32_16x16x32_bf16 v[212:215], a[240:243], v[116:119], v[212:215]
ds_read_b128 a[240:243], v12 offset:53248
v_fmac_f32 v182, v242, v246
s_waitcnt lgkmcnt(3)
v_mfma_f32_16x16x32_bf16 v[216:219], a[244:247], v[112:115], v[216:219]
v_fmac_f32 v183, v242, v247
v_fmac_f32 v184, v8, v248
v_mfma_f32_16x16x32_bf16 v[220:223], a[244:247], v[116:119], v[220:223]
ds_read_b128 a[244:247], v12 offset:54272
s_waitcnt vmcnt(18) lgkmcnt(3)
v_mfma_f32_16x16x32_bf16 v[144:147], a[248:251], v[120:123], v[144:147]
s_add_u32 m0, s100, 100352
s_add_u32 s18, s99, 204800
buffer_load_dwordx4 v1, s[36:39], s18 offen lds
v_fmac_f32 v185, v8, v249
v_mfma_f32_16x16x32_bf16 v[148:151], a[248:251], v[124:127], v[148:151]
ds_read_b128 a[248:251], v12 offset:55296
v_fmac_f32 v186, v8, v250
s_waitcnt lgkmcnt(3)
v_mfma_f32_16x16x32_bf16 v[152:155], a[252:255], v[120:123], v[152:155]
v_fmac_f32 v187, v8, v251
v_fmac_f32 v188, v242, v248
v_mfma_f32_16x16x32_bf16 v[156:159], a[252:255], v[124:127], v[156:159]
ds_read_b128 a[252:255], v12 offset:56320
s_waitcnt lgkmcnt(3)
v_mfma_f32_16x16x32_bf16 v[160:163], a[240:243], v[120:123], v[160:163]
buffer_load_dwordx4 v1, s[36:39], s18 offen offset:1024 lds
v_fmac_f32 v189, v242, v249
v_fmac_f32_e64 v190, v242, v250
v_mfma_f32_16x16x32_bf16 v[164:167], a[240:243], v[124:127], v[164:167]
ds_read_b128 a[240:243], v12 offset:57344
v_fmac_f32 v191, v242, v251
s_waitcnt lgkmcnt(3)
v_mfma_f32_16x16x32_bf16 v[168:171], a[244:247], v[120:123], v[168:171]
ds_read_b128 v[244:247], v240 offset:384
ds_read_b128 v[248:251], v240 offset:448
v_mfma_f32_16x16x32_bf16 v[172:175], a[244:247], v[124:127], v[172:175]
ds_read_b128 a[244:247], v12 offset:58368
s_waitcnt lgkmcnt(5)
v_mfma_f32_16x16x32_bf16 v[176:179], a[248:251], v[120:123], v[176:179]
s_add_u32 s15, s101, 0
buffer_load_dwordx4 a[0:3], v1, s[36:39], s15 offen
v_mfma_f32_16x16x32_bf16 v[180:183], a[248:251], v[124:127], v[180:183]
ds_read_b128 a[248:251], v12 offset:59392
s_waitcnt lgkmcnt(5)
v_mfma_f32_16x16x32_bf16 v[184:187], a[252:255], v[120:123], v[184:187]
v_mfma_f32_16x16x32_bf16 v[188:191], a[252:255], v[124:127], v[188:191]
ds_read_b128 a[252:255], v12 offset:60416
s_waitcnt lgkmcnt(5)
v_mfma_f32_16x16x32_bf16 v[192:195], a[240:243], v[120:123], v[192:195]
buffer_load_dwordx4 a[4:7], v1, s[36:39], s15 offen offset:1024
v_mfma_f32_16x16x32_bf16 v[196:199], a[240:243], v[124:127], v[196:199]
ds_read_b128 a[240:243], v12 offset:61440
s_waitcnt lgkmcnt(3)
v_mfma_f32_16x16x32_bf16 v[200:203], a[244:247], v[120:123], v[200:203]
v_mfma_f32_16x16x32_bf16 v[204:207], a[244:247], v[124:127], v[204:207]
ds_read_b128 a[244:247], v12 offset:62464
s_waitcnt lgkmcnt(3)
v_mfma_f32_16x16x32_bf16 v[208:211], a[248:251], v[120:123], v[208:211]
buffer_load_dwordx4 a[8:11], v1, s[36:39], s15 offen offset:2048
v_fmac_f32 v192, v8, v244
v_fmac_f32 v193, v8, v245
v_mfma_f32_16x16x32_bf16 v[212:215], a[248:251], v[124:127], v[212:215]
ds_read_b128 a[248:251], v12 offset:63488
v_fmac_f32 v194, v8, v246
s_waitcnt lgkmcnt(3)
v_mfma_f32_16x16x32_bf16 v[216:219], a[252:255], v[120:123], v[216:219]
v_fmac_f32 v195, v8, v247
v_fmac_f32 v196, v242, v244
v_mfma_f32_16x16x32_bf16 v[220:223], a[252:255], v[124:127], v[220:223]
ds_read_b128 a[252:255], v12 offset:64512
s_waitcnt vmcnt(17) lgkmcnt(3)
v_mfma_f32_16x16x32_bf16 v[144:147], a[240:243], v[128:131], v[144:147]
buffer_load_dwordx4 a[12:15], v1, s[36:39], s15 offen offset:3072
v_fmac_f32 v197, v242, v245
v_fmac_f32_e64 v198, v242, v246
v_mfma_f32_16x16x32_bf16 v[148:151], a[240:243], v[132:135], v[148:151]
s_barrier
ds_read_b128 a[240:243], v13 offset:0
v_fmac_f32_e64 v199, v242, v247
s_waitcnt lgkmcnt(3)
v_mfma_f32_16x16x32_bf16 v[152:155], a[244:247], v[128:131], v[152:155]
v_fmac_f32 v200, v8, v248
v_fmac_f32 v201, v8, v249
v_mfma_f32_16x16x32_bf16 v[156:159], a[244:247], v[132:135], v[156:159]
ds_read_b128 a[244:247], v13 offset:1024
s_waitcnt lgkmcnt(3)
v_mfma_f32_16x16x32_bf16 v[160:163], a[248:251], v[128:131], v[160:163]
s_add_u32 m0, s100, 108544
s_add_u32 s18, s99, 212992
buffer_load_dwordx4 v1, s[36:39], s18 offen lds
v_fmac_f32 v202, v8, v250
v_mfma_f32_16x16x32_bf16 v[164:167], a[248:251], v[132:135], v[164:167]
ds_read_b128 a[248:251], v13 offset:2048
v_fmac_f32 v203, v8, v251
s_waitcnt lgkmcnt(3)
v_mfma_f32_16x16x32_bf16 v[168:171], a[252:255], v[128:131], v[168:171]
v_fmac_f32 v204, v242, v248
v_fmac_f32 v205, v242, v249
v_mfma_f32_16x16x32_bf16 v[172:175], a[252:255], v[132:135], v[172:175]
ds_read_b128 a[252:255], v13 offset:3072
s_waitcnt lgkmcnt(3)
v_mfma_f32_16x16x32_bf16 v[176:179], a[240:243], v[128:131], v[176:179]
buffer_load_dwordx4 v1, s[36:39], s18 offen offset:1024 lds
v_fmac_f32 v206, v242, v250
v_fmac_f32_e64 v207, v242, v251
v_mfma_f32_16x16x32_bf16 v[180:183], a[240:243], v[132:135], v[180:183]
ds_read_b128 a[240:243], v13 offset:4096
ds_read_b128 v[244:247], v240 offset:512
ds_read_b128 v[248:251], v240 offset:576
s_waitcnt lgkmcnt(5)
v_mfma_f32_16x16x32_bf16 v[184:187], a[244:247], v[128:131], v[184:187]
v_mfma_f32_16x16x32_bf16 v[188:191], a[244:247], v[132:135], v[188:191]
ds_read_b128 a[244:247], v13 offset:5120
s_waitcnt lgkmcnt(5)
v_mfma_f32_16x16x32_bf16 v[192:195], a[248:251], v[128:131], v[192:195]
s_add_u32 m0, s100, 116736
s_add_u32 s18, s99, 221184
buffer_load_dwordx4 v1, s[36:39], s18 offen lds
v_mfma_f32_16x16x32_bf16 v[196:199], a[248:251], v[132:135], v[196:199]
ds_read_b128 a[248:251], v13 offset:6144
s_waitcnt lgkmcnt(5)
v_mfma_f32_16x16x32_bf16 v[200:203], a[252:255], v[128:131], v[200:203]
v_mfma_f32_16x16x32_bf16 v[204:207], a[252:255], v[132:135], v[204:207]
ds_read_b128 a[252:255], v13 offset:7168
s_waitcnt lgkmcnt(5)
v_mfma_f32_16x16x32_bf16 v[208:211], a[240:243], v[128:131], v[208:211]
buffer_load_dwordx4 v1, s[36:39], s18 offen offset:1024 lds
v_mfma_f32_16x16x32_bf16 v[212:215], a[240:243], v[132:135], v[212:215]
ds_read_b128 a[240:243], v13 offset:8192
s_waitcnt lgkmcnt(3)
v_mfma_f32_16x16x32_bf16 v[216:219], a[244:247], v[128:131], v[216:219]
v_mfma_f32_16x16x32_bf16 v[220:223], a[244:247], v[132:135], v[220:223]
ds_read_b128 a[244:247], v13 offset:9216
s_waitcnt vmcnt(20) lgkmcnt(3)
v_mfma_f32_16x16x32_bf16 v[144:147], a[248:251], v[136:139], v[144:147]
s_add_u32 s15, s101, 4096
buffer_load_dwordx4 a[16:19], v1, s[36:39], s15 offen
v_fmac_f32 v208, v8, v244
v_fmac_f32 v209, v8, v245
v_mfma_f32_16x16x32_bf16 v[148:151], a[248:251], v[140:143], v[148:151]
ds_read_b128 a[248:251], v13 offset:10240
v_fmac_f32 v210, v8, v246
s_waitcnt lgkmcnt(3)
v_mfma_f32_16x16x32_bf16 v[152:155], a[252:255], v[136:139], v[152:155]
v_fmac_f32 v211, v8, v247
v_fmac_f32 v212, v242, v244
v_mfma_f32_16x16x32_bf16 v[156:159], a[252:255], v[140:143], v[156:159]
ds_read_b128 a[252:255], v13 offset:11264
s_waitcnt lgkmcnt(3)
v_mfma_f32_16x16x32_bf16 v[160:163], a[240:243], v[136:139], v[160:163]
buffer_load_dwordx4 a[20:23], v1, s[36:39], s15 offen offset:1024
v_fmac_f32 v213, v242, v245
v_fmac_f32_e64 v214, v242, v246
v_mfma_f32_16x16x32_bf16 v[164:167], a[240:243], v[140:143], v[164:167]
ds_read_b128 a[240:243], v13 offset:12288
v_fmac_f32 v215, v242, v247
s_waitcnt lgkmcnt(3)
v_mfma_f32_16x16x32_bf16 v[168:171], a[244:247], v[136:139], v[168:171]
v_fmac_f32 v216, v8, v248
v_fmac_f32 v217, v8, v249
v_mfma_f32_16x16x32_bf16 v[172:175], a[244:247], v[140:143], v[172:175]
ds_read_b128 a[244:247], v13 offset:13312
s_waitcnt lgkmcnt(3)
v_mfma_f32_16x16x32_bf16 v[176:179], a[248:251], v[136:139], v[176:179]
buffer_load_dwordx4 a[24:27], v1, s[36:39], s15 offen offset:2048
v_fmac_f32 v218, v8, v250
v_fmac_f32_e64 v219, v8, v251
v_mfma_f32_16x16x32_bf16 v[180:183], a[248:251], v[140:143], v[180:183]
ds_read_b128 a[248:251], v13 offset:14336
v_fmac_f32 v220, v242, v248
s_waitcnt lgkmcnt(3)
v_mfma_f32_16x16x32_bf16 v[184:187], a[252:255], v[136:139], v[184:187]
v_fmac_f32 v221, v242, v249
v_fmac_f32 v222, v242, v250
v_mfma_f32_16x16x32_bf16 v[188:191], a[252:255], v[140:143], v[188:191]
ds_read_b128 a[252:255], v13 offset:15360
s_waitcnt lgkmcnt(3)
v_mfma_f32_16x16x32_bf16 v[192:195], a[240:243], v[136:139], v[192:195]
buffer_load_dwordx4 a[28:31], v1, s[36:39], s15 offen offset:3072
v_fmac_f32 v223, v242, v251
ds_read_b128 v[244:247], v240 offset:768
ds_read_b128 v[248:251], v240 offset:832
v_mfma_f32_16x16x32_bf16 v[196:199], a[240:243], v[140:143], v[196:199]
s_waitcnt vmcnt(20)
s_barrier
ds_read_b128 a[240:243], v13 offset:16384
s_waitcnt lgkmcnt(5)
v_mfma_f32_16x16x32_bf16 v[200:203], a[244:247], v[136:139], v[200:203]
v_mfma_f32_16x16x32_bf16 v[204:207], a[244:247], v[140:143], v[204:207]
ds_read_b128 a[244:247], v13 offset:17408
s_waitcnt lgkmcnt(5)
v_mfma_f32_16x16x32_bf16 v[208:211], a[248:251], v[136:139], v[208:211]
s_add_u32 s15, s101, 8192
buffer_load_dwordx4 a[32:35], v1, s[36:39], s15 offen
v_mfma_f32_16x16x32_bf16 v[212:215], a[248:251], v[140:143], v[212:215]
ds_read_b128 a[248:251], v13 offset:18432
s_waitcnt lgkmcnt(5)
v_mfma_f32_16x16x32_bf16 v[216:219], a[252:255], v[136:139], v[216:219]
v_mfma_f32_16x16x32_bf16 v[220:223], a[252:255], v[140:143], v[220:223]
ds_read_b128 a[252:255], v13 offset:19456
s_waitcnt lgkmcnt(3)
v_mfma_f32_16x16x32_bf16 v[224:227], a[240:243], v[16:19], v[224:227]
buffer_load_dwordx4 a[36:39], v1, s[36:39], s15 offen offset:1024
v_mfma_f32_16x16x32_bf16 v[228:231], a[240:243], v[20:23], v[228:231]
ds_read_b128 a[240:243], v13 offset:20480
s_waitcnt lgkmcnt(3)
v_mfma_f32_16x16x32_bf16 v[232:235], a[244:247], v[16:19], v[232:235]
v_mul_f32 v144, v144, v152
v_mul_f32_e64 v145, v145, v153
v_mfma_f32_16x16x32_bf16 v[236:239], a[244:247], v[20:23], v[236:239]
ds_read_b128 a[244:247], v13 offset:21504
s_waitcnt lgkmcnt(3)
v_mfma_f32_16x16x32_bf16 v[224:227], a[248:251], v[24:27], v[224:227]
buffer_load_dwordx4 a[40:43], v1, s[36:39], s15 offen offset:2048
v_mul_f32 v146, v146, v154
v_mfma_f32_16x16x32_bf16 v[228:231], a[248:251], v[28:31], v[228:231]
ds_read_b128 a[248:251], v13 offset:22528
v_mul_f32 v147, v147, v155
s_waitcnt lgkmcnt(3)
v_mfma_f32_16x16x32_bf16 v[232:235], a[252:255], v[24:27], v[232:235]
v_mul_f32 v148, v148, v156
v_mul_f32 v149, v149, v157
v_mfma_f32_16x16x32_bf16 v[236:239], a[252:255], v[28:31], v[236:239]
ds_read_b128 a[252:255], v13 offset:23552
s_waitcnt lgkmcnt(3)
v_mfma_f32_16x16x32_bf16 v[224:227], a[240:243], v[32:35], v[224:227]
buffer_load_dwordx4 a[44:47], v1, s[36:39], s15 offen offset:3072
v_mul_f32 v150, v150, v158
v_mfma_f32_16x16x32_bf16 v[228:231], a[240:243], v[36:39], v[228:231]
ds_read_b128 a[240:243], v12 offset:24576
v_mul_f32 v151, v151, v159
s_waitcnt lgkmcnt(3)
v_mfma_f32_16x16x32_bf16 v[232:235], a[244:247], v[32:35], v[232:235]
v_cvt_pk_bf16_f32 v152, v144, v145
v_cvt_pk_bf16_f32 v154, v148, v149
v_mfma_f32_16x16x32_bf16 v[236:239], a[244:247], v[36:39], v[236:239]
ds_read_b128 a[244:247], v12 offset:25600
s_waitcnt lgkmcnt(3)
v_mfma_f32_16x16x32_bf16 v[224:227], a[248:251], v[40:43], v[224:227]
s_add_u32 s15, s101, 12288
buffer_load_dwordx4 a[48:51], v1, s[36:39], s15 offen
v_cvt_pk_bf16_f32 v153, v146, v147
v_mfma_f32_16x16x32_bf16 v[228:231], a[248:251], v[44:47], v[228:231]
ds_read_b128 a[248:251], v12 offset:26624
v_cvt_pk_bf16_f32 v155, v150, v151
s_waitcnt lgkmcnt(3)
v_mfma_f32_16x16x32_bf16 v[232:235], a[252:255], v[40:43], v[232:235]
v_permlane16_swap_b32 v152, v154
v_permlane16_swap_b32 v153, v155
v_mfma_f32_16x16x32_bf16 v[236:239], a[252:255], v[44:47], v[236:239]
ds_read_b128 a[252:255], v12 offset:27648
s_waitcnt lgkmcnt(3)
v_mfma_f32_16x16x32_bf16 v[224:227], a[240:243], v[48:51], v[224:227]
buffer_load_dwordx4 a[52:55], v1, s[36:39], s15 offen offset:1024
buffer_store_dwordx4 v[152:155], v1, s[36:39], s90 offen sc1
v_mfma_f32_16x16x32_bf16 v[228:231], a[240:243], v[52:55], v[228:231]
ds_read_b128 a[240:243], v12 offset:28672
v_mul_f32_e64 v160, v160, v168
s_waitcnt lgkmcnt(3)
v_mfma_f32_16x16x32_bf16 v[232:235], a[244:247], v[48:51], v[232:235]
v_mul_f32 v161, v161, v169
v_mul_f32 v162, v162, v170
v_mfma_f32_16x16x32_bf16 v[236:239], a[244:247], v[52:55], v[236:239]
ds_read_b128 a[244:247], v12 offset:29696
s_waitcnt lgkmcnt(3)
v_mfma_f32_16x16x32_bf16 v[224:227], a[248:251], v[56:59], v[224:227]
buffer_load_dwordx4 a[56:59], v1, s[36:39], s15 offen offset:2048
v_mul_f32 v163, v163, v171
v_mfma_f32_16x16x32_bf16 v[228:231], a[248:251], v[60:63], v[228:231]
ds_read_b128 a[248:251], v12 offset:30720
v_mul_f32 v164, v164, v172
s_waitcnt lgkmcnt(3)
v_mfma_f32_16x16x32_bf16 v[232:235], a[252:255], v[56:59], v[232:235]
v_mul_f32 v165, v165, v173
v_mul_f32 v166, v166, v174
v_mfma_f32_16x16x32_bf16 v[236:239], a[252:255], v[60:63], v[236:239]
ds_read_b128 a[252:255], v12 offset:31744
s_waitcnt lgkmcnt(3)
v_mfma_f32_16x16x32_bf16 v[224:227], a[240:243], v[64:67], v[224:227]
buffer_load_dwordx4 a[60:63], v1, s[36:39], s15 offen offset:3072
v_mul_f32 v167, v167, v175
v_mfma_f32_16x16x32_bf16 v[228:231], a[240:243], v[68:71], v[228:231]
s_waitcnt vmcnt(25)
s_barrier
ds_read_b128 a[240:243], v12 offset:0
v_cvt_pk_bf16_f32 v168, v160, v161
s_waitcnt lgkmcnt(3)
v_mfma_f32_16x16x32_bf16 v[232:235], a[244:247], v[64:67], v[232:235]
v_cvt_pk_bf16_f32 v170, v164, v165
v_cvt_pk_bf16_f32 v169, v162, v163
v_mfma_f32_16x16x32_bf16 v[236:239], a[244:247], v[68:71], v[236:239]
ds_read_b128 a[244:247], v12 offset:1024
s_waitcnt lgkmcnt(3)
v_mfma_f32_16x16x32_bf16 v[224:227], a[248:251], v[72:75], v[224:227]
s_add_u32 s15, s101, 16384
buffer_load_dwordx4 a[64:67], v1, s[36:39], s15 offen
v_cvt_pk_bf16_f32 v171, v166, v167
v_mfma_f32_16x16x32_bf16 v[228:231], a[248:251], v[76:79], v[228:231]
ds_read_b128 a[248:251], v12 offset:2048
v_permlane16_swap_b32 v168, v170
s_waitcnt lgkmcnt(3)
v_mfma_f32_16x16x32_bf16 v[232:235], a[252:255], v[72:75], v[232:235]
v_permlane16_swap_b32_e64 v169, v171
buffer_store_dwordx4 v[168:171], v1, s[36:39], s90 offen offset:1024 sc1
v_mfma_f32_16x16x32_bf16 v[236:239], a[252:255], v[76:79], v[236:239]
ds_read_b128 a[252:255], v12 offset:3072
s_waitcnt lgkmcnt(3)
v_mfma_f32_16x16x32_bf16 v[224:227], a[240:243], v[80:83], v[224:227]
buffer_load_dwordx4 a[68:71], v1, s[36:39], s15 offen offset:1024
v_mul_f32 v176, v176, v184
v_mfma_f32_16x16x32_bf16 v[228:231], a[240:243], v[84:87], v[228:231]
ds_read_b128 a[240:243], v12 offset:4096
v_mul_f32 v177, v177, v185
s_waitcnt lgkmcnt(3)
v_mfma_f32_16x16x32_bf16 v[232:235], a[244:247], v[80:83], v[232:235]
v_mul_f32 v178, v178, v186
v_mul_f32 v179, v179, v187
v_mfma_f32_16x16x32_bf16 v[236:239], a[244:247], v[84:87], v[236:239]
ds_read_b128 a[244:247], v12 offset:5120
s_waitcnt lgkmcnt(3)
v_mfma_f32_16x16x32_bf16 v[224:227], a[248:251], v[88:91], v[224:227]
buffer_load_dwordx4 a[72:75], v1, s[36:39], s15 offen offset:2048
v_mul_f32 v180, v180, v188
v_mfma_f32_16x16x32_bf16 v[228:231], a[248:251], v[92:95], v[228:231]
ds_read_b128 a[248:251], v12 offset:6144
v_mul_f32 v181, v181, v189
s_waitcnt lgkmcnt(3)
v_mfma_f32_16x16x32_bf16 v[232:235], a[252:255], v[88:91], v[232:235]
v_mul_f32 v182, v182, v190
v_mul_f32 v183, v183, v191
v_mfma_f32_16x16x32_bf16 v[236:239], a[252:255], v[92:95], v[236:239]
ds_read_b128 a[252:255], v12 offset:7168
s_waitcnt lgkmcnt(3)
v_mfma_f32_16x16x32_bf16 v[224:227], a[240:243], v[96:99], v[224:227]
buffer_load_dwordx4 a[76:79], v1, s[36:39], s15 offen offset:3072
v_cvt_pk_bf16_f32 v184, v176, v177
v_mfma_f32_16x16x32_bf16 v[228:231], a[240:243], v[100:103], v[228:231]
ds_read_b128 a[240:243], v12 offset:8192
v_cvt_pk_bf16_f32 v186, v180, v181
s_waitcnt lgkmcnt(3)
v_mfma_f32_16x16x32_bf16 v[232:235], a[244:247], v[96:99], v[232:235]
v_cvt_pk_bf16_f32 v185, v178, v179
v_cvt_pk_bf16_f32 v187, v182, v183
v_mfma_f32_16x16x32_bf16 v[236:239], a[244:247], v[100:103], v[236:239]
ds_read_b128 a[244:247], v12 offset:9216
s_waitcnt lgkmcnt(3)
v_mfma_f32_16x16x32_bf16 v[224:227], a[248:251], v[104:107], v[224:227]
s_add_u32 s15, s101, 20480
buffer_load_dwordx4 a[80:83], v1, s[36:39], s15 offen
v_permlane16_swap_b32 v184, v186
v_mfma_f32_16x16x32_bf16 v[228:231], a[248:251], v[108:111], v[228:231]
ds_read_b128 a[248:251], v12 offset:10240
v_permlane16_swap_b32 v185, v187
s_waitcnt lgkmcnt(3)
v_mfma_f32_16x16x32_bf16 v[232:235], a[252:255], v[104:107], v[232:235]
buffer_store_dwordx4 v[184:187], v1, s[36:39], s90 offen offset:2048 sc1
v_mul_f32_e64 v192, v192, v200
v_mfma_f32_16x16x32_bf16 v[236:239], a[252:255], v[108:111], v[236:239]
ds_read_b128 a[252:255], v12 offset:11264
s_waitcnt lgkmcnt(3)
v_mfma_f32_16x16x32_bf16 v[224:227], a[240:243], v[112:115], v[224:227]
buffer_load_dwordx4 a[84:87], v1, s[36:39], s15 offen offset:1024
v_mul_f32 v193, v193, v201
v_mfma_f32_16x16x32_bf16 v[228:231], a[240:243], v[116:119], v[228:231]
ds_read_b128 a[240:243], v12 offset:12288
v_mul_f32 v194, v194, v202
s_waitcnt lgkmcnt(3)
v_mfma_f32_16x16x32_bf16 v[232:235], a[244:247], v[112:115], v[232:235]
v_mul_f32 v195, v195, v203
v_mul_f32 v196, v196, v204
v_mfma_f32_16x16x32_bf16 v[236:239], a[244:247], v[116:119], v[236:239]
ds_read_b128 a[244:247], v12 offset:13312
s_waitcnt lgkmcnt(3)
v_mfma_f32_16x16x32_bf16 v[224:227], a[248:251], v[120:123], v[224:227]
buffer_load_dwordx4 a[88:91], v1, s[36:39], s15 offen offset:2048
v_mul_f32 v197, v197, v205
v_mfma_f32_16x16x32_bf16 v[228:231], a[248:251], v[124:127], v[228:231]
ds_read_b128 a[248:251], v12 offset:14336
v_mul_f32 v198, v198, v206
s_waitcnt lgkmcnt(3)
v_mfma_f32_16x16x32_bf16 v[232:235], a[252:255], v[120:123], v[232:235]
v_mul_f32_e64 v199, v199, v207
v_cvt_pk_bf16_f32 v200, v192, v193
v_mfma_f32_16x16x32_bf16 v[236:239], a[252:255], v[124:127], v[236:239]
ds_read_b128 a[252:255], v12 offset:15360
s_waitcnt lgkmcnt(3)
v_mfma_f32_16x16x32_bf16 v[224:227], a[240:243], v[128:131], v[224:227]
buffer_load_dwordx4 a[92:95], v1, s[36:39], s15 offen offset:3072
v_cvt_pk_bf16_f32 v202, v196, v197
v_mfma_f32_16x16x32_bf16 v[228:231], a[240:243], v[132:135], v[228:231]
s_waitcnt vmcnt(31)
s_barrier
ds_read_b128 a[240:243], v12 offset:16384
v_cvt_pk_bf16_f32 v201, v194, v195
s_waitcnt lgkmcnt(3)
v_mfma_f32_16x16x32_bf16 v[232:235], a[244:247], v[128:131], v[232:235]
v_cvt_pk_bf16_f32 v203, v198, v199
v_permlane16_swap_b32_e64 v200, v202
v_mfma_f32_16x16x32_bf16 v[236:239], a[244:247], v[132:135], v[236:239]
ds_read_b128 a[244:247], v12 offset:17408
s_waitcnt lgkmcnt(3)
v_mfma_f32_16x16x32_bf16 v[224:227], a[248:251], v[136:139], v[224:227]
s_add_u32 s15, s101, 24576
buffer_load_dwordx4 a[96:99], v1, s[36:39], s15 offen
v_permlane16_swap_b32 v201, v203
v_mfma_f32_16x16x32_bf16 v[228:231], a[248:251], v[140:143], v[228:231]
ds_read_b128 a[248:251], v12 offset:18432
buffer_store_dwordx4 v[200:203], v1, s[36:39], s90 offen offset:3072 sc1
s_waitcnt lgkmcnt(3)
v_mfma_f32_16x16x32_bf16 v[232:235], a[252:255], v[136:139], v[232:235]
v_mul_f32 v208, v208, v216
v_mul_f32_e64 v209, v209, v217
v_mfma_f32_16x16x32_bf16 v[236:239], a[252:255], v[140:143], v[236:239]
ds_read_b128 a[252:255], v12 offset:19456
s_waitcnt lgkmcnt(3)
v_mfma_f32_16x16x32_bf16 v[144:147], a[240:243], v[16:19], 0
buffer_load_dwordx4 a[100:103], v1, s[36:39], s15 offen offset:1024
v_mul_f32 v210, v210, v218
v_mfma_f32_16x16x32_bf16 v[148:151], a[240:243], v[20:23], 0
ds_read_b128 a[240:243], v12 offset:20480
v_mul_f32 v211, v211, v219
s_waitcnt lgkmcnt(3)
v_mfma_f32_16x16x32_bf16 v[152:155], a[244:247], v[16:19], 0
v_mul_f32 v212, v212, v220
v_mul_f32 v213, v213, v221
v_mfma_f32_16x16x32_bf16 v[156:159], a[244:247], v[20:23], 0
ds_read_b128 a[244:247], v12 offset:21504
s_waitcnt lgkmcnt(3)
v_mfma_f32_16x16x32_bf16 v[144:147], a[248:251], v[24:27], v[144:147]
buffer_load_dwordx4 a[104:107], v1, s[36:39], s15 offen offset:2048
v_mul_f32 v214, v214, v222
v_mfma_f32_16x16x32_bf16 v[148:151], a[248:251], v[28:31], v[148:151]
ds_read_b128 a[248:251], v12 offset:22528
v_mul_f32 v215, v215, v223
s_waitcnt lgkmcnt(3)
v_mfma_f32_16x16x32_bf16 v[152:155], a[252:255], v[24:27], v[152:155]
v_cvt_pk_bf16_f32 v216, v208, v209
v_cvt_pk_bf16_f32 v218, v212, v213
v_mfma_f32_16x16x32_bf16 v[156:159], a[252:255], v[28:31], v[156:159]
ds_read_b128 a[252:255], v12 offset:23552
s_waitcnt lgkmcnt(3)
v_mfma_f32_16x16x32_bf16 v[144:147], a[240:243], v[32:35], v[144:147]
buffer_load_dwordx4 a[108:111], v1, s[36:39], s15 offen offset:3072
v_cvt_pk_bf16_f32 v217, v210, v211
v_mfma_f32_16x16x32_bf16 v[148:151], a[240:243], v[36:39], v[148:151]
ds_read_b128 a[240:243], v12 offset:32768
v_cvt_pk_bf16_f32 v219, v214, v215
s_waitcnt lgkmcnt(3)
v_mfma_f32_16x16x32_bf16 v[152:155], a[244:247], v[32:35], v[152:155]
v_permlane16_swap_b32 v216, v218
v_permlane16_swap_b32 v217, v219
v_mfma_f32_16x16x32_bf16 v[156:159], a[244:247], v[36:39], v[156:159]
ds_read_b128 a[244:247], v12 offset:33792
s_waitcnt lgkmcnt(3)
v_mfma_f32_16x16x32_bf16 v[144:147], a[248:251], v[40:43], v[144:147]
s_add_u32 s15, s101, 28672
buffer_load_dwordx4 a[112:115], v1, s[36:39], s15 offen
s_add_u32 s90, s90, 4096
buffer_store_dwordx4 v[216:219], v1, s[36:39], s90 offen sc1
v_mfma_f32_16x16x32_bf16 v[148:151], a[248:251], v[44:47], v[148:151]
ds_read_b128 a[248:251], v12 offset:34816
s_lshl_b32 s80, s69, 2
s_waitcnt lgkmcnt(3)
v_mfma_f32_16x16x32_bf16 v[152:155], a[252:255], v[40:43], v[152:155]
s_lshl_b32 s77, s73, 1
s_add_u32 s80, s80, s77
s_add_u32 s80, s80, s75
s_lshl_b32 s81, s80, 12
v_mfma_f32_16x16x32_bf16 v[156:159], a[252:255], v[44:47], v[156:159]
ds_read_b128 a[252:255], v12 offset:35840
s_waitcnt lgkmcnt(3)
v_mfma_f32_16x16x32_bf16 v[144:147], a[240:243], v[48:51], v[144:147]
buffer_load_dwordx4 a[116:119], v1, s[36:39], s15 offen offset:1024
s_lshl_b32 s77, s72, 9
s_add_u32 s81, s81, s77
v_mfma_f32_16x16x32_bf16 v[148:151], a[240:243], v[52:55], v[148:151]
ds_read_b128 a[240:243], v12 offset:36864
s_lshl_b32 s77, s74, 3
s_waitcnt lgkmcnt(3)
v_mfma_f32_16x16x32_bf16 v[152:155], a[244:247], v[48:51], v[152:155]
s_add_u32 s81, s81, s77
s_lshl_b32 s80, s80, 15
s_lshl_b32 s77, s72, 7
s_lshl_b32 s78, s74, 6
v_mfma_f32_16x16x32_bf16 v[156:159], a[244:247], v[52:55], v[156:159]
ds_read_b128 a[244:247], v12 offset:37888
s_waitcnt lgkmcnt(3)
v_mfma_f32_16x16x32_bf16 v[144:147], a[248:251], v[56:59], v[144:147]
buffer_load_dwordx4 a[120:123], v1, s[36:39], s15 offen offset:2048
s_add_u32 s77, s77, s78
s_add_u32 s79, s80, s77
v_mfma_f32_16x16x32_bf16 v[148:151], a[248:251], v[60:63], v[148:151]
ds_read_b128 a[248:251], v12 offset:38912
s_lshl_b32 s77, s77, 5
s_waitcnt lgkmcnt(3)
v_mfma_f32_16x16x32_bf16 v[152:155], a[252:255], v[56:59], v[152:155]
s_add_u32 s80, s80, s77
v_and_b32 v7, 31, v0
v_lshrrev_b32 v11, 5, v0
v_mfma_f32_16x16x32_bf16 v[156:159], a[252:255], v[60:63], v[156:159]
ds_read_b128 a[252:255], v12 offset:39936
s_waitcnt lgkmcnt(3)
v_mfma_f32_16x16x32_bf16 v[144:147], a[240:243], v[64:67], v[144:147]
buffer_load_dwordx4 a[124:127], v1, s[36:39], s15 offen offset:3072
v_mov_b32 v243, 3
v_mov_b32_e64 v6, s83
s_waitcnt vmcnt(8)
s_mov_b64 exec, 1
buffer_store_dword v243, v6, s[36:39], 0 offen sc1
s_mov_b64 exec, -1
v_mfma_f32_16x16x32_bf16 v[148:151], a[240:243], v[68:71], v[148:151]
s_barrier
ds_read_b128 a[240:243], v12 offset:40960
v_lshlrev_b32 v7, 4, v7
s_waitcnt lgkmcnt(3)
v_mfma_f32_16x16x32_bf16 v[152:155], a[244:247], v[64:67], v[152:155]
v_lshl_add_u32 v5, v11, 2, v7
s_lshl_b32 s77, s69, 8
s_lshl_b32 s78, s73, 7
v_mfma_f32_16x16x32_bf16 v[156:159], a[244:247], v[68:71], v[156:159]
ds_read_b128 a[244:247], v12 offset:41984
s_waitcnt lgkmcnt(3)
v_mfma_f32_16x16x32_bf16 v[144:147], a[248:251], v[72:75], v[144:147]
s_add_u32 s15, s101, 32768
buffer_load_dwordx4 a[128:131], v1, s[36:39], s15 offen
s_add_u32 s77, s77, s78
v_mfma_f32_16x16x32_bf16 v[148:151], a[248:251], v[76:79], v[148:151]
ds_read_b128 a[248:251], v12 offset:43008
s_lshl_b32 s78, s68, 4
s_waitcnt lgkmcnt(3)
v_mfma_f32_16x16x32_bf16 v[152:155], a[252:255], v[72:75], v[152:155]
s_add_u32 s77, s77, s78
s_add_u32 s77, s77, 16384
v_and_b32 v7, 3, v0
v_mfma_f32_16x16x32_bf16 v[156:159], a[252:255], v[76:79], v[156:159]
ds_read_b128 a[252:255], v12 offset:44032
s_waitcnt lgkmcnt(3)
v_mfma_f32_16x16x32_bf16 v[144:147], a[240:243], v[80:83], v[144:147]
buffer_load_dwordx4 a[132:135], v1, s[36:39], s15 offen offset:1024
v_bfe_u32 v11, v0, 2, 1
v_mfma_f32_16x16x32_bf16 v[148:151], a[240:243], v[84:87], v[148:151]
ds_read_b128 a[240:243], v12 offset:45056
v_lshlrev_b32_e64 v11, 6, v11
s_waitcnt lgkmcnt(3)
v_mfma_f32_16x16x32_bf16 v[152:155], a[244:247], v[80:83], v[152:155]
v_lshl_add_u32 v11, v7, 2, v11
v_add_u32_e64 v11, s77, v11
v_mfma_f32_16x16x32_bf16 v[156:159], a[244:247], v[84:87], v[156:159]
ds_read_b128 a[244:247], v12 offset:46080
s_waitcnt lgkmcnt(3)
v_mfma_f32_16x16x32_bf16 v[144:147], a[248:251], v[88:91], v[144:147]
buffer_load_dwordx4 a[136:139], v1, s[36:39], s15 offen offset:2048
s_lshl_b32 s77, s69, 2
s_lshl_b32 s78, s73, 1
v_mfma_f32_16x16x32_bf16 v[148:151], a[248:251], v[92:95], v[148:151]
ds_read_b128 a[248:251], v12 offset:47104
s_add_u32 s77, s77, s78
s_waitcnt lgkmcnt(3)
v_mfma_f32_16x16x32_bf16 v[152:155], a[252:255], v[88:91], v[152:155]
s_mul_i32 s92, s77, 114688
s_mul_i32 s78, s68, 28672
s_add_u32 s92, s92, s78
s_add_u32 s92, s92, 10485760
v_mfma_f32_16x16x32_bf16 v[156:159], a[252:255], v[92:95], v[156:159]
ds_read_b128 a[252:255], v12 offset:48128
s_waitcnt lgkmcnt(3)
v_mfma_f32_16x16x32_bf16 v[144:147], a[240:243], v[96:99], v[144:147]
buffer_load_dwordx4 a[140:143], v1, s[36:39], s15 offen offset:3072
s_add_u32 s93, s92, 114688
v_mul_f32 v224, v224, v232
v_mfma_f32_16x16x32_bf16 v[148:151], a[240:243], v[100:103], v[148:151]
ds_read_b128 a[240:243], v12 offset:49152
v_mul_f32 v225, v225, v233
s_waitcnt lgkmcnt(3)
v_mfma_f32_16x16x32_bf16 v[152:155], a[244:247], v[96:99], v[152:155]
v_mul_f32 v226, v226, v234
v_mul_f32 v227, v227, v235
v_mfma_f32_16x16x32_bf16 v[156:159], a[244:247], v[100:103], v[156:159]
ds_read_b128 a[244:247], v12 offset:50176
s_waitcnt lgkmcnt(3)
v_mfma_f32_16x16x32_bf16 v[144:147], a[248:251], v[104:107], v[144:147]
s_add_u32 s15, s101, 36864
buffer_load_dwordx4 a[144:147], v1, s[36:39], s15 offen
v_mul_f32 v228, v228, v236
v_mfma_f32_16x16x32_bf16 v[148:151], a[248:251], v[108:111], v[148:151]
ds_read_b128 a[248:251], v12 offset:51200
v_mul_f32 v229, v229, v237
s_waitcnt lgkmcnt(3)
v_mfma_f32_16x16x32_bf16 v[152:155], a[252:255], v[104:107], v[152:155]
v_mul_f32 v230, v230, v238
v_mul_f32 v231, v231, v239
v_mfma_f32_16x16x32_bf16 v[156:159], a[252:255], v[108:111], v[156:159]
ds_read_b128 a[252:255], v12 offset:52224
s_waitcnt lgkmcnt(3)
v_mfma_f32_16x16x32_bf16 v[144:147], a[240:243], v[112:115], v[144:147]
buffer_load_dwordx4 a[148:151], v1, s[36:39], s15 offen offset:1024
v_cvt_pk_bf16_f32 v232, v224, v225
v_mfma_f32_16x16x32_bf16 v[148:151], a[240:243], v[116:119], v[148:151]
ds_read_b128 a[240:243], v12 offset:53248
v_cvt_pk_bf16_f32 v234, v228, v229
s_waitcnt lgkmcnt(3)
v_mfma_f32_16x16x32_bf16 v[152:155], a[244:247], v[112:115], v[152:155]
v_cvt_pk_bf16_f32 v233, v226, v227
v_cvt_pk_bf16_f32 v235, v230, v231
v_mfma_f32_16x16x32_bf16 v[156:159], a[244:247], v[116:119], v[156:159]
ds_read_b128 a[244:247], v12 offset:54272
s_waitcnt lgkmcnt(3)
v_mfma_f32_16x16x32_bf16 v[144:147], a[248:251], v[120:123], v[144:147]
buffer_load_dwordx4 a[152:155], v1, s[36:39], s15 offen offset:2048
v_permlane16_swap_b32 v232, v234
v_mfma_f32_16x16x32_bf16 v[148:151], a[248:251], v[124:127], v[148:151]
ds_read_b128 a[248:251], v12 offset:55296
v_permlane16_swap_b32 v233, v235
s_waitcnt lgkmcnt(3)
v_mfma_f32_16x16x32_bf16 v[152:155], a[252:255], v[120:123], v[152:155]
buffer_store_dwordx4 v[232:235], v1, s[36:39], s90 offen offset:1024 sc1
v_mfma_f32_16x16x32_bf16 v[156:159], a[252:255], v[124:127], v[156:159]
ds_read_b128 a[252:255], v12 offset:56320
buffer_load_dword v6, v11, s[36:39], 0 offen sc1
s_waitcnt lgkmcnt(3)
v_mfma_f32_16x16x32_bf16 v[144:147], a[240:243], v[128:131], v[144:147]
buffer_load_dwordx4 a[156:159], v1, s[36:39], s15 offen offset:3072
v_mfma_f32_16x16x32_bf16 v[148:151], a[240:243], v[132:135], v[148:151]
s_waitcnt lgkmcnt(2)
v_mfma_f32_16x16x32_bf16 v[152:155], a[244:247], v[128:131], v[152:155]
v_mfma_f32_16x16x32_bf16 v[156:159], a[244:247], v[132:135], v[156:159]
s_waitcnt lgkmcnt(1)
v_mfma_f32_16x16x32_bf16 v[144:147], a[248:251], v[136:139], v[144:147]
s_add_u32 s15, s101, 40960
buffer_load_dwordx4 a[160:163], v1, s[36:39], s15 offen
v_mfma_f32_16x16x32_bf16 v[148:151], a[248:251], v[140:143], v[148:151]
s_waitcnt lgkmcnt(0)
v_mfma_f32_16x16x32_bf16 v[152:155], a[252:255], v[136:139], v[152:155]
v_mfma_f32_16x16x32_bf16 v[156:159], a[252:255], v[140:143], v[156:159]
s_barrier
s_nop 0
v_fmac_f32 v144, v8, v244
v_fmac_f32 v145, v8, v245
v_fmac_f32 v146, v8, v246
v_fmac_f32 v147, v8, v247
v_fmac_f32 v148, v242, v244
v_fmac_f32 v149, v242, v245
v_fmac_f32 v150, v242, v246
v_fmac_f32 v151, v242, v247
v_fmac_f32 v152, v8, v248
v_fmac_f32 v153, v8, v249
v_fmac_f32 v154, v8, v250
v_fmac_f32 v155, v8, v251
v_fmac_f32 v156, v242, v248
v_fmac_f32 v157, v242, v249
v_fmac_f32 v158, v242, v250
v_fmac_f32 v159, v242, v251
v_mul_f32 v144, v144, v152
v_mul_f32 v145, v145, v153
v_mul_f32 v146, v146, v154
v_mul_f32 v147, v147, v155
v_mul_f32 v148, v148, v156
v_mul_f32 v149, v149, v157
v_mul_f32 v150, v150, v158
v_mul_f32 v151, v151, v159
v_cvt_pk_bf16_f32 v152, v144, v145
v_cvt_pk_bf16_f32 v154, v148, v149
v_cvt_pk_bf16_f32 v153, v146, v147
v_cvt_pk_bf16_f32 v155, v150, v151
v_permlane16_swap_b32 v152, v154
s_nop 0
v_permlane16_swap_b32_e64 v153, v155
buffer_store_dwordx4 v[152:155], v1, s[36:39], s90 offen offset:2048 sc1
s_waitcnt vmcnt(3)
v_cmp_gt_u32 vcc, 3, v6
s_nop 0
s_cbranch_vccz Lgo_80
Lpoll_79:
buffer_load_dword v6, v11, s[36:39], 0 offen sc1
s_waitcnt vmcnt(0)
v_cmp_gt_u32 vcc, 3, v6
s_nop 0
s_cbranch_vccz Lgo_80
s_add_u32 s91, s91, 1
s_bitcmp0_b32 s91, 16
s_cbranch_scc1 Lpoll_79
Lgo_80:
s_add_u32 s77, s92, 0
buffer_load_dwordx4 v[80:83], v14, s[36:39], s77 offen sc1
buffer_load_dwordx4 v[84:87], v14, s[36:39], s77 offen offset:256 sc1
s_add_u32 s77, s93, 0
buffer_load_dwordx4 v[88:91], v14, s[36:39], s77 offen sc1
buffer_load_dwordx4 v[92:95], v14, s[36:39], s77 offen offset:256 sc1
v_mov_b32 v7, 4
v_mov_b32_e64 v6, s83
s_waitcnt vmcnt(4)
s_mov_b64 exec, 1
buffer_store_dword v7, v6, s[36:39], 0 offen sc1
s_mov_b64 exec, -1
s_add_u32 s77, s92, 7168
buffer_load_dwordx4 v[96:99], v14, s[36:39], s77 offen sc1
buffer_load_dwordx4 v[100:103], v14, s[36:39], s77 offen offset:256 sc1
s_add_u32 s77, s93, 7168
buffer_load_dwordx4 v[104:107], v14, s[36:39], s77 offen sc1
buffer_load_dwordx4 v[108:111], v14, s[36:39], s77 offen offset:256 sc1
s_add_u32 s77, s92, 14336
buffer_load_dwordx4 v[112:115], v14, s[36:39], s77 offen sc1
buffer_load_dwordx4 v[116:119], v14, s[36:39], s77 offen offset:256 sc1
s_add_u32 s77, s93, 14336
buffer_load_dwordx4 v[120:123], v14, s[36:39], s77 offen sc1
buffer_load_dwordx4 v[124:127], v14, s[36:39], s77 offen offset:256 sc1
s_waitcnt vmcnt(12)
v_mfma_f32_16x16x32_bf16 v[16:19], a[0:3], v[80:83], 0
s_add_u32 s77, s92, 21504
buffer_load_dwordx4 v[128:131], v14, s[36:39], s77 offen sc1
v_mfma_f32_16x16x32_bf16 v[24:27], a[4:7], v[80:83], 0
v_lshrrev_b32_e64 v7, 5, v0
v_mul_u32_u24 v7, 6144, v7
v_mfma_f32_16x16x32_bf16 v[48:51], a[8:11], v[80:83], 0
v_mfma_f32_16x16x32_bf16 v[56:59], a[12:15], v[80:83], 0
s_waitcnt vmcnt(12)
v_mfma_f32_16x16x32_bf16 v[20:23], a[0:3], v[84:87], 0
buffer_load_dwordx4 v[132:135], v14, s[36:39], s77 offen offset:256 sc1
v_mfma_f32_16x16x32_bf16 v[28:31], a[4:7], v[84:87], 0
v_add_u32_e64 v250, v7, v14
s_sub_u32 s78, s68, 1
v_mfma_f32_16x16x32_bf16 v[52:55], a[8:11], v[84:87], 0
v_mfma_f32_16x16x32_bf16 v[60:63], a[12:15], v[84:87], 0
s_waitcnt vmcnt(12)
v_mfma_f32_16x16x32_bf16 v[32:35], a[0:3], v[88:91], 0
s_add_u32 s77, s93, 21504
buffer_load_dwordx4 v[136:139], v14, s[36:39], s77 offen sc1
v_mfma_f32_16x16x32_bf16 v[40:43], a[4:7], v[88:91], 0
s_and_b32 s78, s78, 3
s_lshl_b32 s78, s78, 12
v_mfma_f32_16x16x32_bf16 v[64:67], a[8:11], v[88:91], 0
buffer_load_dwordx4 a[164:167], v1, s[36:39], s15 offen offset:1024
v_mfma_f32_16x16x32_bf16 v[72:75], a[12:15], v[88:91], 0
s_waitcnt vmcnt(13)
v_mfma_f32_16x16x32_bf16 v[36:39], a[0:3], v[92:95], 0
buffer_load_dwordx4 v[140:143], v14, s[36:39], s77 offen offset:256 sc1
v_mfma_f32_16x16x32_bf16 v[44:47], a[4:7], v[92:95], 0
s_add_u32 s78, s78, 67584
v_add_u32_e64 v12, s78, v1
v_mfma_f32_16x16x32_bf16 v[68:71], a[8:11], v[92:95], 0
buffer_load_dwordx4 a[168:171], v1, s[36:39], s15 offen offset:2048
v_mfma_f32_16x16x32_bf16 v[76:79], a[12:15], v[92:95], 0
s_waitcnt vmcnt(13)
v_mfma_f32_16x16x32_bf16 v[16:19], a[16:19], v[96:99], v[16:19]
s_add_u32 s77, s92, 2048
buffer_load_dwordx4 v[160:163], v14, s[36:39], s77 offen sc1
v_mfma_f32_16x16x32_bf16 v[24:27], a[20:23], v[96:99], v[24:27]
s_sub_u32 s78, s68, 3
s_and_b32 s78, s78, 3
v_mfma_f32_16x16x32_bf16 v[48:51], a[24:27], v[96:99], v[48:51]
buffer_load_dwordx4 a[172:175], v1, s[36:39], s15 offen offset:3072
v_mfma_f32_16x16x32_bf16 v[56:59], a[28:31], v[96:99], v[56:59]
s_waitcnt vmcnt(14)
v_mfma_f32_16x16x32_bf16 v[20:23], a[16:19], v[100:103], v[20:23]
buffer_load_dwordx4 v[164:167], v14, s[36:39], s77 offen offset:256 sc1
v_mfma_f32_16x16x32_bf16 v[28:31], a[20:23], v[100:103], v[28:31]
s_lshl_b32 s78, s78, 12
s_add_u32 s78, s78, 100352
v_mfma_f32_16x16x32_bf16 v[52:55], a[24:27], v[100:103], v[52:55]
s_add_u32 s15, s101, 45056
buffer_load_dwordx4 a[176:179], v1, s[36:39], s15 offen
v_mfma_f32_16x16x32_bf16 v[60:63], a[28:31], v[100:103], v[60:63]
s_waitcnt vmcnt(15)
v_mfma_f32_16x16x32_bf16 v[32:35], a[16:19], v[104:107], v[32:35]
s_add_u32 s77, s93, 2048
buffer_load_dwordx4 v[168:171], v14, s[36:39], s77 offen sc1
v_mfma_f32_16x16x32_bf16 v[40:43], a[20:23], v[104:107], v[40:43]
v_add_u32 v13, s78, v1
s_lshl_b32 s78, s68, 14
v_mfma_f32_16x16x32_bf16 v[64:67], a[24:27], v[104:107], v[64:67]
buffer_load_dwordx4 a[180:183], v1, s[36:39], s15 offen offset:1024
v_mfma_f32_16x16x32_bf16 v[72:75], a[28:31], v[104:107], v[72:75]
s_waitcnt vmcnt(16)
v_mfma_f32_16x16x32_bf16 v[36:39], a[16:19], v[108:111], v[36:39]
buffer_load_dwordx4 v[172:175], v14, s[36:39], s77 offen offset:256 sc1
v_mfma_f32_16x16x32_bf16 v[44:47], a[20:23], v[108:111], v[44:47]
s_add_u32 s78, s78, 67584
v_add_u32 v248, s78, v1
v_mfma_f32_16x16x32_bf16 v[68:71], a[24:27], v[108:111], v[68:71]
buffer_load_dwordx4 a[184:187], v1, s[36:39], s15 offen offset:2048
v_mfma_f32_16x16x32_bf16 v[76:79], a[28:31], v[108:111], v[76:79]
s_waitcnt vmcnt(17)
v_mfma_f32_16x16x32_bf16 v[16:19], a[32:35], v[112:115], v[16:19]
buffer_load_dword v6, v11, s[36:39], 0 offen sc1
s_add_u32 s77, s92, 9216
buffer_load_dwordx4 v[176:179], v14, s[36:39], s77 offen sc1
v_mfma_f32_16x16x32_bf16 v[24:27], a[36:39], v[112:115], v[24:27]
s_lshl_b32 s78, s73, 1
s_add_u32 s78, s78, s75
v_mfma_f32_16x16x32_bf16 v[48:51], a[40:43], v[112:115], v[48:51]
buffer_load_dwordx4 a[188:191], v1, s[36:39], s15 offen offset:3072
v_mfma_f32_16x16x32_bf16 v[56:59], a[44:47], v[112:115], v[56:59]
s_waitcnt vmcnt(19)
v_mfma_f32_16x16x32_bf16 v[20:23], a[32:35], v[116:119], v[20:23]
buffer_load_dwordx4 v[180:183], v14, s[36:39], s77 offen offset:256 sc1
v_mfma_f32_16x16x32_bf16 v[28:31], a[36:39], v[116:119], v[28:31]
s_lshl_b32 s78, s78, 7
s_add_u32 s78, s78, 66944
v_mfma_f32_16x16x32_bf16 v[52:55], a[40:43], v[116:119], v[52:55]
s_add_u32 s15, s101, 49152
buffer_load_dwordx4 a[192:195], v1, s[36:39], s15 offen
v_mfma_f32_16x16x32_bf16 v[60:63], a[44:47], v[116:119], v[60:63]
s_waitcnt vmcnt(20)
v_mfma_f32_16x16x32_bf16 v[32:35], a[32:35], v[120:123], v[32:35]
s_add_u32 s77, s93, 9216
buffer_load_dwordx4 v[184:187], v14, s[36:39], s77 offen sc1
v_mfma_f32_16x16x32_bf16 v[40:43], a[36:39], v[120:123], v[40:43]
v_and_b32_e64 v7, 15, v0
v_lshl_add_u32 v249, v7, 2, s78
v_mfma_f32_16x16x32_bf16 v[64:67], a[40:43], v[120:123], v[64:67]
buffer_load_dwordx4 a[196:199], v1, s[36:39], s15 offen offset:1024
v_mfma_f32_16x16x32_bf16 v[72:75], a[44:47], v[120:123], v[72:75]
s_waitcnt vmcnt(21)
v_mfma_f32_16x16x32_bf16 v[36:39], a[32:35], v[124:127], v[36:39]
buffer_load_dwordx4 v[188:191], v14, s[36:39], s77 offen offset:256 sc1
v_mfma_f32_16x16x32_bf16 v[44:47], a[36:39], v[124:127], v[44:47]
v_mfma_f32_16x16x32_bf16 v[68:71], a[40:43], v[124:127], v[68:71]
buffer_load_dwordx4 a[200:203], v1, s[36:39], s15 offen offset:2048
v_mfma_f32_16x16x32_bf16 v[76:79], a[44:47], v[124:127], v[76:79]
s_waitcnt vmcnt(22)
v_mfma_f32_16x16x32_bf16 v[16:19], a[48:51], v[128:131], v[16:19]
s_add_u32 s77, s92, 16384
buffer_load_dwordx4 v[192:195], v14, s[36:39], s77 offen sc1
v_mfma_f32_16x16x32_bf16 v[24:27], a[52:55], v[128:131], v[24:27]
v_mfma_f32_16x16x32_bf16 v[48:51], a[56:59], v[128:131], v[48:51]
buffer_load_dwordx4 a[204:207], v1, s[36:39], s15 offen offset:3072
v_mfma_f32_16x16x32_bf16 v[56:59], a[60:63], v[128:131], v[56:59]
s_waitcnt vmcnt(23)
v_mfma_f32_16x16x32_bf16 v[20:23], a[48:51], v[132:135], v[20:23]
buffer_load_dwordx4 v[196:199], v14, s[36:39], s77 offen offset:256 sc1
v_mfma_f32_16x16x32_bf16 v[28:31], a[52:55], v[132:135], v[28:31]
v_mfma_f32_16x16x32_bf16 v[52:55], a[56:59], v[132:135], v[52:55]
s_add_u32 s15, s101, 53248
buffer_load_dwordx4 a[208:211], v1, s[36:39], s15 offen
v_mfma_f32_16x16x32_bf16 v[60:63], a[60:63], v[132:135], v[60:63]
s_waitcnt vmcnt(24)
v_mfma_f32_16x16x32_bf16 v[32:35], a[48:51], v[136:139], v[32:35]
s_add_u32 s77, s93, 16384
buffer_load_dwordx4 v[200:203], v14, s[36:39], s77 offen sc1
v_mfma_f32_16x16x32_bf16 v[40:43], a[52:55], v[136:139], v[40:43]
v_mfma_f32_16x16x32_bf16 v[64:67], a[56:59], v[136:139], v[64:67]
buffer_load_dwordx4 a[212:215], v1, s[36:39], s15 offen offset:1024
v_mfma_f32_16x16x32_bf16 v[72:75], a[60:63], v[136:139], v[72:75]
s_waitcnt vmcnt(24)
v_mfma_f32_16x16x32_bf16 v[36:39], a[48:51], v[140:143], v[36:39]
buffer_load_dwordx4 v[204:207], v14, s[36:39], s77 offen offset:256 sc1
v_mfma_f32_16x16x32_bf16 v[44:47], a[52:55], v[140:143], v[44:47]
v_mfma_f32_16x16x32_bf16 v[68:71], a[56:59], v[140:143], v[68:71]
buffer_load_dwordx4 a[216:219], v1, s[36:39], s15 offen offset:2048
v_mfma_f32_16x16x32_bf16 v[76:79], a[60:63], v[140:143], v[76:79]
s_waitcnt vmcnt(24)
v_mfma_f32_16x16x32_bf16 v[16:19], a[64:67], v[160:163], v[16:19]
s_add_u32 s77, s92, 23552
buffer_load_dwordx4 v[208:211], v14, s[36:39], s77 offen sc1
v_mfma_f32_16x16x32_bf16 v[24:27], a[68:71], v[160:163], v[24:27]
v_mfma_f32_16x16x32_bf16 v[48:51], a[72:75], v[160:163], v[48:51]
buffer_load_dwordx4 a[220:223], v1, s[36:39], s15 offen offset:3072
v_mfma_f32_16x16x32_bf16 v[56:59], a[76:79], v[160:163], v[56:59]
s_waitcnt vmcnt(24)
v_mfma_f32_16x16x32_bf16 v[20:23], a[64:67], v[164:167], v[20:23]
buffer_load_dwordx4 v[212:215], v14, s[36:39], s77 offen offset:256 sc1
v_mfma_f32_16x16x32_bf16 v[28:31], a[68:71], v[164:167], v[28:31]
v_mfma_f32_16x16x32_bf16 v[52:55], a[72:75], v[164:167], v[52:55]
v_mfma_f32_16x16x32_bf16 v[60:63], a[76:79], v[164:167], v[60:63]
s_waitcnt vmcnt(23)
v_mfma_f32_16x16x32_bf16 v[32:35], a[64:67], v[168:171], v[32:35]
s_add_u32 s77, s93, 23552
buffer_load_dwordx4 v[216:219], v14, s[36:39], s77 offen sc1
v_mfma_f32_16x16x32_bf16 v[40:43], a[68:71], v[168:171], v[40:43]
v_mfma_f32_16x16x32_bf16 v[64:67], a[72:75], v[168:171], v[64:67]
v_mfma_f32_16x16x32_bf16 v[72:75], a[76:79], v[168:171], v[72:75]
s_waitcnt vmcnt(22)
v_mfma_f32_16x16x32_bf16 v[36:39], a[64:67], v[172:175], v[36:39]
buffer_load_dwordx4 v[220:223], v14, s[36:39], s77 offen offset:256 sc1
v_mfma_f32_16x16x32_bf16 v[44:47], a[68:71], v[172:175], v[44:47]
v_mfma_f32_16x16x32_bf16 v[68:71], a[72:75], v[172:175], v[68:71]
v_mfma_f32_16x16x32_bf16 v[76:79], a[76:79], v[172:175], v[76:79]
s_waitcnt vmcnt(20)
v_mfma_f32_16x16x32_bf16 v[16:19], a[80:83], v[176:179], v[16:19]
v_cmp_gt_u32 vcc, 4, v6
s_nop 0
s_cbranch_vccz Lgo_82
Lpoll_81:
buffer_load_dword v6, v11, s[36:39], 0 offen sc1
s_waitcnt vmcnt(0)
v_cmp_gt_u32 vcc, 4, v6
s_nop 0
s_cbranch_vccz Lgo_82
s_add_u32 s91, s91, 1
s_bitcmp0_b32 s91, 16
s_cbranch_scc1 Lpoll_81
Lgo_82:
s_add_u32 s77, s92, 4096
buffer_load_dwordx4 v[224:227], v14, s[36:39], s77 offen sc1
v_mfma_f32_16x16x32_bf16 v[24:27], a[84:87], v[176:179], v[24:27]
v_mfma_f32_16x16x32_bf16 v[48:51], a[88:91], v[176:179], v[48:51]
v_mfma_f32_16x16x32_bf16 v[56:59], a[92:95], v[176:179], v[56:59]
s_waitcnt vmcnt(19)
v_mfma_f32_16x16x32_bf16 v[20:23], a[80:83], v[180:183], v[20:23]
buffer_load_dwordx4 v[228:231], v14, s[36:39], s77 offen offset:256 sc1
v_mfma_f32_16x16x32_bf16 v[28:31], a[84:87], v[180:183], v[28:31]
v_mfma_f32_16x16x32_bf16 v[52:55], a[88:91], v[180:183], v[52:55]
v_mfma_f32_16x16x32_bf16 v[60:63], a[92:95], v[180:183], v[60:63]
s_waitcnt vmcnt(18)
v_mfma_f32_16x16x32_bf16 v[32:35], a[80:83], v[184:187], v[32:35]
s_add_u32 s77, s92, 11264
buffer_load_dwordx4 v[232:235], v14, s[36:39], s77 offen sc1
v_mfma_f32_16x16x32_bf16 v[40:43], a[84:87], v[184:187], v[40:43]
v_mfma_f32_16x16x32_bf16 v[64:67], a[88:91], v[184:187], v[64:67]
v_mfma_f32_16x16x32_bf16 v[72:75], a[92:95], v[184:187], v[72:75]
s_waitcnt vmcnt(17)
v_mfma_f32_16x16x32_bf16 v[36:39], a[80:83], v[188:191], v[36:39]
buffer_load_dwordx4 v[236:239], v14, s[36:39], s77 offen offset:256 sc1
v_mfma_f32_16x16x32_bf16 v[44:47], a[84:87], v[188:191], v[44:47]
v_mfma_f32_16x16x32_bf16 v[68:71], a[88:91], v[188:191], v[68:71]
v_mfma_f32_16x16x32_bf16 v[76:79], a[92:95], v[188:191], v[76:79]
s_waitcnt vmcnt(16)
v_mfma_f32_16x16x32_bf16 v[16:19], a[96:99], v[192:195], v[16:19]
s_add_u32 s77, s92, 18432
buffer_load_dwordx4 v[80:83], v14, s[36:39], s77 offen sc1
v_mfma_f32_16x16x32_bf16 v[24:27], a[100:103], v[192:195], v[24:27]
v_mfma_f32_16x16x32_bf16 v[48:51], a[104:107], v[192:195], v[48:51]
v_mfma_f32_16x16x32_bf16 v[56:59], a[108:111], v[192:195], v[56:59]
s_waitcnt vmcnt(15)
v_mfma_f32_16x16x32_bf16 v[20:23], a[96:99], v[196:199], v[20:23]
buffer_load_dwordx4 v[84:87], v14, s[36:39], s77 offen offset:256 sc1
v_mfma_f32_16x16x32_bf16 v[28:31], a[100:103], v[196:199], v[28:31]
v_mfma_f32_16x16x32_bf16 v[52:55], a[104:107], v[196:199], v[52:55]
v_mfma_f32_16x16x32_bf16 v[60:63], a[108:111], v[196:199], v[60:63]
s_waitcnt vmcnt(14)
v_mfma_f32_16x16x32_bf16 v[32:35], a[96:99], v[200:203], v[32:35]
s_add_u32 s77, s92, 25600
buffer_load_dwordx4 v[88:91], v14, s[36:39], s77 offen sc1
v_mfma_f32_16x16x32_bf16 v[40:43], a[100:103], v[200:203], v[40:43]
v_mfma_f32_16x16x32_bf16 v[64:67], a[104:107], v[200:203], v[64:67]
v_mfma_f32_16x16x32_bf16 v[72:75], a[108:111], v[200:203], v[72:75]
s_waitcnt vmcnt(13)
v_mfma_f32_16x16x32_bf16 v[36:39], a[96:99], v[204:207], v[36:39]
buffer_load_dwordx4 v[92:95], v14, s[36:39], s77 offen offset:256 sc1
v_mfma_f32_16x16x32_bf16 v[44:47], a[100:103], v[204:207], v[44:47]
v_mfma_f32_16x16x32_bf16 v[68:71], a[104:107], v[204:207], v[68:71]
v_mfma_f32_16x16x32_bf16 v[76:79], a[108:111], v[204:207], v[76:79]
s_waitcnt vmcnt(12)
v_mfma_f32_16x16x32_bf16 v[16:19], a[112:115], v[208:211], v[16:19]
s_add_u32 s77, s92, 6144
buffer_load_dwordx4 v[96:99], v250, s[36:39], s77 offen sc1
v_mfma_f32_16x16x32_bf16 v[24:27], a[116:119], v[208:211], v[24:27]
v_mfma_f32_16x16x32_bf16 v[48:51], a[120:123], v[208:211], v[48:51]
v_mfma_f32_16x16x32_bf16 v[56:59], a[124:127], v[208:211], v[56:59]
s_waitcnt vmcnt(11)
v_mfma_f32_16x16x32_bf16 v[20:23], a[112:115], v[212:215], v[20:23]
buffer_load_dwordx4 v[100:103], v250, s[36:39], s77 offen offset:256 sc1
v_mfma_f32_16x16x32_bf16 v[28:31], a[116:119], v[212:215], v[28:31]
v_mfma_f32_16x16x32_bf16 v[52:55], a[120:123], v[212:215], v[52:55]
v_mfma_f32_16x16x32_bf16 v[60:63], a[124:127], v[212:215], v[60:63]
s_waitcnt vmcnt(11)
v_mfma_f32_16x16x32_bf16 v[32:35], a[112:115], v[216:219], v[32:35]
s_add_u32 s77, s92, 20480
buffer_load_dwordx4 v[104:107], v250, s[36:39], s77 offen sc1
v_mfma_f32_16x16x32_bf16 v[40:43], a[116:119], v[216:219], v[40:43]
v_mfma_f32_16x16x32_bf16 v[64:67], a[120:123], v[216:219], v[64:67]
v_mfma_f32_16x16x32_bf16 v[72:75], a[124:127], v[216:219], v[72:75]
s_waitcnt vmcnt(11)
v_mfma_f32_16x16x32_bf16 v[36:39], a[112:115], v[220:223], v[36:39]
buffer_load_dwordx4 v[108:111], v250, s[36:39], s77 offen offset:256 sc1
v_mfma_f32_16x16x32_bf16 v[44:47], a[116:119], v[220:223], v[44:47]
v_mfma_f32_16x16x32_bf16 v[68:71], a[120:123], v[220:223], v[68:71]
v_mfma_f32_16x16x32_bf16 v[76:79], a[124:127], v[220:223], v[76:79]
s_waitcnt vmcnt(11)
v_mfma_f32_16x16x32_bf16 v[16:19], a[128:131], v[224:227], v[16:19]
s_add_u32 s77, s93, 4096
buffer_load_dwordx4 v[112:115], v14, s[36:39], s77 offen sc1
v_mfma_f32_16x16x32_bf16 v[24:27], a[132:135], v[224:227], v[24:27]
v_mfma_f32_16x16x32_bf16 v[48:51], a[136:139], v[224:227], v[48:51]
v_mfma_f32_16x16x32_bf16 v[56:59], a[140:143], v[224:227], v[56:59]
s_waitcnt vmcnt(11)
v_mfma_f32_16x16x32_bf16 v[20:23], a[128:131], v[228:231], v[20:23]
buffer_load_dwordx4 v[116:119], v14, s[36:39], s77 offen offset:256 sc1
v_mfma_f32_16x16x32_bf16 v[28:31], a[132:135], v[228:231], v[28:31]
v_mfma_f32_16x16x32_bf16 v[52:55], a[136:139], v[228:231], v[52:55]
v_mfma_f32_16x16x32_bf16 v[60:63], a[140:143], v[228:231], v[60:63]
s_waitcnt vmcnt(11)
v_mfma_f32_16x16x32_bf16 v[16:19], a[144:147], v[232:235], v[16:19]
s_add_u32 s77, s93, 11264
buffer_load_dwordx4 v[120:123], v14, s[36:39], s77 offen sc1
v_mfma_f32_16x16x32_bf16 v[24:27], a[148:151], v[232:235], v[24:27]
v_mfma_f32_16x16x32_bf16 v[48:51], a[152:155], v[232:235], v[48:51]
v_mfma_f32_16x16x32_bf16 v[56:59], a[156:159], v[232:235], v[56:59]
s_waitcnt vmcnt(11)
v_mfma_f32_16x16x32_bf16 v[20:23], a[144:147], v[236:239], v[20:23]
buffer_load_dwordx4 v[124:127], v14, s[36:39], s77 offen offset:256 sc1
v_mfma_f32_16x16x32_bf16 v[28:31], a[148:151], v[236:239], v[28:31]
v_mfma_f32_16x16x32_bf16 v[52:55], a[152:155], v[236:239], v[52:55]
v_mfma_f32_16x16x32_bf16 v[60:63], a[156:159], v[236:239], v[60:63]
s_waitcnt vmcnt(11)
v_mfma_f32_16x16x32_bf16 v[16:19], a[160:163], v[80:83], v[16:19]
s_add_u32 s77, s93, 18432
buffer_load_dwordx4 v[128:131], v14, s[36:39], s77 offen sc1
v_mfma_f32_16x16x32_bf16 v[24:27], a[164:167], v[80:83], v[24:27]
v_mfma_f32_16x16x32_bf16 v[48:51], a[168:171], v[80:83], v[48:51]
v_mfma_f32_16x16x32_bf16 v[56:59], a[172:175], v[80:83], v[56:59]
s_waitcnt vmcnt(11)
v_mfma_f32_16x16x32_bf16 v[20:23], a[160:163], v[84:87], v[20:23]
buffer_load_dwordx4 v[132:135], v14, s[36:39], s77 offen offset:256 sc1
v_mfma_f32_16x16x32_bf16 v[28:31], a[164:167], v[84:87], v[28:31]
v_mfma_f32_16x16x32_bf16 v[52:55], a[168:171], v[84:87], v[52:55]
v_mfma_f32_16x16x32_bf16 v[60:63], a[172:175], v[84:87], v[60:63]
s_waitcnt vmcnt(11)
v_mfma_f32_16x16x32_bf16 v[16:19], a[176:179], v[88:91], v[16:19]
s_add_u32 s77, s93, 25600
buffer_load_dwordx4 v[136:139], v14, s[36:39], s77 offen sc1
v_mfma_f32_16x16x32_bf16 v[24:27], a[180:183], v[88:91], v[24:27]
v_mfma_f32_16x16x32_bf16 v[48:51], a[184:187], v[88:91], v[48:51]
v_mfma_f32_16x16x32_bf16 v[56:59], a[188:191], v[88:91], v[56:59]
s_waitcnt vmcnt(11)
v_mfma_f32_16x16x32_bf16 v[20:23], a[176:179], v[92:95], v[20:23]
buffer_load_dwordx4 v[140:143], v14, s[36:39], s77 offen offset:256 sc1
v_mfma_f32_16x16x32_bf16 v[28:31], a[180:183], v[92:95], v[28:31]
v_mfma_f32_16x16x32_bf16 v[52:55], a[184:187], v[92:95], v[52:55]
v_mfma_f32_16x16x32_bf16 v[60:63], a[188:191], v[92:95], v[60:63]
s_waitcnt vmcnt(11)
v_mfma_f32_16x16x32_bf16 v[16:19], a[192:195], v[96:99], v[16:19]
s_add_u32 s77, s93, 6144
buffer_load_dwordx4 v[160:163], v250, s[36:39], s77 offen sc1
v_mfma_f32_16x16x32_bf16 v[24:27], a[196:199], v[96:99], v[24:27]
v_mfma_f32_16x16x32_bf16 v[48:51], a[200:203], v[96:99], v[48:51]
v_mfma_f32_16x16x32_bf16 v[56:59], a[204:207], v[96:99], v[56:59]
s_waitcnt vmcnt(11)
v_mfma_f32_16x16x32_bf16 v[20:23], a[192:195], v[100:103], v[20:23]
buffer_load_dwordx4 v[164:167], v250, s[36:39], s77 offen offset:256 sc1
v_mfma_f32_16x16x32_bf16 v[28:31], a[196:199], v[100:103], v[28:31]
v_mfma_f32_16x16x32_bf16 v[52:55], a[200:203], v[100:103], v[52:55]
v_mfma_f32_16x16x32_bf16 v[60:63], a[204:207], v[100:103], v[60:63]
s_waitcnt vmcnt(11)
v_mfma_f32_16x16x32_bf16 v[16:19], a[208:211], v[104:107], v[16:19]
s_add_u32 s77, s93, 20480
buffer_load_dwordx4 v[168:171], v250, s[36:39], s77 offen sc1
v_mfma_f32_16x16x32_bf16 v[24:27], a[212:215], v[104:107], v[24:27]
v_mfma_f32_16x16x32_bf16 v[48:51], a[216:219], v[104:107], v[48:51]
v_mfma_f32_16x16x32_bf16 v[56:59], a[220:223], v[104:107], v[56:59]
s_waitcnt vmcnt(11)
v_mfma_f32_16x16x32_bf16 v[20:23], a[208:211], v[108:111], v[20:23]
buffer_load_dwordx4 v[172:175], v250, s[36:39], s77 offen offset:256 sc1
v_mfma_f32_16x16x32_bf16 v[28:31], a[212:215], v[108:111], v[28:31]
v_mfma_f32_16x16x32_bf16 v[52:55], a[216:219], v[108:111], v[52:55]
v_mfma_f32_16x16x32_bf16 v[60:63], a[220:223], v[108:111], v[60:63]
s_waitcnt vmcnt(11)
v_mfma_f32_16x16x32_bf16 v[32:35], a[128:131], v[112:115], v[32:35]
s_add_u32 s94, s80, 6291456
buffer_load_dwordx4 v[240:243], v1, s[36:39], s94 offen sc1
buffer_load_dwordx4 v[244:247], v1, s[36:39], s94 offen offset:1024 sc1
v_mfma_f32_16x16x32_bf16 v[40:43], a[132:135], v[112:115], v[40:43]
v_mfma_f32_16x16x32_bf16 v[64:67], a[136:139], v[112:115], v[64:67]
v_mfma_f32_16x16x32_bf16 v[72:75], a[140:143], v[112:115], v[72:75]
s_waitcnt vmcnt(12)
v_mfma_f32_16x16x32_bf16 v[36:39], a[128:131], v[116:119], v[36:39]
v_mfma_f32_16x16x32_bf16 v[44:47], a[132:135], v[116:119], v[44:47]
v_mfma_f32_16x16x32_bf16 v[68:71], a[136:139], v[116:119], v[68:71]
v_mfma_f32_16x16x32_bf16 v[76:79], a[140:143], v[116:119], v[76:79]
s_waitcnt vmcnt(11)
v_mfma_f32_16x16x32_bf16 v[32:35], a[144:147], v[120:123], v[32:35]
v_mfma_f32_16x16x32_bf16 v[40:43], a[148:151], v[120:123], v[40:43]
v_mfma_f32_16x16x32_bf16 v[64:67], a[152:155], v[120:123], v[64:67]
v_mfma_f32_16x16x32_bf16 v[72:75], a[156:159], v[120:123], v[72:75]
ds_read2_b32 v[8:9], v249 offset0:0 offset1:16
s_waitcnt vmcnt(10)
v_mfma_f32_16x16x32_bf16 v[36:39], a[144:147], v[124:127], v[36:39]
v_mfma_f32_16x16x32_bf16 v[44:47], a[148:151], v[124:127], v[44:47]
v_mfma_f32_16x16x32_bf16 v[68:71], a[152:155], v[124:127], v[68:71]
v_mfma_f32_16x16x32_bf16 v[76:79], a[156:159], v[124:127], v[76:79]
ds_write_b128 v12, v[16:19] offset:0
s_waitcnt vmcnt(9)
v_mfma_f32_16x16x32_bf16 v[32:35], a[160:163], v[128:131], v[32:35]
v_mfma_f32_16x16x32_bf16 v[40:43], a[164:167], v[128:131], v[40:43]
v_mfma_f32_16x16x32_bf16 v[64:67], a[168:171], v[128:131], v[64:67]
v_mfma_f32_16x16x32_bf16 v[72:75], a[172:175], v[128:131], v[72:75]
ds_write_b128 v12, v[20:23] offset:1024
s_waitcnt vmcnt(8)
v_mfma_f32_16x16x32_bf16 v[36:39], a[160:163], v[132:135], v[36:39]
v_mfma_f32_16x16x32_bf16 v[44:47], a[164:167], v[132:135], v[44:47]
v_mfma_f32_16x16x32_bf16 v[68:71], a[168:171], v[132:135], v[68:71]
v_mfma_f32_16x16x32_bf16 v[76:79], a[172:175], v[132:135], v[76:79]
ds_write_b128 v12, v[24:27] offset:2048
s_waitcnt vmcnt(7)
v_mfma_f32_16x16x32_bf16 v[32:35], a[176:179], v[136:139], v[32:35]
v_mfma_f32_16x16x32_bf16 v[40:43], a[180:183], v[136:139], v[40:43]
v_mfma_f32_16x16x32_bf16 v[64:67], a[184:187], v[136:139], v[64:67]
v_mfma_f32_16x16x32_bf16 v[72:75], a[188:191], v[136:139], v[72:75]
ds_write_b128 v12, v[28:31] offset:3072
s_waitcnt vmcnt(6)
v_mfma_f32_16x16x32_bf16 v[36:39], a[176:179], v[140:143], v[36:39]
v_mfma_f32_16x16x32_bf16 v[44:47], a[180:183], v[140:143], v[44:47]
v_mfma_f32_16x16x32_bf16 v[68:71], a[184:187], v[140:143], v[68:71]
v_mfma_f32_16x16x32_bf16 v[76:79], a[188:191], v[140:143], v[76:79]
ds_write_b128 v13, v[48:51] offset:0
s_waitcnt vmcnt(5)
v_mfma_f32_16x16x32_bf16 v[32:35], a[192:195], v[160:163], v[32:35]
v_mfma_f32_16x16x32_bf16 v[40:43], a[196:199], v[160:163], v[40:43]
v_mfma_f32_16x16x32_bf16 v[64:67], a[200:203], v[160:163], v[64:67]
v_mfma_f32_16x16x32_bf16 v[72:75], a[204:207], v[160:163], v[72:75]
ds_write_b128 v13, v[52:55] offset:1024
s_waitcnt vmcnt(4)
v_mfma_f32_16x16x32_bf16 v[36:39], a[192:195], v[164:167], v[36:39]
v_mfma_f32_16x16x32_bf16 v[44:47], a[196:199], v[164:167], v[44:47]
v_mfma_f32_16x16x32_bf16 v[68:71], a[200:203], v[164:167], v[68:71]
v_mfma_f32_16x16x32_bf16 v[76:79], a[204:207], v[164:167], v[76:79]
ds_write_b128 v13, v[56:59] offset:2048
s_waitcnt vmcnt(3)
v_mfma_f32_16x16x32_bf16 v[32:35], a[208:211], v[168:171], v[32:35]
v_mfma_f32_16x16x32_bf16 v[40:43], a[212:215], v[168:171], v[40:43]
v_mfma_f32_16x16x32_bf16 v[64:67], a[216:219], v[168:171], v[64:67]
v_mfma_f32_16x16x32_bf16 v[72:75], a[220:223], v[168:171], v[72:75]
ds_write_b128 v13, v[60:63] offset:3072
s_waitcnt vmcnt(2)
v_mfma_f32_16x16x32_bf16 v[36:39], a[208:211], v[172:175], v[36:39]
v_mfma_f32_16x16x32_bf16 v[44:47], a[212:215], v[172:175], v[44:47]
v_mfma_f32_16x16x32_bf16 v[68:71], a[216:219], v[172:175], v[68:71]
v_mfma_f32_16x16x32_bf16 v[76:79], a[220:223], v[172:175], v[76:79]
v_add_u32 v11, 67584, v1
s_cmp_ge_u32 s68, 2
s_cbranch_scc1 Lsc_85
Lsc_83:
s_cmp_eq_u32 s68, 1
s_cbranch_scc1 Lsc_84
ds_write_b128 v11, v[32:35] offset:24576
ds_write_b128 v11, v[36:39] offset:25600
ds_write_b128 v11, v[40:43] offset:26624
ds_write_b128 v11, v[44:47] offset:27648
ds_write_b128 v11, v[64:67] offset:49152
ds_write_b128 v11, v[68:71] offset:50176
ds_write_b128 v11, v[72:75] offset:51200
ds_write_b128 v11, v[76:79] offset:52224
v_pk_add_f32 v[144:145], v[16:17], 0
v_pk_add_f32 v[146:147], v[18:19], 0
v_pk_add_f32 v[148:149], v[20:21], 0
v_pk_add_f32 v[150:151], v[22:23], 0
v_pk_add_f32 v[152:153], v[24:25], 0
v_pk_add_f32 v[154:155], v[26:27], 0
v_pk_add_f32 v[156:157], v[28:29], 0
v_pk_add_f32 v[158:159], v[30:31], 0
s_branch Lscd_87
Lsc_84:
ds_write_b128 v11, v[64:67] offset:53248
s_nop 0
ds_write_b128 v11, v[68:71] offset:54272
ds_write_b128 v11, v[72:75] offset:55296
ds_write_b128 v11, v[76:79] offset:56320
v_pk_add_f32 v[144:145], v[32:33], 0
v_pk_add_f32 v[146:147], v[34:35], 0
v_pk_add_f32 v[148:149], v[36:37], 0
v_pk_add_f32 v[150:151], v[38:39], 0
v_pk_add_f32 v[152:153], v[40:41], 0
v_pk_add_f32 v[154:155], v[42:43], 0
v_pk_add_f32 v[156:157], v[44:45], 0
v_pk_add_f32 v[158:159], v[46:47], 0
s_branch Lscd_87
Lsc_85:
s_cmp_eq_u32 s68, 3
s_cbranch_scc1 Lsc_86
ds_write_b128 v11, v[32:35] offset:16384
ds_write_b128 v11, v[36:39] offset:17408
ds_write_b128 v11, v[40:43] offset:18432
ds_write_b128 v11, v[44:47] offset:19456
ds_write_b128 v11, v[64:67] offset:57344
ds_write_b128 v11, v[68:71] offset:58368
ds_write_b128 v11, v[72:75] offset:59392
ds_write_b128 v11, v[76:79] offset:60416
v_pk_add_f32 v[144:145], v[48:49], 0
v_pk_add_f32 v[146:147], v[50:51], 0
v_pk_add_f32 v[148:149], v[52:53], 0
v_pk_add_f32 v[150:151], v[54:55], 0
v_pk_add_f32 v[152:153], v[56:57], 0
v_pk_add_f32 v[154:155], v[58:59], 0
v_pk_add_f32 v[156:157], v[60:61], 0
v_pk_add_f32 v[158:159], v[62:63], 0
s_branch Lscd_87
Lsc_86:
ds_write_b128 v11, v[32:35] offset:20480
ds_write_b128 v11, v[36:39] offset:21504
ds_write_b128 v11, v[40:43] offset:22528
ds_write_b128 v11, v[44:47] offset:23552
v_pk_add_f32 v[144:145], v[64:65], 0
v_pk_add_f32 v[146:147], v[66:67], 0
v_pk_add_f32 v[148:149], v[68:69], 0
v_pk_add_f32 v[150:151], v[70:71], 0
v_pk_add_f32 v[152:153], v[72:73], 0
v_pk_add_f32 v[154:155], v[74:75], 0
v_pk_add_f32 v[156:157], v[76:77], 0
v_pk_add_f32 v[158:159], v[78:79], 0
Lscd_87:
s_waitcnt lgkmcnt(0)
s_barrier
ds_read_b128 v[16:19], v248 offset:0
ds_read_b128 v[20:23], v248 offset:1024
ds_read_b128 v[24:27], v248 offset:2048
ds_read_b128 v[28:31], v248 offset:3072
ds_read_b128 v[32:35], v248 offset:4096
ds_read_b128 v[36:39], v248 offset:5120
ds_read_b128 v[40:43], v248 offset:6144
ds_read_b128 v[44:47], v248 offset:7168
ds_read_b128 v[48:51], v248 offset:8192
ds_read_b128 v[52:55], v248 offset:9216
ds_read_b128 v[56:59], v248 offset:10240
ds_read_b128 v[60:63], v248 offset:11264
s_waitcnt vmcnt(0)
v_permlane16_swap_b32 v240, v242
v_permlane16_swap_b32 v241, v243
v_permlane16_swap_b32 v244, v246
v_permlane16_swap_b32_e64 v245, v247
s_waitcnt lgkmcnt(8)
v_pk_add_f32 v[144:145], v[144:145], v[16:17]
v_pk_add_f32 v[146:147], v[146:147], v[18:19]
v_pk_add_f32 v[148:149], v[148:149], v[20:21]
v_pk_add_f32 v[150:151], v[150:151], v[22:23]
v_pk_add_f32 v[152:153], v[152:153], v[24:25]
v_pk_add_f32 v[154:155], v[154:155], v[26:27]
v_pk_add_f32 v[156:157], v[156:157], v[28:29]
v_pk_add_f32 v[158:159], v[158:159], v[30:31]
s_waitcnt lgkmcnt(4)
v_pk_add_f32 v[144:145], v[144:145], v[32:33]
v_pk_add_f32 v[146:147], v[146:147], v[34:35]
v_pk_add_f32 v[148:149], v[148:149], v[36:37]
v_pk_add_f32 v[150:151], v[150:151], v[38:39]
v_pk_add_f32 v[152:153], v[152:153], v[40:41]
v_pk_add_f32 v[154:155], v[154:155], v[42:43]
v_pk_add_f32 v[156:157], v[156:157], v[44:45]
v_pk_add_f32 v[158:159], v[158:159], v[46:47]
s_waitcnt lgkmcnt(0)
v_pk_add_f32 v[144:145], v[144:145], v[48:49]
v_pk_add_f32 v[146:147], v[146:147], v[50:51]
v_pk_add_f32 v[148:149], v[148:149], v[52:53]
v_pk_add_f32 v[150:151], v[150:151], v[54:55]
v_pk_add_f32 v[152:153], v[152:153], v[56:57]
v_pk_add_f32 v[154:155], v[154:155], v[58:59]
v_pk_add_f32 v[156:157], v[156:157], v[60:61]
v_pk_add_f32 v[158:159], v[158:159], v[62:63]
v_pk_mul_f32 v[144:145], v[144:145], v[8:9] op_sel_hi:[1,0]
v_pk_mul_f32 v[146:147], v[146:147], v[8:9] op_sel_hi:[1,0]
v_pk_mul_f32 v[148:149], v[148:149], v[8:9] op_sel:[0,1] op_sel_hi:[1,1]
v_pk_mul_f32 v[150:151], v[150:151], v[8:9] op_sel:[0,1] op_sel_hi:[1,1]
v_pk_mul_f32 v[152:153], v[152:153], v[8:9] op_sel_hi:[1,0]
v_pk_mul_f32 v[154:155], v[154:155], v[8:9] op_sel_hi:[1,0]
v_pk_mul_f32 v[156:157], v[156:157], v[8:9] op_sel:[0,1] op_sel_hi:[1,1]
v_pk_mul_f32 v[158:159], v[158:159], v[8:9] op_sel:[0,1] op_sel_hi:[1,1]
v_dot2c_f32_bf16 v144, s87, v240
v_dot2c_f32_bf16 v145, s88, v240
v_dot2c_f32_bf16 v146, s87, v241
v_dot2c_f32_bf16 v147, s88, v241
v_dot2c_f32_bf16 v148, s87, v242
v_dot2c_f32_bf16 v149, s88, v242
v_dot2c_f32_bf16 v150, s87, v243
v_dot2c_f32_bf16 v151, s88, v243
v_dot2c_f32_bf16 v152, s87, v244
v_dot2c_f32_bf16 v153, s88, v244
v_dot2c_f32_bf16 v154, s87, v245
v_dot2c_f32_bf16 v155, s88, v245
v_dot2c_f32_bf16 v156, s87, v246
v_dot2c_f32_bf16 v157, s88, v246
v_dot2c_f32_bf16 v158, s87, v247
v_dot2c_f32_bf16 v159, s88, v247
v_cvt_pk_bf16_f32 v240, v144, v145
v_cvt_pk_bf16_f32 v241, v146, v147
v_cvt_pk_bf16_f32 v242, v148, v149
v_cvt_pk_bf16_f32 v243, v150, v151
v_cvt_pk_bf16_f32 v244, v152, v153
v_cvt_pk_bf16_f32 v245, v154, v155
v_cvt_pk_bf16_f32 v246, v156, v157
v_cvt_pk_bf16_f32 v247, v158, v159
v_permlane16_swap_b32 v240, v242
v_permlane16_swap_b32 v241, v243
v_permlane16_swap_b32 v244, v246
v_permlane16_swap_b32 v245, v247
s_add_u32 s77, s80, 4194304
buffer_store_dwordx4 v[240:243], v1, s[36:39], s77 offen sc1
buffer_store_dwordx4 v[244:247], v1, s[36:39], s77 offen offset:1024 sc1
v_mov_b32 v144, 0
v_mov_b32 v145, 0
v_dot2c_f32_bf16 v144, s86, v240
v_dot2c_f32_bf16 v145, v240, v240
v_dot2c_f32_bf16 v144, s86, v241
v_dot2c_f32_bf16 v145, v241, v241
v_dot2c_f32_bf16 v144, s86, v242
v_dot2c_f32_bf16 v145, v242, v242
v_dot2c_f32_bf16 v144, s86, v243
v_dot2c_f32_bf16 v145, v243, v243
v_dot2c_f32_bf16 v144, s86, v244
v_dot2c_f32_bf16 v145, v244, v244
v_dot2c_f32_bf16 v144, s86, v245
v_dot2c_f32_bf16 v145, v245, v245
v_dot2c_f32_bf16 v144, s86, v246
v_dot2c_f32_bf16 v145, v246, v246
v_dot2c_f32_bf16 v144, s86, v247
v_dot2c_f32_bf16 v145, v247, v247
s_add_u32 s77, s81, 262144
s_nop 1
v_permlane32_swap_b32 v144, v145
v_add_f32_e64 v144, v144, v145
buffer_store_dword v144, v5, s[36:39], s77 offen sc1
s_lshl_b32 s97, s71, 12
s_add_u32 s97, s97, 262144
v_and_b32 v7, 31, v0
v_lshlrev_b32 v7, 4, v7
v_lshrrev_b32 v12, 5, v0
v_lshl_add_u32 v12, v12, 11, v7
v_lshrrev_b32_e64 v7, 2, v0
v_mul_u32_u24 v7, 3072, v7
v_and_b32_e64 v5, 3, v0
v_lshl_add_u32 v5, v5, 4, v7
s_mul_i32 s95, s68, 393216
s_lshl_b32 s78, s70, 6
s_add_u32 s95, s95, s78
s_lshl_b32 s96, s68, 13
s_lshl_b32 s89, s71, 15
s_add_u32 s89, s89, 4194304
s_lshl_b32 s77, s69, 8
s_lshl_b32 s78, s75, 6
s_add_u32 s77, s77, s78
s_lshl_b32 s78, s74, 5
s_add_u32 s77, s77, s78
s_add_u32 s77, s77, 16384
v_and_b32 v7, 7, v0
v_bfe_u32 v11, v0, 3, 1
v_lshlrev_b32_e64 v11, 7, v11
v_lshl_add_u32 v11, v7, 2, v11
v_add_u32 v11, s77, v11
v_mov_b32 v7, 5
v_mov_b32_e64 v6, s83
s_waitcnt vmcnt(0)
s_mov_b64 exec, 1
buffer_store_dword v7, v6, s[36:39], 0 offen sc1
s_mov_b64 exec, -1
s_barrier
Lpoll_88:
buffer_load_dword v6, v11, s[36:39], 0 offen sc1
s_waitcnt vmcnt(0)
v_cmp_gt_u32 vcc, 5, v6
s_nop 0
s_cbranch_vccz Lgo_89
s_add_u32 s91, s91, 1
s_bitcmp0_b32 s91, 16
s_cbranch_scc1 Lpoll_88
Lgo_89:
buffer_load_dwordx4 v[16:19], v1, s[36:39], s89 offen sc1
buffer_load_dwordx4 v[20:23], v1, s[36:39], s89 offen offset:1024 sc1
buffer_load_dwordx4 v[24:27], v1, s[36:39], s89 offen offset:2048 sc1
buffer_load_dwordx4 v[28:31], v1, s[36:39], s89 offen offset:3072 sc1
s_add_u32 s89, s89, 4096
buffer_load_dwordx4 v[32:35], v1, s[36:39], s89 offen sc1
buffer_load_dwordx4 v[36:39], v1, s[36:39], s89 offen offset:1024 sc1
buffer_load_dwordx4 v[40:43], v1, s[36:39], s89 offen offset:2048 sc1
buffer_load_dwordx4 v[44:47], v1, s[36:39], s89 offen offset:3072 sc1
s_add_u32 s89, s89, 4096
buffer_load_dwordx4 v[48:51], v1, s[36:39], s89 offen sc1
buffer_load_dwordx4 v[52:55], v1, s[36:39], s89 offen offset:1024 sc1
buffer_load_dwordx4 v[56:59], v1, s[36:39], s89 offen offset:2048 sc1
buffer_load_dwordx4 v[60:63], v1, s[36:39], s89 offen offset:3072 sc1
ds_read_b64_tr_b16 v[192:193], v2 offset:0
ds_read_b64_tr_b16 v[194:195], v2 offset:512
ds_read_b64_tr_b16 v[196:197], v3 offset:0
ds_read_b64_tr_b16 v[198:199], v3 offset:512
ds_read_b64_tr_b16 v[200:201], v2 offset:2048
ds_read_b64_tr_b16 v[202:203], v2 offset:2560
ds_read_b64_tr_b16 v[204:205], v3 offset:2048
ds_read_b64_tr_b16 v[206:207], v3 offset:2560
s_waitcnt vmcnt(11) lgkmcnt(4)
v_mfma_f32_32x32x16_bf16 v[160:175], v[192:195], v[16:19], 0
ds_read_b64_tr_b16 v[208:209], v2 offset:4096
ds_read_b64_tr_b16 v[210:211], v2 offset:4608
v_mfma_f32_32x32x16_bf16 v[176:191], v[196:199], v[16:19], 0
s_add_u32 s89, s89, 4096
buffer_load_dwordx4 v[64:67], v1, s[36:39], s89 offen sc1
ds_read_b64_tr_b16 v[212:213], v3 offset:4096
ds_read_b64_tr_b16 v[214:215], v3 offset:4608
s_waitcnt vmcnt(11) lgkmcnt(4)
v_mfma_f32_32x32x16_bf16 v[160:175], v[200:203], v[20:23], v[160:175]
ds_read_b64_tr_b16 v[192:193], v2 offset:6144
ds_read_b64_tr_b16 v[194:195], v2 offset:6656
v_mfma_f32_32x32x16_bf16 v[176:191], v[204:207], v[20:23], v[176:191]
buffer_load_dwordx4 v[68:71], v1, s[36:39], s89 offen offset:1024 sc1
ds_read_b64_tr_b16 v[196:197], v3 offset:6144
ds_read_b64_tr_b16 v[198:199], v3 offset:6656
s_waitcnt vmcnt(11) lgkmcnt(4)
v_mfma_f32_32x32x16_bf16 v[160:175], v[208:211], v[24:27], v[160:175]
ds_read_b64_tr_b16 v[200:201], v2 offset:8192
ds_read_b64_tr_b16 v[202:203], v2 offset:8704
v_mfma_f32_32x32x16_bf16 v[176:191], v[212:215], v[24:27], v[176:191]
buffer_load_dwordx4 v[72:75], v1, s[36:39], s89 offen offset:2048 sc1
ds_read_b64_tr_b16 v[204:205], v3 offset:8192
ds_read_b64_tr_b16 v[206:207], v3 offset:8704
s_waitcnt vmcnt(11) lgkmcnt(4)
v_mfma_f32_32x32x16_bf16 v[160:175], v[192:195], v[28:31], v[160:175]
ds_read_b64_tr_b16 v[208:209], v2 offset:10240
ds_read_b64_tr_b16 v[210:211], v2 offset:10752
v_mfma_f32_32x32x16_bf16 v[176:191], v[196:199], v[28:31], v[176:191]
buffer_load_dwordx4 v[76:79], v1, s[36:39], s89 offen offset:3072 sc1
ds_read_b64_tr_b16 v[212:213], v3 offset:10240
ds_read_b64_tr_b16 v[214:215], v3 offset:10752
s_waitcnt vmcnt(11) lgkmcnt(4)
v_mfma_f32_32x32x16_bf16 v[160:175], v[200:203], v[32:35], v[160:175]
ds_read_b64_tr_b16 v[192:193], v2 offset:12288
ds_read_b64_tr_b16 v[194:195], v2 offset:12800
v_mfma_f32_32x32x16_bf16 v[176:191], v[204:207], v[32:35], v[176:191]
s_add_u32 s89, s89, 4096
buffer_load_dwordx4 v[80:83], v1, s[36:39], s89 offen sc1
ds_read_b64_tr_b16 v[196:197], v3 offset:12288
ds_read_b64_tr_b16 v[198:199], v3 offset:12800
s_waitcnt vmcnt(11) lgkmcnt(4)
v_mfma_f32_32x32x16_bf16 v[160:175], v[208:211], v[36:39], v[160:175]
ds_read_b64_tr_b16 v[200:201], v2 offset:14336
ds_read_b64_tr_b16 v[202:203], v2 offset:14848
v_mfma_f32_32x32x16_bf16 v[176:191], v[212:215], v[36:39], v[176:191]
buffer_load_dwordx4 v[84:87], v1, s[36:39], s89 offen offset:1024 sc1
ds_read_b64_tr_b16 v[204:205], v3 offset:14336
ds_read_b64_tr_b16 v[206:207], v3 offset:14848
s_waitcnt vmcnt(11) lgkmcnt(4)
v_mfma_f32_32x32x16_bf16 v[160:175], v[192:195], v[40:43], v[160:175]
ds_read_b64_tr_b16 v[208:209], v2 offset:16384
ds_read_b64_tr_b16 v[210:211], v2 offset:16896
v_mfma_f32_32x32x16_bf16 v[176:191], v[196:199], v[40:43], v[176:191]
buffer_load_dwordx4 v[88:91], v1, s[36:39], s89 offen offset:2048 sc1
ds_read_b64_tr_b16 v[212:213], v3 offset:16384
ds_read_b64_tr_b16 v[214:215], v3 offset:16896
s_waitcnt vmcnt(11) lgkmcnt(4)
v_mfma_f32_32x32x16_bf16 v[160:175], v[200:203], v[44:47], v[160:175]
ds_read_b64_tr_b16 v[192:193], v2 offset:18432
ds_read_b64_tr_b16 v[194:195], v2 offset:18944
v_mfma_f32_32x32x16_bf16 v[176:191], v[204:207], v[44:47], v[176:191]
buffer_load_dwordx4 v[92:95], v1, s[36:39], s89 offen offset:3072 sc1
ds_read_b64_tr_b16 v[196:197], v3 offset:18432
ds_read_b64_tr_b16 v[198:199], v3 offset:18944
s_waitcnt vmcnt(11) lgkmcnt(4)
v_mfma_f32_32x32x16_bf16 v[160:175], v[208:211], v[48:51], v[160:175]
ds_read_b64_tr_b16 v[200:201], v2 offset:20480
ds_read_b64_tr_b16 v[202:203], v2 offset:20992
v_mfma_f32_32x32x16_bf16 v[176:191], v[212:215], v[48:51], v[176:191]
buffer_load_dwordx4 v[224:227], v12, s[36:39], s97 offen sc1
ds_read_b64_tr_b16 v[204:205], v3 offset:20480
ds_read_b64_tr_b16 v[206:207], v3 offset:20992
s_waitcnt vmcnt(11) lgkmcnt(4)
v_mfma_f32_32x32x16_bf16 v[160:175], v[192:195], v[52:55], v[160:175]
ds_read_b64_tr_b16 v[208:209], v2 offset:22528
ds_read_b64_tr_b16 v[210:211], v2 offset:23040
v_mfma_f32_32x32x16_bf16 v[176:191], v[196:199], v[52:55], v[176:191]
buffer_load_dwordx4 v[228:231], v12, s[36:39], s97 offen offset:512 sc1
ds_read_b64_tr_b16 v[212:213], v3 offset:22528
ds_read_b64_tr_b16 v[214:215], v3 offset:23040
s_waitcnt vmcnt(11) lgkmcnt(4)
v_mfma_f32_32x32x16_bf16 v[160:175], v[200:203], v[56:59], v[160:175]
ds_read_b64_tr_b16 v[192:193], v2 offset:24576
ds_read_b64_tr_b16 v[194:195], v2 offset:25088
v_mfma_f32_32x32x16_bf16 v[176:191], v[204:207], v[56:59], v[176:191]
buffer_load_dwordx4 v[232:235], v12, s[36:39], s97 offen offset:1024 sc1
ds_read_b64_tr_b16 v[196:197], v3 offset:24576
ds_read_b64_tr_b16 v[198:199], v3 offset:25088
s_waitcnt vmcnt(11) lgkmcnt(4)
v_mfma_f32_32x32x16_bf16 v[160:175], v[208:211], v[60:63], v[160:175]
ds_read_b64_tr_b16 v[200:201], v2 offset:26624
ds_read_b64_tr_b16 v[202:203], v2 offset:27136
v_mfma_f32_32x32x16_bf16 v[176:191], v[212:215], v[60:63], v[176:191]
buffer_load_dwordx4 v[236:239], v12, s[36:39], s97 offen offset:1536 sc1
ds_read_b64_tr_b16 v[204:205], v3 offset:26624
ds_read_b64_tr_b16 v[206:207], v3 offset:27136
s_waitcnt vmcnt(11) lgkmcnt(4)
v_mfma_f32_32x32x16_bf16 v[160:175], v[192:195], v[64:67], v[160:175]
ds_read_b64_tr_b16 v[208:209], v2 offset:28672
ds_read_b64_tr_b16 v[210:211], v2 offset:29184
v_mfma_f32_32x32x16_bf16 v[176:191], v[196:199], v[64:67], v[176:191]
s_add_u32 s89, s89, 4096
buffer_load_dwordx4 v[96:99], v1, s[36:39], s89 offen sc1
ds_read_b64_tr_b16 v[212:213], v3 offset:28672
ds_read_b64_tr_b16 v[214:215], v3 offset:29184
s_waitcnt vmcnt(11) lgkmcnt(4)
v_mfma_f32_32x32x16_bf16 v[160:175], v[200:203], v[68:71], v[160:175]
ds_read_b64_tr_b16 v[192:193], v2 offset:30720
ds_read_b64_tr_b16 v[194:195], v2 offset:31232
v_mfma_f32_32x32x16_bf16 v[176:191], v[204:207], v[68:71], v[176:191]
buffer_load_dwordx4 v[100:103], v1, s[36:39], s89 offen offset:1024 sc1
ds_read_b64_tr_b16 v[196:197], v3 offset:30720
ds_read_b64_tr_b16 v[198:199], v3 offset:31232
s_waitcnt vmcnt(11) lgkmcnt(4)
v_mfma_f32_32x32x16_bf16 v[160:175], v[208:211], v[72:75], v[160:175]
ds_read_b64_tr_b16 v[200:201], v2 offset:32768
ds_read_b64_tr_b16 v[202:203], v2 offset:33280
v_mfma_f32_32x32x16_bf16 v[176:191], v[212:215], v[72:75], v[176:191]
buffer_load_dwordx4 v[104:107], v1, s[36:39], s89 offen offset:2048 sc1
ds_read_b64_tr_b16 v[204:205], v3 offset:32768
ds_read_b64_tr_b16 v[206:207], v3 offset:33280
s_waitcnt vmcnt(11) lgkmcnt(4)
v_mfma_f32_32x32x16_bf16 v[160:175], v[192:195], v[76:79], v[160:175]
ds_read_b64_tr_b16 v[208:209], v2 offset:34816
ds_read_b64_tr_b16 v[210:211], v2 offset:35328
v_mfma_f32_32x32x16_bf16 v[176:191], v[196:199], v[76:79], v[176:191]
buffer_load_dwordx4 v[108:111], v1, s[36:39], s89 offen offset:3072 sc1
ds_read_b64_tr_b16 v[212:213], v3 offset:34816
ds_read_b64_tr_b16 v[214:215], v3 offset:35328
s_waitcnt vmcnt(11) lgkmcnt(4)
v_mfma_f32_32x32x16_bf16 v[160:175], v[200:203], v[80:83], v[160:175]
ds_read_b64_tr_b16 v[192:193], v2 offset:36864
ds_read_b64_tr_b16 v[194:195], v2 offset:37376
v_mfma_f32_32x32x16_bf16 v[176:191], v[204:207], v[80:83], v[176:191]
s_add_u32 s89, s89, 4096
buffer_load_dwordx4 v[112:115], v1, s[36:39], s89 offen sc1
ds_read_b64_tr_b16 v[196:197], v3 offset:36864
ds_read_b64_tr_b16 v[198:199], v3 offset:37376
s_waitcnt vmcnt(11) lgkmcnt(4)
v_mfma_f32_32x32x16_bf16 v[160:175], v[208:211], v[84:87], v[160:175]
ds_read_b64_tr_b16 v[200:201], v2 offset:38912
ds_read_b64_tr_b16 v[202:203], v2 offset:39424
v_mfma_f32_32x32x16_bf16 v[176:191], v[212:215], v[84:87], v[176:191]
buffer_load_dwordx4 v[116:119], v1, s[36:39], s89 offen offset:1024 sc1
ds_read_b64_tr_b16 v[204:205], v3 offset:38912
ds_read_b64_tr_b16 v[206:207], v3 offset:39424
s_waitcnt vmcnt(11) lgkmcnt(4)
v_mfma_f32_32x32x16_bf16 v[160:175], v[192:195], v[88:91], v[160:175]
ds_read_b64_tr_b16 v[208:209], v2 offset:40960
ds_read_b64_tr_b16 v[210:211], v2 offset:41472
v_mfma_f32_32x32x16_bf16 v[176:191], v[196:199], v[88:91], v[176:191]
buffer_load_dwordx4 v[120:123], v1, s[36:39], s89 offen offset:2048 sc1
ds_read_b64_tr_b16 v[212:213], v3 offset:40960
ds_read_b64_tr_b16 v[214:215], v3 offset:41472
s_waitcnt vmcnt(11) lgkmcnt(4)
v_mfma_f32_32x32x16_bf16 v[160:175], v[200:203], v[92:95], v[160:175]
ds_read_b64_tr_b16 v[192:193], v2 offset:43008
ds_read_b64_tr_b16 v[194:195], v2 offset:43520
v_mfma_f32_32x32x16_bf16 v[176:191], v[204:207], v[92:95], v[176:191]
buffer_load_dwordx4 v[124:127], v1, s[36:39], s89 offen offset:3072 sc1
ds_read_b64_tr_b16 v[196:197], v3 offset:43008
ds_read_b64_tr_b16 v[198:199], v3 offset:43520
s_waitcnt vmcnt(7) lgkmcnt(4)
v_mfma_f32_32x32x16_bf16 v[160:175], v[208:211], v[96:99], v[160:175]
ds_read_b64_tr_b16 v[200:201], v2 offset:45056
ds_read_b64_tr_b16 v[202:203], v2 offset:45568
v_mfma_f32_32x32x16_bf16 v[176:191], v[212:215], v[96:99], v[176:191]
s_add_u32 s89, s89, 4096
buffer_load_dwordx4 v[128:131], v1, s[36:39], s89 offen sc1
ds_read_b64_tr_b16 v[204:205], v3 offset:45056
ds_read_b64_tr_b16 v[206:207], v3 offset:45568
s_waitcnt vmcnt(7) lgkmcnt(4)
v_mfma_f32_32x32x16_bf16 v[160:175], v[192:195], v[100:103], v[160:175]
ds_read_b64_tr_b16 v[208:209], v2 offset:47104
ds_read_b64_tr_b16 v[210:211], v2 offset:47616
v_mfma_f32_32x32x16_bf16 v[176:191], v[196:199], v[100:103], v[176:191]
buffer_load_dwordx4 v[132:135], v1, s[36:39], s89 offen offset:1024 sc1
ds_read_b64_tr_b16 v[212:213], v3 offset:47104
ds_read_b64_tr_b16 v[214:215], v3 offset:47616
s_waitcnt vmcnt(7) lgkmcnt(4)
v_mfma_f32_32x32x16_bf16 v[160:175], v[200:203], v[104:107], v[160:175]
ds_read_b64_tr_b16 v[192:193], v2 offset:49152
ds_read_b64_tr_b16 v[194:195], v2 offset:49664
v_add_f32 v224, v224, v232
v_add_f32 v225, v225, v233
v_add_f32_e64 v226, v226, v234
v_mfma_f32_32x32x16_bf16 v[176:191], v[204:207], v[104:107], v[176:191]
buffer_load_dwordx4 v[136:139], v1, s[36:39], s89 offen offset:2048 sc1
ds_read_b64_tr_b16 v[196:197], v3 offset:49152
ds_read_b64_tr_b16 v[198:199], v3 offset:49664
v_add_f32 v227, v227, v235
v_add_f32 v228, v228, v236
v_add_f32 v229, v229, v237
s_waitcnt vmcnt(7) lgkmcnt(4)
v_mfma_f32_32x32x16_bf16 v[160:175], v[208:211], v[108:111], v[160:175]
ds_read_b64_tr_b16 v[200:201], v2 offset:51200
ds_read_b64_tr_b16 v[202:203], v2 offset:51712
v_add_f32 v230, v230, v238
v_add_f32 v231, v231, v239
v_add_f32_e64 v224, v224, v228
v_mfma_f32_32x32x16_bf16 v[176:191], v[212:215], v[108:111], v[176:191]
buffer_load_dwordx4 v[140:143], v1, s[36:39], s89 offen offset:3072 sc1
ds_read_b64_tr_b16 v[204:205], v3 offset:51200
ds_read_b64_tr_b16 v[206:207], v3 offset:51712
v_add_f32 v225, v225, v229
v_add_f32 v226, v226, v230
v_add_f32 v227, v227, v231
s_waitcnt vmcnt(7) lgkmcnt(4)
v_mfma_f32_32x32x16_bf16 v[160:175], v[192:195], v[112:115], v[160:175]
ds_read_b64_tr_b16 v[208:209], v2 offset:53248
ds_read_b64_tr_b16 v[210:211], v2 offset:53760
v_add_f32 v224, v224, v226
v_add_f32 v225, v225, v227
s_nop 1
v_permlane32_swap_b32 v224, v225
v_mfma_f32_32x32x16_bf16 v[176:191], v[196:199], v[112:115], v[176:191]
ds_read_b64_tr_b16 v[212:213], v3 offset:53248
ds_read_b64_tr_b16 v[214:215], v3 offset:53760
v_add_f32 v224, v224, v225
v_mov_b32 v225, v224
s_nop 1
v_permlane32_swap_b32_e64 v224, v225
s_waitcnt vmcnt(6) lgkmcnt(4)
v_mfma_f32_32x32x16_bf16 v[160:175], v[200:203], v[116:119], v[160:175]
ds_read_b64_tr_b16 v[192:193], v2 offset:55296
ds_read_b64_tr_b16 v[194:195], v2 offset:55808
v_mul_f32 v8, -0.001953125, v224
v_mul_f32 v225, 0.001953125, v225
v_fma_f32 v225, -v8, v8, v225
v_mfma_f32_32x32x16_bf16 v[176:191], v[204:207], v[116:119], v[176:191]
ds_read_b64_tr_b16 v[196:197], v3 offset:55296
ds_read_b64_tr_b16 v[198:199], v3 offset:55808
v_max_f32_e64 v225, 0, v225
v_add_f32 v225, 0x3727c5ac, v225
v_rsq_f32 v9, v225
s_waitcnt vmcnt(5) lgkmcnt(4)
v_mfma_f32_32x32x16_bf16 v[160:175], v[208:211], v[120:123], v[160:175]
s_add_u32 m0, s96, 67584
s_add_u32 s94, s95, 0
buffer_load_dwordx4 v5, s[32:35], s94 offen lds
ds_read_b64_tr_b16 v[200:201], v2 offset:57344
ds_read_b64_tr_b16 v[202:203], v2 offset:57856
s_lshl_b32 s77, s70, 4
s_add_u32 s77, s77, s69
s_mul_i32 s77, s77, 2304
v_mfma_f32_32x32x16_bf16 v[176:191], v[212:215], v[120:123], v[176:191]
ds_read_b64_tr_b16 v[204:205], v3 offset:57344
ds_read_b64_tr_b16 v[206:207], v3 offset:57856
s_add_u32 s20, s77, 2949120
s_lshl_b32 s78, s68, 9
s_add_u32 s21, s78, s20
s_waitcnt vmcnt(5) lgkmcnt(4)
v_mfma_f32_32x32x16_bf16 v[160:175], v[192:195], v[124:127], v[160:175]
ds_read_b64_tr_b16 v[208:209], v2 offset:59392
ds_read_b64_tr_b16 v[210:211], v2 offset:59904
s_lshl_b32 s77, s70, 8
s_lshl_b32 s78, s68, 6
s_add_u32 s77, s77, s78
v_mfma_f32_32x32x16_bf16 v[176:191], v[196:199], v[124:127], v[176:191]
ds_read_b64_tr_b16 v[212:213], v3 offset:59392
ds_read_b64_tr_b16 v[214:215], v3 offset:59904
s_add_u32 s23, s77, 24576
s_lshl_b32 s78, s69, 2
s_add_u32 s22, s23, s78
s_waitcnt vmcnt(4) lgkmcnt(4)
v_mfma_f32_32x32x16_bf16 v[160:175], v[200:203], v[128:131], v[160:175]
ds_read_b64_tr_b16 v[192:193], v2 offset:61440
ds_read_b64_tr_b16 v[194:195], v2 offset:61952
s_lshl_b32 s24, s68, 8
s_add_u32 s24, s24, 112640
s_mul_i32 s25, s68, 3072
v_mfma_f32_32x32x16_bf16 v[176:191], v[204:207], v[128:131], v[176:191]
s_add_u32 m0, s96, 68608
s_add_u32 s94, s95, 49152
buffer_load_dwordx4 v5, s[32:35], s94 offen lds
ds_read_b64_tr_b16 v[196:197], v3 offset:61440
ds_read_b64_tr_b16 v[198:199], v3 offset:61952
s_add_u32 s25, s25, 100352
s_waitcnt vmcnt(4) lgkmcnt(4)
v_mfma_f32_32x32x16_bf16 v[160:175], v[208:211], v[132:135], v[160:175]
ds_read_b64_tr_b16 v[200:201], v2 offset:63488
ds_read_b64_tr_b16 v[202:203], v2 offset:64000
v_mfma_f32_32x32x16_bf16 v[176:191], v[212:215], v[132:135], v[176:191]
ds_read_b64_tr_b16 v[204:205], v3 offset:63488
ds_read_b64_tr_b16 v[206:207], v3 offset:64000
s_waitcnt vmcnt(3) lgkmcnt(4)
v_mfma_f32_32x32x16_bf16 v[160:175], v[192:195], v[136:139], v[160:175]
v_mfma_f32_32x32x16_bf16 v[176:191], v[196:199], v[136:139], v[176:191]
s_waitcnt vmcnt(2) lgkmcnt(0)
v_mfma_f32_32x32x16_bf16 v[160:175], v[200:203], v[140:143], v[160:175]
s_add_u32 m0, s96, 69632
s_add_u32 s94, s95, 98304
buffer_load_dwordx4 v5, s[32:35], s94 offen lds
v_mfma_f32_32x32x16_bf16 v[176:191], v[204:207], v[140:143], v[176:191]
ds_read_b128 v[192:195], v10 offset:0
ds_read_b128 v[196:199], v10 offset:16
ds_read_b128 v[200:203], v10 offset:64
ds_read_b128 v[204:207], v10 offset:80
ds_read_b128 v[208:211], v10 offset:128
ds_read_b128 v[212:215], v10 offset:144
ds_read_b128 v[216:219], v10 offset:192
ds_read_b128 v[220:223], v10 offset:208
s_waitcnt lgkmcnt(4)
v_pk_fma_f32 v[160:161], v[192:193], v[8:9], v[160:161] op_sel_hi:[1,0,1]
v_pk_fma_f32 v[162:163], v[194:195], v[8:9], v[162:163] op_sel_hi:[1,0,1]
v_pk_fma_f32 v[164:165], v[196:197], v[8:9], v[164:165] op_sel_hi:[1,0,1]
v_pk_fma_f32 v[166:167], v[198:199], v[8:9], v[166:167] op_sel_hi:[1,0,1]
v_pk_fma_f32 v[168:169], v[200:201], v[8:9], v[168:169] op_sel_hi:[1,0,1]
v_pk_fma_f32 v[170:171], v[202:203], v[8:9], v[170:171] op_sel_hi:[1,0,1]
v_pk_fma_f32 v[172:173], v[204:205], v[8:9], v[172:173] op_sel_hi:[1,0,1]
v_pk_fma_f32 v[174:175], v[206:207], v[8:9], v[174:175] op_sel_hi:[1,0,1]
v_pk_mul_f32 v[160:161], v[160:161], v[8:9] op_sel:[0,1] op_sel_hi:[1,1]
v_pk_mul_f32 v[162:163], v[162:163], v[8:9] op_sel:[0,1] op_sel_hi:[1,1]
v_pk_mul_f32 v[164:165], v[164:165], v[8:9] op_sel:[0,1] op_sel_hi:[1,1]
v_pk_mul_f32 v[166:167], v[166:167], v[8:9] op_sel:[0,1] op_sel_hi:[1,1]
v_pk_mul_f32 v[168:169], v[168:169], v[8:9] op_sel:[0,1] op_sel_hi:[1,1]
v_pk_mul_f32 v[170:171], v[170:171], v[8:9] op_sel:[0,1] op_sel_hi:[1,1]
v_pk_mul_f32 v[172:173], v[172:173], v[8:9] op_sel:[0,1] op_sel_hi:[1,1]
v_pk_mul_f32 v[174:175], v[174:175], v[8:9] op_sel:[0,1] op_sel_hi:[1,1]
s_waitcnt lgkmcnt(0)
v_pk_fma_f32 v[176:177], v[208:209], v[8:9], v[176:177] op_sel_hi:[1,0,1]
v_pk_fma_f32 v[178:179], v[210:211], v[8:9], v[178:179] op_sel_hi:[1,0,1]
v_pk_fma_f32 v[180:181], v[212:213], v[8:9], v[180:181] op_sel_hi:[1,0,1]
v_pk_fma_f32 v[182:183], v[214:215], v[8:9], v[182:183] op_sel_hi:[1,0,1]
v_pk_fma_f32 v[184:185], v[216:217], v[8:9], v[184:185] op_sel_hi:[1,0,1]
v_pk_fma_f32 v[186:187], v[218:219], v[8:9], v[186:187] op_sel_hi:[1,0,1]
v_pk_fma_f32 v[188:189], v[220:221], v[8:9], v[188:189] op_sel_hi:[1,0,1]
v_pk_fma_f32 v[190:191], v[222:223], v[8:9], v[190:191] op_sel_hi:[1,0,1]
v_pk_mul_f32 v[176:177], v[176:177], v[8:9] op_sel:[0,1] op_sel_hi:[1,1]
v_pk_mul_f32 v[178:179], v[178:179], v[8:9] op_sel:[0,1] op_sel_hi:[1,1]
v_pk_mul_f32 v[180:181], v[180:181], v[8:9] op_sel:[0,1] op_sel_hi:[1,1]
s_add_u32 m0, s96, 70656
s_add_u32 s94, s95, 147456
buffer_load_dwordx4 v5, s[32:35], s94 offen lds
v_pk_mul_f32 v[182:183], v[182:183], v[8:9] op_sel:[0,1] op_sel_hi:[1,1]
v_pk_mul_f32 v[184:185], v[184:185], v[8:9] op_sel:[0,1] op_sel_hi:[1,1]
v_pk_mul_f32 v[186:187], v[186:187], v[8:9] op_sel:[0,1] op_sel_hi:[1,1]
v_pk_mul_f32 v[188:189], v[188:189], v[8:9] op_sel:[0,1] op_sel_hi:[1,1]
v_pk_mul_f32 v[190:191], v[190:191], v[8:9] op_sel:[0,1] op_sel_hi:[1,1]
v_cvt_pk_bf16_f32 v224, v160, v161
v_cvt_pk_bf16_f32 v225, v162, v163
v_cvt_pk_bf16_f32 v226, v164, v165
v_cvt_pk_bf16_f32 v227, v166, v167
v_cvt_pk_bf16_f32 v228, v168, v169
v_cvt_pk_bf16_f32 v229, v170, v171
v_cvt_pk_bf16_f32 v230, v172, v173
v_cvt_pk_bf16_f32 v231, v174, v175
v_mfma_f32_32x32x16_bf16 v[160:175], a[232:235], v[224:227], 0
s_nop 0
v_mfma_f32_32x32x16_bf16 v[240:255], a[236:239], v[228:231], 0
v_cvt_pk_bf16_f32 v232, v176, v177
v_cvt_pk_bf16_f32 v233, v178, v179
v_cvt_pk_bf16_f32 v234, v180, v181
v_cvt_pk_bf16_f32 v235, v182, v183
v_cvt_pk_bf16_f32 v236, v184, v185
v_cvt_pk_bf16_f32 v237, v186, v187
s_add_u32 m0, s96, 71680
s_add_u32 s94, s95, 196608
buffer_load_dwordx4 v5, s[32:35], s94 offen lds
v_cvt_pk_bf16_f32 v238, v188, v189
v_cvt_pk_bf16_f32 v239, v190, v191
v_mfma_f32_32x32x16_bf16 v[176:191], v[232:235], a[224:227], 0
s_nop 0
v_mfma_f32_32x32x16_bf16 v[144:159], v[236:239], a[228:231], 0
v_max3_f32 v192, v160, v161, v162
v_max3_f32 v193, v163, v164, v165
v_max3_f32 v192, v166, v167, v192
v_max_f32_e64 v192, v192, v193
v_max3_f32 v194, v168, v169, v170
v_max3_f32 v195, v171, v172, v173
v_max3_f32 v194, v174, v175, v194
v_max_f32_e64 v194, v194, v195
v_max3_f32 v196, v240, v241, v242
v_max3_f32 v197, v243, v244, v245
v_max3_f32 v196, v246, v247, v196
v_max_f32_e64 v196, v196, v197
v_max3_f32 v198, v248, v249, v250
v_max3_f32 v199, v251, v252, v253
v_max3_f32 v198, v254, v255, v198
v_max_f32 v198, v198, v199
v_permlane32_swap_b32 v192, v194
s_add_u32 m0, s96, 72704
s_add_u32 s94, s95, 245760
buffer_load_dwordx4 v5, s[32:35], s94 offen lds
v_permlane32_swap_b32 v196, v198
v_max_f32 v192, v192, v194
v_max_f32 v196, v196, v198
v_mov_b32 v194, v192
v_mov_b32 v198, v196
s_nop 0
v_permlane32_swap_b32 v192, v194
v_permlane32_swap_b32 v196, v198
v_mul_f32 v192, 0xbfb8aa3b, v192
v_mul_f32 v194, 0xbfb8aa3b, v194
v_mul_f32 v196, 0xbfb8aa3b, v196
v_mul_f32 v198, 0xbfb8aa3b, v198
v_pk_fma_f32 v[160:161], v[160:161], s[84:85], v[192:193] op_sel_hi:[1,1,0]
v_pk_fma_f32 v[162:163], v[162:163], s[84:85], v[192:193] op_sel_hi:[1,1,0]
v_pk_fma_f32 v[164:165], v[164:165], s[84:85], v[192:193] op_sel_hi:[1,1,0]
v_pk_fma_f32 v[166:167], v[166:167], s[84:85], v[192:193] op_sel_hi:[1,1,0]
v_pk_fma_f32 v[168:169], v[168:169], s[84:85], v[194:195] op_sel_hi:[1,1,0]
v_pk_fma_f32 v[170:171], v[170:171], s[84:85], v[194:195] op_sel_hi:[1,1,0]
v_pk_fma_f32 v[172:173], v[172:173], s[84:85], v[194:195] op_sel_hi:[1,1,0]
v_pk_fma_f32 v[174:175], v[174:175], s[84:85], v[194:195] op_sel_hi:[1,1,0]
v_pk_fma_f32 v[240:241], v[240:241], s[84:85], v[196:197] op_sel_hi:[1,1,0]
v_pk_fma_f32 v[242:243], v[242:243], s[84:85], v[196:197] op_sel_hi:[1,1,0]
v_pk_fma_f32 v[244:245], v[244:245], s[84:85], v[196:197] op_sel_hi:[1,1,0]
v_pk_fma_f32 v[246:247], v[246:247], s[84:85], v[196:197] op_sel_hi:[1,1,0]
v_pk_fma_f32 v[248:249], v[248:249], s[84:85], v[198:199] op_sel_hi:[1,1,0]
v_pk_fma_f32 v[250:251], v[250:251], s[84:85], v[198:199] op_sel_hi:[1,1,0]
v_pk_fma_f32 v[252:253], v[252:253], s[84:85], v[198:199] op_sel_hi:[1,1,0]
v_pk_fma_f32 v[254:255], v[254:255], s[84:85], v[198:199] op_sel_hi:[1,1,0]
v_exp_f32 v160, v160
v_exp_f32 v161, v161
v_exp_f32_e64 v162, v162
s_add_u32 m0, s96, 73728
s_add_u32 s94, s95, 294912
buffer_load_dwordx4 v5, s[32:35], s94 offen lds
v_exp_f32 v163, v163
v_exp_f32 v164, v164
v_exp_f32 v165, v165
v_exp_f32 v166, v166
v_exp_f32 v167, v167
v_exp_f32 v168, v168
v_exp_f32 v169, v169
v_exp_f32 v170, v170
v_exp_f32 v171, v171
v_exp_f32 v172, v172
v_exp_f32 v173, v173
v_exp_f32 v174, v174
v_exp_f32 v175, v175
v_exp_f32 v240, v240
v_exp_f32 v241, v241
v_exp_f32 v242, v242
v_exp_f32 v243, v243
v_exp_f32 v244, v244
s_add_u32 m0, s96, 74752
s_add_u32 s94, s95, 344064
buffer_load_dwordx4 v5, s[32:35], s94 offen lds
v_exp_f32 v245, v245
v_exp_f32 v246, v246
v_exp_f32 v247, v247
v_exp_f32 v248, v248
v_exp_f32 v249, v249
v_exp_f32 v250, v250
v_exp_f32 v251, v251
v_exp_f32 v252, v252
v_exp_f32 v253, v253
v_exp_f32 v254, v254
v_exp_f32_e64 v255, v255
v_pk_add_f32 v[192:193], v[160:161], v[162:163]
v_pk_add_f32 v[200:201], v[164:165], v[166:167]
v_pk_add_f32 v[192:193], v[192:193], v[200:201]
v_add_f32_e64 v192, v192, v193
v_pk_add_f32 v[194:195], v[168:169], v[170:171]
v_pk_add_f32 v[200:201], v[172:173], v[174:175]
v_pk_add_f32 v[194:195], v[194:195], v[200:201]
v_add_f32_e64 v194, v194, v195
v_pk_add_f32 v[196:197], v[240:241], v[242:243]
v_pk_add_f32 v[200:201], v[244:245], v[246:247]
v_pk_add_f32 v[196:197], v[196:197], v[200:201]
v_add_f32_e64 v196, v196, v197
v_pk_add_f32 v[198:199], v[248:249], v[250:251]
v_pk_add_f32 v[200:201], v[252:253], v[254:255]
v_pk_add_f32 v[198:199], v[198:199], v[200:201]
v_add_f32 v198, v198, v199
v_permlane32_swap_b32 v192, v194
s_nop 0
v_permlane32_swap_b32 v196, v198
v_add_f32 v192, v192, v194
v_add_f32 v196, v196, v198
v_mov_b32 v194, v192
v_mov_b32 v198, v196
s_nop 0
v_permlane32_swap_b32 v192, v194
v_permlane32_swap_b32 v196, v198
v_rcp_f32 v192, v192
v_rcp_f32 v194, v194
v_rcp_f32 v196, v196
v_rcp_f32_e64 v198, v198
v_pk_mul_f32 v[160:161], v[160:161], v[192:193] op_sel_hi:[1,0]
v_pk_mul_f32 v[162:163], v[162:163], v[192:193] op_sel_hi:[1,0]
v_pk_mul_f32 v[164:165], v[164:165], v[192:193] op_sel_hi:[1,0]
v_pk_mul_f32 v[166:167], v[166:167], v[192:193] op_sel_hi:[1,0]
v_pk_mul_f32 v[168:169], v[168:169], v[194:195] op_sel_hi:[1,0]
v_pk_mul_f32 v[170:171], v[170:171], v[194:195] op_sel_hi:[1,0]
v_pk_mul_f32 v[172:173], v[172:173], v[194:195] op_sel_hi:[1,0]
v_pk_mul_f32 v[174:175], v[174:175], v[194:195] op_sel_hi:[1,0]
v_pk_mul_f32 v[240:241], v[240:241], v[196:197] op_sel_hi:[1,0]
v_pk_mul_f32 v[242:243], v[242:243], v[196:197] op_sel_hi:[1,0]
v_pk_mul_f32 v[244:245], v[244:245], v[196:197] op_sel_hi:[1,0]
v_pk_mul_f32 v[246:247], v[246:247], v[196:197] op_sel_hi:[1,0]
v_pk_mul_f32 v[248:249], v[248:249], v[198:199] op_sel_hi:[1,0]
v_pk_mul_f32 v[250:251], v[250:251], v[198:199] op_sel_hi:[1,0]
v_pk_mul_f32 v[252:253], v[252:253], v[198:199] op_sel_hi:[1,0]
v_pk_mul_f32 v[254:255], v[254:255], v[198:199] op_sel_hi:[1,0]
v_cvt_pk_bf16_f32 v204, v160, v161
v_cvt_pk_bf16_f32 v205, v162, v163
v_cvt_pk_bf16_f32 v206, v164, v165
v_cvt_pk_bf16_f32 v207, v166, v167
v_cvt_pk_bf16_f32 v208, v168, v169
v_cvt_pk_bf16_f32 v209, v170, v171
v_cvt_pk_bf16_f32 v210, v172, v173
v_cvt_pk_bf16_f32 v211, v174, v175
v_cvt_pk_bf16_f32 v212, v240, v241
v_cvt_pk_bf16_f32 v213, v242, v243
v_cvt_pk_bf16_f32 v214, v244, v245
v_cvt_pk_bf16_f32 v215, v246, v247
v_cvt_pk_bf16_f32 v216, v248, v249
v_cvt_pk_bf16_f32 v217, v250, v251
v_cvt_pk_bf16_f32 v218, v252, v253
v_cvt_pk_bf16_f32 v219, v254, v255
v_mfma_f32_32x32x16_bf16 v[160:175], v[204:207], a[224:227], 0
v_mfma_f32_32x32x16_bf16 v[160:175], v[208:211], a[228:231], v[160:175]
v_mfma_f32_32x32x16_bf16 v[240:255], v[212:215], a[224:227], 0
v_mfma_f32_32x32x16_bf16 v[240:255], v[216:219], a[228:231], v[240:255]
v_cvt_pk_bf16_f32 v224, v176, v177
v_cvt_pk_bf16_f32 v225, v178, v179
v_cvt_pk_bf16_f32 v226, v180, v181
v_cvt_pk_bf16_f32 v227, v182, v183
v_cvt_pk_bf16_f32 v228, v184, v185
v_cvt_pk_bf16_f32 v229, v186, v187
v_cvt_pk_bf16_f32 v230, v188, v189
v_cvt_pk_bf16_f32 v231, v190, v191
v_cvt_pk_bf16_f32 v232, v144, v145
v_cvt_pk_bf16_f32 v233, v146, v147
v_cvt_pk_bf16_f32 v234, v148, v149
v_cvt_pk_bf16_f32 v235, v150, v151
v_cvt_pk_bf16_f32 v236, v152, v153
v_cvt_pk_bf16_f32 v237, v154, v155
v_cvt_pk_bf16_f32 v238, v156, v157
v_cvt_pk_bf16_f32 v239, v158, v159
v_cvt_pk_bf16_f32 v204, v160, v161
v_cvt_pk_bf16_f32 v205, v162, v163
v_cvt_pk_bf16_f32 v206, v164, v165
v_cvt_pk_bf16_f32 v207, v166, v167
v_cvt_pk_bf16_f32 v208, v168, v169
v_cvt_pk_bf16_f32 v209, v170, v171
v_cvt_pk_bf16_f32 v210, v172, v173
v_cvt_pk_bf16_f32 v211, v174, v175
v_mfma_f32_32x32x16_bf16 v[176:191], v[204:207], v[224:227], 0
s_nop 0
v_mfma_f32_32x32x16_bf16 v[176:191], v[208:211], v[228:231], v[176:191]
v_cvt_pk_bf16_f32 v212, v240, v241
v_cvt_pk_bf16_f32 v213, v242, v243
v_cvt_pk_bf16_f32 v214, v244, v245
v_cvt_pk_bf16_f32 v215, v246, v247
v_cvt_pk_bf16_f32 v216, v248, v249
v_cvt_pk_bf16_f32 v217, v250, v251
v_cvt_pk_bf16_f32 v218, v252, v253
v_cvt_pk_bf16_f32 v219, v254, v255
v_mfma_f32_32x32x16_bf16 v[176:191], v[212:215], v[232:235], v[176:191]
s_nop 0
v_mfma_f32_32x32x16_bf16 v[176:191], v[216:219], v[236:239], v[176:191]
v_add_f32 v160, v160, v168
v_add_f32 v161, v161, v169
v_add_f32 v162, v162, v170
v_add_f32 v163, v163, v171
v_add_f32 v164, v164, v172
v_add_f32 v165, v165, v173
v_add_f32 v166, v166, v174
v_add_f32 v167, v167, v175
v_add_f32 v240, v240, v248
v_add_f32 v241, v241, v249
v_add_f32 v242, v242, v250
v_add_f32 v243, v243, v251
v_add_f32 v244, v244, v252
v_add_f32 v245, v245, v253
v_add_f32 v246, v246, v254
v_add_f32 v247, v247, v255
v_add_f32 v160, v160, v164
v_add_f32 v161, v161, v165
v_add_f32 v162, v162, v166
v_add_f32 v163, v163, v167
v_add_f32 v240, v240, v244
v_add_f32 v241, v241, v245
v_add_f32 v242, v242, v246
v_add_f32 v243, v243, v247
v_add_f32 v160, v160, v162
v_add_f32 v161, v161, v163
v_add_f32 v240, v240, v242
v_add_f32 v241, v241, v243
v_add_f32 v160, v160, v161
v_add_f32 v240, v240, v241
v_lshl_add_u32 v11, v0, 2, s24
v_lshlrev_b32 v7, 2, v0
v_permlane32_swap_b32 v160, v240
v_add_u32 v12, 112640, v7
v_add_u32 v13, s25, v1
v_add_f32 v160, v160, v240
ds_write_b32 v11, v160
v_add_u32 v11, 100352, v1
s_cmp_ge_u32 s68, 2
s_cbranch_scc1 Lsc_92
Lsc_90:
s_cmp_eq_u32 s68, 1
s_cbranch_scc1 Lsc_91
ds_write_b128 v11, v[180:183] offset:5120
ds_write_b128 v11, v[184:187] offset:7168
ds_write_b128 v11, v[188:191] offset:9216
v_pk_add_f32 v[192:193], v[176:177], 0
v_pk_add_f32 v[194:195], v[178:179], 0
s_branch Lscd_94
Lsc_91:
ds_write_b128 v11, v[176:179] offset:0
ds_write_b128 v11, v[184:187] offset:8192
ds_write_b128 v11, v[188:191] offset:10240
v_pk_add_f32 v[192:193], v[180:181], 0
v_pk_add_f32 v[194:195], v[182:183], 0
s_branch Lscd_94
Lsc_92:
s_cmp_eq_u32 s68, 3
s_cbranch_scc1 Lsc_93
ds_write_b128 v11, v[176:179] offset:1024
ds_write_b128 v11, v[180:183] offset:3072
ds_write_b128 v11, v[188:191] offset:11264
v_pk_add_f32 v[192:193], v[184:185], 0
v_pk_add_f32 v[194:195], v[186:187], 0
s_branch Lscd_94
Lsc_93:
ds_write_b128 v11, v[176:179] offset:2048
ds_write_b128 v11, v[180:183] offset:4096
ds_write_b128 v11, v[184:187] offset:6144
v_pk_add_f32 v[192:193], v[188:189], 0
v_pk_add_f32 v[194:195], v[190:191], 0
Lscd_94:
v_lshlrev_b32 v11, 3, v0
s_waitcnt lgkmcnt(0)
s_barrier
ds_read_b128 v[196:199], v13 offset:0
ds_read_b128 v[200:203], v13 offset:1024
ds_read_b128 v[204:207], v13 offset:2048
ds_read_b32 v208, v12 offset:0
ds_read_b32 v209, v12 offset:256
ds_read_b32 v210, v12 offset:512
ds_read_b32 v211, v12 offset:768
s_waitcnt lgkmcnt(4)
v_pk_add_f32 v[192:193], v[192:193], v[196:197]
v_pk_add_f32 v[200:201], v[200:201], v[204:205]
v_pk_add_f32 v[194:195], v[194:195], v[198:199]
v_pk_add_f32 v[202:203], v[202:203], v[206:207]
v_pk_add_f32 v[192:193], v[192:193], v[200:201]
v_pk_add_f32 v[194:195], v[194:195], v[202:203]
v_cvt_pk_bf16_f32 v192, v192, v193
v_cvt_pk_bf16_f32 v193, v194, v195
buffer_store_dwordx2 v[192:193], v11, s[36:39], s21 offen sc1
s_waitcnt lgkmcnt(0)
s_cmp_lg_u32 s68, 0
s_cbranch_scc1 Lnoz_95
v_pk_add_f32 v[208:209], v[208:209], v[210:211]
v_add_f32_e64 v208, v208, v209
buffer_store_dword v208, v7, s[36:39], s20 offen offset:2048 sc1
Lnoz_95:
v_lshrrev_b32_e64 v7, 3, v0
v_mul_u32_u24 v7, 1024, v7
v_and_b32_e64 v14, 3, v0
v_lshl_add_u32 v7, v14, 4, v7
v_lshrrev_b32 v14, 2, v0
v_lshrrev_b32 v11, 4, v0
v_xor_b32 v14, v14, v11
v_and_b32 v14, 1, v14
v_mul_u32_u24 v14, 64, v14
v_add_u32 v14, v14, v7
s_lshl_b32 s93, s68, 14
s_lshl_b32 s77, s68, 17
s_lshl_b32 s78, s72, 7
s_add_u32 s92, s77, s78
s_sub_u32 s77, s92, 16384
s_and_b32 s97, s77, 0x7ffff
v_and_b32_e64 v11, 15, v0
v_lshl_add_u32 v5, v11, 2, s23
v_lshrrev_b32_e64 v7, 4, v0
v_mul_u32_u24 v7, 2304, v7
v_lshl_add_u32 v13, v11, 4, v7
v_lshrrev_b32_e64 v7, 5, v0
v_mul_u32_u24 v7, 2304, v7
v_and_b32_e64 v12, 31, v0
v_lshl_add_u32 v12, v12, 4, v7
s_mul_i32 s79, s70, 36864
s_add_u32 s79, s79, 2949120
s_lshl_b32 s80, s68, 9
s_add_u32 s80, s80, s79
s_lshl_b32 s100, s68, 11
s_mul_i32 s99, s70, 229376
s_add_u32 s99, s99, s100
s_add_u32 s99, s99, 18874368
v_mov_b32 v188, 0
v_mov_b32 v189, 0
v_mov_b32 v190, 0
v_mov_b32 v191, 0
v_mov_b32 v192, 0
v_mov_b32 v193, 0
v_mov_b32 v194, 0
v_mov_b32 v7, 1
v_mov_b32_e64 v6, s22
s_waitcnt vmcnt(0)
s_mov_b64 exec, 1
buffer_store_dword v7, v6, s[36:39], 0 offen sc1
s_mov_b64 exec, -1
s_barrier
s_add_u32 m0, s93, 100352
s_add_u32 s94, s92, 0
buffer_load_dwordx4 v14, s[48:51], s94 offen lds
s_add_u32 m0, s93, 101376
s_add_u32 s94, s92, 8192
buffer_load_dwordx4 v14, s[48:51], s94 offen lds
ds_read_b64_tr_b16 v[160:161], v4 offset:0
ds_read_b64_tr_b16 v[162:163], v4 offset:256
ds_read_b64_tr_b16 v[164:165], v4 offset:1024
ds_read_b64_tr_b16 v[166:167], v4 offset:1280
ds_read_b64_tr_b16 v[168:169], v4 offset:2048
ds_read_b64_tr_b16 v[170:171], v4 offset:2304
ds_read_b64_tr_b16 v[172:173], v4 offset:3072
ds_read_b64_tr_b16 v[174:175], v4 offset:3328
s_waitcnt lgkmcnt(6)
v_mfma_f32_32x32x16_bf16 v[144:159], v[160:163], v[16:19], 0
v_mov_b32 v195, 0
v_lshlrev_b32 v11, 1, v0
ds_read_b64_tr_b16 v[160:161], v4 offset:4096
ds_read_b64_tr_b16 v[162:163], v4 offset:4352
s_waitcnt lgkmcnt(6)
v_mfma_f32_32x32x16_bf16 v[144:159], v[164:167], v[20:23], v[144:159]
s_add_u32 m0, s93, 102400
s_add_u32 s94, s92, 16384
buffer_load_dwordx4 v14, s[48:51], s94 offen lds
v_lshrrev_b32 v7, 5, v0
v_and_or_b32 v11, v11, 62, v7
ds_read_b64_tr_b16 v[164:165], v4 offset:5120
ds_read_b64_tr_b16 v[166:167], v4 offset:5376
s_waitcnt lgkmcnt(6)
v_mfma_f32_32x32x16_bf16 v[144:159], v[168:171], v[24:27], v[144:159]
v_bfe_u32 v7, v11, 4, 1
v_lshlrev_b32 v7, 11, v7
ds_read_b64_tr_b16 v[168:169], v4 offset:6144
ds_read_b64_tr_b16 v[170:171], v4 offset:6400
s_waitcnt lgkmcnt(6)
v_mfma_f32_32x32x16_bf16 v[144:159], v[172:175], v[28:31], v[144:159]
s_add_u32 m0, s93, 103424
s_add_u32 s94, s92, 24576
buffer_load_dwordx4 v14, s[48:51], s94 offen lds
v_and_b32 v11, 47, v11
v_lshl_add_u32 v7, v11, 4, v7
ds_read_b64_tr_b16 v[172:173], v4 offset:7168
ds_read_b64_tr_b16 v[174:175], v4 offset:7424
s_waitcnt lgkmcnt(6)
v_mfma_f32_32x32x16_bf16 v[144:159], v[160:163], v[32:35], v[144:159]
s_lshl_b32 s77, s74, 10
s_lshl_b32 s78, s75, 3
ds_read_b64_tr_b16 v[160:161], v4 offset:8192
ds_read_b64_tr_b16 v[162:163], v4 offset:8448
s_waitcnt lgkmcnt(6)
v_mfma_f32_32x32x16_bf16 v[144:159], v[164:167], v[36:39], v[144:159]
s_add_u32 m0, s93, 104448
s_add_u32 s94, s92, 32768
buffer_load_dwordx4 v14, s[48:51], s94 offen lds
s_add_u32 s77, s77, s78
s_add_u32 s77, s77, 92160
ds_read_b64_tr_b16 v[164:165], v4 offset:9216
ds_read_b64_tr_b16 v[166:167], v4 offset:9472
s_waitcnt lgkmcnt(6)
v_mfma_f32_32x32x16_bf16 v[144:159], v[168:171], v[40:43], v[144:159]
v_add_u32 v196, s77, v7
v_and_b32 v7, 31, v0
ds_read_b64_tr_b16 v[168:169], v4 offset:10240
ds_read_b64_tr_b16 v[170:171], v4 offset:10496
s_waitcnt lgkmcnt(6)
v_mfma_f32_32x32x16_bf16 v[144:159], v[172:175], v[44:47], v[144:159]
s_add_u32 m0, s93, 105472
s_add_u32 s94, s92, 40960
buffer_load_dwordx4 v14, s[48:51], s94 offen lds
v_min_u32 v7, 16, v7
v_and_b32_e64 v11, 32, v0
ds_read_b64_tr_b16 v[172:173], v4 offset:11264
ds_read_b64_tr_b16 v[174:175], v4 offset:11520
s_waitcnt lgkmcnt(6)
v_mfma_f32_32x32x16_bf16 v[144:159], v[160:163], v[48:51], v[144:159]
v_add_u32 v7, v7, v11
v_lshlrev_b32_e64 v7, 4, v7
ds_read_b64_tr_b16 v[160:161], v4 offset:12288
ds_read_b64_tr_b16 v[162:163], v4 offset:12544
s_waitcnt lgkmcnt(6)
v_mfma_f32_32x32x16_bf16 v[144:159], v[164:167], v[52:55], v[144:159]
s_add_u32 m0, s93, 106496
s_add_u32 s94, s92, 49152
buffer_load_dwordx4 v14, s[48:51], s94 offen lds
v_add_u32 v197, 92160, v7
s_lshl_b32 s77, s71, 15
ds_read_b64_tr_b16 v[164:165], v4 offset:13312
ds_read_b64_tr_b16 v[166:167], v4 offset:13568
s_waitcnt lgkmcnt(6)
v_mfma_f32_32x32x16_bf16 v[144:159], v[168:171], v[56:59], v[144:159]
s_lshl_b32 s78, s70, 11
s_add_u32 s77, s77, s78
ds_read_b64_tr_b16 v[168:169], v4 offset:14336
ds_read_b64_tr_b16 v[170:171], v4 offset:14592
s_waitcnt lgkmcnt(6)
v_mfma_f32_32x32x16_bf16 v[144:159], v[172:175], v[60:63], v[144:159]
s_add_u32 m0, s93, 107520
s_add_u32 s94, s92, 57344
buffer_load_dwordx4 v14, s[48:51], s94 offen lds
s_add_u32 s82, s77, 6291456
v_bfe_u32 v7, v0, 2, 2
ds_read_b64_tr_b16 v[172:173], v4 offset:15360
ds_read_b64_tr_b16 v[174:175], v4 offset:15616
s_waitcnt lgkmcnt(6)
v_mfma_f32_32x32x16_bf16 v[144:159], v[160:163], v[64:67], v[144:159]
v_lshlrev_b32 v7, 10, v7
v_and_b32_e64 v11, 1, v0
ds_read_b64_tr_b16 v[160:161], v4 offset:16384
ds_read_b64_tr_b16 v[162:163], v4 offset:16640
s_waitcnt lgkmcnt(6)
v_mfma_f32_32x32x16_bf16 v[144:159], v[164:167], v[68:71], v[144:159]
s_add_u32 m0, s93, 108544
s_add_u32 s94, s92, 65536
buffer_load_dwordx4 v14, s[48:51], s94 offen lds
v_lshl_add_u32 v7, v11, 9, v7
v_bfe_u32 v11, v0, 1, 1
ds_read_b64_tr_b16 v[164:165], v4 offset:17408
ds_read_b64_tr_b16 v[166:167], v4 offset:17664
s_waitcnt lgkmcnt(6)
v_mfma_f32_32x32x16_bf16 v[144:159], v[168:171], v[72:75], v[144:159]
v_lshl_add_u32 v7, v11, 3, v7
v_add_u32 v198, 92416, v7
ds_read_b64_tr_b16 v[168:169], v4 offset:18432
ds_read_b64_tr_b16 v[170:171], v4 offset:18688
s_waitcnt lgkmcnt(6)
v_mfma_f32_32x32x16_bf16 v[144:159], v[172:175], v[76:79], v[144:159]
s_add_u32 m0, s93, 109568
s_add_u32 s94, s92, 73728
buffer_load_dwordx4 v14, s[48:51], s94 offen lds
ds_read_b64_tr_b16 v[172:173], v4 offset:19456
ds_read_b64_tr_b16 v[174:175], v4 offset:19712
s_waitcnt lgkmcnt(6)
v_mfma_f32_32x32x16_bf16 v[144:159], v[160:163], v[80:83], v[144:159]
ds_read_b64_tr_b16 v[160:161], v4 offset:20480
ds_read_b64_tr_b16 v[162:163], v4 offset:20736
s_waitcnt lgkmcnt(6)
v_mfma_f32_32x32x16_bf16 v[144:159], v[164:167], v[84:87], v[144:159]
s_add_u32 m0, s93, 110592
s_add_u32 s94, s92, 81920
buffer_load_dwordx4 v14, s[48:51], s94 offen lds
ds_read_b64_tr_b16 v[164:165], v4 offset:21504
ds_read_b64_tr_b16 v[166:167], v4 offset:21760
s_waitcnt lgkmcnt(6)
v_mfma_f32_32x32x16_bf16 v[144:159], v[168:171], v[88:91], v[144:159]
ds_read_b64_tr_b16 v[168:169], v4 offset:22528
ds_read_b64_tr_b16 v[170:171], v4 offset:22784
s_waitcnt lgkmcnt(6)
v_mfma_f32_32x32x16_bf16 v[144:159], v[172:175], v[92:95], v[144:159]
s_add_u32 m0, s93, 111616
s_add_u32 s94, s92, 90112
buffer_load_dwordx4 v14, s[48:51], s94 offen lds
ds_read_b64_tr_b16 v[172:173], v4 offset:23552
ds_read_b64_tr_b16 v[174:175], v4 offset:23808
s_waitcnt lgkmcnt(6)
v_mfma_f32_32x32x16_bf16 v[144:159], v[160:163], v[96:99], v[144:159]
ds_read_b64_tr_b16 v[160:161], v4 offset:24576
ds_read_b64_tr_b16 v[162:163], v4 offset:24832
s_waitcnt lgkmcnt(6)
v_mfma_f32_32x32x16_bf16 v[144:159], v[164:167], v[100:103], v[144:159]
s_add_u32 m0, s93, 112640
s_add_u32 s94, s92, 98304
buffer_load_dwordx4 v14, s[48:51], s94 offen lds
ds_read_b64_tr_b16 v[164:165], v4 offset:25600
ds_read_b64_tr_b16 v[166:167], v4 offset:25856
s_waitcnt lgkmcnt(6)
v_mfma_f32_32x32x16_bf16 v[144:159], v[168:171], v[104:107], v[144:159]
ds_read_b64_tr_b16 v[168:169], v4 offset:26624
ds_read_b64_tr_b16 v[170:171], v4 offset:26880
s_waitcnt lgkmcnt(6)
v_mfma_f32_32x32x16_bf16 v[144:159], v[172:175], v[108:111], v[144:159]
s_add_u32 m0, s93, 113664
s_add_u32 s94, s92, 106496
buffer_load_dwordx4 v14, s[48:51], s94 offen lds
ds_read_b64_tr_b16 v[172:173], v4 offset:27648
ds_read_b64_tr_b16 v[174:175], v4 offset:27904
s_waitcnt lgkmcnt(6)
v_mfma_f32_32x32x16_bf16 v[144:159], v[160:163], v[112:115], v[144:159]
ds_read_b64_tr_b16 v[160:161], v4 offset:28672
ds_read_b64_tr_b16 v[162:163], v4 offset:28928
s_waitcnt lgkmcnt(6)
v_mfma_f32_32x32x16_bf16 v[144:159], v[164:167], v[116:119], v[144:159]
buffer_load_dword v6, v5, s[36:39], 0 offen sc1
ds_read_b64_tr_b16 v[164:165], v4 offset:29696
ds_read_b64_tr_b16 v[166:167], v4 offset:29952
s_waitcnt lgkmcnt(6)
v_mfma_f32_32x32x16_bf16 v[144:159], v[168:171], v[120:123], v[144:159]
ds_read_b64_tr_b16 v[168:169], v4 offset:30720
ds_read_b64_tr_b16 v[170:171], v4 offset:30976
s_waitcnt lgkmcnt(6)
v_mfma_f32_32x32x16_bf16 v[144:159], v[172:175], v[124:127], v[144:159]
ds_read_b64_tr_b16 v[172:173], v4 offset:31744
ds_read_b64_tr_b16 v[174:175], v4 offset:32000
s_waitcnt lgkmcnt(6)
v_mfma_f32_32x32x16_bf16 v[144:159], v[160:163], v[128:131], v[144:159]
s_waitcnt lgkmcnt(4)
v_mfma_f32_32x32x16_bf16 v[144:159], v[164:167], v[132:135], v[144:159]
s_waitcnt lgkmcnt(2)
v_mfma_f32_32x32x16_bf16 v[144:159], v[168:171], v[136:139], v[144:159]
s_waitcnt lgkmcnt(0)
v_mfma_f32_32x32x16_bf16 v[144:159], v[172:175], v[140:143], v[144:159]
s_waitcnt lgkmcnt(0)
s_barrier
ds_read_b128 v[160:163], v10 offset:256
ds_read_b128 v[164:167], v10 offset:272
ds_read_b128 v[168:171], v10 offset:320
ds_read_b128 v[172:175], v10 offset:336
s_waitcnt vmcnt(0)
v_cmp_gt_u32 vcc, 1, v6
s_nop 0
s_cbranch_vccz Lgo_97
Lpoll_96:
s_sleep 1
buffer_load_dword v6, v5, s[36:39], 0 offen sc1
s_waitcnt vmcnt(0)
v_cmp_gt_u32 vcc, 1, v6
s_nop 0
s_cbranch_vccz Lgo_97
s_add_u32 s91, s91, 1
s_bitcmp0_b32 s91, 16
s_cbranch_scc1 Lpoll_96
Lgo_97:
s_cmp_lg_u32 s68, 0
s_cbranch_scc1 Lzld_98
buffer_load_dwordx4 v[16:19], v13, s[36:39], s79 offen offset:2048 sc1
s_add_u32 s79, s79, 9216
buffer_load_dwordx4 v[20:23], v13, s[36:39], s79 offen offset:2048 sc1
s_add_u32 s79, s79, 9216
buffer_load_dwordx4 v[24:27], v13, s[36:39], s79 offen offset:2048 sc1
s_add_u32 s79, s79, 9216
buffer_load_dwordx4 v[28:31], v13, s[36:39], s79 offen offset:2048 sc1
Lzld_98:
buffer_load_dwordx4 v[220:223], v12, s[36:39], s80 offen sc1
s_add_u32 s80, s80, 4608
buffer_load_dwordx4 v[224:227], v12, s[36:39], s80 offen sc1
s_add_u32 s80, s80, 4608
buffer_load_dwordx4 v[228:231], v12, s[36:39], s80 offen sc1
s_add_u32 s80, s80, 4608
buffer_load_dwordx4 v[232:235], v12, s[36:39], s80 offen sc1
s_waitcnt lgkmcnt(0)
v_pk_fma_f32 v[144:145], v[160:161], v[8:9], v[144:145] op_sel_hi:[1,0,1]
v_pk_fma_f32 v[146:147], v[162:163], v[8:9], v[146:147] op_sel_hi:[1,0,1]
v_pk_fma_f32 v[148:149], v[164:165], v[8:9], v[148:149] op_sel_hi:[1,0,1]
v_pk_fma_f32 v[150:151], v[166:167], v[8:9], v[150:151] op_sel_hi:[1,0,1]
v_pk_fma_f32 v[152:153], v[168:169], v[8:9], v[152:153] op_sel_hi:[1,0,1]
v_pk_fma_f32 v[154:155], v[170:171], v[8:9], v[154:155] op_sel_hi:[1,0,1]
v_pk_fma_f32 v[156:157], v[172:173], v[8:9], v[156:157] op_sel_hi:[1,0,1]
v_pk_fma_f32 v[158:159], v[174:175], v[8:9], v[158:159] op_sel_hi:[1,0,1]
v_pk_mul_f32 v[144:145], v[144:145], v[8:9] op_sel:[0,1] op_sel_hi:[1,1]
v_pk_mul_f32 v[146:147], v[146:147], v[8:9] op_sel:[0,1] op_sel_hi:[1,1]
s_add_u32 s80, s80, 4608
buffer_load_dwordx4 v[236:239], v12, s[36:39], s80 offen sc1
v_pk_mul_f32 v[148:149], v[148:149], v[8:9] op_sel:[0,1] op_sel_hi:[1,1]
v_pk_mul_f32 v[150:151], v[150:151], v[8:9] op_sel:[0,1] op_sel_hi:[1,1]
v_pk_mul_f32 v[152:153], v[152:153], v[8:9] op_sel:[0,1] op_sel_hi:[1,1]
v_pk_mul_f32 v[154:155], v[154:155], v[8:9] op_sel:[0,1] op_sel_hi:[1,1]
v_pk_mul_f32 v[156:157], v[156:157], v[8:9] op_sel:[0,1] op_sel_hi:[1,1]
v_pk_mul_f32 v[158:159], v[158:159], v[8:9] op_sel:[0,1] op_sel_hi:[1,1]
v_cvt_pk_bf16_f32 v176, v144, v145
v_cvt_pk_bf16_f32 v177, v146, v147
v_cvt_pk_bf16_f32 v178, v148, v149
v_cvt_pk_bf16_f32 v179, v150, v151
s_add_u32 s80, s80, 4608
buffer_load_dwordx4 v[240:243], v12, s[36:39], s80 offen sc1
v_cvt_pk_bf16_f32 v180, v152, v153
v_cvt_pk_bf16_f32 v181, v154, v155
v_cvt_pk_bf16_f32 v182, v156, v157
v_cvt_pk_bf16_f32 v183, v158, v159
v_mfma_f32_32x32x16_bf16 v[144:159], a[232:235], v[176:179], 0
s_add_u32 s80, s80, 4608
buffer_load_dwordx4 v[244:247], v12, s[36:39], s80 offen sc1
v_mfma_f32_32x32x16_bf16 v[200:215], a[236:239], v[180:183], 0
s_nop 8
v_max3_f32 v176, v144, v145, v146
v_max3_f32 v177, v147, v148, v149
s_add_u32 s80, s80, 4608
buffer_load_dwordx4 v[248:251], v12, s[36:39], s80 offen sc1
v_max3_f32 v176, v150, v151, v176
v_max_f32 v176, v176, v177
v_max3_f32 v178, v152, v153, v154
v_max3_f32 v179, v155, v156, v157
v_max3_f32 v178, v158, v159, v178
v_max_f32_e64 v178, v178, v179
v_max3_f32 v180, v200, v201, v202
v_max3_f32 v181, v203, v204, v205
v_max3_f32 v180, v206, v207, v180
v_max_f32_e64 v180, v180, v181
v_max3_f32 v182, v208, v209, v210
v_max3_f32 v183, v211, v212, v213
v_max3_f32 v182, v214, v215, v182
v_max_f32 v182, v182, v183
v_permlane32_swap_b32 v176, v178
s_nop 0
v_permlane32_swap_b32 v180, v182
s_add_u32 m0, s93, 98304
s_add_u32 s94, s97, 0
buffer_load_dwordx4 v14, s[48:51], s94 offen lds
v_max_f32 v176, v176, v178
v_max_f32 v180, v180, v182
v_mov_b32 v178, v176
v_mov_b32 v182, v180
s_nop 0
v_permlane32_swap_b32 v176, v178
v_permlane32_swap_b32 v180, v182
v_mul_f32 v176, 0xbfb8aa3b, v176
v_mul_f32 v178, 0xbfb8aa3b, v178
v_mul_f32 v180, 0xbfb8aa3b, v180
v_mul_f32 v182, 0xbfb8aa3b, v182
v_pk_fma_f32 v[144:145], v[144:145], s[84:85], v[176:177] op_sel_hi:[1,1,0]
v_pk_fma_f32 v[146:147], v[146:147], s[84:85], v[176:177] op_sel_hi:[1,1,0]
v_pk_fma_f32 v[148:149], v[148:149], s[84:85], v[176:177] op_sel_hi:[1,1,0]
v_pk_fma_f32 v[150:151], v[150:151], s[84:85], v[176:177] op_sel_hi:[1,1,0]
v_pk_fma_f32 v[152:153], v[152:153], s[84:85], v[178:179] op_sel_hi:[1,1,0]
v_pk_fma_f32 v[154:155], v[154:155], s[84:85], v[178:179] op_sel_hi:[1,1,0]
s_add_u32 m0, s93, 99328
s_add_u32 s94, s97, 8192
buffer_load_dwordx4 v14, s[48:51], s94 offen lds
v_pk_fma_f32 v[156:157], v[156:157], s[84:85], v[178:179] op_sel_hi:[1,1,0]
v_pk_fma_f32 v[158:159], v[158:159], s[84:85], v[178:179] op_sel_hi:[1,1,0]
v_pk_fma_f32 v[200:201], v[200:201], s[84:85], v[180:181] op_sel_hi:[1,1,0]
v_pk_fma_f32 v[202:203], v[202:203], s[84:85], v[180:181] op_sel_hi:[1,1,0]
v_pk_fma_f32 v[204:205], v[204:205], s[84:85], v[180:181] op_sel_hi:[1,1,0]
v_pk_fma_f32 v[206:207], v[206:207], s[84:85], v[180:181] op_sel_hi:[1,1,0]
v_pk_fma_f32 v[208:209], v[208:209], s[84:85], v[182:183] op_sel_hi:[1,1,0]
v_pk_fma_f32 v[210:211], v[210:211], s[84:85], v[182:183] op_sel_hi:[1,1,0]
v_pk_fma_f32 v[212:213], v[212:213], s[84:85], v[182:183] op_sel_hi:[1,1,0]
v_pk_fma_f32 v[214:215], v[214:215], s[84:85], v[182:183] op_sel_hi:[1,1,0]
v_exp_f32 v144, v144
v_exp_f32 v145, v145
v_exp_f32 v146, v146
v_exp_f32 v147, v147
v_exp_f32 v148, v148
v_exp_f32 v149, v149
v_exp_f32 v150, v150
v_exp_f32 v151, v151
s_add_u32 m0, s100, 67584
s_add_u32 s18, s99, 0
buffer_load_dwordx4 v1, s[36:39], s18 offen lds
v_exp_f32 v152, v152
v_exp_f32 v153, v153
v_exp_f32 v154, v154
v_exp_f32 v155, v155
v_exp_f32 v156, v156
v_exp_f32 v157, v157
v_exp_f32 v158, v158
v_exp_f32 v159, v159
v_exp_f32 v200, v200
v_exp_f32 v201, v201
v_exp_f32 v202, v202
v_exp_f32 v203, v203
v_exp_f32 v204, v204
s_add_u32 m0, s100, 67584
s_add_u32 s18, s99, 0
buffer_load_dwordx4 v1, s[36:39], s18 offen offset:1024 lds
v_exp_f32 v205, v205
v_exp_f32 v206, v206
v_exp_f32 v207, v207
v_exp_f32 v208, v208
v_exp_f32 v209, v209
v_exp_f32 v210, v210
v_exp_f32 v211, v211
v_exp_f32 v212, v212
v_exp_f32 v213, v213
v_exp_f32 v214, v214
v_exp_f32 v215, v215
v_pk_add_f32 v[176:177], v[144:145], v[146:147]
v_pk_add_f32 v[184:185], v[148:149], v[150:151]
v_pk_add_f32 v[176:177], v[176:177], v[184:185]
s_add_u32 m0, s100, 75776
s_add_u32 s18, s99, 8192
buffer_load_dwordx4 v1, s[36:39], s18 offen lds
v_add_f32_e64 v176, v176, v177
v_pk_add_f32 v[178:179], v[152:153], v[154:155]
v_pk_add_f32 v[184:185], v[156:157], v[158:159]
v_pk_add_f32 v[178:179], v[178:179], v[184:185]
v_add_f32_e64 v178, v178, v179
v_pk_add_f32 v[180:181], v[200:201], v[202:203]
v_pk_add_f32 v[184:185], v[204:205], v[206:207]
v_pk_add_f32 v[180:181], v[180:181], v[184:185]
v_add_f32_e64 v180, v180, v181
v_pk_add_f32 v[182:183], v[208:209], v[210:211]
v_pk_add_f32 v[184:185], v[212:213], v[214:215]
v_pk_add_f32 v[182:183], v[182:183], v[184:185]
v_add_f32 v182, v182, v183
v_permlane32_swap_b32 v176, v178
s_nop 0
v_permlane32_swap_b32 v180, v182
v_add_f32 v176, v176, v178
v_add_f32 v180, v180, v182
v_mov_b32 v178, v176
v_mov_b32 v182, v180
s_nop 0
v_permlane32_swap_b32 v176, v178
v_permlane32_swap_b32_e64 v180, v182
s_add_u32 m0, s100, 75776
s_add_u32 s18, s99, 8192
buffer_load_dwordx4 v1, s[36:39], s18 offen offset:1024 lds
v_rcp_f32 v176, v176
v_rcp_f32 v178, v178
v_rcp_f32 v180, v180
v_rcp_f32 v182, v182
v_pk_mul_f32 v[144:145], v[144:145], v[176:177] op_sel_hi:[1,0]
v_pk_mul_f32 v[146:147], v[146:147], v[176:177] op_sel_hi:[1,0]
v_pk_mul_f32 v[148:149], v[148:149], v[176:177] op_sel_hi:[1,0]
v_pk_mul_f32 v[150:151], v[150:151], v[176:177] op_sel_hi:[1,0]
v_pk_mul_f32 v[152:153], v[152:153], v[178:179] op_sel_hi:[1,0]
v_pk_mul_f32 v[154:155], v[154:155], v[178:179] op_sel_hi:[1,0]
v_pk_mul_f32 v[156:157], v[156:157], v[178:179] op_sel_hi:[1,0]
v_pk_mul_f32 v[158:159], v[158:159], v[178:179] op_sel_hi:[1,0]
v_pk_mul_f32 v[200:201], v[200:201], v[180:181] op_sel_hi:[1,0]
v_pk_mul_f32 v[202:203], v[202:203], v[180:181] op_sel_hi:[1,0]
v_pk_mul_f32 v[204:205], v[204:205], v[180:181] op_sel_hi:[1,0]
v_pk_mul_f32 v[206:207], v[206:207], v[180:181] op_sel_hi:[1,0]
v_pk_mul_f32 v[208:209], v[208:209], v[182:183] op_sel_hi:[1,0]
v_pk_mul_f32 v[210:211], v[210:211], v[182:183] op_sel_hi:[1,0]
v_pk_mul_f32 v[212:213], v[212:213], v[182:183] op_sel_hi:[1,0]
v_pk_mul_f32 v[214:215], v[214:215], v[182:183] op_sel_hi:[1,0]
v_cvt_pk_bf16_f32 v160, v144, v145
s_add_u32 m0, s100, 83968
s_add_u32 s18, s99, 16384
buffer_load_dwordx4 v1, s[36:39], s18 offen lds
v_cvt_pk_bf16_f32 v161, v146, v147
v_cvt_pk_bf16_f32 v162, v148, v149
v_cvt_pk_bf16_f32 v163, v150, v151
v_cvt_pk_bf16_f32 v164, v152, v153
v_cvt_pk_bf16_f32 v165, v154, v155
v_cvt_pk_bf16_f32 v166, v156, v157
v_cvt_pk_bf16_f32 v167, v158, v159
v_cvt_pk_bf16_f32 v168, v200, v201
v_cvt_pk_bf16_f32 v169, v202, v203
v_cvt_pk_bf16_f32 v170, v204, v205
v_cvt_pk_bf16_f32 v171, v206, v207
v_cvt_pk_bf16_f32 v172, v208, v209
v_cvt_pk_bf16_f32 v173, v210, v211
v_cvt_pk_bf16_f32 v174, v212, v213
v_cvt_pk_bf16_f32 v175, v214, v215
s_add_u32 m0, s100, 83968
s_add_u32 s18, s99, 16384
buffer_load_dwordx4 v1, s[36:39], s18 offen offset:1024 lds
s_cmp_lg_u32 s68, 0
s_cbranch_scc1 Lzsum_99
s_waitcnt vmcnt(16)
v_pk_add_f32 v[16:17], v[16:17], v[20:21]
v_pk_add_f32 v[24:25], v[24:25], v[28:29]
v_pk_add_f32 v[18:19], v[18:19], v[22:23]
v_pk_add_f32 v[26:27], v[26:27], v[30:31]
v_pk_add_f32 v[16:17], v[16:17], v[24:25]
v_pk_add_f32 v[18:19], v[18:19], v[26:27]
v_mov_b32 v20, v16
v_mov_b32 v21, v17
v_mov_b32 v22, v18
v_mov_b32 v23, v19
v_permlane16_swap_b32 v16, v20
v_permlane16_swap_b32 v17, v21
v_permlane16_swap_b32 v18, v22
v_permlane16_swap_b32 v19, v23
v_add_f32 v16, v16, v20
v_add_f32 v17, v17, v21
v_add_f32 v18, v18, v22
v_add_f32 v19, v19, v23
v_mov_b32 v20, v16
v_mov_b32 v21, v17
v_mov_b32 v22, v18
v_mov_b32 v23, v19
v_permlane32_swap_b32 v16, v20
v_permlane32_swap_b32 v17, v21
v_permlane32_swap_b32 v18, v22
v_permlane32_swap_b32 v19, v23
v_add_f32 v16, v16, v20
v_add_f32 v17, v17, v21
v_add_f32 v18, v18, v22
v_add_f32_e64 v19, v19, v23
v_cvt_pk_bf16_f32 v16, v16, v17
v_cvt_pk_bf16_f32 v17, v18, v19
ds_write_b64 v198, v[16:17]
Lzsum_99:
s_waitcnt vmcnt(15)
v_dot2c_f32_bf16 v188, s87, v220
v_dot2c_f32_bf16 v189, s88, v220
v_dot2c_f32_bf16 v190, s87, v221
v_dot2c_f32_bf16 v191, s88, v221
v_dot2c_f32_bf16 v192, s87, v222
v_dot2c_f32_bf16 v193, s88, v222
v_dot2c_f32_bf16 v194, s87, v223
v_dot2c_f32_bf16 v195, s88, v223
s_waitcnt vmcnt(14)
v_dot2c_f32_bf16 v188, s87, v224
v_dot2c_f32_bf16 v189, s88, v224
v_dot2c_f32_bf16 v190, s87, v225
v_dot2c_f32_bf16 v191, s88, v225
v_dot2c_f32_bf16 v192, s87, v226
v_dot2c_f32_bf16 v193, s88, v226
v_dot2c_f32_bf16 v194, s87, v227
v_dot2c_f32_bf16 v195, s88, v227
s_waitcnt vmcnt(13)
v_dot2c_f32_bf16 v188, s87, v228
v_dot2c_f32_bf16 v189, s88, v228
v_dot2c_f32_bf16 v190, s87, v229
v_dot2c_f32_bf16 v191, s88, v229
v_dot2c_f32_bf16 v192, s87, v230
v_dot2c_f32_bf16 v193, s88, v230
v_dot2c_f32_bf16 v194, s87, v231
v_dot2c_f32_bf16 v195, s88, v231
s_waitcnt vmcnt(12)
v_dot2c_f32_bf16 v188, s87, v232
v_dot2c_f32_bf16 v189, s88, v232
v_dot2c_f32_bf16 v190, s87, v233
v_dot2c_f32_bf16 v191, s88, v233
v_dot2c_f32_bf16 v192, s87, v234
v_dot2c_f32_bf16 v193, s88, v234
v_dot2c_f32_bf16 v194, s87, v235
v_dot2c_f32_bf16 v195, s88, v235
s_waitcnt vmcnt(11)
v_dot2c_f32_bf16 v188, s87, v236
v_dot2c_f32_bf16 v189, s88, v236
v_dot2c_f32_bf16 v190, s87, v237
v_dot2c_f32_bf16 v191, s88, v237
v_dot2c_f32_bf16 v192, s87, v238
v_dot2c_f32_bf16 v193, s88, v238
v_dot2c_f32_bf16 v194, s87, v239
v_dot2c_f32_bf16 v195, s88, v239
s_waitcnt vmcnt(10)
v_dot2c_f32_bf16 v188, s87, v240
v_dot2c_f32_bf16 v189, s88, v240
v_dot2c_f32_bf16 v190, s87, v241
v_dot2c_f32_bf16 v191, s88, v241
v_dot2c_f32_bf16 v192, s87, v242
v_dot2c_f32_bf16 v193, s88, v242
v_dot2c_f32_bf16 v194, s87, v243
v_dot2c_f32_bf16 v195, s88, v243
s_waitcnt vmcnt(9)
v_dot2c_f32_bf16 v188, s87, v244
v_dot2c_f32_bf16 v189, s88, v244
v_dot2c_f32_bf16 v190, s87, v245
v_dot2c_f32_bf16 v191, s88, v245
v_dot2c_f32_bf16 v192, s87, v246
v_dot2c_f32_bf16 v193, s88, v246
v_dot2c_f32_bf16 v194, s87, v247
v_dot2c_f32_bf16 v195, s88, v247
s_waitcnt vmcnt(8)
v_dot2c_f32_bf16 v188, s87, v248
v_dot2c_f32_bf16 v189, s88, v248
v_dot2c_f32_bf16 v190, s87, v249
v_dot2c_f32_bf16 v191, s88, v249
v_dot2c_f32_bf16 v192, s87, v250
v_dot2c_f32_bf16 v193, s88, v250
v_dot2c_f32_bf16 v194, s87, v251
v_dot2c_f32_bf16 v195, s88, v251
v_permlane32_swap_b32 v188, v192
v_permlane32_swap_b32 v189, v193
v_permlane32_swap_b32 v190, v194
v_permlane32_swap_b32 v191, v195
v_pk_add_f32 v[188:189], v[188:189], v[192:193]
v_pk_add_f32 v[190:191], v[190:191], v[194:195]
v_cvt_pk_bf16_f32 v188, v188, v189
v_cvt_pk_bf16_f32 v189, v190, v191
ds_write_b64 v196, v[188:189]
s_waitcnt vmcnt(6)
s_waitcnt lgkmcnt(0)
s_barrier
ds_read_b128 v[176:179], v197 offset:0
ds_read_b128 v[180:183], v197 offset:1024
ds_read_b128 v[184:187], v197 offset:2048
ds_read_b128 v[188:191], v197 offset:3072
s_waitcnt lgkmcnt(0)
v_mfma_f32_32x32x16_bf16 v[200:215], v[176:179], v[160:163], 0
v_mfma_f32_32x32x16_bf16 v[200:215], v[180:183], v[164:167], v[200:215]
v_mfma_f32_32x32x16_bf16 v[216:231], v[184:187], v[168:171], 0
v_mfma_f32_32x32x16_bf16 v[216:231], v[188:191], v[172:175], v[216:231]
s_nop 9
v_add_f32 v208, 0x358637bd, v208
v_rcp_f32_e64 v208, v208
s_nop 0
v_pk_mul_f32 v[200:201], v[200:201], v[208:209] op_sel_hi:[1,0]
v_pk_mul_f32 v[202:203], v[202:203], v[208:209] op_sel_hi:[1,0]
v_pk_mul_f32 v[204:205], v[204:205], v[208:209] op_sel_hi:[1,0]
v_pk_mul_f32 v[206:207], v[206:207], v[208:209] op_sel_hi:[1,0]
v_cvt_pk_bf16_f32 v212, v200, v201
v_cvt_pk_bf16_f32 v213, v202, v203
v_cvt_pk_bf16_f32 v214, v204, v205
v_cvt_pk_bf16_f32 v215, v206, v207
buffer_store_dwordx4 v[212:215], v1, s[36:39], s82 offen sc1
v_add_f32 v224, 0x358637bd, v224
v_rcp_f32 v224, v224
s_nop 0
v_pk_mul_f32 v[216:217], v[216:217], v[224:225] op_sel_hi:[1,0]
v_pk_mul_f32 v[218:219], v[218:219], v[224:225] op_sel_hi:[1,0]
v_pk_mul_f32 v[220:221], v[220:221], v[224:225] op_sel_hi:[1,0]
v_pk_mul_f32 v[222:223], v[222:223], v[224:225] op_sel_hi:[1,0]
v_cvt_pk_bf16_f32 v228, v216, v217
v_cvt_pk_bf16_f32 v229, v218, v219
v_cvt_pk_bf16_f32 v230, v220, v221
v_cvt_pk_bf16_f32 v231, v222, v223
buffer_store_dwordx4 v[228:231], v1, s[36:39], s82 offen offset:1024 sc1
s_lshl_b32 s77, s74, 15
s_add_u32 s77, s77, 100352
s_mul_i32 s78, s74, 4294934528
s_add_u32 s78, s78, 131072
v_add_u32 v7, s77, v2
v_add_u32_e64 v11, s77, v3
ds_read_b64_tr_b16 v[16:17], v7 offset:0
ds_read_b64_tr_b16 v[18:19], v7 offset:512
ds_read_b64_tr_b16 v[20:21], v11 offset:0
ds_read_b64_tr_b16 v[22:23], v11 offset:512
ds_read_b64_tr_b16 v[24:25], v7 offset:2048
ds_read_b64_tr_b16 v[26:27], v7 offset:2560
ds_read_b64_tr_b16 v[28:29], v11 offset:2048
ds_read_b64_tr_b16 v[30:31], v11 offset:2560
ds_read_b64_tr_b16 v[32:33], v7 offset:4096
ds_read_b64_tr_b16 v[34:35], v7 offset:4608
ds_read_b64_tr_b16 v[36:37], v11 offset:4096
ds_read_b64_tr_b16 v[38:39], v11 offset:4608
s_lshl_b32 s80, s69, 2
s_lshl_b32 s77, s73, 1
s_add_u32 s80, s80, s77
s_add_u32 s80, s80, s75
s_lshl_b32 s81, s80, 12
s_lshl_b32 s77, s72, 9
s_add_u32 s81, s81, s77
s_lshl_b32 s77, s74, 3
s_add_u32 s81, s81, s77
s_lshl_b32 s80, s80, 15
s_lshl_b32 s77, s72, 7
s_lshl_b32 s78, s74, 6
s_add_u32 s77, s77, s78
s_add_u32 s79, s80, s77
s_lshl_b32 s77, s77, 5
s_add_u32 s80, s80, s77
v_and_b32 v7, 31, v0
v_lshrrev_b32 v11, 5, v0
v_lshlrev_b32_e64 v14, 10, v7
v_lshl_add_u32 v14, v11, 4, v14
v_lshlrev_b32_e64 v7, 4, v7
v_lshl_add_u32 v5, v11, 2, v7
s_lshl_b32 s77, s73, 1
s_add_u32 s77, s77, s75
s_lshl_b32 s82, s69, 2
s_add_u32 s82, s82, s77
s_lshl_b32 s77, s82, 6
s_lshl_b32 s78, s74, 5
s_add_u32 s77, s77, s78
s_add_u32 s77, s77, 16384
v_and_b32 v252, 7, v0
v_lshl_add_u32 v252, v252, 2, s77
s_lshl_b32 s82, s82, 15
s_lshl_b32 s78, s74, 14
s_add_u32 s82, s82, s78
s_add_u32 s89, s82, 6291456
s_xor_b32 s77, s68, 2
s_lshl_b32 s77, s77, 12
s_add_u32 s77, s77, 141312
v_add_u32_e64 v12, s77, v1
s_lshl_b32 s77, s68, 12
s_add_u32 s77, s77, 141312
v_add_u32 v13, s77, v1
v_mov_b32 v7, 6
v_mov_b32_e64 v6, s83
s_waitcnt vmcnt(0)
s_mov_b64 exec, 1
buffer_store_dword v7, v6, s[36:39], 0 offen sc1
s_mov_b64 exec, -1
s_lshl_b32 s77, s74, 15
s_add_u32 s77, s77, 100352
s_mul_i32 s78, s74, 4294934528
s_add_u32 s78, s78, 131072
v_add_u32 v7, s77, v2
v_add_u32 v11, s77, v3
ds_read_b64_tr_b16 v[40:41], v7 offset:6144
ds_read_b64_tr_b16 v[42:43], v7 offset:6656
ds_read_b64_tr_b16 v[44:45], v11 offset:6144
ds_read_b64_tr_b16 v[46:47], v11 offset:6656
ds_read_b64_tr_b16 v[48:49], v7 offset:8192
ds_read_b64_tr_b16 v[50:51], v7 offset:8704
ds_read_b64_tr_b16 v[52:53], v11 offset:8192
ds_read_b64_tr_b16 v[54:55], v11 offset:8704
ds_read_b64_tr_b16 v[56:57], v7 offset:10240
ds_read_b64_tr_b16 v[58:59], v7 offset:10752
ds_read_b64_tr_b16 v[60:61], v11 offset:10240
ds_read_b64_tr_b16 v[62:63], v11 offset:10752
ds_read_b64_tr_b16 v[64:65], v7 offset:12288
ds_read_b64_tr_b16 v[66:67], v7 offset:12800
ds_read_b64_tr_b16 v[68:69], v11 offset:12288
ds_read_b64_tr_b16 v[70:71], v11 offset:12800
ds_read_b64_tr_b16 v[72:73], v7 offset:14336
ds_read_b64_tr_b16 v[74:75], v7 offset:14848
ds_read_b64_tr_b16 v[76:77], v11 offset:14336
ds_read_b64_tr_b16 v[78:79], v11 offset:14848
ds_read_b64_tr_b16 v[80:81], v7 offset:16384
ds_read_b64_tr_b16 v[82:83], v7 offset:16896
ds_read_b64_tr_b16 v[84:85], v11 offset:16384
ds_read_b64_tr_b16 v[86:87], v11 offset:16896
buffer_load_dword v6, v252, s[36:39], 0 offen sc1
s_lshl_b32 s77, s74, 15
s_add_u32 s77, s77, 100352
s_mul_i32 s78, s74, 4294934528
s_add_u32 s78, s78, 131072
v_add_u32 v7, s77, v2
v_add_u32_e64 v11, s77, v3
ds_read_b64_tr_b16 v[88:89], v7 offset:18432
ds_read_b64_tr_b16 v[90:91], v7 offset:18944
ds_read_b64_tr_b16 v[92:93], v11 offset:18432
ds_read_b64_tr_b16 v[94:95], v11 offset:18944
ds_read_b64_tr_b16 v[96:97], v7 offset:20480
ds_read_b64_tr_b16 v[98:99], v7 offset:20992
ds_read_b64_tr_b16 v[100:101], v11 offset:20480
ds_read_b64_tr_b16 v[102:103], v11 offset:20992
ds_read_b64_tr_b16 v[104:105], v7 offset:22528
ds_read_b64_tr_b16 v[106:107], v7 offset:23040
ds_read_b64_tr_b16 v[108:109], v11 offset:22528
ds_read_b64_tr_b16 v[110:111], v11 offset:23040
ds_read_b64_tr_b16 v[112:113], v7 offset:24576
ds_read_b64_tr_b16 v[114:115], v7 offset:25088
ds_read_b64_tr_b16 v[116:117], v11 offset:24576
ds_read_b64_tr_b16 v[118:119], v11 offset:25088
ds_read_b64_tr_b16 v[120:121], v7 offset:26624
ds_read_b64_tr_b16 v[122:123], v7 offset:27136
ds_read_b64_tr_b16 v[124:125], v11 offset:26624
ds_read_b64_tr_b16 v[126:127], v11 offset:27136
ds_read_b64_tr_b16 v[128:129], v7 offset:28672
ds_read_b64_tr_b16 v[130:131], v7 offset:29184
ds_read_b64_tr_b16 v[132:133], v11 offset:28672
ds_read_b64_tr_b16 v[134:135], v11 offset:29184
v_add_u32 v7, s78, v2
v_add_u32 v11, s78, v3
ds_read_b64_tr_b16 v[136:137], v7 offset:0
ds_read_b64_tr_b16 v[138:139], v7 offset:512
ds_read_b64_tr_b16 v[140:141], v11 offset:0
ds_read_b64_tr_b16 v[142:143], v11 offset:512
s_waitcnt vmcnt(0)
v_cmp_gt_u32 vcc, 6, v6
s_nop 0
s_cbranch_vccz Lgo_101
Lpoll_100:
buffer_load_dword v6, v252, s[36:39], 0 offen sc1
s_waitcnt vmcnt(0)
v_cmp_gt_u32 vcc, 6, v6
s_nop 0
s_cbranch_vccz Lgo_101
s_add_u32 s91, s91, 1
s_bitcmp0_b32 s91, 16
s_cbranch_scc1 Lpoll_100
Lgo_101:
buffer_load_dwordx4 v[144:147], v1, s[36:39], s89 offen sc1
buffer_load_dwordx4 v[148:151], v1, s[36:39], s89 offen offset:1024 sc1
buffer_load_dwordx4 v[152:155], v1, s[36:39], s89 offen offset:2048 sc1
buffer_load_dwordx4 v[156:159], v1, s[36:39], s89 offen offset:3072 sc1
s_add_u32 s89, s89, 4096
buffer_load_dwordx4 v[160:163], v1, s[36:39], s89 offen sc1
buffer_load_dwordx4 v[164:167], v1, s[36:39], s89 offen offset:1024 sc1
buffer_load_dwordx4 v[168:171], v1, s[36:39], s89 offen offset:2048 sc1
buffer_load_dwordx4 v[172:175], v1, s[36:39], s89 offen offset:3072 sc1
s_add_u32 s89, s89, 4096
buffer_load_dwordx4 v[176:179], v1, s[36:39], s89 offen sc1
buffer_load_dwordx4 v[180:183], v1, s[36:39], s89 offen offset:1024 sc1
buffer_load_dwordx4 v[184:187], v1, s[36:39], s89 offen offset:2048 sc1
buffer_load_dwordx4 v[188:191], v1, s[36:39], s89 offen offset:3072 sc1
s_waitcnt lgkmcnt(0)
s_barrier
s_waitcnt vmcnt(11)
v_mfma_f32_32x32x16_bf16 v[208:223], v[16:19], v[144:147], 0
v_mfma_f32_32x32x16_bf16 v[224:239], v[20:23], v[144:147], 0
s_add_u32 s89, s89, 4096
buffer_load_dwordx4 v[192:195], v1, s[36:39], s89 offen sc1
s_waitcnt vmcnt(11)
v_mfma_f32_32x32x16_bf16 v[208:223], v[24:27], v[148:151], v[208:223]
v_mfma_f32_32x32x16_bf16 v[224:239], v[28:31], v[148:151], v[224:239]
buffer_load_dwordx4 v[196:199], v1, s[36:39], s89 offen offset:1024 sc1
s_waitcnt vmcnt(11)
v_mfma_f32_32x32x16_bf16 v[208:223], v[32:35], v[152:155], v[208:223]
v_mfma_f32_32x32x16_bf16 v[224:239], v[36:39], v[152:155], v[224:239]
buffer_load_dwordx4 v[200:203], v1, s[36:39], s89 offen offset:2048 sc1
s_waitcnt vmcnt(11)
v_mfma_f32_32x32x16_bf16 v[208:223], v[40:43], v[156:159], v[208:223]
v_mfma_f32_32x32x16_bf16 v[224:239], v[44:47], v[156:159], v[224:239]
buffer_load_dwordx4 v[204:207], v1, s[36:39], s89 offen offset:3072 sc1
s_waitcnt vmcnt(11)
v_mfma_f32_32x32x16_bf16 v[208:223], v[48:51], v[160:163], v[208:223]
v_mfma_f32_32x32x16_bf16 v[224:239], v[52:55], v[160:163], v[224:239]
s_add_u32 s94, s80, 4194304
buffer_load_dwordx4 v[240:243], v1, s[36:39], s94 offen sc1
buffer_load_dwordx4 v[244:247], v1, s[36:39], s94 offen offset:1024 sc1
s_waitcnt vmcnt(12)
v_mfma_f32_32x32x16_bf16 v[208:223], v[56:59], v[164:167], v[208:223]
v_mfma_f32_32x32x16_bf16 v[224:239], v[60:63], v[164:167], v[224:239]
s_add_u32 m0, s100, 100352
s_add_u32 s18, s99, 24576
buffer_load_dwordx4 v1, s[36:39], s18 offen lds
s_waitcnt vmcnt(12)
v_mfma_f32_32x32x16_bf16 v[208:223], v[64:67], v[168:171], v[208:223]
v_mfma_f32_32x32x16_bf16 v[224:239], v[68:71], v[168:171], v[224:239]
s_add_u32 m0, s100, 100352
s_add_u32 s18, s99, 24576
buffer_load_dwordx4 v1, s[36:39], s18 offen offset:1024 lds
s_waitcnt vmcnt(12)
v_mfma_f32_32x32x16_bf16 v[208:223], v[72:75], v[172:175], v[208:223]
v_mfma_f32_32x32x16_bf16 v[224:239], v[76:79], v[172:175], v[224:239]
s_add_u32 m0, s100, 108544
s_add_u32 s18, s99, 32768
buffer_load_dwordx4 v1, s[36:39], s18 offen lds
s_waitcnt vmcnt(12)
v_mfma_f32_32x32x16_bf16 v[208:223], v[80:83], v[176:179], v[208:223]
v_mfma_f32_32x32x16_bf16 v[224:239], v[84:87], v[176:179], v[224:239]
s_add_u32 m0, s100, 108544
s_add_u32 s18, s99, 32768
buffer_load_dwordx4 v1, s[36:39], s18 offen offset:1024 lds
s_waitcnt vmcnt(12)
v_mfma_f32_32x32x16_bf16 v[208:223], v[88:91], v[180:183], v[208:223]
v_mfma_f32_32x32x16_bf16 v[224:239], v[92:95], v[180:183], v[224:239]
s_add_u32 m0, s100, 116736
s_add_u32 s18, s99, 40960
buffer_load_dwordx4 v1, s[36:39], s18 offen lds
s_waitcnt vmcnt(12)
v_mfma_f32_32x32x16_bf16 v[208:223], v[96:99], v[184:187], v[208:223]
v_mfma_f32_32x32x16_bf16 v[224:239], v[100:103], v[184:187], v[224:239]
s_add_u32 m0, s100, 116736
s_add_u32 s18, s99, 40960
buffer_load_dwordx4 v1, s[36:39], s18 offen offset:1024 lds
s_waitcnt vmcnt(12)
v_mfma_f32_32x32x16_bf16 v[208:223], v[104:107], v[188:191], v[208:223]
v_mfma_f32_32x32x16_bf16 v[224:239], v[108:111], v[188:191], v[224:239]
s_add_u32 m0, s100, 124928
s_add_u32 s18, s99, 49152
buffer_load_dwordx4 v1, s[36:39], s18 offen lds
s_waitcnt vmcnt(12)
v_mfma_f32_32x32x16_bf16 v[208:223], v[112:115], v[192:195], v[208:223]
v_mfma_f32_32x32x16_bf16 v[224:239], v[116:119], v[192:195], v[224:239]
s_add_u32 m0, s100, 124928
s_add_u32 s18, s99, 49152
buffer_load_dwordx4 v1, s[36:39], s18 offen offset:1024 lds
s_waitcnt vmcnt(12)
v_mfma_f32_32x32x16_bf16 v[208:223], v[120:123], v[196:199], v[208:223]
v_mfma_f32_32x32x16_bf16 v[224:239], v[124:127], v[196:199], v[224:239]
s_add_u32 m0, s100, 133120
s_add_u32 s18, s99, 57344
buffer_load_dwordx4 v1, s[36:39], s18 offen lds
s_waitcnt vmcnt(12)
v_mfma_f32_32x32x16_bf16 v[208:223], v[128:131], v[200:203], v[208:223]
v_mfma_f32_32x32x16_bf16 v[224:239], v[132:135], v[200:203], v[224:239]
s_add_u32 m0, s100, 133120
s_add_u32 s18, s99, 57344
buffer_load_dwordx4 v1, s[36:39], s18 offen offset:1024 lds
s_waitcnt vmcnt(12)
v_mfma_f32_32x32x16_bf16 v[208:223], v[136:139], v[204:207], v[208:223]
v_mfma_f32_32x32x16_bf16 v[224:239], v[140:143], v[204:207], v[224:239]
s_cmp_lg_u32 s74, 0
s_cbranch_scc1 Lkhi_102
s_nop 9
ds_write_b128 v12, v[224:227] offset:0
ds_write_b128 v12, v[228:231] offset:1024
ds_write_b128 v12, v[232:235] offset:2048
ds_write_b128 v12, v[236:239] offset:3072
s_branch Lkd_103
Lkhi_102:
s_nop 8
ds_write_b128 v12, v[208:211] offset:0
ds_write_b128 v12, v[212:215] offset:1024
ds_write_b128 v12, v[216:219] offset:2048
ds_write_b128 v12, v[220:223] offset:3072
v_pk_add_f32 v[208:209], v[224:225], 0
v_pk_add_f32 v[210:211], v[226:227], 0
v_pk_add_f32 v[212:213], v[228:229], 0
v_pk_add_f32 v[214:215], v[230:231], 0
v_pk_add_f32 v[216:217], v[232:233], 0
v_pk_add_f32 v[218:219], v[234:235], 0
v_pk_add_f32 v[220:221], v[236:237], 0
v_pk_add_f32 v[222:223], v[238:239], 0
Lkd_103:
s_waitcnt vmcnt(10)
v_dot2c_f32_bf16 v208, s87, v240
v_dot2c_f32_bf16 v209, s88, v240
v_dot2c_f32_bf16 v210, s87, v241
v_dot2c_f32_bf16 v211, s88, v241
v_dot2c_f32_bf16 v212, s87, v242
v_dot2c_f32_bf16 v213, s88, v242
v_dot2c_f32_bf16 v214, s87, v243
v_dot2c_f32_bf16 v215, s88, v243
v_dot2c_f32_bf16 v216, s87, v244
v_dot2c_f32_bf16 v217, s88, v244
v_dot2c_f32_bf16 v218, s87, v245
v_dot2c_f32_bf16 v219, s88, v245
v_dot2c_f32_bf16 v220, s87, v246
v_dot2c_f32_bf16 v221, s88, v246
v_dot2c_f32_bf16 v222, s87, v247
v_dot2c_f32_bf16 v223, s88, v247
s_waitcnt lgkmcnt(0)
s_barrier
ds_read_b128 v[224:227], v13 offset:0
ds_read_b128 v[228:231], v13 offset:1024
ds_read_b128 v[232:235], v13 offset:2048
ds_read_b128 v[236:239], v13 offset:3072
s_waitcnt lgkmcnt(0)
v_pk_add_f32 v[208:209], v[208:209], v[224:225]
v_pk_add_f32 v[210:211], v[210:211], v[226:227]
v_pk_add_f32 v[212:213], v[212:213], v[228:229]
v_pk_add_f32 v[214:215], v[214:215], v[230:231]
v_pk_add_f32 v[216:217], v[216:217], v[232:233]
v_pk_add_f32 v[218:219], v[218:219], v[234:235]
v_pk_add_f32 v[220:221], v[220:221], v[236:237]
v_pk_add_f32 v[222:223], v[222:223], v[238:239]
v_cvt_pk_bf16_f32 v240, v208, v209
v_cvt_pk_bf16_f32 v241, v210, v211
v_cvt_pk_bf16_f32 v242, v212, v213
v_cvt_pk_bf16_f32 v243, v214, v215
v_cvt_pk_bf16_f32 v244, v216, v217
v_cvt_pk_bf16_f32 v245, v218, v219
v_cvt_pk_bf16_f32 v246, v220, v221
v_cvt_pk_bf16_f32 v247, v222, v223
s_add_u32 s77, s80, 4194304
buffer_store_dwordx4 v[240:243], v1, s[36:39], s77 offen sc1
buffer_store_dwordx4 v[244:247], v1, s[36:39], s77 offen offset:1024 sc1
v_mov_b32 v208, 0
v_mov_b32 v209, 0
v_dot2c_f32_bf16 v208, s86, v240
v_dot2c_f32_bf16 v209, v240, v240
v_dot2c_f32_bf16 v208, s86, v241
v_dot2c_f32_bf16 v209, v241, v241
v_dot2c_f32_bf16 v208, s86, v242
v_dot2c_f32_bf16 v209, v242, v242
v_dot2c_f32_bf16 v208, s86, v243
v_dot2c_f32_bf16 v209, v243, v243
v_dot2c_f32_bf16 v208, s86, v244
v_dot2c_f32_bf16 v209, v244, v244
v_dot2c_f32_bf16 v208, s86, v245
v_dot2c_f32_bf16 v209, v245, v245
v_dot2c_f32_bf16 v208, s86, v246
v_dot2c_f32_bf16 v209, v246, v246
v_dot2c_f32_bf16 v208, s86, v247
v_dot2c_f32_bf16 v209, v247, v247
s_add_u32 s77, s81, 262144
s_nop 1
v_permlane32_swap_b32 v208, v209
v_add_f32_e64 v208, v208, v209
buffer_store_dword v208, v5, s[36:39], s77 offen sc1
s_lshl_b32 s97, s71, 12
s_add_u32 s97, s97, 262144
v_and_b32 v7, 31, v0
v_lshlrev_b32 v7, 4, v7
v_lshrrev_b32 v5, 5, v0
v_lshl_add_u32 v5, v5, 11, v7
s_lshl_b32 s89, s71, 15
s_add_u32 s89, s89, 4194304
v_lshrrev_b32 v7, 4, v0
v_and_b32 v14, 15, v0
v_lshlrev_b32 v14, 4, v14
v_lshl_add_u32 v14, v7, 9, v14
v_add_u32 v12, 67584, v1
v_add_u32 v13, 133120, v1
s_mul_i32 s90, s71, 114688
s_mul_i32 s77, s70, 7168
s_add_u32 s90, s90, s77
s_add_u32 s90, s90, 10485760
s_lshl_b32 s77, s69, 8
s_lshl_b32 s78, s75, 6
s_add_u32 s77, s77, s78
s_lshl_b32 s78, s74, 5
s_add_u32 s77, s77, s78
s_add_u32 s77, s77, 16384
v_and_b32_e64 v7, 7, v0
v_bfe_u32 v11, v0, 3, 1
v_lshlrev_b32_e64 v11, 7, v11
v_lshl_add_u32 v11, v7, 2, v11
v_add_u32 v11, s77, v11
v_mov_b32 v7, 7
v_mov_b32_e64 v6, s83
s_waitcnt vmcnt(0)
s_mov_b64 exec, 1
buffer_store_dword v7, v6, s[36:39], 0 offen sc1
s_mov_b64 exec, -1
s_barrier
ds_read_b128 a[240:243], v12 offset:0
ds_read_b128 a[244:247], v12 offset:1024
ds_read_b128 a[248:251], v12 offset:2048
ds_read_b128 a[252:255], v12 offset:3072
Lpoll_104:
buffer_load_dword v6, v11, s[36:39], 0 offen sc1
s_waitcnt vmcnt(0)
v_cmp_gt_u32 vcc, 7, v6
s_nop 0
s_cbranch_vccz Lgo_105
s_add_u32 s91, s91, 1
s_bitcmp0_b32 s91, 16
s_cbranch_scc1 Lpoll_104
Lgo_105:
buffer_load_dwordx4 v[16:19], v14, s[36:39], s89 offen sc1
buffer_load_dwordx4 v[20:23], v14, s[36:39], s89 offen offset:256 sc1
buffer_load_dwordx4 v[24:27], v14, s[36:39], s89 offen offset:2048 sc1
buffer_load_dwordx4 v[28:31], v14, s[36:39], s89 offen offset:2304 sc1
s_waitcnt vmcnt(2) lgkmcnt(3)
v_mfma_f32_16x16x32_bf16 v[144:147], a[240:243], v[16:19], 0
s_add_u32 s89, s89, 4096
buffer_load_dwordx4 v[32:35], v14, s[36:39], s89 offen sc1
v_mfma_f32_16x16x32_bf16 v[148:151], a[240:243], v[20:23], 0
ds_read_b128 a[240:243], v12 offset:4096
s_waitcnt lgkmcnt(3)
v_mfma_f32_16x16x32_bf16 v[152:155], a[244:247], v[16:19], 0
buffer_load_dwordx4 v[36:39], v14, s[36:39], s89 offen offset:256 sc1
v_mfma_f32_16x16x32_bf16 v[156:159], a[244:247], v[20:23], 0
ds_read_b128 a[244:247], v12 offset:5120
s_waitcnt lgkmcnt(3)
v_mfma_f32_16x16x32_bf16 v[160:163], a[248:251], v[16:19], 0
buffer_load_dwordx4 v[40:43], v14, s[36:39], s89 offen offset:2048 sc1
v_mfma_f32_16x16x32_bf16 v[164:167], a[248:251], v[20:23], 0
ds_read_b128 a[248:251], v12 offset:6144
s_waitcnt lgkmcnt(3)
v_mfma_f32_16x16x32_bf16 v[168:171], a[252:255], v[16:19], 0
buffer_load_dwordx4 v[44:47], v14, s[36:39], s89 offen offset:2304 sc1
v_mfma_f32_16x16x32_bf16 v[172:175], a[252:255], v[20:23], 0
ds_read_b128 a[252:255], v12 offset:7168
s_waitcnt lgkmcnt(3)
v_mfma_f32_16x16x32_bf16 v[176:179], a[240:243], v[16:19], 0
s_add_u32 s89, s89, 4096
buffer_load_dwordx4 v[48:51], v14, s[36:39], s89 offen sc1
v_mfma_f32_16x16x32_bf16 v[180:183], a[240:243], v[20:23], 0
ds_read_b128 a[240:243], v12 offset:8192
s_waitcnt lgkmcnt(3)
v_mfma_f32_16x16x32_bf16 v[184:187], a[244:247], v[16:19], 0
buffer_load_dwordx4 v[52:55], v14, s[36:39], s89 offen offset:256 sc1
v_mfma_f32_16x16x32_bf16 v[188:191], a[244:247], v[20:23], 0
ds_read_b128 a[244:247], v12 offset:9216
s_waitcnt lgkmcnt(3)
v_mfma_f32_16x16x32_bf16 v[192:195], a[248:251], v[16:19], 0
buffer_load_dwordx4 v[240:243], v5, s[36:39], s97 offen sc1
v_mfma_f32_16x16x32_bf16 v[196:199], a[248:251], v[20:23], 0
ds_read_b128 a[248:251], v12 offset:10240
s_waitcnt lgkmcnt(3)
v_mfma_f32_16x16x32_bf16 v[200:203], a[252:255], v[16:19], 0
v_mfma_f32_16x16x32_bf16 v[204:207], a[252:255], v[20:23], 0
ds_read_b128 a[252:255], v12 offset:11264
s_waitcnt lgkmcnt(3)
v_mfma_f32_16x16x32_bf16 v[208:211], a[240:243], v[16:19], 0
buffer_load_dwordx4 v[244:247], v5, s[36:39], s97 offen offset:512 sc1
v_mfma_f32_16x16x32_bf16 v[212:215], a[240:243], v[20:23], 0
ds_read_b128 a[240:243], v12 offset:12288
s_waitcnt lgkmcnt(3)
v_mfma_f32_16x16x32_bf16 v[216:219], a[244:247], v[16:19], 0
v_mfma_f32_16x16x32_bf16 v[220:223], a[244:247], v[20:23], 0
ds_read_b128 a[244:247], v12 offset:13312
s_waitcnt vmcnt(8) lgkmcnt(3)
v_mfma_f32_16x16x32_bf16 v[144:147], a[248:251], v[24:27], v[144:147]
buffer_load_dwordx4 v[248:251], v5, s[36:39], s97 offen offset:1024 sc1
v_mfma_f32_16x16x32_bf16 v[148:151], a[248:251], v[28:31], v[148:151]
ds_read_b128 a[248:251], v12 offset:14336
s_waitcnt lgkmcnt(3)
v_mfma_f32_16x16x32_bf16 v[152:155], a[252:255], v[24:27], v[152:155]
v_mfma_f32_16x16x32_bf16 v[156:159], a[252:255], v[28:31], v[156:159]
ds_read_b128 a[252:255], v12 offset:15360
s_waitcnt lgkmcnt(3)
v_mfma_f32_16x16x32_bf16 v[160:163], a[240:243], v[24:27], v[160:163]
buffer_load_dwordx4 v[252:255], v5, s[36:39], s97 offen offset:1536 sc1
v_mfma_f32_16x16x32_bf16 v[164:167], a[240:243], v[28:31], v[164:167]
s_barrier
ds_read_b128 a[240:243], v12 offset:16384
s_waitcnt lgkmcnt(3)
v_mfma_f32_16x16x32_bf16 v[168:171], a[244:247], v[24:27], v[168:171]
v_mfma_f32_16x16x32_bf16 v[172:175], a[244:247], v[28:31], v[172:175]
ds_read_b128 a[244:247], v12 offset:17408
s_waitcnt lgkmcnt(3)
v_mfma_f32_16x16x32_bf16 v[176:179], a[248:251], v[24:27], v[176:179]
buffer_load_dwordx4 v[56:59], v14, s[36:39], s89 offen offset:2048 sc1
v_mfma_f32_16x16x32_bf16 v[180:183], a[248:251], v[28:31], v[180:183]
ds_read_b128 a[248:251], v12 offset:18432
s_waitcnt lgkmcnt(3)
v_mfma_f32_16x16x32_bf16 v[184:187], a[252:255], v[24:27], v[184:187]
v_mfma_f32_16x16x32_bf16 v[188:191], a[252:255], v[28:31], v[188:191]
ds_read_b128 a[252:255], v12 offset:19456
s_waitcnt lgkmcnt(3)
v_mfma_f32_16x16x32_bf16 v[192:195], a[240:243], v[24:27], v[192:195]
buffer_load_dwordx4 v[60:63], v14, s[36:39], s89 offen offset:2304 sc1
v_mfma_f32_16x16x32_bf16 v[196:199], a[240:243], v[28:31], v[196:199]
ds_read_b128 a[240:243], v12 offset:20480
s_waitcnt lgkmcnt(3)
v_mfma_f32_16x16x32_bf16 v[200:203], a[244:247], v[24:27], v[200:203]
v_mfma_f32_16x16x32_bf16 v[204:207], a[244:247], v[28:31], v[204:207]
ds_read_b128 a[244:247], v12 offset:21504
s_waitcnt lgkmcnt(3)
v_mfma_f32_16x16x32_bf16 v[208:211], a[248:251], v[24:27], v[208:211]
s_add_u32 s89, s89, 4096
buffer_load_dwordx4 v[64:67], v14, s[36:39], s89 offen sc1
v_mfma_f32_16x16x32_bf16 v[212:215], a[248:251], v[28:31], v[212:215]
ds_read_b128 a[248:251], v12 offset:22528
s_waitcnt lgkmcnt(3)
v_mfma_f32_16x16x32_bf16 v[216:219], a[252:255], v[24:27], v[216:219]
v_mfma_f32_16x16x32_bf16 v[220:223], a[252:255], v[28:31], v[220:223]
ds_read_b128 a[252:255], v12 offset:23552
s_waitcnt vmcnt(11) lgkmcnt(3)
v_mfma_f32_16x16x32_bf16 v[144:147], a[240:243], v[32:35], v[144:147]
s_add_u32 m0, s100, 141312
s_add_u32 s18, s99, 65536
buffer_load_dwordx4 v1, s[36:39], s18 offen lds
v_mfma_f32_16x16x32_bf16 v[148:151], a[240:243], v[36:39], v[148:151]
ds_read_b128 a[240:243], v12 offset:32768
s_waitcnt lgkmcnt(3)
v_mfma_f32_16x16x32_bf16 v[152:155], a[244:247], v[32:35], v[152:155]
v_mfma_f32_16x16x32_bf16 v[156:159], a[244:247], v[36:39], v[156:159]
ds_read_b128 a[244:247], v12 offset:33792
s_waitcnt lgkmcnt(3)
v_mfma_f32_16x16x32_bf16 v[160:163], a[248:251], v[32:35], v[160:163]
buffer_load_dwordx4 v1, s[36:39], s18 offen offset:1024 lds
v_mfma_f32_16x16x32_bf16 v[164:167], a[248:251], v[36:39], v[164:167]
ds_read_b128 a[248:251], v12 offset:34816
s_waitcnt lgkmcnt(3)
v_mfma_f32_16x16x32_bf16 v[168:171], a[252:255], v[32:35], v[168:171]
v_mfma_f32_16x16x32_bf16 v[172:175], a[252:255], v[36:39], v[172:175]
ds_read_b128 a[252:255], v12 offset:35840
s_waitcnt lgkmcnt(3)
v_mfma_f32_16x16x32_bf16 v[176:179], a[240:243], v[32:35], v[176:179]
s_add_u32 m0, s100, 149504
s_add_u32 s18, s99, 73728
buffer_load_dwordx4 v1, s[36:39], s18 offen lds
v_mfma_f32_16x16x32_bf16 v[180:183], a[240:243], v[36:39], v[180:183]
ds_read_b128 a[240:243], v12 offset:36864
s_waitcnt lgkmcnt(3)
v_mfma_f32_16x16x32_bf16 v[184:187], a[244:247], v[32:35], v[184:187]
v_mfma_f32_16x16x32_bf16 v[188:191], a[244:247], v[36:39], v[188:191]
ds_read_b128 a[244:247], v12 offset:37888
s_waitcnt lgkmcnt(3)
v_mfma_f32_16x16x32_bf16 v[192:195], a[248:251], v[32:35], v[192:195]
buffer_load_dwordx4 v1, s[36:39], s18 offen offset:1024 lds
v_mfma_f32_16x16x32_bf16 v[196:199], a[248:251], v[36:39], v[196:199]
ds_read_b128 a[248:251], v12 offset:38912
s_waitcnt lgkmcnt(3)
v_mfma_f32_16x16x32_bf16 v[200:203], a[252:255], v[32:35], v[200:203]
v_mfma_f32_16x16x32_bf16 v[204:207], a[252:255], v[36:39], v[204:207]
ds_read_b128 a[252:255], v12 offset:39936
s_waitcnt lgkmcnt(3)
v_mfma_f32_16x16x32_bf16 v[208:211], a[240:243], v[32:35], v[208:211]
buffer_load_dwordx4 v[68:71], v14, s[36:39], s89 offen offset:256 sc1
v_mfma_f32_16x16x32_bf16 v[212:215], a[240:243], v[36:39], v[212:215]
s_barrier
ds_read_b128 a[240:243], v12 offset:40960
s_waitcnt lgkmcnt(3)
v_mfma_f32_16x16x32_bf16 v[216:219], a[244:247], v[32:35], v[216:219]
v_mfma_f32_16x16x32_bf16 v[220:223], a[244:247], v[36:39], v[220:223]
ds_read_b128 a[244:247], v12 offset:41984
s_waitcnt vmcnt(14) lgkmcnt(3)
v_mfma_f32_16x16x32_bf16 v[144:147], a[248:251], v[40:43], v[144:147]
buffer_load_dwordx4 v[72:75], v14, s[36:39], s89 offen offset:2048 sc1
s_waitcnt vmcnt(9)
v_add_f32 v240, v240, v248
v_mfma_f32_16x16x32_bf16 v[148:151], a[248:251], v[44:47], v[148:151]
ds_read_b128 a[248:251], v12 offset:43008
s_waitcnt lgkmcnt(3)
v_mfma_f32_16x16x32_bf16 v[152:155], a[252:255], v[40:43], v[152:155]
v_add_f32 v241, v241, v249
v_add_f32_e64 v242, v242, v250
v_mfma_f32_16x16x32_bf16 v[156:159], a[252:255], v[44:47], v[156:159]
ds_read_b128 a[252:255], v12 offset:44032
s_waitcnt lgkmcnt(3)
v_mfma_f32_16x16x32_bf16 v[160:163], a[240:243], v[40:43], v[160:163]
buffer_load_dwordx4 v[76:79], v14, s[36:39], s89 offen offset:2304 sc1
v_add_f32 v243, v243, v251
v_mfma_f32_16x16x32_bf16 v[164:167], a[240:243], v[44:47], v[164:167]
ds_read_b128 a[240:243], v12 offset:45056
s_waitcnt lgkmcnt(3)
v_mfma_f32_16x16x32_bf16 v[168:171], a[244:247], v[40:43], v[168:171]
v_add_f32 v244, v244, v252
v_add_f32_e64 v245, v245, v253
v_mfma_f32_16x16x32_bf16 v[172:175], a[244:247], v[44:47], v[172:175]
ds_read_b128 a[244:247], v12 offset:46080
s_waitcnt lgkmcnt(3)
v_mfma_f32_16x16x32_bf16 v[176:179], a[248:251], v[40:43], v[176:179]
s_add_u32 s89, s89, 4096
buffer_load_dwordx4 v[80:83], v14, s[36:39], s89 offen sc1
v_add_f32 v246, v246, v254
v_mfma_f32_16x16x32_bf16 v[180:183], a[248:251], v[44:47], v[180:183]
ds_read_b128 a[248:251], v12 offset:47104
s_waitcnt lgkmcnt(3)
v_mfma_f32_16x16x32_bf16 v[184:187], a[252:255], v[40:43], v[184:187]
v_add_f32 v247, v247, v255
v_add_f32_e64 v240, v240, v244
v_mfma_f32_16x16x32_bf16 v[188:191], a[252:255], v[44:47], v[188:191]
ds_read_b128 a[252:255], v12 offset:48128
s_waitcnt lgkmcnt(3)
v_mfma_f32_16x16x32_bf16 v[192:195], a[240:243], v[40:43], v[192:195]
s_add_u32 m0, s100, 92160
s_add_u32 s18, s99, 81920
buffer_load_dwordx4 v1, s[36:39], s18 offen lds
v_mfma_f32_16x16x32_bf16 v[196:199], a[240:243], v[44:47], v[196:199]
ds_read_b128 a[240:243], v12 offset:49152
s_waitcnt lgkmcnt(3)
v_mfma_f32_16x16x32_bf16 v[200:203], a[244:247], v[40:43], v[200:203]
v_add_f32 v241, v241, v245
v_add_f32 v242, v242, v246
v_mfma_f32_16x16x32_bf16 v[204:207], a[244:247], v[44:47], v[204:207]
ds_read_b128 a[244:247], v12 offset:50176
s_waitcnt lgkmcnt(3)
v_mfma_f32_16x16x32_bf16 v[208:211], a[248:251], v[40:43], v[208:211]
buffer_load_dwordx4 v1, s[36:39], s18 offen offset:1024 lds
v_add_f32 v243, v243, v247
v_mfma_f32_16x16x32_bf16 v[212:215], a[248:251], v[44:47], v[212:215]
ds_read_b128 a[248:251], v12 offset:51200
s_waitcnt lgkmcnt(3)
v_mfma_f32_16x16x32_bf16 v[216:219], a[252:255], v[40:43], v[216:219]
v_add_f32 v240, v240, v242
v_add_f32_e64 v241, v241, v243
v_mfma_f32_16x16x32_bf16 v[220:223], a[252:255], v[44:47], v[220:223]
ds_read_b128 a[252:255], v12 offset:52224
s_waitcnt lgkmcnt(3)
v_mfma_f32_16x16x32_bf16 v[144:147], a[240:243], v[48:51], v[144:147]
s_add_u32 m0, s100, 67584
s_add_u32 s18, s99, 90112
buffer_load_dwordx4 v1, s[36:39], s18 offen lds
v_mfma_f32_16x16x32_bf16 v[148:151], a[240:243], v[52:55], v[148:151]
ds_read_b128 a[240:243], v12 offset:53248
s_waitcnt lgkmcnt(3)
v_mfma_f32_16x16x32_bf16 v[152:155], a[244:247], v[48:51], v[152:155]
v_permlane32_swap_b32 v240, v241
v_add_f32 v240, v240, v241
v_mfma_f32_16x16x32_bf16 v[156:159], a[244:247], v[52:55], v[156:159]
ds_read_b128 a[244:247], v12 offset:54272
s_waitcnt lgkmcnt(3)
v_mfma_f32_16x16x32_bf16 v[160:163], a[248:251], v[48:51], v[160:163]
buffer_load_dwordx4 v1, s[36:39], s18 offen offset:1024 lds
v_mov_b32 v241, v240
v_mfma_f32_16x16x32_bf16 v[164:167], a[248:251], v[52:55], v[164:167]
ds_read_b128 a[248:251], v12 offset:55296
s_waitcnt lgkmcnt(3)
v_mfma_f32_16x16x32_bf16 v[168:171], a[252:255], v[48:51], v[168:171]
v_permlane32_swap_b32 v240, v241
v_mul_f32 v8, -0.001953125, v240
v_mfma_f32_16x16x32_bf16 v[172:175], a[252:255], v[52:55], v[172:175]
ds_read_b128 a[252:255], v12 offset:56320
s_waitcnt lgkmcnt(3)
v_mfma_f32_16x16x32_bf16 v[176:179], a[240:243], v[48:51], v[176:179]
buffer_load_dwordx4 v[84:87], v14, s[36:39], s89 offen offset:256 sc1
v_mul_f32 v241, 0.001953125, v241
v_mfma_f32_16x16x32_bf16 v[180:183], a[240:243], v[52:55], v[180:183]
s_barrier
ds_read_b128 a[240:243], v12 offset:57344
s_waitcnt lgkmcnt(3)
v_mfma_f32_16x16x32_bf16 v[184:187], a[244:247], v[48:51], v[184:187]
v_fma_f32 v241, -v8, v8, v241
v_max_f32 v241, 0, v241
v_mfma_f32_16x16x32_bf16 v[188:191], a[244:247], v[52:55], v[188:191]
ds_read_b128 a[244:247], v12 offset:58368
s_waitcnt lgkmcnt(3)
v_mfma_f32_16x16x32_bf16 v[192:195], a[248:251], v[48:51], v[192:195]
buffer_load_dwordx4 v[88:91], v14, s[36:39], s89 offen offset:2048 sc1
v_add_f32 v241, 0x3727c5ac, v241
v_mfma_f32_16x16x32_bf16 v[196:199], a[248:251], v[52:55], v[196:199]
ds_read_b128 a[248:251], v12 offset:59392
s_waitcnt lgkmcnt(3)
v_mfma_f32_16x16x32_bf16 v[200:203], a[252:255], v[48:51], v[200:203]
v_rsq_f32 v9, v241
s_nop 0
v_mul_f32_e64 v9, v9, v9
v_mfma_f32_16x16x32_bf16 v[204:207], a[252:255], v[52:55], v[204:207]
ds_read_b128 a[252:255], v12 offset:60416
s_waitcnt lgkmcnt(3)
v_mfma_f32_16x16x32_bf16 v[208:211], a[240:243], v[48:51], v[208:211]
buffer_load_dwordx4 v[92:95], v14, s[36:39], s89 offen offset:2304 sc1
v_mov_b32 v242, v8
v_mfma_f32_16x16x32_bf16 v[212:215], a[240:243], v[52:55], v[212:215]
ds_read_b128 a[240:243], v12 offset:61440
s_waitcnt lgkmcnt(3)
v_mfma_f32_16x16x32_bf16 v[216:219], a[244:247], v[48:51], v[216:219]
v_and_b32_e64 v241, 31, v0
s_lshl_b32 s77, s68, 7
s_add_u32 s77, s77, 66944
v_mfma_f32_16x16x32_bf16 v[220:223], a[244:247], v[52:55], v[220:223]
ds_read_b128 a[244:247], v12 offset:62464
s_waitcnt vmcnt(16) lgkmcnt(3)
v_mfma_f32_16x16x32_bf16 v[144:147], a[248:251], v[56:59], v[144:147]
s_add_u32 m0, s100, 75776
s_add_u32 s18, s99, 98304
buffer_load_dwordx4 v1, s[36:39], s18 offen lds
v_mfma_f32_16x16x32_bf16 v[148:151], a[248:251], v[60:63], v[148:151]
ds_read_b128 a[248:251], v12 offset:63488
s_waitcnt lgkmcnt(3)
v_mfma_f32_16x16x32_bf16 v[152:155], a[252:255], v[56:59], v[152:155]
v_lshl_add_u32 v241, v241, 2, s77
v_permlane16_swap_b32_e64 v8, v242
v_mfma_f32_16x16x32_bf16 v[156:159], a[252:255], v[60:63], v[156:159]
ds_read_b128 a[252:255], v12 offset:64512
s_waitcnt lgkmcnt(3)
v_mfma_f32_16x16x32_bf16 v[160:163], a[240:243], v[56:59], v[160:163]
buffer_load_dwordx4 v1, s[36:39], s18 offen offset:1024 lds
v_and_b32 v240, 48, v0
v_mfma_f32_16x16x32_bf16 v[164:167], a[240:243], v[60:63], v[164:167]
ds_read_b128 a[240:243], v13 offset:0
s_waitcnt lgkmcnt(3)
v_mfma_f32_16x16x32_bf16 v[168:171], a[244:247], v[56:59], v[168:171]
v_add_u32 v240, 66048, v240
ds_write_b32 v241, v9
v_mfma_f32_16x16x32_bf16 v[172:175], a[244:247], v[60:63], v[172:175]
ds_read_b128 a[244:247], v13 offset:1024
s_waitcnt lgkmcnt(4)
v_mfma_f32_16x16x32_bf16 v[176:179], a[248:251], v[56:59], v[176:179]
s_add_u32 m0, s100, 83968
s_add_u32 s18, s99, 106496
buffer_load_dwordx4 v1, s[36:39], s18 offen lds
v_mfma_f32_16x16x32_bf16 v[180:183], a[248:251], v[60:63], v[180:183]
ds_read_b128 a[248:251], v13 offset:2048
s_waitcnt lgkmcnt(4)
v_mfma_f32_16x16x32_bf16 v[184:187], a[252:255], v[56:59], v[184:187]
s_lshl_b32 s80, s69, 2
s_lshl_b32 s77, s73, 1
s_add_u32 s80, s80, s77
s_add_u32 s80, s80, s75
v_mfma_f32_16x16x32_bf16 v[188:191], a[252:255], v[60:63], v[188:191]
ds_read_b128 a[252:255], v13 offset:3072
s_waitcnt lgkmcnt(4)
v_mfma_f32_16x16x32_bf16 v[192:195], a[240:243], v[56:59], v[192:195]
buffer_load_dwordx4 v1, s[36:39], s18 offen offset:1024 lds
s_lshl_b32 s81, s80, 12
s_lshl_b32 s77, s72, 9
v_mfma_f32_16x16x32_bf16 v[196:199], a[240:243], v[60:63], v[196:199]
ds_read_b128 a[240:243], v13 offset:4096
s_waitcnt lgkmcnt(3)
v_mfma_f32_16x16x32_bf16 v[200:203], a[244:247], v[56:59], v[200:203]
s_add_u32 s81, s81, s77
s_lshl_b32 s77, s74, 3
s_add_u32 s81, s81, s77
s_lshl_b32 s80, s80, 15
v_mfma_f32_16x16x32_bf16 v[204:207], a[244:247], v[60:63], v[204:207]
ds_read_b128 a[244:247], v13 offset:5120
s_waitcnt lgkmcnt(3)
v_mfma_f32_16x16x32_bf16 v[208:211], a[248:251], v[56:59], v[208:211]
s_add_u32 s89, s89, 4096
buffer_load_dwordx4 v[96:99], v14, s[36:39], s89 offen sc1
s_lshl_b32 s77, s72, 7
v_mfma_f32_16x16x32_bf16 v[212:215], a[248:251], v[60:63], v[212:215]
ds_read_b128 a[248:251], v13 offset:6144
s_waitcnt lgkmcnt(3)
v_mfma_f32_16x16x32_bf16 v[216:219], a[252:255], v[56:59], v[216:219]
s_lshl_b32 s78, s74, 6
s_add_u32 s77, s77, s78
s_add_u32 s79, s80, s77
s_lshl_b32 s77, s77, 5
v_mfma_f32_16x16x32_bf16 v[220:223], a[252:255], v[60:63], v[220:223]
ds_read_b128 a[252:255], v13 offset:7168
s_waitcnt vmcnt(15) lgkmcnt(3)
v_mfma_f32_16x16x32_bf16 v[144:147], a[240:243], v[64:67], v[144:147]
buffer_load_dwordx4 v[100:103], v14, s[36:39], s89 offen offset:256 sc1
s_add_u32 s80, s80, s77
v_and_b32_e64 v7, 31, v0
v_mfma_f32_16x16x32_bf16 v[148:151], a[240:243], v[68:71], v[148:151]
s_barrier
ds_read_b128 a[240:243], v13 offset:8192
s_waitcnt lgkmcnt(3)
v_mfma_f32_16x16x32_bf16 v[152:155], a[244:247], v[64:67], v[152:155]
v_lshrrev_b32 v11, 5, v0
v_lshlrev_b32 v7, 4, v7
v_mfma_f32_16x16x32_bf16 v[156:159], a[244:247], v[68:71], v[156:159]
ds_read_b128 a[244:247], v13 offset:9216
s_waitcnt lgkmcnt(3)
v_mfma_f32_16x16x32_bf16 v[160:163], a[248:251], v[64:67], v[160:163]
buffer_load_dwordx4 v[104:107], v14, s[36:39], s89 offen offset:2048 sc1
v_lshl_add_u32 v5, v11, 2, v7
v_mfma_f32_16x16x32_bf16 v[164:167], a[248:251], v[68:71], v[164:167]
ds_read_b128 a[248:251], v13 offset:10240
s_waitcnt lgkmcnt(3)
v_mfma_f32_16x16x32_bf16 v[168:171], a[252:255], v[64:67], v[168:171]
s_lshl_b32 s77, s69, 8
s_lshl_b32 s78, s73, 7
s_add_u32 s77, s77, s78
s_lshl_b32 s78, s68, 4
v_mfma_f32_16x16x32_bf16 v[172:175], a[252:255], v[68:71], v[172:175]
ds_read_b128 a[252:255], v13 offset:11264
s_waitcnt lgkmcnt(3)
v_mfma_f32_16x16x32_bf16 v[176:179], a[240:243], v[64:67], v[176:179]
s_add_u32 m0, s100, 100352
s_add_u32 s18, s99, 114688
buffer_load_dwordx4 v1, s[36:39], s18 offen lds
v_mfma_f32_16x16x32_bf16 v[180:183], a[240:243], v[68:71], v[180:183]
ds_read_b128 a[240:243], v13 offset:12288
s_waitcnt lgkmcnt(3)
v_mfma_f32_16x16x32_bf16 v[184:187], a[244:247], v[64:67], v[184:187]
s_add_u32 s77, s77, s78
s_add_u32 s77, s77, 16384
v_and_b32 v7, 3, v0
v_mfma_f32_16x16x32_bf16 v[188:191], a[244:247], v[68:71], v[188:191]
ds_read_b128 a[244:247], v13 offset:13312
s_waitcnt lgkmcnt(3)
v_mfma_f32_16x16x32_bf16 v[192:195], a[248:251], v[64:67], v[192:195]
buffer_load_dwordx4 v1, s[36:39], s18 offen offset:1024 lds
v_bfe_u32 v11, v0, 2, 1
v_mfma_f32_16x16x32_bf16 v[196:199], a[248:251], v[68:71], v[196:199]
ds_read_b128 a[248:251], v13 offset:14336
s_waitcnt lgkmcnt(3)
v_mfma_f32_16x16x32_bf16 v[200:203], a[252:255], v[64:67], v[200:203]
v_lshlrev_b32_e64 v11, 6, v11
v_lshl_add_u32 v11, v7, 2, v11
v_mfma_f32_16x16x32_bf16 v[204:207], a[252:255], v[68:71], v[204:207]
ds_read_b128 a[252:255], v13 offset:15360
s_waitcnt lgkmcnt(3)
v_mfma_f32_16x16x32_bf16 v[208:211], a[240:243], v[64:67], v[208:211]
s_add_u32 m0, s100, 108544
s_add_u32 s18, s99, 122880
buffer_load_dwordx4 v1, s[36:39], s18 offen lds
v_mfma_f32_16x16x32_bf16 v[212:215], a[240:243], v[68:71], v[212:215]
ds_read_b128 a[240:243], v13 offset:16384
s_waitcnt lgkmcnt(3)
v_mfma_f32_16x16x32_bf16 v[216:219], a[244:247], v[64:67], v[216:219]
v_add_u32_e64 v11, s77, v11
s_lshl_b32 s77, s69, 2
s_lshl_b32 s78, s73, 1
v_mfma_f32_16x16x32_bf16 v[220:223], a[244:247], v[68:71], v[220:223]
ds_read_b128 a[244:247], v13 offset:17408
s_waitcnt vmcnt(18) lgkmcnt(3)
v_mfma_f32_16x16x32_bf16 v[144:147], a[248:251], v[72:75], v[144:147]
buffer_load_dwordx4 v1, s[36:39], s18 offen offset:1024 lds
s_add_u32 s77, s77, s78
s_mul_i32 s92, s77, 114688
v_mfma_f32_16x16x32_bf16 v[148:151], a[248:251], v[76:79], v[148:151]
ds_read_b128 a[248:251], v13 offset:18432
s_waitcnt lgkmcnt(3)
v_mfma_f32_16x16x32_bf16 v[152:155], a[252:255], v[72:75], v[152:155]
s_mul_i32 s78, s68, 28672
s_add_u32 s92, s92, s78
s_add_u32 s92, s92, 10485760
s_add_u32 s93, s92, 114688
v_mfma_f32_16x16x32_bf16 v[156:159], a[252:255], v[76:79], v[156:159]
ds_read_b128 a[252:255], v13 offset:19456
s_waitcnt lgkmcnt(3)
v_mfma_f32_16x16x32_bf16 v[160:163], a[240:243], v[72:75], v[160:163]
buffer_load_dwordx4 v[108:111], v14, s[36:39], s89 offen offset:2304 sc1
v_mfma_f32_16x16x32_bf16 v[164:167], a[240:243], v[76:79], v[164:167]
ds_read_b128 a[240:243], v13 offset:20480
s_waitcnt lgkmcnt(3)
v_mfma_f32_16x16x32_bf16 v[168:171], a[244:247], v[72:75], v[168:171]
v_mfma_f32_16x16x32_bf16 v[172:175], a[244:247], v[76:79], v[172:175]
ds_read_b128 a[244:247], v13 offset:21504
s_waitcnt lgkmcnt(3)
v_mfma_f32_16x16x32_bf16 v[176:179], a[248:251], v[72:75], v[176:179]
s_add_u32 s89, s89, 4096
buffer_load_dwordx4 v[112:115], v14, s[36:39], s89 offen sc1
v_mfma_f32_16x16x32_bf16 v[180:183], a[248:251], v[76:79], v[180:183]
ds_read_b128 a[248:251], v13 offset:22528
s_waitcnt lgkmcnt(3)
v_mfma_f32_16x16x32_bf16 v[184:187], a[252:255], v[72:75], v[184:187]
v_mfma_f32_16x16x32_bf16 v[188:191], a[252:255], v[76:79], v[188:191]
ds_read_b128 a[252:255], v13 offset:23552
s_waitcnt lgkmcnt(3)
v_mfma_f32_16x16x32_bf16 v[192:195], a[240:243], v[72:75], v[192:195]
buffer_load_dwordx4 v[116:119], v14, s[36:39], s89 offen offset:256 sc1
v_mfma_f32_16x16x32_bf16 v[196:199], a[240:243], v[76:79], v[196:199]
s_waitcnt vmcnt(17)
s_barrier
ds_read_b128 a[240:243], v12 offset:24576
s_waitcnt lgkmcnt(3)
v_mfma_f32_16x16x32_bf16 v[200:203], a[244:247], v[72:75], v[200:203]
v_mfma_f32_16x16x32_bf16 v[204:207], a[244:247], v[76:79], v[204:207]
ds_read_b128 a[244:247], v12 offset:25600
s_waitcnt lgkmcnt(3)
v_mfma_f32_16x16x32_bf16 v[208:211], a[248:251], v[72:75], v[208:211]
s_add_u32 m0, s100, 116736
s_add_u32 s18, s99, 131072
buffer_load_dwordx4 v1, s[36:39], s18 offen lds
v_mfma_f32_16x16x32_bf16 v[212:215], a[248:251], v[76:79], v[212:215]
ds_read_b128 a[248:251], v12 offset:26624
s_waitcnt lgkmcnt(3)
v_mfma_f32_16x16x32_bf16 v[216:219], a[252:255], v[72:75], v[216:219]
v_mfma_f32_16x16x32_bf16 v[220:223], a[252:255], v[76:79], v[220:223]
ds_read_b128 a[252:255], v12 offset:27648
s_waitcnt vmcnt(17) lgkmcnt(3)
v_mfma_f32_16x16x32_bf16 v[144:147], a[240:243], v[80:83], v[144:147]
buffer_load_dwordx4 v1, s[36:39], s18 offen offset:1024 lds
v_mfma_f32_16x16x32_bf16 v[148:151], a[240:243], v[84:87], v[148:151]
ds_read_b128 a[240:243], v12 offset:28672
s_waitcnt lgkmcnt(3)
v_mfma_f32_16x16x32_bf16 v[152:155], a[244:247], v[80:83], v[152:155]
v_mfma_f32_16x16x32_bf16 v[156:159], a[244:247], v[84:87], v[156:159]
ds_read_b128 a[244:247], v12 offset:29696
s_waitcnt lgkmcnt(3)
v_mfma_f32_16x16x32_bf16 v[160:163], a[248:251], v[80:83], v[160:163]
s_add_u32 m0, s100, 124928
s_add_u32 s18, s99, 139264
buffer_load_dwordx4 v1, s[36:39], s18 offen lds
v_mfma_f32_16x16x32_bf16 v[164:167], a[248:251], v[84:87], v[164:167]
ds_read_b128 a[248:251], v12 offset:30720
s_waitcnt lgkmcnt(3)
v_mfma_f32_16x16x32_bf16 v[168:171], a[252:255], v[80:83], v[168:171]
v_mfma_f32_16x16x32_bf16 v[172:175], a[252:255], v[84:87], v[172:175]
ds_read_b128 a[252:255], v12 offset:31744
s_waitcnt lgkmcnt(3)
v_mfma_f32_16x16x32_bf16 v[176:179], a[240:243], v[80:83], v[176:179]
buffer_load_dwordx4 v1, s[36:39], s18 offen offset:1024 lds
v_mfma_f32_16x16x32_bf16 v[180:183], a[240:243], v[84:87], v[180:183]
ds_read_b128 a[240:243], v12 offset:0
s_waitcnt lgkmcnt(3)
v_mfma_f32_16x16x32_bf16 v[184:187], a[244:247], v[80:83], v[184:187]
v_mfma_f32_16x16x32_bf16 v[188:191], a[244:247], v[84:87], v[188:191]
ds_read_b128 a[244:247], v12 offset:1024
s_waitcnt lgkmcnt(3)
v_mfma_f32_16x16x32_bf16 v[192:195], a[248:251], v[80:83], v[192:195]
buffer_load_dwordx4 v[120:123], v14, s[36:39], s89 offen offset:2048 sc1
v_mfma_f32_16x16x32_bf16 v[196:199], a[248:251], v[84:87], v[196:199]
ds_read_b128 a[248:251], v12 offset:2048
s_waitcnt lgkmcnt(3)
v_mfma_f32_16x16x32_bf16 v[200:203], a[252:255], v[80:83], v[200:203]
v_mfma_f32_16x16x32_bf16 v[204:207], a[252:255], v[84:87], v[204:207]
ds_read_b128 a[252:255], v12 offset:3072
s_waitcnt lgkmcnt(3)
v_mfma_f32_16x16x32_bf16 v[208:211], a[240:243], v[80:83], v[208:211]
buffer_load_dwordx4 v[124:127], v14, s[36:39], s89 offen offset:2304 sc1
v_mfma_f32_16x16x32_bf16 v[212:215], a[240:243], v[84:87], v[212:215]
ds_read_b128 a[240:243], v12 offset:4096
s_waitcnt lgkmcnt(3)
v_mfma_f32_16x16x32_bf16 v[216:219], a[244:247], v[80:83], v[216:219]
v_mfma_f32_16x16x32_bf16 v[220:223], a[244:247], v[84:87], v[220:223]
ds_read_b128 a[244:247], v12 offset:5120
s_waitcnt vmcnt(20) lgkmcnt(3)
v_mfma_f32_16x16x32_bf16 v[144:147], a[248:251], v[88:91], v[144:147]
s_add_u32 s89, s89, 4096
buffer_load_dwordx4 v[128:131], v14, s[36:39], s89 offen sc1
ds_read_b128 v[244:247], v240 offset:640
ds_read_b128 v[248:251], v240 offset:704
v_mfma_f32_16x16x32_bf16 v[148:151], a[248:251], v[92:95], v[148:151]
ds_read_b128 a[248:251], v12 offset:6144
s_waitcnt lgkmcnt(5)
v_mfma_f32_16x16x32_bf16 v[152:155], a[252:255], v[88:91], v[152:155]
v_mfma_f32_16x16x32_bf16 v[156:159], a[252:255], v[92:95], v[156:159]
ds_read_b128 a[252:255], v12 offset:7168
s_waitcnt lgkmcnt(5)
v_mfma_f32_16x16x32_bf16 v[160:163], a[240:243], v[88:91], v[160:163]
s_add_u32 m0, s100, 133120
s_add_u32 s18, s99, 147456
buffer_load_dwordx4 v1, s[36:39], s18 offen lds
s_waitcnt lgkmcnt(2)
v_mul_f32_e64 v224, v8, v244
v_mfma_f32_16x16x32_bf16 v[164:167], a[240:243], v[92:95], v[164:167]
s_waitcnt vmcnt(18)
s_barrier
ds_read_b128 a[240:243], v12 offset:8192
v_mfma_f32_16x16x32_bf16 v[168:171], a[244:247], v[88:91], v[168:171]
v_mul_f32 v225, v8, v245
v_mul_f32 v226, v8, v246
v_mfma_f32_16x16x32_bf16 v[172:175], a[244:247], v[92:95], v[172:175]
ds_read_b128 a[244:247], v12 offset:9216
s_waitcnt lgkmcnt(3)
v_mfma_f32_16x16x32_bf16 v[176:179], a[248:251], v[88:91], v[176:179]
buffer_load_dwordx4 v1, s[36:39], s18 offen offset:1024 lds
v_mul_f32 v227, v8, v247
v_mul_f32_e64 v228, v242, v244
v_mfma_f32_16x16x32_bf16 v[180:183], a[248:251], v[92:95], v[180:183]
ds_read_b128 a[248:251], v12 offset:10240
s_waitcnt lgkmcnt(3)
v_mfma_f32_16x16x32_bf16 v[184:187], a[252:255], v[88:91], v[184:187]
v_mul_f32 v229, v242, v245
v_mul_f32_e64 v230, v242, v246
v_mfma_f32_16x16x32_bf16 v[188:191], a[252:255], v[92:95], v[188:191]
ds_read_b128 a[252:255], v12 offset:11264
s_waitcnt lgkmcnt(3)
v_mfma_f32_16x16x32_bf16 v[192:195], a[240:243], v[88:91], v[192:195]
s_add_u32 m0, s100, 141312
s_add_u32 s18, s99, 155648
buffer_load_dwordx4 v1, s[36:39], s18 offen lds
v_mul_f32 v231, v242, v247
v_mfma_f32_16x16x32_bf16 v[196:199], a[240:243], v[92:95], v[196:199]
ds_read_b128 a[240:243], v12 offset:12288
s_waitcnt lgkmcnt(3)
v_mfma_f32_16x16x32_bf16 v[200:203], a[244:247], v[88:91], v[200:203]
v_mul_f32 v232, v8, v248
v_mul_f32_e64 v233, v8, v249
v_mfma_f32_16x16x32_bf16 v[204:207], a[244:247], v[92:95], v[204:207]
ds_read_b128 a[244:247], v12 offset:13312
s_waitcnt lgkmcnt(3)
v_mfma_f32_16x16x32_bf16 v[208:211], a[248:251], v[88:91], v[208:211]
buffer_load_dwordx4 v1, s[36:39], s18 offen offset:1024 lds
v_mul_f32 v234, v8, v250
v_mul_f32_e64 v235, v8, v251
v_mfma_f32_16x16x32_bf16 v[212:215], a[248:251], v[92:95], v[212:215]
ds_read_b128 a[248:251], v12 offset:14336
s_waitcnt lgkmcnt(3)
v_mfma_f32_16x16x32_bf16 v[216:219], a[252:255], v[88:91], v[216:219]
v_mul_f32 v236, v242, v248
v_mul_f32_e64 v237, v242, v249
v_mfma_f32_16x16x32_bf16 v[220:223], a[252:255], v[92:95], v[220:223]
ds_read_b128 a[252:255], v12 offset:15360
s_waitcnt vmcnt(19) lgkmcnt(3)
v_mfma_f32_16x16x32_bf16 v[144:147], a[240:243], v[96:99], v[144:147]
buffer_load_dwordx4 v[132:135], v14, s[36:39], s89 offen offset:256 sc1
v_mul_f32 v238, v242, v250
v_mul_f32_e64 v239, v242, v251
v_mfma_f32_16x16x32_bf16 v[148:151], a[240:243], v[100:103], v[148:151]
ds_read_b128 a[240:243], v12 offset:16384
s_waitcnt lgkmcnt(3)
v_mfma_f32_16x16x32_bf16 v[152:155], a[244:247], v[96:99], v[152:155]
ds_read_b128 v[244:247], v240 offset:0
ds_read_b128 v[248:251], v240 offset:64
v_mfma_f32_16x16x32_bf16 v[156:159], a[244:247], v[100:103], v[156:159]
ds_read_b128 a[244:247], v12 offset:17408
s_waitcnt lgkmcnt(5)
v_mfma_f32_16x16x32_bf16 v[160:163], a[248:251], v[96:99], v[160:163]
buffer_load_dwordx4 v[136:139], v14, s[36:39], s89 offen offset:2048 sc1
s_waitcnt lgkmcnt(1)
v_fmac_f32 v144, v8, v244
v_fmac_f32_e64 v145, v8, v245
v_mfma_f32_16x16x32_bf16 v[164:167], a[248:251], v[100:103], v[164:167]
ds_read_b128 a[248:251], v12 offset:18432
v_mfma_f32_16x16x32_bf16 v[168:171], a[252:255], v[96:99], v[168:171]
v_fmac_f32 v146, v8, v246
v_fmac_f32 v147, v8, v247
v_mfma_f32_16x16x32_bf16 v[172:175], a[252:255], v[100:103], v[172:175]
ds_read_b128 a[252:255], v12 offset:19456
v_mfma_f32_16x16x32_bf16 v[176:179], a[240:243], v[96:99], v[176:179]
buffer_load_dwordx4 v[140:143], v14, s[36:39], s89 offen offset:2304 sc1
v_fmac_f32 v148, v242, v244
v_fmac_f32 v149, v242, v245
v_mfma_f32_16x16x32_bf16 v[180:183], a[240:243], v[100:103], v[180:183]
ds_read_b128 a[240:243], v12 offset:20480
s_waitcnt lgkmcnt(3)
v_mfma_f32_16x16x32_bf16 v[184:187], a[244:247], v[96:99], v[184:187]
v_fmac_f32 v150, v242, v246
v_fmac_f32_e64 v151, v242, v247
v_mfma_f32_16x16x32_bf16 v[188:191], a[244:247], v[100:103], v[188:191]
ds_read_b128 a[244:247], v12 offset:21504
s_waitcnt lgkmcnt(3)
v_mfma_f32_16x16x32_bf16 v[192:195], a[248:251], v[96:99], v[192:195]
s_add_u32 m0, s100, 149504
s_add_u32 s18, s99, 163840
buffer_load_dwordx4 v1, s[36:39], s18 offen lds
v_fmac_f32 v152, v8, v248
v_mfma_f32_16x16x32_bf16 v[196:199], a[248:251], v[100:103], v[196:199]
ds_read_b128 a[248:251], v12 offset:22528
s_waitcnt lgkmcnt(3)
v_mfma_f32_16x16x32_bf16 v[200:203], a[252:255], v[96:99], v[200:203]
v_fmac_f32 v153, v8, v249
v_fmac_f32_e64 v154, v8, v250
v_mfma_f32_16x16x32_bf16 v[204:207], a[252:255], v[100:103], v[204:207]
ds_read_b128 a[252:255], v12 offset:23552
s_waitcnt lgkmcnt(3)
v_mfma_f32_16x16x32_bf16 v[208:211], a[240:243], v[96:99], v[208:211]
buffer_load_dwordx4 v1, s[36:39], s18 offen offset:1024 lds
v_fmac_f32 v155, v8, v251
v_fmac_f32_e64 v156, v242, v248
v_mfma_f32_16x16x32_bf16 v[212:215], a[240:243], v[100:103], v[212:215]
s_waitcnt vmcnt(19)
s_barrier
ds_read_b128 a[240:243], v12 offset:32768
s_waitcnt lgkmcnt(3)
v_mfma_f32_16x16x32_bf16 v[216:219], a[244:247], v[96:99], v[216:219]
v_fmac_f32 v157, v242, v249
v_fmac_f32_e64 v158, v242, v250
v_mfma_f32_16x16x32_bf16 v[220:223], a[244:247], v[100:103], v[220:223]
ds_read_b128 a[244:247], v12 offset:33792
s_waitcnt vmcnt(18) lgkmcnt(3)
v_mfma_f32_16x16x32_bf16 v[144:147], a[248:251], v[104:107], v[144:147]
s_add_u32 m0, s100, 92160
s_add_u32 s18, s99, 172032
buffer_load_dwordx4 v1, s[36:39], s18 offen lds
v_fmac_f32 v159, v242, v251
v_mfma_f32_16x16x32_bf16 v[148:151], a[248:251], v[108:111], v[148:151]
ds_read_b128 a[248:251], v12 offset:34816
s_waitcnt lgkmcnt(3)
v_mfma_f32_16x16x32_bf16 v[152:155], a[252:255], v[104:107], v[152:155]
ds_read_b128 v[244:247], v240 offset:128
ds_read_b128 v[248:251], v240 offset:192
v_mfma_f32_16x16x32_bf16 v[156:159], a[252:255], v[108:111], v[156:159]
ds_read_b128 a[252:255], v12 offset:35840
s_waitcnt lgkmcnt(5)
v_mfma_f32_16x16x32_bf16 v[160:163], a[240:243], v[104:107], v[160:163]
buffer_load_dwordx4 v1, s[36:39], s18 offen offset:1024 lds
v_mfma_f32_16x16x32_bf16 v[164:167], a[240:243], v[108:111], v[164:167]
ds_read_b128 a[240:243], v12 offset:36864
s_waitcnt lgkmcnt(5)
v_mfma_f32_16x16x32_bf16 v[168:171], a[244:247], v[104:107], v[168:171]
v_mfma_f32_16x16x32_bf16 v[172:175], a[244:247], v[108:111], v[172:175]
ds_read_b128 a[244:247], v12 offset:37888
s_waitcnt lgkmcnt(5)
v_mfma_f32_16x16x32_bf16 v[176:179], a[248:251], v[104:107], v[176:179]
s_add_u32 m0, s100, 67584
s_add_u32 s18, s99, 180224
buffer_load_dwordx4 v1, s[36:39], s18 offen lds
s_waitcnt lgkmcnt(3)
v_fmac_f32 v160, v8, v244
v_mfma_f32_16x16x32_bf16 v[180:183], a[248:251], v[108:111], v[180:183]
ds_read_b128 a[248:251], v12 offset:38912
s_waitcnt lgkmcnt(3)
v_mfma_f32_16x16x32_bf16 v[184:187], a[252:255], v[104:107], v[184:187]
v_fmac_f32 v161, v8, v245
v_fmac_f32_e64 v162, v8, v246
v_mfma_f32_16x16x32_bf16 v[188:191], a[252:255], v[108:111], v[188:191]
ds_read_b128 a[252:255], v12 offset:39936
s_waitcnt lgkmcnt(3)
v_mfma_f32_16x16x32_bf16 v[192:195], a[240:243], v[104:107], v[192:195]
buffer_load_dwordx4 v1, s[36:39], s18 offen offset:1024 lds
v_fmac_f32 v163, v8, v247
v_fmac_f32_e64 v164, v242, v244
v_mfma_f32_16x16x32_bf16 v[196:199], a[240:243], v[108:111], v[196:199]
ds_read_b128 a[240:243], v12 offset:40960
s_waitcnt lgkmcnt(3)
v_mfma_f32_16x16x32_bf16 v[200:203], a[244:247], v[104:107], v[200:203]
v_fmac_f32 v165, v242, v245
v_fmac_f32_e64 v166, v242, v246
v_mfma_f32_16x16x32_bf16 v[204:207], a[244:247], v[108:111], v[204:207]
ds_read_b128 a[244:247], v12 offset:41984
s_waitcnt lgkmcnt(3)
v_mfma_f32_16x16x32_bf16 v[208:211], a[248:251], v[104:107], v[208:211]
s_add_u32 m0, s100, 75776
s_add_u32 s18, s99, 188416
buffer_load_dwordx4 v1, s[36:39], s18 offen lds
v_fmac_f32 v167, v242, v247
v_mfma_f32_16x16x32_bf16 v[212:215], a[248:251], v[108:111], v[212:215]
ds_read_b128 a[248:251], v12 offset:43008
s_waitcnt lgkmcnt(3)
v_mfma_f32_16x16x32_bf16 v[216:219], a[252:255], v[104:107], v[216:219]
v_fmac_f32 v168, v8, v248
v_fmac_f32_e64 v169, v8, v249
v_mfma_f32_16x16x32_bf16 v[220:223], a[252:255], v[108:111], v[220:223]
ds_read_b128 a[252:255], v12 offset:44032
s_waitcnt vmcnt(21) lgkmcnt(3)
v_mfma_f32_16x16x32_bf16 v[144:147], a[240:243], v[112:115], v[144:147]
buffer_load_dwordx4 v1, s[36:39], s18 offen offset:1024 lds
v_fmac_f32 v170, v8, v250
v_fmac_f32_e64 v171, v8, v251
v_mfma_f32_16x16x32_bf16 v[148:151], a[240:243], v[116:119], v[148:151]
ds_read_b128 a[240:243], v12 offset:45056
s_waitcnt lgkmcnt(3)
v_mfma_f32_16x16x32_bf16 v[152:155], a[244:247], v[112:115], v[152:155]
v_fmac_f32 v172, v242, v248
v_fmac_f32_e64 v173, v242, v249
v_mfma_f32_16x16x32_bf16 v[156:159], a[244:247], v[116:119], v[156:159]
ds_read_b128 a[244:247], v12 offset:46080
s_waitcnt lgkmcnt(3)
v_mfma_f32_16x16x32_bf16 v[160:163], a[248:251], v[112:115], v[160:163]
v_fmac_f32 v174, v242, v250
v_fmac_f32_e64 v175, v242, v251
v_mfma_f32_16x16x32_bf16 v[164:167], a[248:251], v[116:119], v[164:167]
ds_read_b128 a[248:251], v12 offset:47104
s_waitcnt lgkmcnt(3)
v_mfma_f32_16x16x32_bf16 v[168:171], a[252:255], v[112:115], v[168:171]
ds_read_b128 v[244:247], v240 offset:256
ds_read_b128 v[248:251], v240 offset:320
v_mfma_f32_16x16x32_bf16 v[172:175], a[252:255], v[116:119], v[172:175]
ds_read_b128 a[252:255], v12 offset:48128
s_waitcnt lgkmcnt(5)
v_mfma_f32_16x16x32_bf16 v[176:179], a[240:243], v[112:115], v[176:179]
v_mfma_f32_16x16x32_bf16 v[180:183], a[240:243], v[116:119], v[180:183]
s_waitcnt vmcnt(18)
s_barrier
ds_read_b128 a[240:243], v12 offset:49152
s_waitcnt lgkmcnt(5)
v_mfma_f32_16x16x32_bf16 v[184:187], a[244:247], v[112:115], v[184:187]
v_mfma_f32_16x16x32_bf16 v[188:191], a[244:247], v[116:119], v[188:191]
ds_read_b128 a[244:247], v12 offset:50176
s_waitcnt lgkmcnt(5)
v_mfma_f32_16x16x32_bf16 v[192:195], a[248:251], v[112:115], v[192:195]
s_add_u32 m0, s100, 83968
s_add_u32 s18, s99, 196608
buffer_load_dwordx4 v1, s[36:39], s18 offen lds
s_waitcnt lgkmcnt(3)
v_fmac_f32 v176, v8, v244
v_mfma_f32_16x16x32_bf16 v[196:199], a[248:251], v[116:119], v[196:199]
ds_read_b128 a[248:251], v12 offset:51200
s_waitcnt lgkmcnt(3)
v_mfma_f32_16x16x32_bf16 v[200:203], a[252:255], v[112:115], v[200:203]
v_fmac_f32 v177, v8, v245
v_fmac_f32_e64 v178, v8, v246
v_mfma_f32_16x16x32_bf16 v[204:207], a[252:255], v[116:119], v[204:207]
ds_read_b128 a[252:255], v12 offset:52224
s_waitcnt lgkmcnt(3)
v_mfma_f32_16x16x32_bf16 v[208:211], a[240:243], v[112:115], v[208:211]
buffer_load_dwordx4 v1, s[36:39], s18 offen offset:1024 lds
v_fmac_f32 v179, v8, v247
v_fmac_f32_e64 v180, v242, v244
v_mfma_f32_16x16x32_bf16 v[212:215], a[240:243], v[116:119], v[212:215]
ds_read_b128 a[240:243], v12 offset:53248
s_waitcnt lgkmcnt(3)
v_mfma_f32_16x16x32_bf16 v[216:219], a[244:247], v[112:115], v[216:219]
v_fmac_f32 v181, v242, v245
v_fmac_f32_e64 v182, v242, v246
v_mfma_f32_16x16x32_bf16 v[220:223], a[244:247], v[116:119], v[220:223]
ds_read_b128 a[244:247], v12 offset:54272
s_waitcnt vmcnt(18) lgkmcnt(3)
v_mfma_f32_16x16x32_bf16 v[144:147], a[248:251], v[120:123], v[144:147]
s_add_u32 m0, s100, 100352
s_add_u32 s18, s99, 204800
buffer_load_dwordx4 v1, s[36:39], s18 offen lds
v_fmac_f32 v183, v242, v247
v_mfma_f32_16x16x32_bf16 v[148:151], a[248:251], v[124:127], v[148:151]
ds_read_b128 a[248:251], v12 offset:55296
s_waitcnt lgkmcnt(3)
v_mfma_f32_16x16x32_bf16 v[152:155], a[252:255], v[120:123], v[152:155]
v_fmac_f32 v184, v8, v248
v_fmac_f32_e64 v185, v8, v249
v_mfma_f32_16x16x32_bf16 v[156:159], a[252:255], v[124:127], v[156:159]
ds_read_b128 a[252:255], v12 offset:56320
s_waitcnt lgkmcnt(3)
v_mfma_f32_16x16x32_bf16 v[160:163], a[240:243], v[120:123], v[160:163]
buffer_load_dwordx4 v1, s[36:39], s18 offen offset:1024 lds
v_fmac_f32 v186, v8, v250
v_fmac_f32_e64 v187, v8, v251
v_mfma_f32_16x16x32_bf16 v[164:167], a[240:243], v[124:127], v[164:167]
ds_read_b128 a[240:243], v12 offset:57344
s_waitcnt lgkmcnt(3)
v_mfma_f32_16x16x32_bf16 v[168:171], a[244:247], v[120:123], v[168:171]
v_fmac_f32 v188, v242, v248
v_fmac_f32_e64 v189, v242, v249
v_mfma_f32_16x16x32_bf16 v[172:175], a[244:247], v[124:127], v[172:175]
ds_read_b128 a[244:247], v12 offset:58368
s_waitcnt lgkmcnt(3)
v_mfma_f32_16x16x32_bf16 v[176:179], a[248:251], v[120:123], v[176:179]
v_fmac_f32 v190, v242, v250
v_fmac_f32_e64 v191, v242, v251
v_mfma_f32_16x16x32_bf16 v[180:183], a[248:251], v[124:127], v[180:183]
ds_read_b128 a[248:251], v12 offset:59392
s_waitcnt lgkmcnt(3)
v_mfma_f32_16x16x32_bf16 v[184:187], a[252:255], v[120:123], v[184:187]
ds_read_b128 v[244:247], v240 offset:384
ds_read_b128 v[248:251], v240 offset:448
v_mfma_f32_16x16x32_bf16 v[188:191], a[252:255], v[124:127], v[188:191]
ds_read_b128 a[252:255], v12 offset:60416
s_waitcnt lgkmcnt(5)
v_mfma_f32_16x16x32_bf16 v[192:195], a[240:243], v[120:123], v[192:195]
v_mfma_f32_16x16x32_bf16 v[196:199], a[240:243], v[124:127], v[196:199]
ds_read_b128 a[240:243], v12 offset:61440
s_waitcnt lgkmcnt(5)
v_mfma_f32_16x16x32_bf16 v[200:203], a[244:247], v[120:123], v[200:203]
v_mfma_f32_16x16x32_bf16 v[204:207], a[244:247], v[124:127], v[204:207]
ds_read_b128 a[244:247], v12 offset:62464
s_waitcnt lgkmcnt(5)
v_mfma_f32_16x16x32_bf16 v[208:211], a[248:251], v[120:123], v[208:211]
s_waitcnt lgkmcnt(3)
v_fmac_f32 v192, v8, v244
v_fmac_f32_e64 v193, v8, v245
v_mfma_f32_16x16x32_bf16 v[212:215], a[248:251], v[124:127], v[212:215]
ds_read_b128 a[248:251], v12 offset:63488
s_waitcnt lgkmcnt(3)
v_mfma_f32_16x16x32_bf16 v[216:219], a[252:255], v[120:123], v[216:219]
v_fmac_f32 v194, v8, v246
v_fmac_f32_e64 v195, v8, v247
v_mfma_f32_16x16x32_bf16 v[220:223], a[252:255], v[124:127], v[220:223]
ds_read_b128 a[252:255], v12 offset:64512
s_waitcnt vmcnt(14) lgkmcnt(3)
v_mfma_f32_16x16x32_bf16 v[144:147], a[240:243], v[128:131], v[144:147]
v_fmac_f32 v196, v242, v244
v_fmac_f32_e64 v197, v242, v245
v_mfma_f32_16x16x32_bf16 v[148:151], a[240:243], v[132:135], v[148:151]
s_barrier
ds_read_b128 a[240:243], v13 offset:0
s_waitcnt lgkmcnt(3)
v_mfma_f32_16x16x32_bf16 v[152:155], a[244:247], v[128:131], v[152:155]
v_fmac_f32 v198, v242, v246
v_fmac_f32 v199, v242, v247
v_mfma_f32_16x16x32_bf16 v[156:159], a[244:247], v[132:135], v[156:159]
ds_read_b128 a[244:247], v13 offset:1024
s_waitcnt lgkmcnt(3)
v_mfma_f32_16x16x32_bf16 v[160:163], a[248:251], v[128:131], v[160:163]
s_add_u32 m0, s100, 108544
s_add_u32 s18, s99, 212992
buffer_load_dwordx4 v1, s[36:39], s18 offen lds
v_fmac_f32 v200, v8, v248
v_mfma_f32_16x16x32_bf16 v[164:167], a[248:251], v[132:135], v[164:167]
ds_read_b128 a[248:251], v13 offset:2048
s_waitcnt lgkmcnt(3)
v_mfma_f32_16x16x32_bf16 v[168:171], a[252:255], v[128:131], v[168:171]
v_fmac_f32 v201, v8, v249
v_fmac_f32_e64 v202, v8, v250
v_mfma_f32_16x16x32_bf16 v[172:175], a[252:255], v[132:135], v[172:175]
ds_read_b128 a[252:255], v13 offset:3072
s_waitcnt lgkmcnt(3)
v_mfma_f32_16x16x32_bf16 v[176:179], a[240:243], v[128:131], v[176:179]
buffer_load_dwordx4 v1, s[36:39], s18 offen offset:1024 lds
v_fmac_f32 v203, v8, v251
v_fmac_f32_e64 v204, v242, v248
v_mfma_f32_16x16x32_bf16 v[180:183], a[240:243], v[132:135], v[180:183]
ds_read_b128 a[240:243], v13 offset:4096
s_waitcnt lgkmcnt(3)
v_mfma_f32_16x16x32_bf16 v[184:187], a[244:247], v[128:131], v[184:187]
v_fmac_f32 v205, v242, v249
v_fmac_f32_e64 v206, v242, v250
v_mfma_f32_16x16x32_bf16 v[188:191], a[244:247], v[132:135], v[188:191]
ds_read_b128 a[244:247], v13 offset:5120
s_waitcnt lgkmcnt(3)
v_mfma_f32_16x16x32_bf16 v[192:195], a[248:251], v[128:131], v[192:195]
s_add_u32 m0, s100, 116736
s_add_u32 s18, s99, 221184
buffer_load_dwordx4 v1, s[36:39], s18 offen lds
v_fmac_f32 v207, v242, v251
v_mfma_f32_16x16x32_bf16 v[196:199], a[248:251], v[132:135], v[196:199]
ds_read_b128 a[248:251], v13 offset:6144
s_waitcnt lgkmcnt(3)
v_mfma_f32_16x16x32_bf16 v[200:203], a[252:255], v[128:131], v[200:203]
ds_read_b128 v[244:247], v240 offset:512
ds_read_b128 v[248:251], v240 offset:576
v_mfma_f32_16x16x32_bf16 v[204:207], a[252:255], v[132:135], v[204:207]
ds_read_b128 a[252:255], v13 offset:7168
s_waitcnt lgkmcnt(5)
v_mfma_f32_16x16x32_bf16 v[208:211], a[240:243], v[128:131], v[208:211]
buffer_load_dwordx4 v1, s[36:39], s18 offen offset:1024 lds
v_mfma_f32_16x16x32_bf16 v[212:215], a[240:243], v[132:135], v[212:215]
ds_read_b128 a[240:243], v13 offset:8192
s_waitcnt lgkmcnt(5)
v_mfma_f32_16x16x32_bf16 v[216:219], a[244:247], v[128:131], v[216:219]
v_mfma_f32_16x16x32_bf16 v[220:223], a[244:247], v[132:135], v[220:223]
ds_read_b128 a[244:247], v13 offset:9216
s_waitcnt vmcnt(16) lgkmcnt(5)
v_mfma_f32_16x16x32_bf16 v[144:147], a[248:251], v[136:139], v[144:147]
s_waitcnt lgkmcnt(3)
v_fmac_f32 v208, v8, v244
v_fmac_f32_e64 v209, v8, v245
v_mfma_f32_16x16x32_bf16 v[148:151], a[248:251], v[140:143], v[148:151]
ds_read_b128 a[248:251], v13 offset:10240
s_waitcnt lgkmcnt(3)
v_mfma_f32_16x16x32_bf16 v[152:155], a[252:255], v[136:139], v[152:155]
v_fmac_f32 v210, v8, v246
v_fmac_f32_e64 v211, v8, v247
v_mfma_f32_16x16x32_bf16 v[156:159], a[252:255], v[140:143], v[156:159]
ds_read_b128 a[252:255], v13 offset:11264
s_waitcnt lgkmcnt(3)
v_mfma_f32_16x16x32_bf16 v[160:163], a[240:243], v[136:139], v[160:163]
v_fmac_f32 v212, v242, v244
v_fmac_f32_e64 v213, v242, v245
v_mfma_f32_16x16x32_bf16 v[164:167], a[240:243], v[140:143], v[164:167]
ds_read_b128 a[240:243], v13 offset:12288
s_waitcnt lgkmcnt(3)
v_mfma_f32_16x16x32_bf16 v[168:171], a[244:247], v[136:139], v[168:171]
v_fmac_f32 v214, v242, v246
v_fmac_f32_e64 v215, v242, v247
v_mfma_f32_16x16x32_bf16 v[172:175], a[244:247], v[140:143], v[172:175]
ds_read_b128 a[244:247], v13 offset:13312
s_waitcnt lgkmcnt(3)
v_mfma_f32_16x16x32_bf16 v[176:179], a[248:251], v[136:139], v[176:179]
v_fmac_f32 v216, v8, v248
v_fmac_f32_e64 v217, v8, v249
v_mfma_f32_16x16x32_bf16 v[180:183], a[248:251], v[140:143], v[180:183]
ds_read_b128 a[248:251], v13 offset:14336
s_waitcnt lgkmcnt(3)
v_mfma_f32_16x16x32_bf16 v[184:187], a[252:255], v[136:139], v[184:187]
v_fmac_f32 v218, v8, v250
v_fmac_f32_e64 v219, v8, v251
v_mfma_f32_16x16x32_bf16 v[188:191], a[252:255], v[140:143], v[188:191]
ds_read_b128 a[252:255], v13 offset:15360
s_waitcnt lgkmcnt(3)
v_mfma_f32_16x16x32_bf16 v[192:195], a[240:243], v[136:139], v[192:195]
v_fmac_f32 v220, v242, v248
v_fmac_f32_e64 v221, v242, v249
v_mfma_f32_16x16x32_bf16 v[196:199], a[240:243], v[140:143], v[196:199]
s_waitcnt vmcnt(12)
s_barrier
ds_read_b128 a[240:243], v13 offset:16384
s_waitcnt lgkmcnt(3)
v_mfma_f32_16x16x32_bf16 v[200:203], a[244:247], v[136:139], v[200:203]
v_fmac_f32 v222, v242, v250
v_fmac_f32_e64 v223, v242, v251
v_mfma_f32_16x16x32_bf16 v[204:207], a[244:247], v[140:143], v[204:207]
ds_read_b128 a[244:247], v13 offset:17408
s_waitcnt lgkmcnt(3)
v_mfma_f32_16x16x32_bf16 v[208:211], a[248:251], v[136:139], v[208:211]
ds_read_b128 v[244:247], v240 offset:768
ds_read_b128 v[248:251], v240 offset:832
v_mfma_f32_16x16x32_bf16 v[212:215], a[248:251], v[140:143], v[212:215]
ds_read_b128 a[248:251], v13 offset:18432
s_waitcnt lgkmcnt(5)
v_mfma_f32_16x16x32_bf16 v[216:219], a[252:255], v[136:139], v[216:219]
v_mfma_f32_16x16x32_bf16 v[220:223], a[252:255], v[140:143], v[220:223]
ds_read_b128 a[252:255], v13 offset:19456
s_waitcnt lgkmcnt(5)
v_mfma_f32_16x16x32_bf16 v[224:227], a[240:243], v[16:19], v[224:227]
v_mfma_f32_16x16x32_bf16 v[228:231], a[240:243], v[20:23], v[228:231]
ds_read_b128 a[240:243], v13 offset:20480
s_waitcnt lgkmcnt(5)
v_mfma_f32_16x16x32_bf16 v[232:235], a[244:247], v[16:19], v[232:235]
v_mul_f32 v144, v144, v152
v_mul_f32 v145, v145, v153
v_mfma_f32_16x16x32_bf16 v[236:239], a[244:247], v[20:23], v[236:239]
ds_read_b128 a[244:247], v13 offset:21504
s_waitcnt lgkmcnt(3)
v_mfma_f32_16x16x32_bf16 v[224:227], a[248:251], v[24:27], v[224:227]
v_mul_f32 v146, v146, v154
v_mul_f32_e64 v147, v147, v155
v_mfma_f32_16x16x32_bf16 v[228:231], a[248:251], v[28:31], v[228:231]
ds_read_b128 a[248:251], v13 offset:22528
s_waitcnt lgkmcnt(3)
v_mfma_f32_16x16x32_bf16 v[232:235], a[252:255], v[24:27], v[232:235]
v_mul_f32 v148, v148, v156
v_mul_f32_e64 v149, v149, v157
v_mfma_f32_16x16x32_bf16 v[236:239], a[252:255], v[28:31], v[236:239]
ds_read_b128 a[252:255], v13 offset:23552
s_waitcnt lgkmcnt(3)
v_mfma_f32_16x16x32_bf16 v[224:227], a[240:243], v[32:35], v[224:227]
v_mul_f32 v150, v150, v158
v_mul_f32_e64 v151, v151, v159
v_mfma_f32_16x16x32_bf16 v[228:231], a[240:243], v[36:39], v[228:231]
ds_read_b128 a[240:243], v12 offset:24576
s_waitcnt lgkmcnt(3)
v_mfma_f32_16x16x32_bf16 v[232:235], a[244:247], v[32:35], v[232:235]
v_cvt_pk_bf16_f32 v152, v144, v145
v_cvt_pk_bf16_f32 v154, v148, v149
v_mfma_f32_16x16x32_bf16 v[236:239], a[244:247], v[36:39], v[236:239]
ds_read_b128 a[244:247], v12 offset:25600
s_waitcnt lgkmcnt(3)
v_mfma_f32_16x16x32_bf16 v[224:227], a[248:251], v[40:43], v[224:227]
v_cvt_pk_bf16_f32 v153, v146, v147
v_cvt_pk_bf16_f32 v155, v150, v151
v_mfma_f32_16x16x32_bf16 v[228:231], a[248:251], v[44:47], v[228:231]
ds_read_b128 a[248:251], v12 offset:26624
s_waitcnt lgkmcnt(3)
v_mfma_f32_16x16x32_bf16 v[232:235], a[252:255], v[40:43], v[232:235]
v_permlane16_swap_b32 v152, v154
v_permlane16_swap_b32_e64 v153, v155
v_mfma_f32_16x16x32_bf16 v[236:239], a[252:255], v[44:47], v[236:239]
ds_read_b128 a[252:255], v12 offset:27648
s_waitcnt lgkmcnt(3)
v_mfma_f32_16x16x32_bf16 v[224:227], a[240:243], v[48:51], v[224:227]
buffer_store_dwordx4 v[152:155], v1, s[36:39], s90 offen sc1
v_mul_f32 v160, v160, v168
v_mfma_f32_16x16x32_bf16 v[228:231], a[240:243], v[52:55], v[228:231]
ds_read_b128 a[240:243], v12 offset:28672
s_waitcnt lgkmcnt(3)
v_mfma_f32_16x16x32_bf16 v[232:235], a[244:247], v[48:51], v[232:235]
v_mul_f32 v161, v161, v169
v_mul_f32_e64 v162, v162, v170
v_mfma_f32_16x16x32_bf16 v[236:239], a[244:247], v[52:55], v[236:239]
ds_read_b128 a[244:247], v12 offset:29696
s_waitcnt lgkmcnt(3)
v_mfma_f32_16x16x32_bf16 v[224:227], a[248:251], v[56:59], v[224:227]
v_mul_f32 v163, v163, v171
v_mul_f32_e64 v164, v164, v172
v_mfma_f32_16x16x32_bf16 v[228:231], a[248:251], v[60:63], v[228:231]
ds_read_b128 a[248:251], v12 offset:30720
s_waitcnt lgkmcnt(3)
v_mfma_f32_16x16x32_bf16 v[232:235], a[252:255], v[56:59], v[232:235]
v_mul_f32 v165, v165, v173
v_mul_f32_e64 v166, v166, v174
v_mfma_f32_16x16x32_bf16 v[236:239], a[252:255], v[60:63], v[236:239]
ds_read_b128 a[252:255], v12 offset:31744
s_waitcnt lgkmcnt(3)
v_mfma_f32_16x16x32_bf16 v[224:227], a[240:243], v[64:67], v[224:227]
v_mul_f32 v167, v167, v175
v_cvt_pk_bf16_f32 v168, v160, v161
v_mfma_f32_16x16x32_bf16 v[228:231], a[240:243], v[68:71], v[228:231]
s_waitcnt vmcnt(9)
s_barrier
ds_read_b128 a[240:243], v12 offset:0
s_waitcnt lgkmcnt(3)
v_mfma_f32_16x16x32_bf16 v[232:235], a[244:247], v[64:67], v[232:235]
v_cvt_pk_bf16_f32 v170, v164, v165
v_cvt_pk_bf16_f32 v169, v162, v163
v_mfma_f32_16x16x32_bf16 v[236:239], a[244:247], v[68:71], v[236:239]
ds_read_b128 a[244:247], v12 offset:1024
s_waitcnt lgkmcnt(3)
v_mfma_f32_16x16x32_bf16 v[224:227], a[248:251], v[72:75], v[224:227]
v_cvt_pk_bf16_f32 v171, v166, v167
v_permlane16_swap_b32_e64 v168, v170
v_mfma_f32_16x16x32_bf16 v[228:231], a[248:251], v[76:79], v[228:231]
ds_read_b128 a[248:251], v12 offset:2048
s_waitcnt lgkmcnt(3)
v_mfma_f32_16x16x32_bf16 v[232:235], a[252:255], v[72:75], v[232:235]
v_permlane16_swap_b32 v169, v171
buffer_store_dwordx4 v[168:171], v1, s[36:39], s90 offen offset:1024 sc1
v_mfma_f32_16x16x32_bf16 v[236:239], a[252:255], v[76:79], v[236:239]
ds_read_b128 a[252:255], v12 offset:3072
s_waitcnt lgkmcnt(3)
v_mfma_f32_16x16x32_bf16 v[224:227], a[240:243], v[80:83], v[224:227]
v_mul_f32 v176, v176, v184
v_mul_f32_e64 v177, v177, v185
v_mfma_f32_16x16x32_bf16 v[228:231], a[240:243], v[84:87], v[228:231]
ds_read_b128 a[240:243], v12 offset:4096
s_waitcnt lgkmcnt(3)
v_mfma_f32_16x16x32_bf16 v[232:235], a[244:247], v[80:83], v[232:235]
v_mul_f32 v178, v178, v186
v_mul_f32_e64 v179, v179, v187
v_mfma_f32_16x16x32_bf16 v[236:239], a[244:247], v[84:87], v[236:239]
ds_read_b128 a[244:247], v12 offset:5120
s_waitcnt lgkmcnt(3)
v_mfma_f32_16x16x32_bf16 v[224:227], a[248:251], v[88:91], v[224:227]
v_mul_f32 v180, v180, v188
v_mul_f32_e64 v181, v181, v189
v_mfma_f32_16x16x32_bf16 v[228:231], a[248:251], v[92:95], v[228:231]
ds_read_b128 a[248:251], v12 offset:6144
s_waitcnt lgkmcnt(3)
v_mfma_f32_16x16x32_bf16 v[232:235], a[252:255], v[88:91], v[232:235]
v_mul_f32 v182, v182, v190
v_mul_f32_e64 v183, v183, v191
v_mfma_f32_16x16x32_bf16 v[236:239], a[252:255], v[92:95], v[236:239]
ds_read_b128 a[252:255], v12 offset:7168
s_waitcnt lgkmcnt(3)
v_mfma_f32_16x16x32_bf16 v[224:227], a[240:243], v[96:99], v[224:227]
v_cvt_pk_bf16_f32 v184, v176, v177
v_cvt_pk_bf16_f32 v186, v180, v181
v_mfma_f32_16x16x32_bf16 v[228:231], a[240:243], v[100:103], v[228:231]
ds_read_b128 a[240:243], v12 offset:8192
s_waitcnt lgkmcnt(3)
v_mfma_f32_16x16x32_bf16 v[232:235], a[244:247], v[96:99], v[232:235]
v_cvt_pk_bf16_f32 v185, v178, v179
v_cvt_pk_bf16_f32 v187, v182, v183
v_mfma_f32_16x16x32_bf16 v[236:239], a[244:247], v[100:103], v[236:239]
ds_read_b128 a[244:247], v12 offset:9216
s_waitcnt lgkmcnt(3)
v_mfma_f32_16x16x32_bf16 v[224:227], a[248:251], v[104:107], v[224:227]
v_permlane16_swap_b32 v184, v186
v_permlane16_swap_b32_e64 v185, v187
v_mfma_f32_16x16x32_bf16 v[228:231], a[248:251], v[108:111], v[228:231]
ds_read_b128 a[248:251], v12 offset:10240
s_waitcnt lgkmcnt(3)
v_mfma_f32_16x16x32_bf16 v[232:235], a[252:255], v[104:107], v[232:235]
buffer_store_dwordx4 v[184:187], v1, s[36:39], s90 offen offset:2048 sc1
v_mul_f32 v192, v192, v200
v_mfma_f32_16x16x32_bf16 v[236:239], a[252:255], v[108:111], v[236:239]
ds_read_b128 a[252:255], v12 offset:11264
s_waitcnt lgkmcnt(3)
v_mfma_f32_16x16x32_bf16 v[224:227], a[240:243], v[112:115], v[224:227]
v_mul_f32 v193, v193, v201
v_mul_f32_e64 v194, v194, v202
v_mfma_f32_16x16x32_bf16 v[228:231], a[240:243], v[116:119], v[228:231]
ds_read_b128 a[240:243], v12 offset:12288
s_waitcnt lgkmcnt(3)
v_mfma_f32_16x16x32_bf16 v[232:235], a[244:247], v[112:115], v[232:235]
v_mul_f32 v195, v195, v203
v_mul_f32_e64 v196, v196, v204
v_mfma_f32_16x16x32_bf16 v[236:239], a[244:247], v[116:119], v[236:239]
ds_read_b128 a[244:247], v12 offset:13312
s_waitcnt lgkmcnt(3)
v_mfma_f32_16x16x32_bf16 v[224:227], a[248:251], v[120:123], v[224:227]
v_mul_f32 v197, v197, v205
v_mul_f32_e64 v198, v198, v206
v_mfma_f32_16x16x32_bf16 v[228:231], a[248:251], v[124:127], v[228:231]
ds_read_b128 a[248:251], v12 offset:14336
s_waitcnt lgkmcnt(3)
v_mfma_f32_16x16x32_bf16 v[232:235], a[252:255], v[120:123], v[232:235]
v_mul_f32 v199, v199, v207
v_cvt_pk_bf16_f32 v200, v192, v193
v_mfma_f32_16x16x32_bf16 v[236:239], a[252:255], v[124:127], v[236:239]
ds_read_b128 a[252:255], v12 offset:15360
s_waitcnt lgkmcnt(3)
v_mfma_f32_16x16x32_bf16 v[224:227], a[240:243], v[128:131], v[224:227]
v_cvt_pk_bf16_f32 v202, v196, v197
v_cvt_pk_bf16_f32 v201, v194, v195
v_mfma_f32_16x16x32_bf16 v[228:231], a[240:243], v[132:135], v[228:231]
s_waitcnt vmcnt(7)
s_barrier
ds_read_b128 a[240:243], v12 offset:16384
s_waitcnt lgkmcnt(3)
v_mfma_f32_16x16x32_bf16 v[232:235], a[244:247], v[128:131], v[232:235]
v_cvt_pk_bf16_f32 v203, v198, v199
v_permlane16_swap_b32_e64 v200, v202
v_mfma_f32_16x16x32_bf16 v[236:239], a[244:247], v[132:135], v[236:239]
ds_read_b128 a[244:247], v12 offset:17408
s_waitcnt lgkmcnt(3)
v_mfma_f32_16x16x32_bf16 v[224:227], a[248:251], v[136:139], v[224:227]
v_permlane16_swap_b32 v201, v203
buffer_store_dwordx4 v[200:203], v1, s[36:39], s90 offen offset:3072 sc1
v_mfma_f32_16x16x32_bf16 v[228:231], a[248:251], v[140:143], v[228:231]
ds_read_b128 a[248:251], v12 offset:18432
s_waitcnt lgkmcnt(3)
v_mfma_f32_16x16x32_bf16 v[232:235], a[252:255], v[136:139], v[232:235]
v_mul_f32 v208, v208, v216
v_mul_f32_e64 v209, v209, v217
v_mfma_f32_16x16x32_bf16 v[236:239], a[252:255], v[140:143], v[236:239]
ds_read_b128 a[252:255], v12 offset:19456
s_waitcnt lgkmcnt(3)
v_mfma_f32_16x16x32_bf16 v[144:147], a[240:243], v[16:19], 0
v_mul_f32 v210, v210, v218
v_mul_f32_e64 v211, v211, v219
v_mfma_f32_16x16x32_bf16 v[148:151], a[240:243], v[20:23], 0
ds_read_b128 a[240:243], v12 offset:20480
s_waitcnt lgkmcnt(3)
v_mfma_f32_16x16x32_bf16 v[152:155], a[244:247], v[16:19], 0
v_mul_f32 v212, v212, v220
v_mul_f32_e64 v213, v213, v221
v_mfma_f32_16x16x32_bf16 v[156:159], a[244:247], v[20:23], 0
ds_read_b128 a[244:247], v12 offset:21504
s_waitcnt lgkmcnt(3)
v_mfma_f32_16x16x32_bf16 v[144:147], a[248:251], v[24:27], v[144:147]
v_mul_f32 v214, v214, v222
v_mul_f32_e64 v215, v215, v223
v_mfma_f32_16x16x32_bf16 v[148:151], a[248:251], v[28:31], v[148:151]
ds_read_b128 a[248:251], v12 offset:22528
s_waitcnt lgkmcnt(3)
v_mfma_f32_16x16x32_bf16 v[152:155], a[252:255], v[24:27], v[152:155]
v_cvt_pk_bf16_f32 v216, v208, v209
v_cvt_pk_bf16_f32 v218, v212, v213
v_mfma_f32_16x16x32_bf16 v[156:159], a[252:255], v[28:31], v[156:159]
ds_read_b128 a[252:255], v12 offset:23552
s_waitcnt lgkmcnt(3)
v_mfma_f32_16x16x32_bf16 v[144:147], a[240:243], v[32:35], v[144:147]
v_cvt_pk_bf16_f32 v217, v210, v211
v_cvt_pk_bf16_f32 v219, v214, v215
v_mfma_f32_16x16x32_bf16 v[148:151], a[240:243], v[36:39], v[148:151]
ds_read_b128 a[240:243], v12 offset:32768
s_waitcnt lgkmcnt(3)
v_mfma_f32_16x16x32_bf16 v[152:155], a[244:247], v[32:35], v[152:155]
v_permlane16_swap_b32 v216, v218
v_permlane16_swap_b32_e64 v217, v219
v_mfma_f32_16x16x32_bf16 v[156:159], a[244:247], v[36:39], v[156:159]
ds_read_b128 a[244:247], v12 offset:33792
s_waitcnt lgkmcnt(3)
v_mfma_f32_16x16x32_bf16 v[144:147], a[248:251], v[40:43], v[144:147]
s_add_u32 s90, s90, 4096
buffer_store_dwordx4 v[216:219], v1, s[36:39], s90 offen sc1
v_mul_f32 v224, v224, v232
v_mfma_f32_16x16x32_bf16 v[148:151], a[248:251], v[44:47], v[148:151]
ds_read_b128 a[248:251], v12 offset:34816
s_waitcnt lgkmcnt(3)
v_mfma_f32_16x16x32_bf16 v[152:155], a[252:255], v[40:43], v[152:155]
v_mul_f32 v225, v225, v233
v_mul_f32_e64 v226, v226, v234
v_mfma_f32_16x16x32_bf16 v[156:159], a[252:255], v[44:47], v[156:159]
ds_read_b128 a[252:255], v12 offset:35840
s_waitcnt lgkmcnt(3)
v_mfma_f32_16x16x32_bf16 v[144:147], a[240:243], v[48:51], v[144:147]
v_mul_f32 v227, v227, v235
v_mul_f32_e64 v228, v228, v236
v_mfma_f32_16x16x32_bf16 v[148:151], a[240:243], v[52:55], v[148:151]
ds_read_b128 a[240:243], v12 offset:36864
s_waitcnt lgkmcnt(3)
v_mfma_f32_16x16x32_bf16 v[152:155], a[244:247], v[48:51], v[152:155]
v_mul_f32 v229, v229, v237
v_mul_f32_e64 v230, v230, v238
v_mfma_f32_16x16x32_bf16 v[156:159], a[244:247], v[52:55], v[156:159]
ds_read_b128 a[244:247], v12 offset:37888
s_waitcnt lgkmcnt(3)
v_mfma_f32_16x16x32_bf16 v[144:147], a[248:251], v[56:59], v[144:147]
v_mul_f32 v231, v231, v239
v_cvt_pk_bf16_f32 v232, v224, v225
v_mfma_f32_16x16x32_bf16 v[148:151], a[248:251], v[60:63], v[148:151]
ds_read_b128 a[248:251], v12 offset:38912
s_waitcnt lgkmcnt(3)
v_mfma_f32_16x16x32_bf16 v[152:155], a[252:255], v[56:59], v[152:155]
v_cvt_pk_bf16_f32 v234, v228, v229
v_cvt_pk_bf16_f32 v233, v226, v227
v_mfma_f32_16x16x32_bf16 v[156:159], a[252:255], v[60:63], v[156:159]
ds_read_b128 a[252:255], v12 offset:39936
s_waitcnt lgkmcnt(3)
v_mfma_f32_16x16x32_bf16 v[144:147], a[240:243], v[64:67], v[144:147]
v_mov_b32 v243, 8
v_mov_b32 v6, s83
s_waitcnt vmcnt(1)
s_mov_b64 exec, 1
buffer_store_dword v243, v6, s[36:39], 0 offen sc1
s_mov_b64 exec, -1
v_mfma_f32_16x16x32_bf16 v[148:151], a[240:243], v[68:71], v[148:151]
s_barrier
ds_read_b128 a[240:243], v12 offset:40960
s_waitcnt lgkmcnt(3)
v_mfma_f32_16x16x32_bf16 v[152:155], a[244:247], v[64:67], v[152:155]
v_cvt_pk_bf16_f32 v235, v230, v231
v_permlane16_swap_b32 v232, v234
v_mfma_f32_16x16x32_bf16 v[156:159], a[244:247], v[68:71], v[156:159]
ds_read_b128 a[244:247], v12 offset:41984
s_waitcnt lgkmcnt(3)
v_mfma_f32_16x16x32_bf16 v[144:147], a[248:251], v[72:75], v[144:147]
v_permlane16_swap_b32 v233, v235
buffer_store_dwordx4 v[232:235], v1, s[36:39], s90 offen offset:1024 sc1
v_mfma_f32_16x16x32_bf16 v[148:151], a[248:251], v[76:79], v[148:151]
ds_read_b128 a[248:251], v12 offset:43008
s_waitcnt lgkmcnt(3)
v_mfma_f32_16x16x32_bf16 v[152:155], a[252:255], v[72:75], v[152:155]
v_mfma_f32_16x16x32_bf16 v[156:159], a[252:255], v[76:79], v[156:159]
ds_read_b128 a[252:255], v12 offset:44032
s_waitcnt lgkmcnt(3)
v_mfma_f32_16x16x32_bf16 v[144:147], a[240:243], v[80:83], v[144:147]
v_mfma_f32_16x16x32_bf16 v[148:151], a[240:243], v[84:87], v[148:151]
ds_read_b128 a[240:243], v12 offset:45056
s_waitcnt lgkmcnt(3)
v_mfma_f32_16x16x32_bf16 v[152:155], a[244:247], v[80:83], v[152:155]
v_mfma_f32_16x16x32_bf16 v[156:159], a[244:247], v[84:87], v[156:159]
ds_read_b128 a[244:247], v12 offset:46080
s_waitcnt lgkmcnt(3)
v_mfma_f32_16x16x32_bf16 v[144:147], a[248:251], v[88:91], v[144:147]
v_mfma_f32_16x16x32_bf16 v[148:151], a[248:251], v[92:95], v[148:151]
ds_read_b128 a[248:251], v12 offset:47104
s_waitcnt lgkmcnt(3)
v_mfma_f32_16x16x32_bf16 v[152:155], a[252:255], v[88:91], v[152:155]
v_mfma_f32_16x16x32_bf16 v[156:159], a[252:255], v[92:95], v[156:159]
ds_read_b128 a[252:255], v12 offset:48128
s_waitcnt lgkmcnt(3)
v_mfma_f32_16x16x32_bf16 v[144:147], a[240:243], v[96:99], v[144:147]
v_mfma_f32_16x16x32_bf16 v[148:151], a[240:243], v[100:103], v[148:151]
ds_read_b128 a[240:243], v12 offset:49152
s_waitcnt lgkmcnt(3)
v_mfma_f32_16x16x32_bf16 v[152:155], a[244:247], v[96:99], v[152:155]
v_mfma_f32_16x16x32_bf16 v[156:159], a[244:247], v[100:103], v[156:159]
ds_read_b128 a[244:247], v12 offset:50176
s_waitcnt lgkmcnt(3)
v_mfma_f32_16x16x32_bf16 v[144:147], a[248:251], v[104:107], v[144:147]
v_mfma_f32_16x16x32_bf16 v[148:151], a[248:251], v[108:111], v[148:151]
ds_read_b128 a[248:251], v12 offset:51200
s_waitcnt lgkmcnt(3)
v_mfma_f32_16x16x32_bf16 v[152:155], a[252:255], v[104:107], v[152:155]
v_mfma_f32_16x16x32_bf16 v[156:159], a[252:255], v[108:111], v[156:159]
ds_read_b128 a[252:255], v12 offset:52224
s_waitcnt lgkmcnt(3)
v_mfma_f32_16x16x32_bf16 v[144:147], a[240:243], v[112:115], v[144:147]
v_mfma_f32_16x16x32_bf16 v[148:151], a[240:243], v[116:119], v[148:151]
ds_read_b128 a[240:243], v12 offset:53248
s_waitcnt lgkmcnt(3)
v_mfma_f32_16x16x32_bf16 v[152:155], a[244:247], v[112:115], v[152:155]
v_mfma_f32_16x16x32_bf16 v[156:159], a[244:247], v[116:119], v[156:159]
ds_read_b128 a[244:247], v12 offset:54272
s_waitcnt lgkmcnt(3)
v_mfma_f32_16x16x32_bf16 v[144:147], a[248:251], v[120:123], v[144:147]
v_mfma_f32_16x16x32_bf16 v[148:151], a[248:251], v[124:127], v[148:151]
ds_read_b128 a[248:251], v12 offset:55296
s_waitcnt lgkmcnt(3)
v_mfma_f32_16x16x32_bf16 v[152:155], a[252:255], v[120:123], v[152:155]
v_mfma_f32_16x16x32_bf16 v[156:159], a[252:255], v[124:127], v[156:159]
ds_read_b128 a[252:255], v12 offset:56320
buffer_load_dword v6, v11, s[36:39], 0 offen sc1
s_waitcnt lgkmcnt(3)
v_mfma_f32_16x16x32_bf16 v[144:147], a[240:243], v[128:131], v[144:147]
v_mfma_f32_16x16x32_bf16 v[148:151], a[240:243], v[132:135], v[148:151]
s_waitcnt lgkmcnt(2)
v_mfma_f32_16x16x32_bf16 v[152:155], a[244:247], v[128:131], v[152:155]
v_mfma_f32_16x16x32_bf16 v[156:159], a[244:247], v[132:135], v[156:159]
s_waitcnt lgkmcnt(1)
v_mfma_f32_16x16x32_bf16 v[144:147], a[248:251], v[136:139], v[144:147]
v_mfma_f32_16x16x32_bf16 v[148:151], a[248:251], v[140:143], v[148:151]
s_waitcnt lgkmcnt(0)
v_mfma_f32_16x16x32_bf16 v[152:155], a[252:255], v[136:139], v[152:155]
v_mfma_f32_16x16x32_bf16 v[156:159], a[252:255], v[140:143], v[156:159]
s_barrier
s_nop 2
v_fmac_f32 v144, v8, v244
v_fmac_f32 v145, v8, v245
v_fmac_f32 v146, v8, v246
v_fmac_f32 v147, v8, v247
v_fmac_f32 v148, v242, v244
v_fmac_f32 v149, v242, v245
v_fmac_f32 v150, v242, v246
v_fmac_f32 v151, v242, v247
v_fmac_f32 v152, v8, v248
v_fmac_f32 v153, v8, v249
v_fmac_f32 v154, v8, v250
v_fmac_f32 v155, v8, v251
v_fmac_f32 v156, v242, v248
v_fmac_f32 v157, v242, v249
v_fmac_f32 v158, v242, v250
v_fmac_f32 v159, v242, v251
v_mul_f32 v144, v144, v152
v_mul_f32 v145, v145, v153
v_mul_f32 v146, v146, v154
v_mul_f32 v147, v147, v155
v_mul_f32 v148, v148, v156
v_mul_f32 v149, v149, v157
v_mul_f32 v150, v150, v158
v_mul_f32_e64 v151, v151, v159
v_cvt_pk_bf16_f32 v152, v144, v145
v_cvt_pk_bf16_f32 v154, v148, v149
v_cvt_pk_bf16_f32 v153, v146, v147
v_cvt_pk_bf16_f32 v155, v150, v151
v_permlane16_swap_b32 v152, v154
s_nop 0
v_permlane16_swap_b32_e64 v153, v155
buffer_store_dwordx4 v[152:155], v1, s[36:39], s90 offen offset:2048 sc1
s_waitcnt vmcnt(1)
v_cmp_gt_u32 vcc, 8, v6
s_nop 0
s_cbranch_vccz Lgo_107
Lpoll_106:
buffer_load_dword v6, v11, s[36:39], 0 offen sc1
s_waitcnt vmcnt(0)
v_cmp_gt_u32 vcc, 8, v6
s_nop 0
s_cbranch_vccz Lgo_107
s_add_u32 s91, s91, 1
s_bitcmp0_b32 s91, 16
s_cbranch_scc1 Lpoll_106
Lgo_107:
s_add_u32 s77, s92, 0
buffer_load_dwordx4 v[80:83], v14, s[36:39], s77 offen sc1
buffer_load_dwordx4 v[84:87], v14, s[36:39], s77 offen offset:256 sc1
s_add_u32 s77, s93, 0
buffer_load_dwordx4 v[88:91], v14, s[36:39], s77 offen sc1
buffer_load_dwordx4 v[92:95], v14, s[36:39], s77 offen offset:256 sc1
v_mov_b32 v7, 9
v_mov_b32_e64 v6, s83
s_waitcnt vmcnt(4)
s_mov_b64 exec, 1
buffer_store_dword v7, v6, s[36:39], 0 offen sc1
s_mov_b64 exec, -1
s_add_u32 s77, s92, 7168
buffer_load_dwordx4 v[96:99], v14, s[36:39], s77 offen sc1
buffer_load_dwordx4 v[100:103], v14, s[36:39], s77 offen offset:256 sc1
s_add_u32 s77, s93, 7168
buffer_load_dwordx4 v[104:107], v14, s[36:39], s77 offen sc1
buffer_load_dwordx4 v[108:111], v14, s[36:39], s77 offen offset:256 sc1
s_add_u32 s77, s92, 14336
buffer_load_dwordx4 v[112:115], v14, s[36:39], s77 offen sc1
buffer_load_dwordx4 v[116:119], v14, s[36:39], s77 offen offset:256 sc1
s_add_u32 s77, s93, 14336
buffer_load_dwordx4 v[120:123], v14, s[36:39], s77 offen sc1
buffer_load_dwordx4 v[124:127], v14, s[36:39], s77 offen offset:256 sc1
s_waitcnt vmcnt(12)
v_mfma_f32_16x16x32_bf16 v[16:19], a[0:3], v[80:83], 0
s_add_u32 s77, s92, 21504
buffer_load_dwordx4 v[128:131], v14, s[36:39], s77 offen sc1
v_mfma_f32_16x16x32_bf16 v[24:27], a[4:7], v[80:83], 0
v_lshrrev_b32_e64 v7, 5, v0
v_mul_u32_u24 v7, 6144, v7
v_mfma_f32_16x16x32_bf16 v[48:51], a[8:11], v[80:83], 0
v_mfma_f32_16x16x32_bf16 v[56:59], a[12:15], v[80:83], 0
s_waitcnt vmcnt(12)
v_mfma_f32_16x16x32_bf16 v[20:23], a[0:3], v[84:87], 0
buffer_load_dwordx4 v[132:135], v14, s[36:39], s77 offen offset:256 sc1
v_mfma_f32_16x16x32_bf16 v[28:31], a[4:7], v[84:87], 0
v_add_u32_e64 v250, v7, v14
s_sub_u32 s78, s68, 1
v_mfma_f32_16x16x32_bf16 v[52:55], a[8:11], v[84:87], 0
v_mfma_f32_16x16x32_bf16 v[60:63], a[12:15], v[84:87], 0
s_waitcnt vmcnt(12)
v_mfma_f32_16x16x32_bf16 v[32:35], a[0:3], v[88:91], 0
s_add_u32 s77, s93, 21504
buffer_load_dwordx4 v[136:139], v14, s[36:39], s77 offen sc1
v_mfma_f32_16x16x32_bf16 v[40:43], a[4:7], v[88:91], 0
s_and_b32 s78, s78, 3
s_lshl_b32 s78, s78, 12
v_mfma_f32_16x16x32_bf16 v[64:67], a[8:11], v[88:91], 0
v_mfma_f32_16x16x32_bf16 v[72:75], a[12:15], v[88:91], 0
s_waitcnt vmcnt(12)
v_mfma_f32_16x16x32_bf16 v[36:39], a[0:3], v[92:95], 0
buffer_load_dwordx4 v[140:143], v14, s[36:39], s77 offen offset:256 sc1
v_mfma_f32_16x16x32_bf16 v[44:47], a[4:7], v[92:95], 0
s_add_u32 s78, s78, 67584
v_add_u32_e64 v12, s78, v1
v_mfma_f32_16x16x32_bf16 v[68:71], a[8:11], v[92:95], 0
v_mfma_f32_16x16x32_bf16 v[76:79], a[12:15], v[92:95], 0
s_waitcnt vmcnt(11)
v_mfma_f32_16x16x32_bf16 v[16:19], a[16:19], v[96:99], v[16:19]
s_add_u32 s77, s92, 2048
buffer_load_dwordx4 v[160:163], v14, s[36:39], s77 offen sc1
v_mfma_f32_16x16x32_bf16 v[24:27], a[20:23], v[96:99], v[24:27]
s_sub_u32 s78, s68, 3
s_and_b32 s78, s78, 3
v_mfma_f32_16x16x32_bf16 v[48:51], a[24:27], v[96:99], v[48:51]
v_mfma_f32_16x16x32_bf16 v[56:59], a[28:31], v[96:99], v[56:59]
s_waitcnt vmcnt(11)
v_mfma_f32_16x16x32_bf16 v[20:23], a[16:19], v[100:103], v[20:23]
buffer_load_dwordx4 v[164:167], v14, s[36:39], s77 offen offset:256 sc1
v_mfma_f32_16x16x32_bf16 v[28:31], a[20:23], v[100:103], v[28:31]
s_lshl_b32 s78, s78, 12
s_add_u32 s78, s78, 100352
v_mfma_f32_16x16x32_bf16 v[52:55], a[24:27], v[100:103], v[52:55]
v_mfma_f32_16x16x32_bf16 v[60:63], a[28:31], v[100:103], v[60:63]
s_waitcnt vmcnt(11)
v_mfma_f32_16x16x32_bf16 v[32:35], a[16:19], v[104:107], v[32:35]
s_add_u32 s77, s93, 2048
buffer_load_dwordx4 v[168:171], v14, s[36:39], s77 offen sc1
v_mfma_f32_16x16x32_bf16 v[40:43], a[20:23], v[104:107], v[40:43]
v_add_u32 v13, s78, v1
s_lshl_b32 s78, s68, 14
v_mfma_f32_16x16x32_bf16 v[64:67], a[24:27], v[104:107], v[64:67]
v_mfma_f32_16x16x32_bf16 v[72:75], a[28:31], v[104:107], v[72:75]
s_waitcnt vmcnt(11)
v_mfma_f32_16x16x32_bf16 v[36:39], a[16:19], v[108:111], v[36:39]
buffer_load_dwordx4 v[172:175], v14, s[36:39], s77 offen offset:256 sc1
v_mfma_f32_16x16x32_bf16 v[44:47], a[20:23], v[108:111], v[44:47]
s_add_u32 s78, s78, 67584
v_add_u32 v248, s78, v1
v_mfma_f32_16x16x32_bf16 v[68:71], a[24:27], v[108:111], v[68:71]
v_mfma_f32_16x16x32_bf16 v[76:79], a[28:31], v[108:111], v[76:79]
s_waitcnt vmcnt(11)
v_mfma_f32_16x16x32_bf16 v[16:19], a[32:35], v[112:115], v[16:19]
buffer_load_dword v6, v11, s[36:39], 0 offen sc1
s_add_u32 s77, s92, 9216
buffer_load_dwordx4 v[176:179], v14, s[36:39], s77 offen sc1
v_mfma_f32_16x16x32_bf16 v[24:27], a[36:39], v[112:115], v[24:27]
s_lshl_b32 s78, s73, 1
s_add_u32 s78, s78, s75
v_mfma_f32_16x16x32_bf16 v[48:51], a[40:43], v[112:115], v[48:51]
v_mfma_f32_16x16x32_bf16 v[56:59], a[44:47], v[112:115], v[56:59]
s_waitcnt vmcnt(12)
v_mfma_f32_16x16x32_bf16 v[20:23], a[32:35], v[116:119], v[20:23]
buffer_load_dwordx4 v[180:183], v14, s[36:39], s77 offen offset:256 sc1
v_mfma_f32_16x16x32_bf16 v[28:31], a[36:39], v[116:119], v[28:31]
s_lshl_b32 s78, s78, 7
s_add_u32 s78, s78, 66944
v_mfma_f32_16x16x32_bf16 v[52:55], a[40:43], v[116:119], v[52:55]
v_mfma_f32_16x16x32_bf16 v[60:63], a[44:47], v[116:119], v[60:63]
s_waitcnt vmcnt(12)
v_mfma_f32_16x16x32_bf16 v[32:35], a[32:35], v[120:123], v[32:35]
s_add_u32 s77, s93, 9216
buffer_load_dwordx4 v[184:187], v14, s[36:39], s77 offen sc1
v_mfma_f32_16x16x32_bf16 v[40:43], a[36:39], v[120:123], v[40:43]
v_and_b32_e64 v7, 15, v0
v_lshl_add_u32 v249, v7, 2, s78
v_mfma_f32_16x16x32_bf16 v[64:67], a[40:43], v[120:123], v[64:67]
v_mfma_f32_16x16x32_bf16 v[72:75], a[44:47], v[120:123], v[72:75]
s_waitcnt vmcnt(12)
v_mfma_f32_16x16x32_bf16 v[36:39], a[32:35], v[124:127], v[36:39]
buffer_load_dwordx4 v[188:191], v14, s[36:39], s77 offen offset:256 sc1
v_mfma_f32_16x16x32_bf16 v[44:47], a[36:39], v[124:127], v[44:47]
v_mfma_f32_16x16x32_bf16 v[68:71], a[40:43], v[124:127], v[68:71]
v_mfma_f32_16x16x32_bf16 v[76:79], a[44:47], v[124:127], v[76:79]
s_waitcnt vmcnt(12)
v_mfma_f32_16x16x32_bf16 v[16:19], a[48:51], v[128:131], v[16:19]
s_add_u32 s77, s92, 16384
buffer_load_dwordx4 v[192:195], v14, s[36:39], s77 offen sc1
v_mfma_f32_16x16x32_bf16 v[24:27], a[52:55], v[128:131], v[24:27]
v_mfma_f32_16x16x32_bf16 v[48:51], a[56:59], v[128:131], v[48:51]
v_mfma_f32_16x16x32_bf16 v[56:59], a[60:63], v[128:131], v[56:59]
s_waitcnt vmcnt(12)
v_mfma_f32_16x16x32_bf16 v[20:23], a[48:51], v[132:135], v[20:23]
buffer_load_dwordx4 v[196:199], v14, s[36:39], s77 offen offset:256 sc1
v_mfma_f32_16x16x32_bf16 v[28:31], a[52:55], v[132:135], v[28:31]
v_mfma_f32_16x16x32_bf16 v[52:55], a[56:59], v[132:135], v[52:55]
v_mfma_f32_16x16x32_bf16 v[60:63], a[60:63], v[132:135], v[60:63]
s_waitcnt vmcnt(12)
v_mfma_f32_16x16x32_bf16 v[32:35], a[48:51], v[136:139], v[32:35]
s_add_u32 s77, s93, 16384
buffer_load_dwordx4 v[200:203], v14, s[36:39], s77 offen sc1
v_mfma_f32_16x16x32_bf16 v[40:43], a[52:55], v[136:139], v[40:43]
v_mfma_f32_16x16x32_bf16 v[64:67], a[56:59], v[136:139], v[64:67]
v_mfma_f32_16x16x32_bf16 v[72:75], a[60:63], v[136:139], v[72:75]
s_waitcnt vmcnt(12)
v_mfma_f32_16x16x32_bf16 v[36:39], a[48:51], v[140:143], v[36:39]
buffer_load_dwordx4 v[204:207], v14, s[36:39], s77 offen offset:256 sc1
v_mfma_f32_16x16x32_bf16 v[44:47], a[52:55], v[140:143], v[44:47]
v_mfma_f32_16x16x32_bf16 v[68:71], a[56:59], v[140:143], v[68:71]
v_mfma_f32_16x16x32_bf16 v[76:79], a[60:63], v[140:143], v[76:79]
s_waitcnt vmcnt(12)
v_mfma_f32_16x16x32_bf16 v[16:19], a[64:67], v[160:163], v[16:19]
s_add_u32 s77, s92, 23552
buffer_load_dwordx4 v[208:211], v14, s[36:39], s77 offen sc1
v_mfma_f32_16x16x32_bf16 v[24:27], a[68:71], v[160:163], v[24:27]
v_mfma_f32_16x16x32_bf16 v[48:51], a[72:75], v[160:163], v[48:51]
v_mfma_f32_16x16x32_bf16 v[56:59], a[76:79], v[160:163], v[56:59]
s_waitcnt vmcnt(12)
v_mfma_f32_16x16x32_bf16 v[20:23], a[64:67], v[164:167], v[20:23]
buffer_load_dwordx4 v[212:215], v14, s[36:39], s77 offen offset:256 sc1
v_mfma_f32_16x16x32_bf16 v[28:31], a[68:71], v[164:167], v[28:31]
v_mfma_f32_16x16x32_bf16 v[52:55], a[72:75], v[164:167], v[52:55]
v_mfma_f32_16x16x32_bf16 v[60:63], a[76:79], v[164:167], v[60:63]
s_waitcnt vmcnt(12)
v_mfma_f32_16x16x32_bf16 v[32:35], a[64:67], v[168:171], v[32:35]
s_add_u32 s77, s93, 23552
buffer_load_dwordx4 v[216:219], v14, s[36:39], s77 offen sc1
v_mfma_f32_16x16x32_bf16 v[40:43], a[68:71], v[168:171], v[40:43]
v_mfma_f32_16x16x32_bf16 v[64:67], a[72:75], v[168:171], v[64:67]
v_mfma_f32_16x16x32_bf16 v[72:75], a[76:79], v[168:171], v[72:75]
s_waitcnt vmcnt(12)
v_mfma_f32_16x16x32_bf16 v[36:39], a[64:67], v[172:175], v[36:39]
buffer_load_dwordx4 v[220:223], v14, s[36:39], s77 offen offset:256 sc1
v_mfma_f32_16x16x32_bf16 v[44:47], a[68:71], v[172:175], v[44:47]
v_mfma_f32_16x16x32_bf16 v[68:71], a[72:75], v[172:175], v[68:71]
v_mfma_f32_16x16x32_bf16 v[76:79], a[76:79], v[172:175], v[76:79]
s_waitcnt vmcnt(11)
v_mfma_f32_16x16x32_bf16 v[16:19], a[80:83], v[176:179], v[16:19]
v_cmp_gt_u32 vcc, 9, v6
s_nop 0
s_cbranch_vccz Lgo_109
Lpoll_108:
buffer_load_dword v6, v11, s[36:39], 0 offen sc1
s_waitcnt vmcnt(0)
v_cmp_gt_u32 vcc, 9, v6
s_nop 0
s_cbranch_vccz Lgo_109
s_add_u32 s91, s91, 1
s_bitcmp0_b32 s91, 16
s_cbranch_scc1 Lpoll_108
Lgo_109:
s_add_u32 s77, s92, 4096
buffer_load_dwordx4 v[224:227], v14, s[36:39], s77 offen sc1
v_mfma_f32_16x16x32_bf16 v[24:27], a[84:87], v[176:179], v[24:27]
v_mfma_f32_16x16x32_bf16 v[48:51], a[88:91], v[176:179], v[48:51]
v_mfma_f32_16x16x32_bf16 v[56:59], a[92:95], v[176:179], v[56:59]
s_waitcnt vmcnt(11)
v_mfma_f32_16x16x32_bf16 v[20:23], a[80:83], v[180:183], v[20:23]
buffer_load_dwordx4 v[228:231], v14, s[36:39], s77 offen offset:256 sc1
v_mfma_f32_16x16x32_bf16 v[28:31], a[84:87], v[180:183], v[28:31]
v_mfma_f32_16x16x32_bf16 v[52:55], a[88:91], v[180:183], v[52:55]
v_mfma_f32_16x16x32_bf16 v[60:63], a[92:95], v[180:183], v[60:63]
s_waitcnt vmcnt(11)
v_mfma_f32_16x16x32_bf16 v[32:35], a[80:83], v[184:187], v[32:35]
s_add_u32 s77, s92, 11264
buffer_load_dwordx4 v[232:235], v14, s[36:39], s77 offen sc1
v_mfma_f32_16x16x32_bf16 v[40:43], a[84:87], v[184:187], v[40:43]
v_mfma_f32_16x16x32_bf16 v[64:67], a[88:91], v[184:187], v[64:67]
v_mfma_f32_16x16x32_bf16 v[72:75], a[92:95], v[184:187], v[72:75]
s_waitcnt vmcnt(11)
v_mfma_f32_16x16x32_bf16 v[36:39], a[80:83], v[188:191], v[36:39]
buffer_load_dwordx4 v[236:239], v14, s[36:39], s77 offen offset:256 sc1
v_mfma_f32_16x16x32_bf16 v[44:47], a[84:87], v[188:191], v[44:47]
v_mfma_f32_16x16x32_bf16 v[68:71], a[88:91], v[188:191], v[68:71]
v_mfma_f32_16x16x32_bf16 v[76:79], a[92:95], v[188:191], v[76:79]
s_waitcnt vmcnt(11)
v_mfma_f32_16x16x32_bf16 v[16:19], a[96:99], v[192:195], v[16:19]
s_add_u32 s77, s92, 18432
buffer_load_dwordx4 v[80:83], v14, s[36:39], s77 offen sc1
v_mfma_f32_16x16x32_bf16 v[24:27], a[100:103], v[192:195], v[24:27]
v_mfma_f32_16x16x32_bf16 v[48:51], a[104:107], v[192:195], v[48:51]
v_mfma_f32_16x16x32_bf16 v[56:59], a[108:111], v[192:195], v[56:59]
s_waitcnt vmcnt(11)
v_mfma_f32_16x16x32_bf16 v[20:23], a[96:99], v[196:199], v[20:23]
buffer_load_dwordx4 v[84:87], v14, s[36:39], s77 offen offset:256 sc1
v_mfma_f32_16x16x32_bf16 v[28:31], a[100:103], v[196:199], v[28:31]
v_mfma_f32_16x16x32_bf16 v[52:55], a[104:107], v[196:199], v[52:55]
v_mfma_f32_16x16x32_bf16 v[60:63], a[108:111], v[196:199], v[60:63]
s_waitcnt vmcnt(11)
v_mfma_f32_16x16x32_bf16 v[32:35], a[96:99], v[200:203], v[32:35]
s_add_u32 s77, s92, 25600
buffer_load_dwordx4 v[88:91], v14, s[36:39], s77 offen sc1
v_mfma_f32_16x16x32_bf16 v[40:43], a[100:103], v[200:203], v[40:43]
v_mfma_f32_16x16x32_bf16 v[64:67], a[104:107], v[200:203], v[64:67]
v_mfma_f32_16x16x32_bf16 v[72:75], a[108:111], v[200:203], v[72:75]
s_waitcnt vmcnt(11)
v_mfma_f32_16x16x32_bf16 v[36:39], a[96:99], v[204:207], v[36:39]
buffer_load_dwordx4 v[92:95], v14, s[36:39], s77 offen offset:256 sc1
v_mfma_f32_16x16x32_bf16 v[44:47], a[100:103], v[204:207], v[44:47]
v_mfma_f32_16x16x32_bf16 v[68:71], a[104:107], v[204:207], v[68:71]
v_mfma_f32_16x16x32_bf16 v[76:79], a[108:111], v[204:207], v[76:79]
s_waitcnt vmcnt(11)
v_mfma_f32_16x16x32_bf16 v[16:19], a[112:115], v[208:211], v[16:19]
s_add_u32 s77, s92, 6144
buffer_load_dwordx4 v[96:99], v250, s[36:39], s77 offen sc1
v_mfma_f32_16x16x32_bf16 v[24:27], a[116:119], v[208:211], v[24:27]
v_mfma_f32_16x16x32_bf16 v[48:51], a[120:123], v[208:211], v[48:51]
v_mfma_f32_16x16x32_bf16 v[56:59], a[124:127], v[208:211], v[56:59]
s_waitcnt vmcnt(11)
v_mfma_f32_16x16x32_bf16 v[20:23], a[112:115], v[212:215], v[20:23]
buffer_load_dwordx4 v[100:103], v250, s[36:39], s77 offen offset:256 sc1
v_mfma_f32_16x16x32_bf16 v[28:31], a[116:119], v[212:215], v[28:31]
v_mfma_f32_16x16x32_bf16 v[52:55], a[120:123], v[212:215], v[52:55]
v_mfma_f32_16x16x32_bf16 v[60:63], a[124:127], v[212:215], v[60:63]
s_waitcnt vmcnt(11)
v_mfma_f32_16x16x32_bf16 v[32:35], a[112:115], v[216:219], v[32:35]
s_add_u32 s77, s92, 20480
buffer_load_dwordx4 v[104:107], v250, s[36:39], s77 offen sc1
v_mfma_f32_16x16x32_bf16 v[40:43], a[116:119], v[216:219], v[40:43]
v_mfma_f32_16x16x32_bf16 v[64:67], a[120:123], v[216:219], v[64:67]
v_mfma_f32_16x16x32_bf16 v[72:75], a[124:127], v[216:219], v[72:75]
s_waitcnt vmcnt(11)
v_mfma_f32_16x16x32_bf16 v[36:39], a[112:115], v[220:223], v[36:39]
buffer_load_dwordx4 v[108:111], v250, s[36:39], s77 offen offset:256 sc1
v_mfma_f32_16x16x32_bf16 v[44:47], a[116:119], v[220:223], v[44:47]
v_mfma_f32_16x16x32_bf16 v[68:71], a[120:123], v[220:223], v[68:71]
v_mfma_f32_16x16x32_bf16 v[76:79], a[124:127], v[220:223], v[76:79]
s_waitcnt vmcnt(11)
v_mfma_f32_16x16x32_bf16 v[16:19], a[128:131], v[224:227], v[16:19]
s_add_u32 s77, s93, 4096
buffer_load_dwordx4 v[112:115], v14, s[36:39], s77 offen sc1
v_mfma_f32_16x16x32_bf16 v[24:27], a[132:135], v[224:227], v[24:27]
v_mfma_f32_16x16x32_bf16 v[48:51], a[136:139], v[224:227], v[48:51]
v_mfma_f32_16x16x32_bf16 v[56:59], a[140:143], v[224:227], v[56:59]
s_waitcnt vmcnt(11)
v_mfma_f32_16x16x32_bf16 v[20:23], a[128:131], v[228:231], v[20:23]
buffer_load_dwordx4 v[116:119], v14, s[36:39], s77 offen offset:256 sc1
v_mfma_f32_16x16x32_bf16 v[28:31], a[132:135], v[228:231], v[28:31]
v_mfma_f32_16x16x32_bf16 v[52:55], a[136:139], v[228:231], v[52:55]
v_mfma_f32_16x16x32_bf16 v[60:63], a[140:143], v[228:231], v[60:63]
s_waitcnt vmcnt(11)
v_mfma_f32_16x16x32_bf16 v[16:19], a[144:147], v[232:235], v[16:19]
s_add_u32 s77, s93, 11264
buffer_load_dwordx4 v[120:123], v14, s[36:39], s77 offen sc1
v_mfma_f32_16x16x32_bf16 v[24:27], a[148:151], v[232:235], v[24:27]
v_mfma_f32_16x16x32_bf16 v[48:51], a[152:155], v[232:235], v[48:51]
v_mfma_f32_16x16x32_bf16 v[56:59], a[156:159], v[232:235], v[56:59]
s_waitcnt vmcnt(11)
v_mfma_f32_16x16x32_bf16 v[20:23], a[144:147], v[236:239], v[20:23]
buffer_load_dwordx4 v[124:127], v14, s[36:39], s77 offen offset:256 sc1
v_mfma_f32_16x16x32_bf16 v[28:31], a[148:151], v[236:239], v[28:31]
v_mfma_f32_16x16x32_bf16 v[52:55], a[152:155], v[236:239], v[52:55]
v_mfma_f32_16x16x32_bf16 v[60:63], a[156:159], v[236:239], v[60:63]
s_waitcnt vmcnt(11)
v_mfma_f32_16x16x32_bf16 v[16:19], a[160:163], v[80:83], v[16:19]
s_add_u32 s77, s93, 18432
buffer_load_dwordx4 v[128:131], v14, s[36:39], s77 offen sc1
v_mfma_f32_16x16x32_bf16 v[24:27], a[164:167], v[80:83], v[24:27]
v_mfma_f32_16x16x32_bf16 v[48:51], a[168:171], v[80:83], v[48:51]
v_mfma_f32_16x16x32_bf16 v[56:59], a[172:175], v[80:83], v[56:59]
s_waitcnt vmcnt(11)
v_mfma_f32_16x16x32_bf16 v[20:23], a[160:163], v[84:87], v[20:23]
buffer_load_dwordx4 v[132:135], v14, s[36:39], s77 offen offset:256 sc1
v_mfma_f32_16x16x32_bf16 v[28:31], a[164:167], v[84:87], v[28:31]
v_mfma_f32_16x16x32_bf16 v[52:55], a[168:171], v[84:87], v[52:55]
v_mfma_f32_16x16x32_bf16 v[60:63], a[172:175], v[84:87], v[60:63]
s_waitcnt vmcnt(11)
v_mfma_f32_16x16x32_bf16 v[16:19], a[176:179], v[88:91], v[16:19]
s_add_u32 s77, s93, 25600
buffer_load_dwordx4 v[136:139], v14, s[36:39], s77 offen sc1
v_mfma_f32_16x16x32_bf16 v[24:27], a[180:183], v[88:91], v[24:27]
v_mfma_f32_16x16x32_bf16 v[48:51], a[184:187], v[88:91], v[48:51]
v_mfma_f32_16x16x32_bf16 v[56:59], a[188:191], v[88:91], v[56:59]
s_waitcnt vmcnt(11)
v_mfma_f32_16x16x32_bf16 v[20:23], a[176:179], v[92:95], v[20:23]
buffer_load_dwordx4 v[140:143], v14, s[36:39], s77 offen offset:256 sc1
v_mfma_f32_16x16x32_bf16 v[28:31], a[180:183], v[92:95], v[28:31]
v_mfma_f32_16x16x32_bf16 v[52:55], a[184:187], v[92:95], v[52:55]
v_mfma_f32_16x16x32_bf16 v[60:63], a[188:191], v[92:95], v[60:63]
s_waitcnt vmcnt(11)
v_mfma_f32_16x16x32_bf16 v[16:19], a[192:195], v[96:99], v[16:19]
s_add_u32 s77, s93, 6144
buffer_load_dwordx4 v[160:163], v250, s[36:39], s77 offen sc1
v_mfma_f32_16x16x32_bf16 v[24:27], a[196:199], v[96:99], v[24:27]
v_mfma_f32_16x16x32_bf16 v[48:51], a[200:203], v[96:99], v[48:51]
v_mfma_f32_16x16x32_bf16 v[56:59], a[204:207], v[96:99], v[56:59]
s_waitcnt vmcnt(11)
v_mfma_f32_16x16x32_bf16 v[20:23], a[192:195], v[100:103], v[20:23]
buffer_load_dwordx4 v[164:167], v250, s[36:39], s77 offen offset:256 sc1
v_mfma_f32_16x16x32_bf16 v[28:31], a[196:199], v[100:103], v[28:31]
v_mfma_f32_16x16x32_bf16 v[52:55], a[200:203], v[100:103], v[52:55]
v_mfma_f32_16x16x32_bf16 v[60:63], a[204:207], v[100:103], v[60:63]
s_waitcnt vmcnt(11)
v_mfma_f32_16x16x32_bf16 v[16:19], a[208:211], v[104:107], v[16:19]
s_add_u32 s77, s93, 20480
buffer_load_dwordx4 v[168:171], v250, s[36:39], s77 offen sc1
v_mfma_f32_16x16x32_bf16 v[24:27], a[212:215], v[104:107], v[24:27]
v_mfma_f32_16x16x32_bf16 v[48:51], a[216:219], v[104:107], v[48:51]
v_mfma_f32_16x16x32_bf16 v[56:59], a[220:223], v[104:107], v[56:59]
s_waitcnt vmcnt(11)
v_mfma_f32_16x16x32_bf16 v[20:23], a[208:211], v[108:111], v[20:23]
buffer_load_dwordx4 v[172:175], v250, s[36:39], s77 offen offset:256 sc1
v_mfma_f32_16x16x32_bf16 v[28:31], a[212:215], v[108:111], v[28:31]
v_mfma_f32_16x16x32_bf16 v[52:55], a[216:219], v[108:111], v[52:55]
v_mfma_f32_16x16x32_bf16 v[60:63], a[220:223], v[108:111], v[60:63]
s_waitcnt vmcnt(11)
v_mfma_f32_16x16x32_bf16 v[32:35], a[128:131], v[112:115], v[32:35]
s_add_u32 s94, s80, 4194304
buffer_load_dwordx4 v[240:243], v1, s[36:39], s94 offen sc1
buffer_load_dwordx4 v[244:247], v1, s[36:39], s94 offen offset:1024 sc1
v_mfma_f32_16x16x32_bf16 v[40:43], a[132:135], v[112:115], v[40:43]
v_and_b32_e64 v7, 15, v0
v_mfma_f32_16x16x32_bf16 v[64:67], a[136:139], v[112:115], v[64:67]
v_mfma_f32_16x16x32_bf16 v[72:75], a[140:143], v[112:115], v[72:75]
s_waitcnt vmcnt(12)
v_mfma_f32_16x16x32_bf16 v[36:39], a[128:131], v[116:119], v[36:39]
v_mfma_f32_16x16x32_bf16 v[44:47], a[132:135], v[116:119], v[44:47]
v_and_b32 v14, 16, v0
v_mfma_f32_16x16x32_bf16 v[68:71], a[136:139], v[116:119], v[68:71]
v_mfma_f32_16x16x32_bf16 v[76:79], a[140:143], v[116:119], v[76:79]
s_waitcnt vmcnt(11)
v_mfma_f32_16x16x32_bf16 v[32:35], a[144:147], v[120:123], v[32:35]
v_mfma_f32_16x16x32_bf16 v[40:43], a[148:151], v[120:123], v[40:43]
v_lshlrev_b32 v14, 1, v14
v_mfma_f32_16x16x32_bf16 v[64:67], a[152:155], v[120:123], v[64:67]
v_mfma_f32_16x16x32_bf16 v[72:75], a[156:159], v[120:123], v[72:75]
ds_read2_b32 v[8:9], v249 offset0:0 offset1:16
s_waitcnt vmcnt(10)
v_mfma_f32_16x16x32_bf16 v[36:39], a[144:147], v[124:127], v[36:39]
v_mfma_f32_16x16x32_bf16 v[44:47], a[148:151], v[124:127], v[44:47]
v_lshl_add_u32 v14, v7, 10, v14
v_mfma_f32_16x16x32_bf16 v[68:71], a[152:155], v[124:127], v[68:71]
v_mfma_f32_16x16x32_bf16 v[76:79], a[156:159], v[124:127], v[76:79]
ds_write_b128 v12, v[16:19] offset:0
s_waitcnt vmcnt(9)
v_mfma_f32_16x16x32_bf16 v[32:35], a[160:163], v[128:131], v[32:35]
v_mfma_f32_16x16x32_bf16 v[40:43], a[164:167], v[128:131], v[40:43]
v_lshrrev_b32_e64 v7, 5, v0
v_mfma_f32_16x16x32_bf16 v[64:67], a[168:171], v[128:131], v[64:67]
v_mfma_f32_16x16x32_bf16 v[72:75], a[172:175], v[128:131], v[72:75]
ds_write_b128 v12, v[20:23] offset:1024
s_waitcnt vmcnt(8)
v_mfma_f32_16x16x32_bf16 v[36:39], a[160:163], v[132:135], v[36:39]
v_mfma_f32_16x16x32_bf16 v[44:47], a[164:167], v[132:135], v[44:47]
v_lshl_add_u32 v14, v7, 4, v14
v_mfma_f32_16x16x32_bf16 v[68:71], a[168:171], v[132:135], v[68:71]
v_mfma_f32_16x16x32_bf16 v[76:79], a[172:175], v[132:135], v[76:79]
ds_write_b128 v12, v[24:27] offset:2048
s_waitcnt vmcnt(7)
v_mfma_f32_16x16x32_bf16 v[32:35], a[176:179], v[136:139], v[32:35]
v_mfma_f32_16x16x32_bf16 v[40:43], a[180:183], v[136:139], v[40:43]
v_mfma_f32_16x16x32_bf16 v[64:67], a[184:187], v[136:139], v[64:67]
v_mfma_f32_16x16x32_bf16 v[72:75], a[188:191], v[136:139], v[72:75]
ds_write_b128 v12, v[28:31] offset:3072
s_waitcnt vmcnt(6)
v_mfma_f32_16x16x32_bf16 v[36:39], a[176:179], v[140:143], v[36:39]
v_mfma_f32_16x16x32_bf16 v[44:47], a[180:183], v[140:143], v[44:47]
v_mfma_f32_16x16x32_bf16 v[68:71], a[184:187], v[140:143], v[68:71]
v_mfma_f32_16x16x32_bf16 v[76:79], a[188:191], v[140:143], v[76:79]
ds_write_b128 v13, v[48:51] offset:0
s_waitcnt vmcnt(5)
v_mfma_f32_16x16x32_bf16 v[32:35], a[192:195], v[160:163], v[32:35]
v_mfma_f32_16x16x32_bf16 v[40:43], a[196:199], v[160:163], v[40:43]
v_mfma_f32_16x16x32_bf16 v[64:67], a[200:203], v[160:163], v[64:67]
v_mfma_f32_16x16x32_bf16 v[72:75], a[204:207], v[160:163], v[72:75]
ds_write_b128 v13, v[52:55] offset:1024
s_waitcnt vmcnt(4)
v_mfma_f32_16x16x32_bf16 v[36:39], a[192:195], v[164:167], v[36:39]
v_mfma_f32_16x16x32_bf16 v[44:47], a[196:199], v[164:167], v[44:47]
v_mfma_f32_16x16x32_bf16 v[68:71], a[200:203], v[164:167], v[68:71]
v_mfma_f32_16x16x32_bf16 v[76:79], a[204:207], v[164:167], v[76:79]
ds_write_b128 v13, v[56:59] offset:2048
s_waitcnt vmcnt(3)
v_mfma_f32_16x16x32_bf16 v[32:35], a[208:211], v[168:171], v[32:35]
v_mfma_f32_16x16x32_bf16 v[40:43], a[212:215], v[168:171], v[40:43]
v_mfma_f32_16x16x32_bf16 v[64:67], a[216:219], v[168:171], v[64:67]
v_mfma_f32_16x16x32_bf16 v[72:75], a[220:223], v[168:171], v[72:75]
ds_write_b128 v13, v[60:63] offset:3072
s_waitcnt vmcnt(2)
v_mfma_f32_16x16x32_bf16 v[36:39], a[208:211], v[172:175], v[36:39]
v_mfma_f32_16x16x32_bf16 v[44:47], a[212:215], v[172:175], v[44:47]
v_mfma_f32_16x16x32_bf16 v[68:71], a[216:219], v[172:175], v[68:71]
v_mfma_f32_16x16x32_bf16 v[76:79], a[220:223], v[172:175], v[76:79]
v_add_u32 v11, 67584, v1
s_cmp_ge_u32 s68, 2
s_cbranch_scc1 Lsc_112
Lsc_110:
s_cmp_eq_u32 s68, 1
s_cbranch_scc1 Lsc_111
ds_write_b128 v11, v[32:35] offset:24576
ds_write_b128 v11, v[36:39] offset:25600
ds_write_b128 v11, v[40:43] offset:26624
ds_write_b128 v11, v[44:47] offset:27648
ds_write_b128 v11, v[64:67] offset:49152
ds_write_b128 v11, v[68:71] offset:50176
ds_write_b128 v11, v[72:75] offset:51200
ds_write_b128 v11, v[76:79] offset:52224
v_pk_add_f32 v[144:145], v[16:17], 0
v_pk_add_f32 v[146:147], v[18:19], 0
v_pk_add_f32 v[148:149], v[20:21], 0
v_pk_add_f32 v[150:151], v[22:23], 0
v_pk_add_f32 v[152:153], v[24:25], 0
v_pk_add_f32 v[154:155], v[26:27], 0
v_pk_add_f32 v[156:157], v[28:29], 0
v_pk_add_f32 v[158:159], v[30:31], 0
s_branch Lscd_114
Lsc_111:
ds_write_b128 v11, v[64:67] offset:53248
s_nop 0
ds_write_b128 v11, v[68:71] offset:54272
ds_write_b128 v11, v[72:75] offset:55296
ds_write_b128 v11, v[76:79] offset:56320
v_pk_add_f32 v[144:145], v[32:33], 0
v_pk_add_f32 v[146:147], v[34:35], 0
v_pk_add_f32 v[148:149], v[36:37], 0
v_pk_add_f32 v[150:151], v[38:39], 0
v_pk_add_f32 v[152:153], v[40:41], 0
v_pk_add_f32 v[154:155], v[42:43], 0
v_pk_add_f32 v[156:157], v[44:45], 0
v_pk_add_f32 v[158:159], v[46:47], 0
s_branch Lscd_114
Lsc_112:
s_cmp_eq_u32 s68, 3
s_cbranch_scc1 Lsc_113
ds_write_b128 v11, v[32:35] offset:16384
ds_write_b128 v11, v[36:39] offset:17408
ds_write_b128 v11, v[40:43] offset:18432
ds_write_b128 v11, v[44:47] offset:19456
ds_write_b128 v11, v[64:67] offset:57344
ds_write_b128 v11, v[68:71] offset:58368
ds_write_b128 v11, v[72:75] offset:59392
ds_write_b128 v11, v[76:79] offset:60416
v_pk_add_f32 v[144:145], v[48:49], 0
v_pk_add_f32 v[146:147], v[50:51], 0
v_pk_add_f32 v[148:149], v[52:53], 0
v_pk_add_f32 v[150:151], v[54:55], 0
v_pk_add_f32 v[152:153], v[56:57], 0
v_pk_add_f32 v[154:155], v[58:59], 0
v_pk_add_f32 v[156:157], v[60:61], 0
v_pk_add_f32 v[158:159], v[62:63], 0
s_branch Lscd_114
Lsc_113:
ds_write_b128 v11, v[32:35] offset:20480
ds_write_b128 v11, v[36:39] offset:21504
ds_write_b128 v11, v[40:43] offset:22528
ds_write_b128 v11, v[44:47] offset:23552
v_pk_add_f32 v[144:145], v[64:65], 0
v_pk_add_f32 v[146:147], v[66:67], 0
v_pk_add_f32 v[148:149], v[68:69], 0
v_pk_add_f32 v[150:151], v[70:71], 0
v_pk_add_f32 v[152:153], v[72:73], 0
v_pk_add_f32 v[154:155], v[74:75], 0
v_pk_add_f32 v[156:157], v[76:77], 0
v_pk_add_f32 v[158:159], v[78:79], 0
Lscd_114:
s_waitcnt lgkmcnt(0)
s_barrier
ds_read_b128 v[16:19], v248 offset:0
ds_read_b128 v[20:23], v248 offset:1024
ds_read_b128 v[24:27], v248 offset:2048
ds_read_b128 v[28:31], v248 offset:3072
ds_read_b128 v[32:35], v248 offset:4096
ds_read_b128 v[36:39], v248 offset:5120
ds_read_b128 v[40:43], v248 offset:6144
ds_read_b128 v[44:47], v248 offset:7168
ds_read_b128 v[48:51], v248 offset:8192
ds_read_b128 v[52:55], v248 offset:9216
ds_read_b128 v[56:59], v248 offset:10240
ds_read_b128 v[60:63], v248 offset:11264
s_waitcnt vmcnt(0)
v_permlane16_swap_b32 v240, v242
v_permlane16_swap_b32 v241, v243
v_permlane16_swap_b32 v244, v246
v_permlane16_swap_b32_e64 v245, v247
s_waitcnt lgkmcnt(8)
v_pk_add_f32 v[144:145], v[144:145], v[16:17]
v_pk_add_f32 v[146:147], v[146:147], v[18:19]
v_pk_add_f32 v[148:149], v[148:149], v[20:21]
v_pk_add_f32 v[150:151], v[150:151], v[22:23]
v_pk_add_f32 v[152:153], v[152:153], v[24:25]
v_pk_add_f32 v[154:155], v[154:155], v[26:27]
v_pk_add_f32 v[156:157], v[156:157], v[28:29]
v_pk_add_f32 v[158:159], v[158:159], v[30:31]
s_waitcnt lgkmcnt(4)
v_pk_add_f32 v[144:145], v[144:145], v[32:33]
v_pk_add_f32 v[146:147], v[146:147], v[34:35]
v_pk_add_f32 v[148:149], v[148:149], v[36:37]
v_pk_add_f32 v[150:151], v[150:151], v[38:39]
v_pk_add_f32 v[152:153], v[152:153], v[40:41]
v_pk_add_f32 v[154:155], v[154:155], v[42:43]
v_pk_add_f32 v[156:157], v[156:157], v[44:45]
v_pk_add_f32 v[158:159], v[158:159], v[46:47]
s_waitcnt lgkmcnt(0)
v_pk_add_f32 v[144:145], v[144:145], v[48:49]
v_pk_add_f32 v[146:147], v[146:147], v[50:51]
v_pk_add_f32 v[148:149], v[148:149], v[52:53]
v_pk_add_f32 v[150:151], v[150:151], v[54:55]
v_pk_add_f32 v[152:153], v[152:153], v[56:57]
v_pk_add_f32 v[154:155], v[154:155], v[58:59]
v_pk_add_f32 v[156:157], v[156:157], v[60:61]
v_pk_add_f32 v[158:159], v[158:159], v[62:63]
v_pk_mul_f32 v[144:145], v[144:145], v[8:9] op_sel_hi:[1,0]
v_pk_mul_f32 v[146:147], v[146:147], v[8:9] op_sel_hi:[1,0]
v_pk_mul_f32 v[148:149], v[148:149], v[8:9] op_sel:[0,1] op_sel_hi:[1,1]
v_pk_mul_f32 v[150:151], v[150:151], v[8:9] op_sel:[0,1] op_sel_hi:[1,1]
v_pk_mul_f32 v[152:153], v[152:153], v[8:9] op_sel_hi:[1,0]
v_pk_mul_f32 v[154:155], v[154:155], v[8:9] op_sel_hi:[1,0]
v_pk_mul_f32 v[156:157], v[156:157], v[8:9] op_sel:[0,1] op_sel_hi:[1,1]
v_pk_mul_f32 v[158:159], v[158:159], v[8:9] op_sel:[0,1] op_sel_hi:[1,1]
v_dot2c_f32_bf16 v144, s87, v240
v_dot2c_f32_bf16 v145, s88, v240
v_dot2c_f32_bf16 v146, s87, v241
v_dot2c_f32_bf16 v147, s88, v241
v_dot2c_f32_bf16 v148, s87, v242
v_dot2c_f32_bf16 v149, s88, v242
v_dot2c_f32_bf16 v150, s87, v243
v_dot2c_f32_bf16 v151, s88, v243
v_dot2c_f32_bf16 v152, s87, v244
v_dot2c_f32_bf16 v153, s88, v244
v_dot2c_f32_bf16 v154, s87, v245
v_dot2c_f32_bf16 v155, s88, v245
v_dot2c_f32_bf16 v156, s87, v246
v_dot2c_f32_bf16 v157, s88, v246
v_dot2c_f32_bf16 v158, s87, v247
v_dot2c_f32_bf16 v159, s88, v247
s_add_u32 s77, s79, 16384
v_cvt_pk_bf16_f32 v160, v144, v145
v_cvt_pk_bf16_f32 v161, v146, v147
v_cvt_pk_bf16_f32 v162, v152, v153
v_cvt_pk_bf16_f32 v163, v154, v155
s_nop 0
v_permlane16_swap_b32 v160, v162
v_permlane16_swap_b32_e64 v161, v163
buffer_store_dwordx4 v[160:163], v14, s[64:67], s79 offen
v_cvt_pk_bf16_f32 v164, v148, v149
v_cvt_pk_bf16_f32 v165, v150, v151
v_cvt_pk_bf16_f32 v166, v156, v157
v_cvt_pk_bf16_f32 v167, v158, v159
s_nop 0
v_permlane16_swap_b32 v164, v166
v_permlane16_swap_b32_e64 v165, v167
buffer_store_dwordx4 v[164:167], v14, s[64:67], s77 offen
s_endpgm
.section .rodata,"a"
.p2align 6
.amdhsa_kernel interleave_layers__linear_kernel_hedgehog__glu_gated_bilinear__prompt_kernel
  .amdhsa_next_free_vgpr 512
  .amdhsa_next_free_sgpr 102
  .amdhsa_accum_offset 256
  .amdhsa_group_segment_fixed_size 0
  .amdhsa_kernarg_size 88
  .amdhsa_user_sgpr_count 2
  .amdhsa_user_sgpr_kernarg_segment_ptr 1
  .amdhsa_system_sgpr_workgroup_id_x 1
.end_amdhsa_kernel
```
